```python
import torch

def _softmax(x, axis=-1):
    return torch.softmax(x, dim=axis)

def _gelu(x):
    return torch.nn.functional.gelu(x, approximate='tanh')

def _silu(x):
    return torch.nn.functional.silu(x)

def _sigmoid(x):
    return torch.sigmoid(x)

def _layernorm(x, axis=-1, eps=1e-05):
    m = x.mean(dim=axis, keepdim=True)
    v = x.var(dim=axis, keepdim=True, unbiased=False)
    return (x - m) / torch.sqrt(v + eps)

def _scatter_add(tgt, idx, src, axis=0):
    return tgt.clone().index_add_(axis, idx, src)

def _segment_sum(src, seg, n):
    out = torch.zeros((n,) + src.shape[1:], dtype=src.dtype)
    return out.index_add_(0, seg, src)

def _pad(x, pw):
    flat = tuple((v for pair in reversed(pw) for v in pair))
    return torch.nn.functional.pad(x, flat)
kernel_name = 'parallel_sum__memory_aug_recurrent_mem_tr__moe_arch_mod__prompt'

def setup_inputs():

    _w = lambda a: (lambda t: t.to(torch.bfloat16) if t.is_floating_point() else t)(torch.as_tensor(a))

    def _A_setup():
        B, S, Dm = (1, 2048, 512)
        H, Dh = (32, 128)
        M, seg = (8, 32)
        seg = min(seg, S)
        S = S // seg * seg
        return {'x': _w((lambda *s: torch.randn(*s, dtype=torch.bfloat16) * 0.05)(B, S, Dm)), 'mem0': _w((lambda *s: torch.randn(*s, dtype=torch.bfloat16) * 1.6)(B, M, Dm)), 'Wq': _w((lambda *s: torch.randn(*s, dtype=torch.bfloat16) * 0.8)(Dm, H, Dh) * Dm ** (-0.5)), 'Wk': _w((lambda *s: torch.randn(*s, dtype=torch.bfloat16) * 0.8)(Dm, H, Dh) * Dm ** (-0.5)), 'Wv': _w((lambda *s: torch.randn(*s, dtype=torch.bfloat16) * 1.6)(Dm, H, Dh) * Dm ** (-0.5)), 'Wo': _w((lambda *s: torch.randn(*s, dtype=torch.bfloat16) * 1.6)(H, Dh, Dm) * (H * Dh) ** (-0.5)), 'seg_len': seg}
    _A_in = _A_setup()

    def _B_setup():
        B, S, D, F, C = (1, 2048, 512, 1792, 2)
        return {'x': _w((lambda *s: torch.randn(*s, dtype=torch.bfloat16) * 0.05)(B, S, D)), 'w_r': _w((lambda *s: torch.randn(*s, dtype=torch.bfloat16) * 0.05)(D)), 'w_gate': _w((lambda *s: torch.randn(*s, dtype=torch.bfloat16) * 0.05)(D, F)), 'w_up': _w((lambda *s: torch.randn(*s, dtype=torch.bfloat16) * 0.05)(D, F)), 'w_down': _w((lambda *s: torch.randn(*s, dtype=torch.bfloat16) * 0.05)(F, D))}
    _B_in = _B_setup()
    return {'A_x': _A_in['x'], 'A_mem0': _A_in['mem0'], 'A_Wq': _A_in['Wq'], 'A_Wk': _A_in['Wk'], 'A_Wv': _A_in['Wv'], 'A_Wo': _A_in['Wo'], 'A_seg_len': _A_in['seg_len'], 'B_x': _B_in['x'], 'B_w_r': _B_in['w_r'], 'B_w_gate': _B_in['w_gate'], 'B_w_up': _B_in['w_up'], 'B_w_down': _B_in['w_down']}

def reference(A_x, A_mem0, A_Wq, A_Wk, A_Wv, A_Wo, A_seg_len, B_x, B_w_r, B_w_gate, B_w_up, B_w_down):

    def _A_ref(x, mem0, Wq, Wk, Wv, Wo, seg_len):
        B, S, Dm = x.shape
        H, Dh = (Wq.shape[1], Wq.shape[2])
        M = mem0.shape[1]
        scale = Dh ** (-0.5)
        n_seg = S // seg_len
        L = M + seg_len
        idx = torch.arange(L)
        mask = (idx[:, None] < M) | (idx[:, None] >= idx[None, :])
        mem = mem0
        outs = []
        for s in range(n_seg):
            xs = x[:, s * seg_len:(s + 1) * seg_len, :].clone()
            h = torch.concatenate([mem, xs], axis=1)
            q = torch.einsum('btd,dhe->bhte', h, Wq)
            k = torch.einsum('btd,dhe->bhte', h, Wk)
            v = torch.einsum('btd,dhe->bhte', h, Wv)
            scores = torch.einsum('bhqe,bhke->bhqk', q, k) * scale
            scores = torch.where(mask[None, None], scores, -1000000000.0)
            p = _softmax(scores, axis=-1)
            o = torch.einsum('bhqk,bhke->bhqe', p, v)
            o = torch.einsum('bhte,hed->btd', o, Wo)
            mem = o[:, :M, :].clone()
            outs.append(o[:, M:, :])
        return torch.concatenate(outs, axis=1)

    def _B_ref(x, w_r, w_gate, w_up, w_down):
        B, S, D = x.shape
        C = 2
        r = x @ w_r
        idx = torch.argsort(-r, axis=-1)[:, :C]
        idx_e = (lambda x, n, axis: torch.repeat_interleave(x, n, dim=axis))(idx.reshape(B, C, 1), D, axis=2)
        x_sel = (lambda x, i, axis: torch.take_along_dim(x, i, dim=axis))(x, idx_e, axis=1)
        g = _silu(x_sel @ w_gate)
        u = x_sel @ w_up
        y = g * u @ w_down
        r_sel = _sigmoid((lambda x, i, axis: torch.take_along_dim(x, i, dim=axis))(r, idx, axis=1))
        y = y * r_sel.reshape(B, C, 1)
        b_off = (torch.arange(B) * S).reshape(B, 1)
        flat_idx = (idx + b_off).reshape(B * C)
        zero = (x * 0.0).reshape(B * S, D)
        upd = _scatter_add(zero, flat_idx, y.reshape(B * C, D), axis=0)
        return x + upd.reshape(B, S, D)
    x = A_x
    xn = _layernorm(x, axis=-1)
    return x + _A_ref(xn, A_mem0, A_Wq, A_Wk, A_Wv, A_Wo, A_seg_len) + _B_ref(xn, B_w_r, B_w_gate, B_w_up, B_w_down)
```

```asm
; @launch grid=(256,1,1) block=(256,1,1) lds=163840
.amdgcn_target "amdgcn-amd-amdhsa--gfx950"
.text
.globl parallel_sum__memory_aug_recurrent_mem_tr__moe_arch_mod__prompt_kernel
.type parallel_sum__memory_aug_recurrent_mem_tr__moe_arch_mod__prompt_kernel,@function
.p2align 8
parallel_sum__memory_aug_recurrent_mem_tr__moe_arch_mod__prompt_kernel:
s_cmp_ge_u32 s2, 256
s_cbranch_scc1 L_exit
s_mov_b32 s41, 0x200000
s_and_b32 s3, s2, 7
s_cmp_lg_u32 s3, 0
s_cbranch_scc1 L_bulk
s_load_dwordx2 s[4:5], s[0:1], 112
s_load_dwordx2 s[6:7], s[0:1], 16
s_load_dwordx2 s[8:9], s[0:1], 24
s_load_dwordx2 s[10:11], s[0:1], 32
s_load_dwordx2 s[16:17], s[0:1], 40
s_load_dwordx2 s[18:19], s[0:1], 8
s_load_dwordx2 s[28:29], s[0:1], 104
s_lshr_b32 s12, s2, 3
v_lshrrev_b32 v1, 6, v0
s_nop 0
v_readfirstlane_b32 s14, v1
s_lshl_b32 s15, s14, 13
s_waitcnt lgkmcnt(0)
s_lshl_b32 s13, s12, 8
s_add_u32 s6, s6, s13
s_addc_u32 s7, s7, 0
s_add_u32 s8, s8, s13
s_addc_u32 s9, s9, 0
s_add_u32 s10, s10, s13
s_addc_u32 s11, s11, 0
s_lshl_b32 s13, s12, 17
s_add_u32 s16, s16, s13
s_addc_u32 s17, s17, 0
v_mov_b32 v6, 0x0
v_bfe_i32 v13, v0, 0, 1
v_and_b32 v13, 0x10, v13
v_xor_b32 v6, v6, v13
v_bfe_i32 v13, v0, 1, 1
v_and_b32 v13, 0x20, v13
v_xor_b32 v6, v6, v13
v_bfe_i32 v13, v0, 2, 1
v_and_b32 v13, 0x40, v13
v_xor_b32 v6, v6, v13
v_bfe_i32 v13, v0, 3, 1
v_and_b32 v13, 0x80, v13
v_xor_b32 v6, v6, v13
v_bfe_i32 v13, v0, 4, 1
v_and_b32 v13, 0x420, v13
v_xor_b32 v6, v6, v13
v_bfe_i32 v13, v0, 5, 1
v_and_b32 v13, 0x800, v13
v_xor_b32 v6, v6, v13
v_bfe_i32 v13, v0, 6, 1
v_and_b32 v13, 0x8000, v13
v_xor_b32 v6, v6, v13
v_bfe_i32 v13, v0, 7, 1
v_and_b32 v13, 0x10000, v13
v_xor_b32 v6, v6, v13
v_mov_b32 v7, 0x0
v_bfe_i32 v13, v0, 0, 1
v_and_b32 v13, 0x10, v13
v_xor_b32 v7, v7, v13
v_bfe_i32 v13, v0, 1, 1
v_and_b32 v13, 0x20, v13
v_xor_b32 v7, v7, v13
v_bfe_i32 v13, v0, 2, 1
v_and_b32 v13, 0x40, v13
v_xor_b32 v7, v7, v13
v_bfe_i32 v13, v0, 3, 1
v_and_b32 v13, 0x80, v13
v_xor_b32 v7, v7, v13
v_bfe_i32 v13, v0, 4, 1
v_and_b32 v13, 0x2020, v13
v_xor_b32 v7, v7, v13
v_bfe_i32 v13, v0, 5, 1
v_and_b32 v13, 0x4000, v13
v_xor_b32 v7, v7, v13
v_bfe_i32 v13, v0, 6, 1
v_and_b32 v13, 0x40000, v13
v_xor_b32 v7, v7, v13
v_bfe_i32 v13, v0, 7, 1
v_and_b32 v13, 0x80000, v13
v_xor_b32 v7, v7, v13
v_mov_b32 v8, 0x0
v_bfe_i32 v13, v0, 0, 1
v_and_b32 v13, 0x8, v13
v_xor_b32 v8, v8, v13
v_bfe_i32 v13, v0, 1, 1
v_and_b32 v13, 0x10, v13
v_xor_b32 v8, v8, v13
v_bfe_i32 v13, v0, 2, 1
v_and_b32 v13, 0x1080, v13
v_xor_b32 v8, v8, v13
v_bfe_i32 v13, v0, 3, 1
v_and_b32 v13, 0x120, v13
v_xor_b32 v8, v8, v13
v_bfe_i32 v13, v0, 4, 1
v_and_b32 v13, 0x440, v13
v_xor_b32 v8, v8, v13
v_bfe_i32 v13, v0, 5, 1
v_and_b32 v13, 0x800, v13
v_xor_b32 v8, v8, v13
v_bfe_i32 v13, v0, 6, 1
v_and_b32 v13, 0x40, v13
v_xor_b32 v8, v8, v13
v_bfe_i32 v13, v0, 7, 1
v_and_b32 v13, 0x80, v13
v_xor_b32 v8, v8, v13
s_add_u32 m0, s15, 0x0
v_xor_b32 v10, 0x0, v6
v_add_u32 v10, 0x0, v10
global_load_lds_dwordx4 v10, s[16:17]
s_add_u32 m0, s15, 0x400
v_xor_b32 v10, 0x40, v6
v_add_u32 v10, 0x1000, v10
global_load_lds_dwordx4 v10, s[16:17]
s_add_u32 m0, s15, 0x800
v_xor_b32 v10, 0x0, v6
v_add_u32 v10, 0x2000, v10
global_load_lds_dwordx4 v10, s[16:17]
s_add_u32 m0, s15, 0xc00
v_xor_b32 v10, 0x40, v6
v_add_u32 v10, 0x3000, v10
global_load_lds_dwordx4 v10, s[16:17]
s_add_u32 m0, s15, 0x1000
v_xor_b32 v10, 0x80, v6
v_add_u32 v10, 0x4000, v10
global_load_lds_dwordx4 v10, s[16:17]
s_add_u32 m0, s15, 0x1400
v_xor_b32 v10, 0xc0, v6
v_add_u32 v10, 0x5000, v10
global_load_lds_dwordx4 v10, s[16:17]
s_add_u32 m0, s15, 0x1800
v_xor_b32 v10, 0x80, v6
v_add_u32 v10, 0x6000, v10
global_load_lds_dwordx4 v10, s[16:17]
s_add_u32 m0, s15, 0x1c00
v_xor_b32 v10, 0xc0, v6
v_add_u32 v10, 0x7000, v10
global_load_lds_dwordx4 v10, s[16:17]
s_add_u32 m0, s15, 0x8000
v_xor_b32 v10, 0x0, v6
v_add_u32 v10, 0x100, v10
global_load_lds_dwordx4 v10, s[16:17]
s_add_u32 m0, s15, 0x8400
v_xor_b32 v10, 0x40, v6
v_add_u32 v10, 0x1100, v10
global_load_lds_dwordx4 v10, s[16:17]
s_add_u32 m0, s15, 0x8800
v_xor_b32 v10, 0x0, v6
v_add_u32 v10, 0x2100, v10
global_load_lds_dwordx4 v10, s[16:17]
s_add_u32 m0, s15, 0x8c00
v_xor_b32 v10, 0x40, v6
v_add_u32 v10, 0x3100, v10
global_load_lds_dwordx4 v10, s[16:17]
s_add_u32 m0, s15, 0x9000
v_xor_b32 v10, 0x80, v6
v_add_u32 v10, 0x4100, v10
global_load_lds_dwordx4 v10, s[16:17]
s_add_u32 m0, s15, 0x9400
v_xor_b32 v10, 0xc0, v6
v_add_u32 v10, 0x5100, v10
global_load_lds_dwordx4 v10, s[16:17]
s_add_u32 m0, s15, 0x9800
v_xor_b32 v10, 0x80, v6
v_add_u32 v10, 0x6100, v10
global_load_lds_dwordx4 v10, s[16:17]
s_add_u32 m0, s15, 0x9c00
v_xor_b32 v10, 0xc0, v6
v_add_u32 v10, 0x7100, v10
global_load_lds_dwordx4 v10, s[16:17]
s_add_u32 m0, s15, 0x10000
v_xor_b32 v10, 0x0, v6
v_add_u32 v10, 0x200, v10
global_load_lds_dwordx4 v10, s[16:17]
s_add_u32 m0, s15, 0x10400
v_xor_b32 v10, 0x40, v6
v_add_u32 v10, 0x1200, v10
global_load_lds_dwordx4 v10, s[16:17]
s_add_u32 m0, s15, 0x10800
v_xor_b32 v10, 0x0, v6
v_add_u32 v10, 0x2200, v10
global_load_lds_dwordx4 v10, s[16:17]
s_add_u32 m0, s15, 0x10c00
v_xor_b32 v10, 0x40, v6
v_add_u32 v10, 0x3200, v10
global_load_lds_dwordx4 v10, s[16:17]
s_add_u32 m0, s15, 0x11000
v_xor_b32 v10, 0x80, v6
v_add_u32 v10, 0x4200, v10
global_load_lds_dwordx4 v10, s[16:17]
s_add_u32 m0, s15, 0x11400
v_xor_b32 v10, 0xc0, v6
v_add_u32 v10, 0x5200, v10
global_load_lds_dwordx4 v10, s[16:17]
s_add_u32 m0, s15, 0x11800
v_xor_b32 v10, 0x80, v6
v_add_u32 v10, 0x6200, v10
global_load_lds_dwordx4 v10, s[16:17]
s_add_u32 m0, s15, 0x11c00
v_xor_b32 v10, 0xc0, v6
v_add_u32 v10, 0x7200, v10
global_load_lds_dwordx4 v10, s[16:17]
v_mov_b32 v20, 0x0
v_bfe_i32 v2, v0, 0, 1
v_and_b32 v2, 0x10, v2
v_xor_b32 v20, v20, v2
v_bfe_i32 v2, v0, 1, 1
v_and_b32 v2, 0x20, v2
v_xor_b32 v20, v20, v2
v_bfe_i32 v2, v0, 2, 1
v_and_b32 v2, 0x40, v2
v_xor_b32 v20, v20, v2
v_bfe_i32 v2, v0, 3, 1
v_and_b32 v2, 0x80, v2
v_xor_b32 v20, v20, v2
v_bfe_i32 v2, v0, 4, 1
v_and_b32 v2, 0x100, v2
v_xor_b32 v20, v20, v2
v_bfe_i32 v2, v0, 5, 1
v_and_b32 v2, 0x200, v2
v_xor_b32 v20, v20, v2
v_add_u32 v21, 0x10000, v20
v_add_u32 v22, 0x20000, v20
v_mov_b32 v23, 0x300000
v_bfe_i32 v2, v0, 0, 1
v_and_b32 v2, 0x8, v2
v_xor_b32 v23, v23, v2
v_bfe_i32 v2, v0, 1, 1
v_and_b32 v2, 0x10, v2
v_xor_b32 v23, v23, v2
v_bfe_i32 v2, v0, 2, 1
v_and_b32 v2, 0x20, v2
v_xor_b32 v23, v23, v2
v_bfe_i32 v2, v0, 3, 1
v_and_b32 v2, 0x2000, v2
v_xor_b32 v23, v23, v2
v_bfe_i32 v2, v0, 4, 1
v_and_b32 v2, 0x800, v2
v_xor_b32 v23, v23, v2
v_bfe_i32 v2, v0, 5, 1
v_and_b32 v2, 0x1000, v2
v_xor_b32 v23, v23, v2
v_bfe_i32 v2, v0, 6, 1
v_and_b32 v2, 0x4000, v2
v_xor_b32 v23, v23, v2
v_bfe_i32 v2, v0, 7, 1
v_and_b32 v2, 0x8000, v2
v_xor_b32 v23, v23, v2
s_lshl_b32 s13, s12, 6
v_add_u32 v23, s13, v23
v_mov_b32 v24, 0x300000
v_bfe_i32 v2, v0, 0, 1
v_and_b32 v2, 0x10, v2
v_xor_b32 v24, v24, v2
v_bfe_i32 v2, v0, 1, 1
v_and_b32 v2, 0x20, v2
v_xor_b32 v24, v24, v2
v_bfe_i32 v2, v0, 2, 1
v_and_b32 v2, 0x40, v2
v_xor_b32 v24, v24, v2
v_bfe_i32 v2, v0, 3, 1
v_and_b32 v2, 0x80, v2
v_xor_b32 v24, v24, v2
v_bfe_i32 v2, v0, 4, 1
v_and_b32 v2, 0x100, v2
v_xor_b32 v24, v24, v2
v_bfe_i32 v2, v0, 5, 1
v_and_b32 v2, 0x200, v2
v_xor_b32 v24, v24, v2
v_bfe_i32 v2, v0, 6, 1
v_and_b32 v2, 0x10000, v2
v_xor_b32 v24, v24, v2
v_bfe_i32 v2, v0, 7, 1
v_and_b32 v2, 0x20000, v2
v_xor_b32 v24, v24, v2
s_lshl_b32 s13, s12, 11
v_add_u32 v24, s13, v24
v_mov_b32 v25, 0x380000
v_bfe_i32 v2, v0, 0, 1
v_and_b32 v2, 0x4, v2
v_xor_b32 v25, v25, v2
v_bfe_i32 v2, v0, 1, 1
v_and_b32 v2, 0x8, v2
v_xor_b32 v25, v25, v2
v_bfe_i32 v2, v0, 4, 1
v_and_b32 v2, 0x10, v2
v_xor_b32 v25, v25, v2
v_bfe_i32 v2, v0, 5, 1
v_and_b32 v2, 0x20, v2
v_xor_b32 v25, v25, v2
v_bfe_i32 v2, v0, 6, 1
v_and_b32 v2, 0x800, v2
v_xor_b32 v25, v25, v2
v_bfe_i32 v2, v0, 7, 1
v_and_b32 v2, 0x1000, v2
v_xor_b32 v25, v25, v2
s_lshl_b32 s13, s12, 6
v_add_u32 v25, s13, v25
v_mov_b32 v26, 0x380000
v_bfe_i32 v2, v0, 0, 1
v_and_b32 v2, 0x10, v2
v_xor_b32 v26, v26, v2
v_bfe_i32 v2, v0, 1, 1
v_and_b32 v2, 0x20, v2
v_xor_b32 v26, v26, v2
v_bfe_i32 v2, v0, 2, 1
v_and_b32 v2, 0x40, v2
v_xor_b32 v26, v26, v2
v_bfe_i32 v2, v0, 3, 1
v_and_b32 v2, 0x80, v2
v_xor_b32 v26, v26, v2
v_bfe_i32 v2, v0, 4, 1
v_and_b32 v2, 0x100, v2
v_xor_b32 v26, v26, v2
v_bfe_i32 v2, v0, 5, 1
v_and_b32 v2, 0x200, v2
v_xor_b32 v26, v26, v2
v_bfe_i32 v2, v0, 6, 1
v_and_b32 v2, 0x800, v2
v_xor_b32 v26, v26, v2
v_bfe_i32 v2, v0, 7, 1
v_and_b32 v2, 0x1000, v2
v_xor_b32 v26, v26, v2
v_mov_b32 v32, -1
v_mov_b32 v33, -1
v_mov_b32 v34, -1
v_mov_b32 v35, -1
global_store_dwordx4 v24, v[32:35], s[4:5] offset:0 sc1
global_store_dwordx4 v24, v[32:35], s[4:5] offset:1024 sc1
v_xor_b32 v24, 0x40000, v24
global_store_dwordx4 v24, v[32:35], s[4:5] offset:0 sc1
global_store_dwordx4 v24, v[32:35], s[4:5] offset:1024 sc1
v_bfe_u32 v3, v0, 2, 2
v_lshlrev_b32 v3, 13, v3
v_add_u32 v4, v3, v25
global_store_dword v4, v32, s[4:5] sc1
v_add_u32 v4, 0x80000, v4
global_store_dword v4, v32, s[4:5] sc1
v_add_u32 v4, 0x8000, v4
global_store_dword v4, v32, s[4:5] sc1
v_add_u32 v4, 0x8000, v4
global_store_dword v4, v32, s[4:5] sc1
v_add_u32 v4, 0x8000, v4
global_store_dword v4, v32, s[4:5] sc1
v_add_u32 v4, 0x8000, v4
global_store_dword v4, v32, s[4:5] sc1
v_add_u32 v4, 0x8000, v4
global_store_dword v4, v32, s[4:5] sc1
v_add_u32 v4, 0x8000, v4
global_store_dword v4, v32, s[4:5] sc1
v_add_u32 v4, 0x8000, v4
global_store_dword v4, v32, s[4:5] sc1
v_add_u32 v4, 0x8000, v4
global_store_dword v4, v32, s[4:5] sc1
v_add_u32 v4, 0x8000, v4
global_store_dword v4, v32, s[4:5] sc1
v_add_u32 v4, 0x8000, v4
global_store_dword v4, v32, s[4:5] sc1
v_add_u32 v4, 0x8000, v4
global_store_dword v4, v32, s[4:5] sc1
v_add_u32 v4, 0x8000, v4
global_store_dword v4, v32, s[4:5] sc1
v_add_u32 v4, 0x8000, v4
global_store_dword v4, v32, s[4:5] sc1
v_add_u32 v4, 0x8000, v4
global_store_dword v4, v32, s[4:5] sc1
v_add_u32 v4, 0x8000, v4
global_store_dword v4, v32, s[4:5] sc1
v_add_u32 v4, 0x8000, v4
v_mov_b32 v5, 0x0
v_bfe_i32 v2, v0, 0, 1
v_and_b32 v2, 0x4, v2
v_xor_b32 v5, v5, v2
v_bfe_i32 v2, v0, 1, 1
v_and_b32 v2, 0x8, v2
v_xor_b32 v5, v5, v2
v_bfe_i32 v2, v0, 4, 1
v_and_b32 v2, 0x400, v2
v_xor_b32 v5, v5, v2
v_bfe_i32 v2, v0, 5, 1
v_and_b32 v2, 0x2, v2
v_xor_b32 v5, v5, v2
v_bfe_i32 v2, v0, 6, 1
v_and_b32 v2, 0x100, v2
v_xor_b32 v5, v5, v2
v_bfe_i32 v2, v0, 7, 1
v_and_b32 v2, 0x200, v2
v_xor_b32 v5, v5, v2
s_and_b32 s13, s12, 3
s_lshl_b32 s13, s13, 11
s_lshr_b32 s20, s12, 3
s_lshl_b32 s20, s20, 6
s_add_u32 s13, s13, s20
s_bfe_u32 s20, s12, 0x10002
s_lshl_b32 s20, s20, 4
s_add_u32 s13, s13, s20
v_add_u32 v5, s13, v5
global_load_ushort v18, v5, s[18:19]
global_load_ushort v19, v5, s[18:19] offset:32
v_mov_b32 v1, 0x4444
v_bfe_i32 v2, v0, 1, 1
v_and_b32 v2, 0xaaaa, v2
v_xor_b32 v1, v1, v2
v_mov_b32 v27, 0x0
v_bfe_i32 v2, v0, 0, 1
v_and_b32 v2, 0x4, v2
v_xor_b32 v27, v27, v2
v_bfe_i32 v2, v0, 1, 1
v_and_b32 v2, 0x8, v2
v_xor_b32 v27, v27, v2
v_bfe_i32 v2, v0, 2, 1
v_and_b32 v2, 0x10, v2
v_xor_b32 v27, v27, v2
v_bfe_i32 v2, v0, 3, 1
v_and_b32 v2, 0x20, v2
v_xor_b32 v27, v27, v2
v_bfe_i32 v2, v0, 6, 1
v_and_b32 v2, 0x40, v2
v_xor_b32 v27, v27, v2
v_bfe_i32 v2, v0, 7, 1
v_and_b32 v2, 0x80, v2
v_xor_b32 v27, v27, v2
v_bfe_u32 v3, v0, 4, 2
v_mul_u32_u24 v3, 1216, v3
v_add_u32 v27, v27, v3
v_add_u32 v27, 32768, v27
v_mov_b32 v28, 0x0
v_bfe_i32 v2, v0, 4, 1
v_and_b32 v2, 0x10, v2
v_xor_b32 v28, v28, v2
v_bfe_i32 v2, v0, 5, 1
v_and_b32 v2, 0x20, v2
v_xor_b32 v28, v28, v2
v_bfe_u32 v3, v0, 2, 2
v_mul_u32_u24 v3, 1216, v3
v_and_b32 v4, 1, v0
v_mul_u32_u24 v4, 288, v4
v_add3_u32 v28, v28, v3, v4
v_add_u32 v28, 32768, v28
v_mov_b32 v29, 0x0
v_bfe_i32 v2, v0, 0, 1
v_and_b32 v2, 0x10, v2
v_xor_b32 v29, v29, v2
v_bfe_i32 v2, v0, 1, 1
v_and_b32 v2, 0x4, v2
v_xor_b32 v29, v29, v2
v_bfe_i32 v2, v0, 2, 1
v_and_b32 v2, 0x8, v2
v_xor_b32 v29, v29, v2
v_bfe_i32 v2, v0, 3, 1
v_and_b32 v2, 0x20, v2
v_xor_b32 v29, v29, v2
v_bfe_i32 v2, v0, 6, 1
v_and_b32 v2, 0x40, v2
v_xor_b32 v29, v29, v2
v_bfe_i32 v2, v0, 7, 1
v_and_b32 v2, 0x80, v2
v_xor_b32 v29, v29, v2
v_bfe_u32 v3, v0, 4, 2
v_mul_u32_u24 v3, 640, v3
v_add_u32 v29, v29, v3
v_add_u32 v29, 24576, v29
v_mov_b32 v30, 0x0
v_bfe_i32 v2, v0, 1, 1
v_and_b32 v2, 0x10, v2
v_xor_b32 v30, v30, v2
v_bfe_i32 v2, v0, 4, 1
v_and_b32 v2, 0x20, v2
v_xor_b32 v30, v30, v2
v_bfe_i32 v2, v0, 5, 1
v_and_b32 v2, 0x40, v2
v_xor_b32 v30, v30, v2
v_mov_b32 v3, 0x0
v_bfe_i32 v2, v0, 0, 1
v_and_b32 v2, 0x1, v2
v_xor_b32 v3, v3, v2
v_bfe_i32 v2, v0, 2, 1
v_and_b32 v2, 0x2, v2
v_xor_b32 v3, v3, v2
v_bfe_i32 v2, v0, 3, 1
v_and_b32 v2, 0x4, v2
v_xor_b32 v3, v3, v2
v_mul_u32_u24 v3, 320, v3
v_add_u32 v30, v30, v3
s_add_u32 s20, s4, 0
s_addc_u32 s21, s5, 0
s_add_u32 s22, s4, 65536
s_addc_u32 s23, s5, 0
s_add_u32 s24, s4, 131072
s_addc_u32 s25, s5, 0
s_add_u32 s26, s4, 196608
s_addc_u32 s27, s5, 0
s_mul_i32 s13, s12, 24576
s_add_u32 s13, s13, 0x1000000
s_lshl_b32 s42, s14, 11
s_add_u32 s13, s13, s42
s_add_u32 s30, s4, s13
s_addc_u32 s31, s5, 0
s_add_u32 s32, s30, 8192
s_addc_u32 s33, s31, 0
s_add_u32 s34, s4, 0x400000
s_addc_u32 s35, s5, 0
s_lshl_b32 s13, s12, 8
s_add_u32 s13, s13, 0x3a0000
s_add_u32 s36, s4, s13
s_addc_u32 s37, s5, 0
s_mov_b32 s38, 0x3e0293ee
s_mov_b32 s39, 0x4b800000
s_mov_b32 s40, 0
s_mov_b32 s43, 0x6000
s_mov_b32 s44, 0x000f000f
s_mov_b32 s45, 0x000f000f
s_mov_b32 s59, 0xffc00000
s_lshl_b32 s13, s14, 11
v_add_u32 v3, s13, v20
v_add_u32 v4, s13, v21
v_add_u32 v5, s13, v22
s_waitcnt vmcnt(16)
s_barrier
s_add_u32 m0, s15, 0x18000
v_xor_b32 v10, 0x0, v6
v_add_u32 v10, 0x300, v10
global_load_lds_dwordx4 v10, s[16:17]
s_add_u32 m0, s15, 0x18400
v_xor_b32 v10, 0x40, v6
v_add_u32 v10, 0x1300, v10
global_load_lds_dwordx4 v10, s[16:17]
s_add_u32 m0, s15, 0x18800
v_xor_b32 v10, 0x0, v6
v_add_u32 v10, 0x2300, v10
global_load_lds_dwordx4 v10, s[16:17]
s_add_u32 m0, s15, 0x18c00
v_xor_b32 v10, 0x40, v6
v_add_u32 v10, 0x3300, v10
global_load_lds_dwordx4 v10, s[16:17]
s_add_u32 m0, s15, 0x19000
v_xor_b32 v10, 0x80, v6
v_add_u32 v10, 0x4300, v10
global_load_lds_dwordx4 v10, s[16:17]
s_add_u32 m0, s15, 0x19400
v_xor_b32 v10, 0xc0, v6
v_add_u32 v10, 0x5300, v10
global_load_lds_dwordx4 v10, s[16:17]
s_add_u32 m0, s15, 0x19800
v_xor_b32 v10, 0x80, v6
v_add_u32 v10, 0x6300, v10
global_load_lds_dwordx4 v10, s[16:17]
s_add_u32 m0, s15, 0x19c00
v_xor_b32 v10, 0xc0, v6
v_add_u32 v10, 0x7300, v10
global_load_lds_dwordx4 v10, s[16:17]
v_add_u32 v11, 0x0, v8
v_xor_b32 v12, 32, v11
ds_read_b64_tr_b16 a[176:177], v11 offset:0
ds_read_b64_tr_b16 a[178:179], v11 offset:512
ds_read_b64_tr_b16 a[180:181], v11 offset:8192
ds_read_b64_tr_b16 a[182:183], v11 offset:8704
ds_read_b64_tr_b16 a[184:185], v11 offset:16384
ds_read_b64_tr_b16 a[186:187], v11 offset:16896
ds_read_b64_tr_b16 a[188:189], v11 offset:24576
ds_read_b64_tr_b16 a[190:191], v11 offset:25088
ds_read_b64_tr_b16 v[32:33], v12 offset:0
ds_read_b64_tr_b16 v[34:35], v12 offset:512
ds_read_b64_tr_b16 v[36:37], v12 offset:8192
ds_read_b64_tr_b16 v[38:39], v12 offset:8704
ds_read_b64_tr_b16 v[40:41], v12 offset:16384
ds_read_b64_tr_b16 v[42:43], v12 offset:16896
ds_read_b64_tr_b16 v[44:45], v12 offset:24576
ds_read_b64_tr_b16 v[46:47], v12 offset:25088
s_waitcnt lgkmcnt(0)
s_waitcnt lgkmcnt(0)
s_waitcnt vmcnt(16)
s_barrier
s_add_u32 m0, s15, 0x0
v_xor_b32 v10, 0x0, v7
v_add_u32 v10, 0x0, v10
global_load_lds_dwordx4 v10, s[10:11]
s_add_u32 m0, s15, 0x400
v_xor_b32 v10, 0x40, v7
v_add_u32 v10, 0x8000, v10
global_load_lds_dwordx4 v10, s[10:11]
s_add_u32 m0, s15, 0x800
v_xor_b32 v10, 0x0, v7
v_add_u32 v10, 0x10000, v10
global_load_lds_dwordx4 v10, s[10:11]
s_add_u32 m0, s15, 0xc00
v_xor_b32 v10, 0x40, v7
v_add_u32 v10, 0x18000, v10
global_load_lds_dwordx4 v10, s[10:11]
s_add_u32 m0, s15, 0x1000
v_xor_b32 v10, 0x80, v7
v_add_u32 v10, 0x20000, v10
global_load_lds_dwordx4 v10, s[10:11]
s_add_u32 m0, s15, 0x1400
v_xor_b32 v10, 0xc0, v7
v_add_u32 v10, 0x28000, v10
global_load_lds_dwordx4 v10, s[10:11]
s_add_u32 m0, s15, 0x1800
v_xor_b32 v10, 0x80, v7
v_add_u32 v10, 0x30000, v10
global_load_lds_dwordx4 v10, s[10:11]
s_add_u32 m0, s15, 0x1c00
v_xor_b32 v10, 0xc0, v7
v_add_u32 v10, 0x38000, v10
global_load_lds_dwordx4 v10, s[10:11]
v_add_u32 v11, 0x0, v8
v_xor_b32 v12, 32, v11
ds_read_b64_tr_b16 a[192:193], v11 offset:32768
ds_read_b64_tr_b16 a[194:195], v11 offset:33280
ds_read_b64_tr_b16 a[196:197], v11 offset:40960
ds_read_b64_tr_b16 a[198:199], v11 offset:41472
ds_read_b64_tr_b16 a[200:201], v11 offset:49152
ds_read_b64_tr_b16 a[202:203], v11 offset:49664
ds_read_b64_tr_b16 a[204:205], v11 offset:57344
ds_read_b64_tr_b16 a[206:207], v11 offset:57856
ds_read_b64_tr_b16 a[208:209], v12 offset:32768
ds_read_b64_tr_b16 a[210:211], v12 offset:33280
ds_read_b64_tr_b16 a[212:213], v12 offset:40960
ds_read_b64_tr_b16 a[214:215], v12 offset:41472
ds_read_b64_tr_b16 v[224:225], v12 offset:49152
ds_read_b64_tr_b16 v[226:227], v12 offset:49664
ds_read_b64_tr_b16 v[228:229], v12 offset:57344
ds_read_b64_tr_b16 v[230:231], v12 offset:57856
s_waitcnt lgkmcnt(0)
ds_write_b128 v5, v[224:227] offset:0
ds_write_b128 v5, v[228:231] offset:1024
s_waitcnt lgkmcnt(0)
s_waitcnt vmcnt(16)
s_barrier
s_add_u32 m0, s15, 0x8000
v_xor_b32 v10, 0x0, v7
v_add_u32 v10, 0x100000, v10
global_load_lds_dwordx4 v10, s[10:11]
s_add_u32 m0, s15, 0x8400
v_xor_b32 v10, 0x40, v7
v_add_u32 v10, 0x108000, v10
global_load_lds_dwordx4 v10, s[10:11]
s_add_u32 m0, s15, 0x8800
v_xor_b32 v10, 0x0, v7
v_add_u32 v10, 0x110000, v10
global_load_lds_dwordx4 v10, s[10:11]
s_add_u32 m0, s15, 0x8c00
v_xor_b32 v10, 0x40, v7
v_add_u32 v10, 0x118000, v10
global_load_lds_dwordx4 v10, s[10:11]
s_add_u32 m0, s15, 0x9000
v_xor_b32 v10, 0x80, v7
v_add_u32 v10, 0x120000, v10
global_load_lds_dwordx4 v10, s[10:11]
s_add_u32 m0, s15, 0x9400
v_xor_b32 v10, 0xc0, v7
v_add_u32 v10, 0x128000, v10
global_load_lds_dwordx4 v10, s[10:11]
s_add_u32 m0, s15, 0x9800
v_xor_b32 v10, 0x80, v7
v_add_u32 v10, 0x130000, v10
global_load_lds_dwordx4 v10, s[10:11]
s_add_u32 m0, s15, 0x9c00
v_xor_b32 v10, 0xc0, v7
v_add_u32 v10, 0x138000, v10
global_load_lds_dwordx4 v10, s[10:11]
v_add_u32 v11, 0x10000, v8
v_xor_b32 v12, 32, v11
ds_read_b64_tr_b16 v[200:201], v11 offset:0
ds_read_b64_tr_b16 v[202:203], v11 offset:512
ds_read_b64_tr_b16 v[204:205], v11 offset:8192
ds_read_b64_tr_b16 v[206:207], v11 offset:8704
ds_read_b64_tr_b16 a[216:217], v11 offset:16384
ds_read_b64_tr_b16 a[218:219], v11 offset:16896
ds_read_b64_tr_b16 a[220:221], v11 offset:24576
ds_read_b64_tr_b16 a[222:223], v11 offset:25088
ds_read_b64_tr_b16 a[224:225], v12 offset:0
ds_read_b64_tr_b16 a[226:227], v12 offset:512
ds_read_b64_tr_b16 a[228:229], v12 offset:8192
ds_read_b64_tr_b16 a[230:231], v12 offset:8704
ds_read_b64_tr_b16 a[232:233], v12 offset:16384
ds_read_b64_tr_b16 a[234:235], v12 offset:16896
ds_read_b64_tr_b16 a[236:237], v12 offset:24576
ds_read_b64_tr_b16 a[238:239], v12 offset:25088
s_waitcnt lgkmcnt(0)
ds_write_b128 v5, v[200:203] offset:8192
ds_write_b128 v5, v[204:207] offset:9216
s_waitcnt lgkmcnt(0)
s_waitcnt vmcnt(16)
s_barrier
s_add_u32 m0, s15, 0x10000
v_xor_b32 v10, 0x0, v7
v_add_u32 v10, 0x200000, v10
global_load_lds_dwordx4 v10, s[10:11]
s_add_u32 m0, s15, 0x10400
v_xor_b32 v10, 0x40, v7
v_add_u32 v10, 0x208000, v10
global_load_lds_dwordx4 v10, s[10:11]
s_add_u32 m0, s15, 0x10800
v_xor_b32 v10, 0x0, v7
v_add_u32 v10, 0x210000, v10
global_load_lds_dwordx4 v10, s[10:11]
s_add_u32 m0, s15, 0x10c00
v_xor_b32 v10, 0x40, v7
v_add_u32 v10, 0x218000, v10
global_load_lds_dwordx4 v10, s[10:11]
s_add_u32 m0, s15, 0x11000
v_xor_b32 v10, 0x80, v7
v_add_u32 v10, 0x220000, v10
global_load_lds_dwordx4 v10, s[10:11]
s_add_u32 m0, s15, 0x11400
v_xor_b32 v10, 0xc0, v7
v_add_u32 v10, 0x228000, v10
global_load_lds_dwordx4 v10, s[10:11]
s_add_u32 m0, s15, 0x11800
v_xor_b32 v10, 0x80, v7
v_add_u32 v10, 0x230000, v10
global_load_lds_dwordx4 v10, s[10:11]
s_add_u32 m0, s15, 0x11c00
v_xor_b32 v10, 0xc0, v7
v_add_u32 v10, 0x238000, v10
global_load_lds_dwordx4 v10, s[10:11]
v_add_u32 v11, 0x10000, v8
v_xor_b32 v12, 32, v11
ds_read_b64_tr_b16 v[200:201], v11 offset:32768
ds_read_b64_tr_b16 v[202:203], v11 offset:33280
ds_read_b64_tr_b16 v[204:205], v11 offset:40960
ds_read_b64_tr_b16 v[206:207], v11 offset:41472
ds_read_b64_tr_b16 v[208:209], v11 offset:49152
ds_read_b64_tr_b16 v[210:211], v11 offset:49664
ds_read_b64_tr_b16 v[212:213], v11 offset:57344
ds_read_b64_tr_b16 v[214:215], v11 offset:57856
ds_read_b64_tr_b16 a[240:241], v12 offset:32768
ds_read_b64_tr_b16 a[242:243], v12 offset:33280
ds_read_b64_tr_b16 a[244:245], v12 offset:40960
ds_read_b64_tr_b16 a[246:247], v12 offset:41472
ds_read_b64_tr_b16 a[248:249], v12 offset:49152
ds_read_b64_tr_b16 a[250:251], v12 offset:49664
ds_read_b64_tr_b16 a[252:253], v12 offset:57344
ds_read_b64_tr_b16 a[254:255], v12 offset:57856
s_waitcnt lgkmcnt(0)
ds_write_b128 v5, v[200:203] offset:16384
ds_write_b128 v5, v[204:207] offset:17408
ds_write_b128 v5, v[208:211] offset:24576
ds_write_b128 v5, v[212:215] offset:25600
s_waitcnt lgkmcnt(0)
s_cmp_lg_u32 s14, 0
s_cbranch_scc1 L_rec_noarr0
s_mov_b64 exec, 1
v_mov_b32 v14, 0
s_getreg_b32 s13, hwreg(HW_REG_XCC_ID, 0, 4)
s_lshl_b32 s13, 1, s13
v_mov_b32 v15, s13
global_atomic_or v14, v15, s[28:29] offset:4
s_mov_b64 exec, -1
L_rec_noarr0:
s_waitcnt vmcnt(16)
s_barrier
s_add_u32 m0, s15, 0x18000
v_xor_b32 v10, 0x0, v7
v_add_u32 v10, 0x300000, v10
global_load_lds_dwordx4 v10, s[10:11]
s_add_u32 m0, s15, 0x18400
v_xor_b32 v10, 0x40, v7
v_add_u32 v10, 0x308000, v10
global_load_lds_dwordx4 v10, s[10:11]
s_add_u32 m0, s15, 0x18800
v_xor_b32 v10, 0x0, v7
v_add_u32 v10, 0x310000, v10
global_load_lds_dwordx4 v10, s[10:11]
s_add_u32 m0, s15, 0x18c00
v_xor_b32 v10, 0x40, v7
v_add_u32 v10, 0x318000, v10
global_load_lds_dwordx4 v10, s[10:11]
s_add_u32 m0, s15, 0x19000
v_xor_b32 v10, 0x80, v7
v_add_u32 v10, 0x320000, v10
global_load_lds_dwordx4 v10, s[10:11]
s_add_u32 m0, s15, 0x19400
v_xor_b32 v10, 0xc0, v7
v_add_u32 v10, 0x328000, v10
global_load_lds_dwordx4 v10, s[10:11]
s_add_u32 m0, s15, 0x19800
v_xor_b32 v10, 0x80, v7
v_add_u32 v10, 0x330000, v10
global_load_lds_dwordx4 v10, s[10:11]
s_add_u32 m0, s15, 0x19c00
v_xor_b32 v10, 0xc0, v7
v_add_u32 v10, 0x338000, v10
global_load_lds_dwordx4 v10, s[10:11]
v_add_u32 v11, 0x0, v8
v_xor_b32 v12, 32, v11
s_cmp_eq_u32 s15, 8192
s_cbranch_scc1 L_rec_c4w1
s_cmp_eq_u32 s15, 16384
s_cbranch_scc1 L_rec_c4w2
s_cmp_eq_u32 s15, 24576
s_cbranch_scc1 L_rec_c4w3
L_rec_c4w0:
ds_read_b64_tr_b16 a[48:49], v11 offset:0
ds_read_b64_tr_b16 a[50:51], v11 offset:512
ds_read_b64_tr_b16 a[52:53], v11 offset:8192
ds_read_b64_tr_b16 a[54:55], v11 offset:8704
ds_read_b64_tr_b16 a[56:57], v11 offset:16384
ds_read_b64_tr_b16 a[58:59], v11 offset:16896
ds_read_b64_tr_b16 a[60:61], v11 offset:24576
ds_read_b64_tr_b16 a[62:63], v11 offset:25088
ds_read_b64_tr_b16 a[112:113], v12 offset:0
ds_read_b64_tr_b16 a[114:115], v12 offset:512
ds_read_b64_tr_b16 a[116:117], v12 offset:8192
ds_read_b64_tr_b16 a[118:119], v12 offset:8704
ds_read_b64_tr_b16 a[120:121], v12 offset:16384
ds_read_b64_tr_b16 a[122:123], v12 offset:16896
ds_read_b64_tr_b16 a[124:125], v12 offset:24576
ds_read_b64_tr_b16 a[126:127], v12 offset:25088
s_waitcnt lgkmcnt(0)
s_branch L_rec_c4e
L_rec_c4w1:
ds_read_b64_tr_b16 a[96:97], v11 offset:0
ds_read_b64_tr_b16 a[98:99], v11 offset:512
ds_read_b64_tr_b16 a[100:101], v11 offset:8192
ds_read_b64_tr_b16 a[102:103], v11 offset:8704
ds_read_b64_tr_b16 a[104:105], v11 offset:16384
ds_read_b64_tr_b16 a[106:107], v11 offset:16896
ds_read_b64_tr_b16 a[108:109], v11 offset:24576
ds_read_b64_tr_b16 a[110:111], v11 offset:25088
ds_read_b64_tr_b16 a[160:161], v12 offset:0
ds_read_b64_tr_b16 a[162:163], v12 offset:512
ds_read_b64_tr_b16 a[164:165], v12 offset:8192
ds_read_b64_tr_b16 a[166:167], v12 offset:8704
ds_read_b64_tr_b16 a[168:169], v12 offset:16384
ds_read_b64_tr_b16 a[170:171], v12 offset:16896
ds_read_b64_tr_b16 a[172:173], v12 offset:24576
ds_read_b64_tr_b16 a[174:175], v12 offset:25088
s_waitcnt lgkmcnt(0)
s_branch L_rec_c4e
L_rec_c4w2:
ds_read_b64_tr_b16 a[80:81], v11 offset:0
ds_read_b64_tr_b16 a[82:83], v11 offset:512
ds_read_b64_tr_b16 a[84:85], v11 offset:8192
ds_read_b64_tr_b16 a[86:87], v11 offset:8704
ds_read_b64_tr_b16 a[88:89], v11 offset:16384
ds_read_b64_tr_b16 a[90:91], v11 offset:16896
ds_read_b64_tr_b16 a[92:93], v11 offset:24576
ds_read_b64_tr_b16 a[94:95], v11 offset:25088
ds_read_b64_tr_b16 a[144:145], v12 offset:0
ds_read_b64_tr_b16 a[146:147], v12 offset:512
ds_read_b64_tr_b16 a[148:149], v12 offset:8192
ds_read_b64_tr_b16 a[150:151], v12 offset:8704
ds_read_b64_tr_b16 a[152:153], v12 offset:16384
ds_read_b64_tr_b16 a[154:155], v12 offset:16896
ds_read_b64_tr_b16 a[156:157], v12 offset:24576
ds_read_b64_tr_b16 a[158:159], v12 offset:25088
s_waitcnt lgkmcnt(0)
s_branch L_rec_c4e
L_rec_c4w3:
ds_read_b64_tr_b16 a[64:65], v11 offset:0
ds_read_b64_tr_b16 a[66:67], v11 offset:512
ds_read_b64_tr_b16 a[68:69], v11 offset:8192
ds_read_b64_tr_b16 a[70:71], v11 offset:8704
ds_read_b64_tr_b16 a[72:73], v11 offset:16384
ds_read_b64_tr_b16 a[74:75], v11 offset:16896
ds_read_b64_tr_b16 a[76:77], v11 offset:24576
ds_read_b64_tr_b16 a[78:79], v11 offset:25088
ds_read_b64_tr_b16 a[128:129], v12 offset:0
ds_read_b64_tr_b16 a[130:131], v12 offset:512
ds_read_b64_tr_b16 a[132:133], v12 offset:8192
ds_read_b64_tr_b16 a[134:135], v12 offset:8704
ds_read_b64_tr_b16 a[136:137], v12 offset:16384
ds_read_b64_tr_b16 a[138:139], v12 offset:16896
ds_read_b64_tr_b16 a[140:141], v12 offset:24576
ds_read_b64_tr_b16 a[142:143], v12 offset:25088
s_waitcnt lgkmcnt(0)
L_rec_c4e:
v_lshlrev_b32 v19, 16, v19
v_or_b32 v18, v18, v19
global_store_dword v25, v18, s[4:5] sc1
s_waitcnt vmcnt(16)
s_barrier
s_add_u32 m0, s15, 0x0
v_xor_b32 v10, 0x0, v7
v_add_u32 v10, 0x0, v10
global_load_lds_dwordx4 v10, s[6:7]
s_add_u32 m0, s15, 0x400
v_xor_b32 v10, 0x40, v7
v_add_u32 v10, 0x8000, v10
global_load_lds_dwordx4 v10, s[6:7]
s_add_u32 m0, s15, 0x800
v_xor_b32 v10, 0x0, v7
v_add_u32 v10, 0x10000, v10
global_load_lds_dwordx4 v10, s[6:7]
s_add_u32 m0, s15, 0xc00
v_xor_b32 v10, 0x40, v7
v_add_u32 v10, 0x18000, v10
global_load_lds_dwordx4 v10, s[6:7]
s_add_u32 m0, s15, 0x1000
v_xor_b32 v10, 0x80, v7
v_add_u32 v10, 0x20000, v10
global_load_lds_dwordx4 v10, s[6:7]
s_add_u32 m0, s15, 0x1400
v_xor_b32 v10, 0xc0, v7
v_add_u32 v10, 0x28000, v10
global_load_lds_dwordx4 v10, s[6:7]
s_add_u32 m0, s15, 0x1800
v_xor_b32 v10, 0x80, v7
v_add_u32 v10, 0x30000, v10
global_load_lds_dwordx4 v10, s[6:7]
s_add_u32 m0, s15, 0x1c00
v_xor_b32 v10, 0xc0, v7
v_add_u32 v10, 0x38000, v10
global_load_lds_dwordx4 v10, s[6:7]
v_add_u32 v11, 0x0, v8
v_xor_b32 v12, 32, v11
s_cmp_eq_u32 s15, 8192
s_cbranch_scc1 L_rec_c5w1
s_cmp_eq_u32 s15, 16384
s_cbranch_scc1 L_rec_c5w2
s_cmp_eq_u32 s15, 24576
s_cbranch_scc1 L_rec_c5w3
L_rec_c5w0:
ds_read_b64_tr_b16 a[64:65], v11 offset:32768
ds_read_b64_tr_b16 a[66:67], v11 offset:33280
ds_read_b64_tr_b16 a[68:69], v11 offset:40960
ds_read_b64_tr_b16 a[70:71], v11 offset:41472
ds_read_b64_tr_b16 a[72:73], v11 offset:49152
ds_read_b64_tr_b16 a[74:75], v11 offset:49664
ds_read_b64_tr_b16 a[76:77], v11 offset:57344
ds_read_b64_tr_b16 a[78:79], v11 offset:57856
ds_read_b64_tr_b16 a[128:129], v12 offset:32768
ds_read_b64_tr_b16 a[130:131], v12 offset:33280
ds_read_b64_tr_b16 a[132:133], v12 offset:40960
ds_read_b64_tr_b16 a[134:135], v12 offset:41472
ds_read_b64_tr_b16 a[136:137], v12 offset:49152
ds_read_b64_tr_b16 a[138:139], v12 offset:49664
ds_read_b64_tr_b16 a[140:141], v12 offset:57344
ds_read_b64_tr_b16 a[142:143], v12 offset:57856
s_waitcnt lgkmcnt(0)
s_branch L_rec_c5e
L_rec_c5w1:
ds_read_b64_tr_b16 a[48:49], v11 offset:32768
ds_read_b64_tr_b16 a[50:51], v11 offset:33280
ds_read_b64_tr_b16 a[52:53], v11 offset:40960
ds_read_b64_tr_b16 a[54:55], v11 offset:41472
ds_read_b64_tr_b16 a[56:57], v11 offset:49152
ds_read_b64_tr_b16 a[58:59], v11 offset:49664
ds_read_b64_tr_b16 a[60:61], v11 offset:57344
ds_read_b64_tr_b16 a[62:63], v11 offset:57856
ds_read_b64_tr_b16 a[112:113], v12 offset:32768
ds_read_b64_tr_b16 a[114:115], v12 offset:33280
ds_read_b64_tr_b16 a[116:117], v12 offset:40960
ds_read_b64_tr_b16 a[118:119], v12 offset:41472
ds_read_b64_tr_b16 a[120:121], v12 offset:49152
ds_read_b64_tr_b16 a[122:123], v12 offset:49664
ds_read_b64_tr_b16 a[124:125], v12 offset:57344
ds_read_b64_tr_b16 a[126:127], v12 offset:57856
s_waitcnt lgkmcnt(0)
s_branch L_rec_c5e
L_rec_c5w2:
ds_read_b64_tr_b16 a[96:97], v11 offset:32768
ds_read_b64_tr_b16 a[98:99], v11 offset:33280
ds_read_b64_tr_b16 a[100:101], v11 offset:40960
ds_read_b64_tr_b16 a[102:103], v11 offset:41472
ds_read_b64_tr_b16 a[104:105], v11 offset:49152
ds_read_b64_tr_b16 a[106:107], v11 offset:49664
ds_read_b64_tr_b16 a[108:109], v11 offset:57344
ds_read_b64_tr_b16 a[110:111], v11 offset:57856
ds_read_b64_tr_b16 a[160:161], v12 offset:32768
ds_read_b64_tr_b16 a[162:163], v12 offset:33280
ds_read_b64_tr_b16 a[164:165], v12 offset:40960
ds_read_b64_tr_b16 a[166:167], v12 offset:41472
ds_read_b64_tr_b16 a[168:169], v12 offset:49152
ds_read_b64_tr_b16 a[170:171], v12 offset:49664
ds_read_b64_tr_b16 a[172:173], v12 offset:57344
ds_read_b64_tr_b16 a[174:175], v12 offset:57856
s_waitcnt lgkmcnt(0)
s_branch L_rec_c5e
L_rec_c5w3:
ds_read_b64_tr_b16 a[80:81], v11 offset:32768
ds_read_b64_tr_b16 a[82:83], v11 offset:33280
ds_read_b64_tr_b16 a[84:85], v11 offset:40960
ds_read_b64_tr_b16 a[86:87], v11 offset:41472
ds_read_b64_tr_b16 a[88:89], v11 offset:49152
ds_read_b64_tr_b16 a[90:91], v11 offset:49664
ds_read_b64_tr_b16 a[92:93], v11 offset:57344
ds_read_b64_tr_b16 a[94:95], v11 offset:57856
ds_read_b64_tr_b16 a[144:145], v12 offset:32768
ds_read_b64_tr_b16 a[146:147], v12 offset:33280
ds_read_b64_tr_b16 a[148:149], v12 offset:40960
ds_read_b64_tr_b16 a[150:151], v12 offset:41472
ds_read_b64_tr_b16 a[152:153], v12 offset:49152
ds_read_b64_tr_b16 a[154:155], v12 offset:49664
ds_read_b64_tr_b16 a[156:157], v12 offset:57344
ds_read_b64_tr_b16 a[158:159], v12 offset:57856
s_waitcnt lgkmcnt(0)
L_rec_c5e:
s_waitcnt vmcnt(16)
s_barrier
s_add_u32 m0, s15, 0x8000
v_xor_b32 v10, 0x0, v7
v_add_u32 v10, 0x100000, v10
global_load_lds_dwordx4 v10, s[6:7]
s_add_u32 m0, s15, 0x8400
v_xor_b32 v10, 0x40, v7
v_add_u32 v10, 0x108000, v10
global_load_lds_dwordx4 v10, s[6:7]
s_add_u32 m0, s15, 0x8800
v_xor_b32 v10, 0x0, v7
v_add_u32 v10, 0x110000, v10
global_load_lds_dwordx4 v10, s[6:7]
s_add_u32 m0, s15, 0x8c00
v_xor_b32 v10, 0x40, v7
v_add_u32 v10, 0x118000, v10
global_load_lds_dwordx4 v10, s[6:7]
s_add_u32 m0, s15, 0x9000
v_xor_b32 v10, 0x80, v7
v_add_u32 v10, 0x120000, v10
global_load_lds_dwordx4 v10, s[6:7]
s_add_u32 m0, s15, 0x9400
v_xor_b32 v10, 0xc0, v7
v_add_u32 v10, 0x128000, v10
global_load_lds_dwordx4 v10, s[6:7]
s_add_u32 m0, s15, 0x9800
v_xor_b32 v10, 0x80, v7
v_add_u32 v10, 0x130000, v10
global_load_lds_dwordx4 v10, s[6:7]
s_add_u32 m0, s15, 0x9c00
v_xor_b32 v10, 0xc0, v7
v_add_u32 v10, 0x138000, v10
global_load_lds_dwordx4 v10, s[6:7]
v_add_u32 v11, 0x10000, v8
v_xor_b32 v12, 32, v11
s_cmp_eq_u32 s15, 8192
s_cbranch_scc1 L_rec_c6w1
s_cmp_eq_u32 s15, 16384
s_cbranch_scc1 L_rec_c6w2
s_cmp_eq_u32 s15, 24576
s_cbranch_scc1 L_rec_c6w3
L_rec_c6w0:
ds_read_b64_tr_b16 a[80:81], v11 offset:0
ds_read_b64_tr_b16 a[82:83], v11 offset:512
ds_read_b64_tr_b16 a[84:85], v11 offset:8192
ds_read_b64_tr_b16 a[86:87], v11 offset:8704
ds_read_b64_tr_b16 a[88:89], v11 offset:16384
ds_read_b64_tr_b16 a[90:91], v11 offset:16896
ds_read_b64_tr_b16 a[92:93], v11 offset:24576
ds_read_b64_tr_b16 a[94:95], v11 offset:25088
ds_read_b64_tr_b16 a[144:145], v12 offset:0
ds_read_b64_tr_b16 a[146:147], v12 offset:512
ds_read_b64_tr_b16 a[148:149], v12 offset:8192
ds_read_b64_tr_b16 a[150:151], v12 offset:8704
ds_read_b64_tr_b16 a[152:153], v12 offset:16384
ds_read_b64_tr_b16 a[154:155], v12 offset:16896
ds_read_b64_tr_b16 a[156:157], v12 offset:24576
ds_read_b64_tr_b16 a[158:159], v12 offset:25088
s_waitcnt lgkmcnt(0)
s_branch L_rec_c6e
L_rec_c6w1:
ds_read_b64_tr_b16 a[64:65], v11 offset:0
ds_read_b64_tr_b16 a[66:67], v11 offset:512
ds_read_b64_tr_b16 a[68:69], v11 offset:8192
ds_read_b64_tr_b16 a[70:71], v11 offset:8704
ds_read_b64_tr_b16 a[72:73], v11 offset:16384
ds_read_b64_tr_b16 a[74:75], v11 offset:16896
ds_read_b64_tr_b16 a[76:77], v11 offset:24576
ds_read_b64_tr_b16 a[78:79], v11 offset:25088
ds_read_b64_tr_b16 a[128:129], v12 offset:0
ds_read_b64_tr_b16 a[130:131], v12 offset:512
ds_read_b64_tr_b16 a[132:133], v12 offset:8192
ds_read_b64_tr_b16 a[134:135], v12 offset:8704
ds_read_b64_tr_b16 a[136:137], v12 offset:16384
ds_read_b64_tr_b16 a[138:139], v12 offset:16896
ds_read_b64_tr_b16 a[140:141], v12 offset:24576
ds_read_b64_tr_b16 a[142:143], v12 offset:25088
s_waitcnt lgkmcnt(0)
s_branch L_rec_c6e
L_rec_c6w2:
ds_read_b64_tr_b16 a[48:49], v11 offset:0
ds_read_b64_tr_b16 a[50:51], v11 offset:512
ds_read_b64_tr_b16 a[52:53], v11 offset:8192
ds_read_b64_tr_b16 a[54:55], v11 offset:8704
ds_read_b64_tr_b16 a[56:57], v11 offset:16384
ds_read_b64_tr_b16 a[58:59], v11 offset:16896
ds_read_b64_tr_b16 a[60:61], v11 offset:24576
ds_read_b64_tr_b16 a[62:63], v11 offset:25088
ds_read_b64_tr_b16 a[112:113], v12 offset:0
ds_read_b64_tr_b16 a[114:115], v12 offset:512
ds_read_b64_tr_b16 a[116:117], v12 offset:8192
ds_read_b64_tr_b16 a[118:119], v12 offset:8704
ds_read_b64_tr_b16 a[120:121], v12 offset:16384
ds_read_b64_tr_b16 a[122:123], v12 offset:16896
ds_read_b64_tr_b16 a[124:125], v12 offset:24576
ds_read_b64_tr_b16 a[126:127], v12 offset:25088
s_waitcnt lgkmcnt(0)
s_branch L_rec_c6e
L_rec_c6w3:
ds_read_b64_tr_b16 a[96:97], v11 offset:0
ds_read_b64_tr_b16 a[98:99], v11 offset:512
ds_read_b64_tr_b16 a[100:101], v11 offset:8192
ds_read_b64_tr_b16 a[102:103], v11 offset:8704
ds_read_b64_tr_b16 a[104:105], v11 offset:16384
ds_read_b64_tr_b16 a[106:107], v11 offset:16896
ds_read_b64_tr_b16 a[108:109], v11 offset:24576
ds_read_b64_tr_b16 a[110:111], v11 offset:25088
ds_read_b64_tr_b16 a[160:161], v12 offset:0
ds_read_b64_tr_b16 a[162:163], v12 offset:512
ds_read_b64_tr_b16 a[164:165], v12 offset:8192
ds_read_b64_tr_b16 a[166:167], v12 offset:8704
ds_read_b64_tr_b16 a[168:169], v12 offset:16384
ds_read_b64_tr_b16 a[170:171], v12 offset:16896
ds_read_b64_tr_b16 a[172:173], v12 offset:24576
ds_read_b64_tr_b16 a[174:175], v12 offset:25088
s_waitcnt lgkmcnt(0)
L_rec_c6e:
s_waitcnt vmcnt(16)
s_barrier
s_add_u32 m0, s15, 0x10000
v_xor_b32 v10, 0x0, v7
v_add_u32 v10, 0x200000, v10
global_load_lds_dwordx4 v10, s[6:7]
s_add_u32 m0, s15, 0x10400
v_xor_b32 v10, 0x40, v7
v_add_u32 v10, 0x208000, v10
global_load_lds_dwordx4 v10, s[6:7]
s_add_u32 m0, s15, 0x10800
v_xor_b32 v10, 0x0, v7
v_add_u32 v10, 0x210000, v10
global_load_lds_dwordx4 v10, s[6:7]
s_add_u32 m0, s15, 0x10c00
v_xor_b32 v10, 0x40, v7
v_add_u32 v10, 0x218000, v10
global_load_lds_dwordx4 v10, s[6:7]
s_add_u32 m0, s15, 0x11000
v_xor_b32 v10, 0x80, v7
v_add_u32 v10, 0x220000, v10
global_load_lds_dwordx4 v10, s[6:7]
s_add_u32 m0, s15, 0x11400
v_xor_b32 v10, 0xc0, v7
v_add_u32 v10, 0x228000, v10
global_load_lds_dwordx4 v10, s[6:7]
s_add_u32 m0, s15, 0x11800
v_xor_b32 v10, 0x80, v7
v_add_u32 v10, 0x230000, v10
global_load_lds_dwordx4 v10, s[6:7]
s_add_u32 m0, s15, 0x11c00
v_xor_b32 v10, 0xc0, v7
v_add_u32 v10, 0x238000, v10
global_load_lds_dwordx4 v10, s[6:7]
v_add_u32 v11, 0x10000, v8
v_xor_b32 v12, 32, v11
s_cmp_eq_u32 s15, 8192
s_cbranch_scc1 L_rec_c7w1
s_cmp_eq_u32 s15, 16384
s_cbranch_scc1 L_rec_c7w2
s_cmp_eq_u32 s15, 24576
s_cbranch_scc1 L_rec_c7w3
L_rec_c7w0:
ds_read_b64_tr_b16 a[96:97], v11 offset:32768
ds_read_b64_tr_b16 a[98:99], v11 offset:33280
ds_read_b64_tr_b16 a[100:101], v11 offset:40960
ds_read_b64_tr_b16 a[102:103], v11 offset:41472
ds_read_b64_tr_b16 a[104:105], v11 offset:49152
ds_read_b64_tr_b16 a[106:107], v11 offset:49664
ds_read_b64_tr_b16 a[108:109], v11 offset:57344
ds_read_b64_tr_b16 a[110:111], v11 offset:57856
ds_read_b64_tr_b16 a[160:161], v12 offset:32768
ds_read_b64_tr_b16 a[162:163], v12 offset:33280
ds_read_b64_tr_b16 a[164:165], v12 offset:40960
ds_read_b64_tr_b16 a[166:167], v12 offset:41472
ds_read_b64_tr_b16 a[168:169], v12 offset:49152
ds_read_b64_tr_b16 a[170:171], v12 offset:49664
ds_read_b64_tr_b16 a[172:173], v12 offset:57344
ds_read_b64_tr_b16 a[174:175], v12 offset:57856
s_waitcnt lgkmcnt(0)
s_branch L_rec_c7e
L_rec_c7w1:
ds_read_b64_tr_b16 a[80:81], v11 offset:32768
ds_read_b64_tr_b16 a[82:83], v11 offset:33280
ds_read_b64_tr_b16 a[84:85], v11 offset:40960
ds_read_b64_tr_b16 a[86:87], v11 offset:41472
ds_read_b64_tr_b16 a[88:89], v11 offset:49152
ds_read_b64_tr_b16 a[90:91], v11 offset:49664
ds_read_b64_tr_b16 a[92:93], v11 offset:57344
ds_read_b64_tr_b16 a[94:95], v11 offset:57856
ds_read_b64_tr_b16 a[144:145], v12 offset:32768
ds_read_b64_tr_b16 a[146:147], v12 offset:33280
ds_read_b64_tr_b16 a[148:149], v12 offset:40960
ds_read_b64_tr_b16 a[150:151], v12 offset:41472
ds_read_b64_tr_b16 a[152:153], v12 offset:49152
ds_read_b64_tr_b16 a[154:155], v12 offset:49664
ds_read_b64_tr_b16 a[156:157], v12 offset:57344
ds_read_b64_tr_b16 a[158:159], v12 offset:57856
s_waitcnt lgkmcnt(0)
s_branch L_rec_c7e
L_rec_c7w2:
ds_read_b64_tr_b16 a[64:65], v11 offset:32768
ds_read_b64_tr_b16 a[66:67], v11 offset:33280
ds_read_b64_tr_b16 a[68:69], v11 offset:40960
ds_read_b64_tr_b16 a[70:71], v11 offset:41472
ds_read_b64_tr_b16 a[72:73], v11 offset:49152
ds_read_b64_tr_b16 a[74:75], v11 offset:49664
ds_read_b64_tr_b16 a[76:77], v11 offset:57344
ds_read_b64_tr_b16 a[78:79], v11 offset:57856
ds_read_b64_tr_b16 a[128:129], v12 offset:32768
ds_read_b64_tr_b16 a[130:131], v12 offset:33280
ds_read_b64_tr_b16 a[132:133], v12 offset:40960
ds_read_b64_tr_b16 a[134:135], v12 offset:41472
ds_read_b64_tr_b16 a[136:137], v12 offset:49152
ds_read_b64_tr_b16 a[138:139], v12 offset:49664
ds_read_b64_tr_b16 a[140:141], v12 offset:57344
ds_read_b64_tr_b16 a[142:143], v12 offset:57856
s_waitcnt lgkmcnt(0)
s_branch L_rec_c7e
L_rec_c7w3:
ds_read_b64_tr_b16 a[48:49], v11 offset:32768
ds_read_b64_tr_b16 a[50:51], v11 offset:33280
ds_read_b64_tr_b16 a[52:53], v11 offset:40960
ds_read_b64_tr_b16 a[54:55], v11 offset:41472
ds_read_b64_tr_b16 a[56:57], v11 offset:49152
ds_read_b64_tr_b16 a[58:59], v11 offset:49664
ds_read_b64_tr_b16 a[60:61], v11 offset:57344
ds_read_b64_tr_b16 a[62:63], v11 offset:57856
ds_read_b64_tr_b16 a[112:113], v12 offset:32768
ds_read_b64_tr_b16 a[114:115], v12 offset:33280
ds_read_b64_tr_b16 a[116:117], v12 offset:40960
ds_read_b64_tr_b16 a[118:119], v12 offset:41472
ds_read_b64_tr_b16 a[120:121], v12 offset:49152
ds_read_b64_tr_b16 a[122:123], v12 offset:49664
ds_read_b64_tr_b16 a[124:125], v12 offset:57344
ds_read_b64_tr_b16 a[126:127], v12 offset:57856
s_waitcnt lgkmcnt(0)
L_rec_c7e:
s_cmp_lg_u32 s14, 0
s_cbranch_scc1 L_rec_noarr1
s_mov_b64 exec, 1
v_mov_b32 v14, 0
v_mov_b32 v15, 1
global_atomic_add v14, v15, s[28:29]
s_mov_b64 exec, -1
L_rec_noarr1:
s_waitcnt vmcnt(16)
s_barrier
s_add_u32 m0, s15, 0x18000
v_xor_b32 v10, 0x0, v7
v_add_u32 v10, 0x300000, v10
global_load_lds_dwordx4 v10, s[6:7]
s_add_u32 m0, s15, 0x18400
v_xor_b32 v10, 0x40, v7
v_add_u32 v10, 0x308000, v10
global_load_lds_dwordx4 v10, s[6:7]
s_add_u32 m0, s15, 0x18800
v_xor_b32 v10, 0x0, v7
v_add_u32 v10, 0x310000, v10
global_load_lds_dwordx4 v10, s[6:7]
s_add_u32 m0, s15, 0x18c00
v_xor_b32 v10, 0x40, v7
v_add_u32 v10, 0x318000, v10
global_load_lds_dwordx4 v10, s[6:7]
s_add_u32 m0, s15, 0x19000
v_xor_b32 v10, 0x80, v7
v_add_u32 v10, 0x320000, v10
global_load_lds_dwordx4 v10, s[6:7]
s_add_u32 m0, s15, 0x19400
v_xor_b32 v10, 0xc0, v7
v_add_u32 v10, 0x328000, v10
global_load_lds_dwordx4 v10, s[6:7]
s_add_u32 m0, s15, 0x19800
v_xor_b32 v10, 0x80, v7
v_add_u32 v10, 0x330000, v10
global_load_lds_dwordx4 v10, s[6:7]
s_add_u32 m0, s15, 0x19c00
v_xor_b32 v10, 0xc0, v7
v_add_u32 v10, 0x338000, v10
global_load_lds_dwordx4 v10, s[6:7]
v_add_u32 v11, 0x0, v8
v_xor_b32 v12, 32, v11
s_cmp_eq_u32 s15, 8192
s_cbranch_scc1 L_rec_c8w1
s_cmp_eq_u32 s15, 16384
s_cbranch_scc1 L_rec_c8w2
s_cmp_eq_u32 s15, 24576
s_cbranch_scc1 L_rec_c8w3
L_rec_c8w0:
ds_read_b64_tr_b16 v[48:49], v11 offset:0
ds_read_b64_tr_b16 v[50:51], v11 offset:512
ds_read_b64_tr_b16 v[52:53], v11 offset:8192
ds_read_b64_tr_b16 v[54:55], v11 offset:8704
ds_read_b64_tr_b16 v[64:65], v11 offset:16384
ds_read_b64_tr_b16 v[66:67], v11 offset:16896
ds_read_b64_tr_b16 v[68:69], v11 offset:24576
ds_read_b64_tr_b16 v[70:71], v11 offset:25088
ds_read_b64_tr_b16 v[56:57], v12 offset:0
ds_read_b64_tr_b16 v[58:59], v12 offset:512
ds_read_b64_tr_b16 v[60:61], v12 offset:8192
ds_read_b64_tr_b16 v[62:63], v12 offset:8704
ds_read_b64_tr_b16 v[72:73], v12 offset:16384
ds_read_b64_tr_b16 v[74:75], v12 offset:16896
ds_read_b64_tr_b16 v[76:77], v12 offset:24576
ds_read_b64_tr_b16 v[78:79], v12 offset:25088
s_waitcnt lgkmcnt(0)
s_branch L_rec_c8e
L_rec_c8w1:
ds_read_b64_tr_b16 v[144:145], v11 offset:0
ds_read_b64_tr_b16 v[146:147], v11 offset:512
ds_read_b64_tr_b16 v[148:149], v11 offset:8192
ds_read_b64_tr_b16 v[150:151], v11 offset:8704
ds_read_b64_tr_b16 v[152:153], v11 offset:16384
ds_read_b64_tr_b16 v[154:155], v11 offset:16896
ds_read_b64_tr_b16 v[156:157], v11 offset:24576
ds_read_b64_tr_b16 v[158:159], v11 offset:25088
ds_read_b64_tr_b16 v[184:185], v12 offset:0
ds_read_b64_tr_b16 v[186:187], v12 offset:512
ds_read_b64_tr_b16 v[188:189], v12 offset:8192
ds_read_b64_tr_b16 v[190:191], v12 offset:8704
ds_read_b64_tr_b16 v[192:193], v12 offset:16384
ds_read_b64_tr_b16 v[194:195], v12 offset:16896
ds_read_b64_tr_b16 v[196:197], v12 offset:24576
ds_read_b64_tr_b16 v[198:199], v12 offset:25088
s_waitcnt lgkmcnt(0)
s_branch L_rec_c8e
L_rec_c8w2:
ds_read_b64_tr_b16 v[128:129], v11 offset:0
ds_read_b64_tr_b16 v[130:131], v11 offset:512
ds_read_b64_tr_b16 v[132:133], v11 offset:8192
ds_read_b64_tr_b16 v[134:135], v11 offset:8704
ds_read_b64_tr_b16 v[136:137], v11 offset:16384
ds_read_b64_tr_b16 v[138:139], v11 offset:16896
ds_read_b64_tr_b16 v[140:141], v11 offset:24576
ds_read_b64_tr_b16 v[142:143], v11 offset:25088
ds_read_b64_tr_b16 v[168:169], v12 offset:0
ds_read_b64_tr_b16 v[170:171], v12 offset:512
ds_read_b64_tr_b16 v[172:173], v12 offset:8192
ds_read_b64_tr_b16 v[174:175], v12 offset:8704
ds_read_b64_tr_b16 v[176:177], v12 offset:16384
ds_read_b64_tr_b16 v[178:179], v12 offset:16896
ds_read_b64_tr_b16 v[180:181], v12 offset:24576
ds_read_b64_tr_b16 v[182:183], v12 offset:25088
s_waitcnt lgkmcnt(0)
s_branch L_rec_c8e
L_rec_c8w3:
ds_read_b64_tr_b16 v[80:81], v11 offset:0
ds_read_b64_tr_b16 v[82:83], v11 offset:512
ds_read_b64_tr_b16 v[84:85], v11 offset:8192
ds_read_b64_tr_b16 v[86:87], v11 offset:8704
ds_read_b64_tr_b16 v[120:121], v11 offset:16384
ds_read_b64_tr_b16 v[122:123], v11 offset:16896
ds_read_b64_tr_b16 v[124:125], v11 offset:24576
ds_read_b64_tr_b16 v[126:127], v11 offset:25088
ds_read_b64_tr_b16 v[88:89], v12 offset:0
ds_read_b64_tr_b16 v[90:91], v12 offset:512
ds_read_b64_tr_b16 v[92:93], v12 offset:8192
ds_read_b64_tr_b16 v[94:95], v12 offset:8704
ds_read_b64_tr_b16 v[160:161], v12 offset:16384
ds_read_b64_tr_b16 v[162:163], v12 offset:16896
ds_read_b64_tr_b16 v[164:165], v12 offset:24576
ds_read_b64_tr_b16 v[166:167], v12 offset:25088
s_waitcnt lgkmcnt(0)
L_rec_c8e:
s_waitcnt vmcnt(16)
s_barrier
s_add_u32 m0, s15, 0x0
v_xor_b32 v10, 0x0, v7
v_add_u32 v10, 0x0, v10
global_load_lds_dwordx4 v10, s[8:9]
s_add_u32 m0, s15, 0x400
v_xor_b32 v10, 0x40, v7
v_add_u32 v10, 0x8000, v10
global_load_lds_dwordx4 v10, s[8:9]
s_add_u32 m0, s15, 0x800
v_xor_b32 v10, 0x0, v7
v_add_u32 v10, 0x10000, v10
global_load_lds_dwordx4 v10, s[8:9]
s_add_u32 m0, s15, 0xc00
v_xor_b32 v10, 0x40, v7
v_add_u32 v10, 0x18000, v10
global_load_lds_dwordx4 v10, s[8:9]
s_add_u32 m0, s15, 0x1000
v_xor_b32 v10, 0x80, v7
v_add_u32 v10, 0x20000, v10
global_load_lds_dwordx4 v10, s[8:9]
s_add_u32 m0, s15, 0x1400
v_xor_b32 v10, 0xc0, v7
v_add_u32 v10, 0x28000, v10
global_load_lds_dwordx4 v10, s[8:9]
s_add_u32 m0, s15, 0x1800
v_xor_b32 v10, 0x80, v7
v_add_u32 v10, 0x30000, v10
global_load_lds_dwordx4 v10, s[8:9]
s_add_u32 m0, s15, 0x1c00
v_xor_b32 v10, 0xc0, v7
v_add_u32 v10, 0x38000, v10
global_load_lds_dwordx4 v10, s[8:9]
v_add_u32 v11, 0x0, v8
v_xor_b32 v12, 32, v11
s_cmp_eq_u32 s15, 8192
s_cbranch_scc1 L_rec_c9w1
s_cmp_eq_u32 s15, 16384
s_cbranch_scc1 L_rec_c9w2
s_cmp_eq_u32 s15, 24576
s_cbranch_scc1 L_rec_c9w3
L_rec_c9w0:
ds_read_b64_tr_b16 v[80:81], v11 offset:32768
ds_read_b64_tr_b16 v[82:83], v11 offset:33280
ds_read_b64_tr_b16 v[84:85], v11 offset:40960
ds_read_b64_tr_b16 v[86:87], v11 offset:41472
ds_read_b64_tr_b16 v[120:121], v11 offset:49152
ds_read_b64_tr_b16 v[122:123], v11 offset:49664
ds_read_b64_tr_b16 v[124:125], v11 offset:57344
ds_read_b64_tr_b16 v[126:127], v11 offset:57856
ds_read_b64_tr_b16 v[88:89], v12 offset:32768
ds_read_b64_tr_b16 v[90:91], v12 offset:33280
ds_read_b64_tr_b16 v[92:93], v12 offset:40960
ds_read_b64_tr_b16 v[94:95], v12 offset:41472
ds_read_b64_tr_b16 v[160:161], v12 offset:49152
ds_read_b64_tr_b16 v[162:163], v12 offset:49664
ds_read_b64_tr_b16 v[164:165], v12 offset:57344
ds_read_b64_tr_b16 v[166:167], v12 offset:57856
s_waitcnt lgkmcnt(0)
s_branch L_rec_c9e
L_rec_c9w1:
ds_read_b64_tr_b16 v[48:49], v11 offset:32768
ds_read_b64_tr_b16 v[50:51], v11 offset:33280
ds_read_b64_tr_b16 v[52:53], v11 offset:40960
ds_read_b64_tr_b16 v[54:55], v11 offset:41472
ds_read_b64_tr_b16 v[64:65], v11 offset:49152
ds_read_b64_tr_b16 v[66:67], v11 offset:49664
ds_read_b64_tr_b16 v[68:69], v11 offset:57344
ds_read_b64_tr_b16 v[70:71], v11 offset:57856
ds_read_b64_tr_b16 v[56:57], v12 offset:32768
ds_read_b64_tr_b16 v[58:59], v12 offset:33280
ds_read_b64_tr_b16 v[60:61], v12 offset:40960
ds_read_b64_tr_b16 v[62:63], v12 offset:41472
ds_read_b64_tr_b16 v[72:73], v12 offset:49152
ds_read_b64_tr_b16 v[74:75], v12 offset:49664
ds_read_b64_tr_b16 v[76:77], v12 offset:57344
ds_read_b64_tr_b16 v[78:79], v12 offset:57856
s_waitcnt lgkmcnt(0)
s_branch L_rec_c9e
L_rec_c9w2:
ds_read_b64_tr_b16 v[144:145], v11 offset:32768
ds_read_b64_tr_b16 v[146:147], v11 offset:33280
ds_read_b64_tr_b16 v[148:149], v11 offset:40960
ds_read_b64_tr_b16 v[150:151], v11 offset:41472
ds_read_b64_tr_b16 v[152:153], v11 offset:49152
ds_read_b64_tr_b16 v[154:155], v11 offset:49664
ds_read_b64_tr_b16 v[156:157], v11 offset:57344
ds_read_b64_tr_b16 v[158:159], v11 offset:57856
ds_read_b64_tr_b16 v[184:185], v12 offset:32768
ds_read_b64_tr_b16 v[186:187], v12 offset:33280
ds_read_b64_tr_b16 v[188:189], v12 offset:40960
ds_read_b64_tr_b16 v[190:191], v12 offset:41472
ds_read_b64_tr_b16 v[192:193], v12 offset:49152
ds_read_b64_tr_b16 v[194:195], v12 offset:49664
ds_read_b64_tr_b16 v[196:197], v12 offset:57344
ds_read_b64_tr_b16 v[198:199], v12 offset:57856
s_waitcnt lgkmcnt(0)
s_branch L_rec_c9e
L_rec_c9w3:
ds_read_b64_tr_b16 v[128:129], v11 offset:32768
ds_read_b64_tr_b16 v[130:131], v11 offset:33280
ds_read_b64_tr_b16 v[132:133], v11 offset:40960
ds_read_b64_tr_b16 v[134:135], v11 offset:41472
ds_read_b64_tr_b16 v[136:137], v11 offset:49152
ds_read_b64_tr_b16 v[138:139], v11 offset:49664
ds_read_b64_tr_b16 v[140:141], v11 offset:57344
ds_read_b64_tr_b16 v[142:143], v11 offset:57856
ds_read_b64_tr_b16 v[168:169], v12 offset:32768
ds_read_b64_tr_b16 v[170:171], v12 offset:33280
ds_read_b64_tr_b16 v[172:173], v12 offset:40960
ds_read_b64_tr_b16 v[174:175], v12 offset:41472
ds_read_b64_tr_b16 v[176:177], v12 offset:49152
ds_read_b64_tr_b16 v[178:179], v12 offset:49664
ds_read_b64_tr_b16 v[180:181], v12 offset:57344
ds_read_b64_tr_b16 v[182:183], v12 offset:57856
s_waitcnt lgkmcnt(0)
L_rec_c9e:
s_waitcnt vmcnt(16)
s_barrier
s_add_u32 m0, s15, 0x8000
v_xor_b32 v10, 0x0, v7
v_add_u32 v10, 0x100000, v10
global_load_lds_dwordx4 v10, s[8:9]
s_add_u32 m0, s15, 0x8400
v_xor_b32 v10, 0x40, v7
v_add_u32 v10, 0x108000, v10
global_load_lds_dwordx4 v10, s[8:9]
s_add_u32 m0, s15, 0x8800
v_xor_b32 v10, 0x0, v7
v_add_u32 v10, 0x110000, v10
global_load_lds_dwordx4 v10, s[8:9]
s_add_u32 m0, s15, 0x8c00
v_xor_b32 v10, 0x40, v7
v_add_u32 v10, 0x118000, v10
global_load_lds_dwordx4 v10, s[8:9]
s_add_u32 m0, s15, 0x9000
v_xor_b32 v10, 0x80, v7
v_add_u32 v10, 0x120000, v10
global_load_lds_dwordx4 v10, s[8:9]
s_add_u32 m0, s15, 0x9400
v_xor_b32 v10, 0xc0, v7
v_add_u32 v10, 0x128000, v10
global_load_lds_dwordx4 v10, s[8:9]
s_add_u32 m0, s15, 0x9800
v_xor_b32 v10, 0x80, v7
v_add_u32 v10, 0x130000, v10
global_load_lds_dwordx4 v10, s[8:9]
s_add_u32 m0, s15, 0x9c00
v_xor_b32 v10, 0xc0, v7
v_add_u32 v10, 0x138000, v10
global_load_lds_dwordx4 v10, s[8:9]
v_add_u32 v11, 0x10000, v8
v_xor_b32 v12, 32, v11
s_cmp_eq_u32 s15, 8192
s_cbranch_scc1 L_rec_c10w1
s_cmp_eq_u32 s15, 16384
s_cbranch_scc1 L_rec_c10w2
s_cmp_eq_u32 s15, 24576
s_cbranch_scc1 L_rec_c10w3
L_rec_c10w0:
ds_read_b64_tr_b16 v[128:129], v11 offset:0
ds_read_b64_tr_b16 v[130:131], v11 offset:512
ds_read_b64_tr_b16 v[132:133], v11 offset:8192
ds_read_b64_tr_b16 v[134:135], v11 offset:8704
ds_read_b64_tr_b16 v[136:137], v11 offset:16384
ds_read_b64_tr_b16 v[138:139], v11 offset:16896
ds_read_b64_tr_b16 v[140:141], v11 offset:24576
ds_read_b64_tr_b16 v[142:143], v11 offset:25088
ds_read_b64_tr_b16 v[168:169], v12 offset:0
ds_read_b64_tr_b16 v[170:171], v12 offset:512
ds_read_b64_tr_b16 v[172:173], v12 offset:8192
ds_read_b64_tr_b16 v[174:175], v12 offset:8704
ds_read_b64_tr_b16 v[176:177], v12 offset:16384
ds_read_b64_tr_b16 v[178:179], v12 offset:16896
ds_read_b64_tr_b16 v[180:181], v12 offset:24576
ds_read_b64_tr_b16 v[182:183], v12 offset:25088
s_waitcnt lgkmcnt(0)
s_branch L_rec_c10e
L_rec_c10w1:
ds_read_b64_tr_b16 v[80:81], v11 offset:0
ds_read_b64_tr_b16 v[82:83], v11 offset:512
ds_read_b64_tr_b16 v[84:85], v11 offset:8192
ds_read_b64_tr_b16 v[86:87], v11 offset:8704
ds_read_b64_tr_b16 v[120:121], v11 offset:16384
ds_read_b64_tr_b16 v[122:123], v11 offset:16896
ds_read_b64_tr_b16 v[124:125], v11 offset:24576
ds_read_b64_tr_b16 v[126:127], v11 offset:25088
ds_read_b64_tr_b16 v[88:89], v12 offset:0
ds_read_b64_tr_b16 v[90:91], v12 offset:512
ds_read_b64_tr_b16 v[92:93], v12 offset:8192
ds_read_b64_tr_b16 v[94:95], v12 offset:8704
ds_read_b64_tr_b16 v[160:161], v12 offset:16384
ds_read_b64_tr_b16 v[162:163], v12 offset:16896
ds_read_b64_tr_b16 v[164:165], v12 offset:24576
ds_read_b64_tr_b16 v[166:167], v12 offset:25088
s_waitcnt lgkmcnt(0)
s_branch L_rec_c10e
L_rec_c10w2:
ds_read_b64_tr_b16 v[48:49], v11 offset:0
ds_read_b64_tr_b16 v[50:51], v11 offset:512
ds_read_b64_tr_b16 v[52:53], v11 offset:8192
ds_read_b64_tr_b16 v[54:55], v11 offset:8704
ds_read_b64_tr_b16 v[64:65], v11 offset:16384
ds_read_b64_tr_b16 v[66:67], v11 offset:16896
ds_read_b64_tr_b16 v[68:69], v11 offset:24576
ds_read_b64_tr_b16 v[70:71], v11 offset:25088
ds_read_b64_tr_b16 v[56:57], v12 offset:0
ds_read_b64_tr_b16 v[58:59], v12 offset:512
ds_read_b64_tr_b16 v[60:61], v12 offset:8192
ds_read_b64_tr_b16 v[62:63], v12 offset:8704
ds_read_b64_tr_b16 v[72:73], v12 offset:16384
ds_read_b64_tr_b16 v[74:75], v12 offset:16896
ds_read_b64_tr_b16 v[76:77], v12 offset:24576
ds_read_b64_tr_b16 v[78:79], v12 offset:25088
s_waitcnt lgkmcnt(0)
s_branch L_rec_c10e
L_rec_c10w3:
ds_read_b64_tr_b16 v[144:145], v11 offset:0
ds_read_b64_tr_b16 v[146:147], v11 offset:512
ds_read_b64_tr_b16 v[148:149], v11 offset:8192
ds_read_b64_tr_b16 v[150:151], v11 offset:8704
ds_read_b64_tr_b16 v[152:153], v11 offset:16384
ds_read_b64_tr_b16 v[154:155], v11 offset:16896
ds_read_b64_tr_b16 v[156:157], v11 offset:24576
ds_read_b64_tr_b16 v[158:159], v11 offset:25088
ds_read_b64_tr_b16 v[184:185], v12 offset:0
ds_read_b64_tr_b16 v[186:187], v12 offset:512
ds_read_b64_tr_b16 v[188:189], v12 offset:8192
ds_read_b64_tr_b16 v[190:191], v12 offset:8704
ds_read_b64_tr_b16 v[192:193], v12 offset:16384
ds_read_b64_tr_b16 v[194:195], v12 offset:16896
ds_read_b64_tr_b16 v[196:197], v12 offset:24576
ds_read_b64_tr_b16 v[198:199], v12 offset:25088
s_waitcnt lgkmcnt(0)
L_rec_c10e:
v_and_b32 v2, 31, v0
v_lshlrev_b32 v2, 2, v2
global_load_dword v16, v2, s[28:29] offset:128 sc1
s_waitcnt vmcnt(16)
s_barrier
s_add_u32 m0, s15, 0x10000
v_xor_b32 v10, 0x0, v7
v_add_u32 v10, 0x200000, v10
global_load_lds_dwordx4 v10, s[8:9]
s_add_u32 m0, s15, 0x10400
v_xor_b32 v10, 0x40, v7
v_add_u32 v10, 0x208000, v10
global_load_lds_dwordx4 v10, s[8:9]
s_add_u32 m0, s15, 0x10800
v_xor_b32 v10, 0x0, v7
v_add_u32 v10, 0x210000, v10
global_load_lds_dwordx4 v10, s[8:9]
s_add_u32 m0, s15, 0x10c00
v_xor_b32 v10, 0x40, v7
v_add_u32 v10, 0x218000, v10
global_load_lds_dwordx4 v10, s[8:9]
s_add_u32 m0, s15, 0x11000
v_xor_b32 v10, 0x80, v7
v_add_u32 v10, 0x220000, v10
global_load_lds_dwordx4 v10, s[8:9]
s_add_u32 m0, s15, 0x11400
v_xor_b32 v10, 0xc0, v7
v_add_u32 v10, 0x228000, v10
global_load_lds_dwordx4 v10, s[8:9]
s_add_u32 m0, s15, 0x11800
v_xor_b32 v10, 0x80, v7
v_add_u32 v10, 0x230000, v10
global_load_lds_dwordx4 v10, s[8:9]
s_add_u32 m0, s15, 0x11c00
v_xor_b32 v10, 0xc0, v7
v_add_u32 v10, 0x238000, v10
global_load_lds_dwordx4 v10, s[8:9]
v_add_u32 v11, 0x10000, v8
v_xor_b32 v12, 32, v11
s_cmp_eq_u32 s15, 8192
s_cbranch_scc1 L_rec_c11w1
s_cmp_eq_u32 s15, 16384
s_cbranch_scc1 L_rec_c11w2
s_cmp_eq_u32 s15, 24576
s_cbranch_scc1 L_rec_c11w3
L_rec_c11w0:
ds_read_b64_tr_b16 v[144:145], v11 offset:32768
ds_read_b64_tr_b16 v[146:147], v11 offset:33280
ds_read_b64_tr_b16 v[148:149], v11 offset:40960
ds_read_b64_tr_b16 v[150:151], v11 offset:41472
ds_read_b64_tr_b16 v[152:153], v11 offset:49152
ds_read_b64_tr_b16 v[154:155], v11 offset:49664
ds_read_b64_tr_b16 v[156:157], v11 offset:57344
ds_read_b64_tr_b16 v[158:159], v11 offset:57856
ds_read_b64_tr_b16 v[184:185], v12 offset:32768
ds_read_b64_tr_b16 v[186:187], v12 offset:33280
ds_read_b64_tr_b16 v[188:189], v12 offset:40960
ds_read_b64_tr_b16 v[190:191], v12 offset:41472
ds_read_b64_tr_b16 v[192:193], v12 offset:49152
ds_read_b64_tr_b16 v[194:195], v12 offset:49664
ds_read_b64_tr_b16 v[196:197], v12 offset:57344
ds_read_b64_tr_b16 v[198:199], v12 offset:57856
s_waitcnt lgkmcnt(0)
s_branch L_rec_c11e
L_rec_c11w1:
ds_read_b64_tr_b16 v[128:129], v11 offset:32768
ds_read_b64_tr_b16 v[130:131], v11 offset:33280
ds_read_b64_tr_b16 v[132:133], v11 offset:40960
ds_read_b64_tr_b16 v[134:135], v11 offset:41472
ds_read_b64_tr_b16 v[136:137], v11 offset:49152
ds_read_b64_tr_b16 v[138:139], v11 offset:49664
ds_read_b64_tr_b16 v[140:141], v11 offset:57344
ds_read_b64_tr_b16 v[142:143], v11 offset:57856
ds_read_b64_tr_b16 v[168:169], v12 offset:32768
ds_read_b64_tr_b16 v[170:171], v12 offset:33280
ds_read_b64_tr_b16 v[172:173], v12 offset:40960
ds_read_b64_tr_b16 v[174:175], v12 offset:41472
ds_read_b64_tr_b16 v[176:177], v12 offset:49152
ds_read_b64_tr_b16 v[178:179], v12 offset:49664
ds_read_b64_tr_b16 v[180:181], v12 offset:57344
ds_read_b64_tr_b16 v[182:183], v12 offset:57856
s_waitcnt lgkmcnt(0)
s_branch L_rec_c11e
L_rec_c11w2:
ds_read_b64_tr_b16 v[80:81], v11 offset:32768
ds_read_b64_tr_b16 v[82:83], v11 offset:33280
ds_read_b64_tr_b16 v[84:85], v11 offset:40960
ds_read_b64_tr_b16 v[86:87], v11 offset:41472
ds_read_b64_tr_b16 v[120:121], v11 offset:49152
ds_read_b64_tr_b16 v[122:123], v11 offset:49664
ds_read_b64_tr_b16 v[124:125], v11 offset:57344
ds_read_b64_tr_b16 v[126:127], v11 offset:57856
ds_read_b64_tr_b16 v[88:89], v12 offset:32768
ds_read_b64_tr_b16 v[90:91], v12 offset:33280
ds_read_b64_tr_b16 v[92:93], v12 offset:40960
ds_read_b64_tr_b16 v[94:95], v12 offset:41472
ds_read_b64_tr_b16 v[160:161], v12 offset:49152
ds_read_b64_tr_b16 v[162:163], v12 offset:49664
ds_read_b64_tr_b16 v[164:165], v12 offset:57344
ds_read_b64_tr_b16 v[166:167], v12 offset:57856
s_waitcnt lgkmcnt(0)
s_branch L_rec_c11e
L_rec_c11w3:
ds_read_b64_tr_b16 v[48:49], v11 offset:32768
ds_read_b64_tr_b16 v[50:51], v11 offset:33280
ds_read_b64_tr_b16 v[52:53], v11 offset:40960
ds_read_b64_tr_b16 v[54:55], v11 offset:41472
ds_read_b64_tr_b16 v[64:65], v11 offset:49152
ds_read_b64_tr_b16 v[66:67], v11 offset:49664
ds_read_b64_tr_b16 v[68:69], v11 offset:57344
ds_read_b64_tr_b16 v[70:71], v11 offset:57856
ds_read_b64_tr_b16 v[56:57], v12 offset:32768
ds_read_b64_tr_b16 v[58:59], v12 offset:33280
ds_read_b64_tr_b16 v[60:61], v12 offset:40960
ds_read_b64_tr_b16 v[62:63], v12 offset:41472
ds_read_b64_tr_b16 v[72:73], v12 offset:49152
ds_read_b64_tr_b16 v[74:75], v12 offset:49664
ds_read_b64_tr_b16 v[76:77], v12 offset:57344
ds_read_b64_tr_b16 v[78:79], v12 offset:57856
s_waitcnt lgkmcnt(0)
L_rec_c11e:
s_getpc_b64 s[60:61]
L_rec_pc:
s_add_u32 s60, s60, L_rec_f0-L_rec_pc
s_addc_u32 s61, s61, 0
s_lshl_b32 s13, s12, 2
s_add_u32 s13, s13, s14
s_lshl_b32 s13, s13, 8
v_and_b32 v2, 3, v0
v_lshlrev_b32 v2, 6, v2
v_add_u32 v2, s13, v2
v_and_b32 v10, 0x3fff, v2
global_load_dword v13, v10, s[60:61]
v_add_u32 v2, 0x380000, v2
global_load_dword v13, v2, s[4:5] sc1
v_and_b32 v2, 31, v0
v_mul_u32_u24 v2, 64, v2
v_sub_u32 v10, v24, v20
v_add_u32 v2, v2, v10
v_and_b32 v10, 32, v0
v_lshlrev_b32 v10, 13, v10
v_xor_b32 v2, v2, v10
global_load_dword v13, v2, s[4:5] sc1
s_waitcnt vmcnt(16)
s_barrier
s_add_u32 m0, s15, 0x18000
v_xor_b32 v10, 0x0, v7
v_add_u32 v10, 0x300000, v10
global_load_lds_dwordx4 v10, s[8:9]
s_add_u32 m0, s15, 0x18400
v_xor_b32 v10, 0x40, v7
v_add_u32 v10, 0x308000, v10
global_load_lds_dwordx4 v10, s[8:9]
s_add_u32 m0, s15, 0x18800
v_xor_b32 v10, 0x0, v7
v_add_u32 v10, 0x310000, v10
global_load_lds_dwordx4 v10, s[8:9]
s_add_u32 m0, s15, 0x18c00
v_xor_b32 v10, 0x40, v7
v_add_u32 v10, 0x318000, v10
global_load_lds_dwordx4 v10, s[8:9]
s_add_u32 m0, s15, 0x19000
v_xor_b32 v10, 0x80, v7
v_add_u32 v10, 0x320000, v10
global_load_lds_dwordx4 v10, s[8:9]
s_add_u32 m0, s15, 0x19400
v_xor_b32 v10, 0xc0, v7
v_add_u32 v10, 0x328000, v10
global_load_lds_dwordx4 v10, s[8:9]
s_add_u32 m0, s15, 0x19800
v_xor_b32 v10, 0x80, v7
v_add_u32 v10, 0x330000, v10
global_load_lds_dwordx4 v10, s[8:9]
s_add_u32 m0, s15, 0x19c00
v_xor_b32 v10, 0xc0, v7
v_add_u32 v10, 0x338000, v10
global_load_lds_dwordx4 v10, s[8:9]
v_add_u32 v11, 0x0, v8
v_xor_b32 v12, 32, v11
s_cmp_eq_u32 s15, 8192
s_cbranch_scc1 L_rec_c12w1
s_cmp_eq_u32 s15, 16384
s_cbranch_scc1 L_rec_c12w2
s_cmp_eq_u32 s15, 24576
s_cbranch_scc1 L_rec_c12w3
L_rec_c12w0:
ds_read_b64_tr_b16 v[96:97], v11 offset:0
ds_read_b64_tr_b16 v[98:99], v11 offset:512
ds_read_b64_tr_b16 v[100:101], v11 offset:8192
ds_read_b64_tr_b16 v[102:103], v11 offset:8704
ds_read_b64_tr_b16 v[112:113], v11 offset:16384
ds_read_b64_tr_b16 v[114:115], v11 offset:16896
ds_read_b64_tr_b16 v[116:117], v11 offset:24576
ds_read_b64_tr_b16 v[118:119], v11 offset:25088
ds_read_b64_tr_b16 v[104:105], v12 offset:0
ds_read_b64_tr_b16 v[106:107], v12 offset:512
ds_read_b64_tr_b16 v[108:109], v12 offset:8192
ds_read_b64_tr_b16 v[110:111], v12 offset:8704
ds_read_b64_tr_b16 v[248:249], v12 offset:16384
ds_read_b64_tr_b16 v[250:251], v12 offset:16896
ds_read_b64_tr_b16 v[252:253], v12 offset:24576
ds_read_b64_tr_b16 v[254:255], v12 offset:25088
s_waitcnt lgkmcnt(0)
s_branch L_rec_c12e
L_rec_c12w1:
ds_read_b64_tr_b16 v[232:233], v11 offset:0
ds_read_b64_tr_b16 v[234:235], v11 offset:512
ds_read_b64_tr_b16 v[236:237], v11 offset:8192
ds_read_b64_tr_b16 v[238:239], v11 offset:8704
ds_read_b64_tr_b16 v[240:241], v11 offset:16384
ds_read_b64_tr_b16 v[242:243], v11 offset:16896
ds_read_b64_tr_b16 v[244:245], v11 offset:24576
ds_read_b64_tr_b16 v[246:247], v11 offset:25088
ds_read_b64_tr_b16 a[32:33], v12 offset:0
ds_read_b64_tr_b16 a[34:35], v12 offset:512
ds_read_b64_tr_b16 a[36:37], v12 offset:8192
ds_read_b64_tr_b16 a[38:39], v12 offset:8704
ds_read_b64_tr_b16 a[40:41], v12 offset:16384
ds_read_b64_tr_b16 a[42:43], v12 offset:16896
ds_read_b64_tr_b16 a[44:45], v12 offset:24576
ds_read_b64_tr_b16 a[46:47], v12 offset:25088
s_waitcnt lgkmcnt(0)
s_branch L_rec_c12e
L_rec_c12w2:
ds_read_b64_tr_b16 v[216:217], v11 offset:0
ds_read_b64_tr_b16 v[218:219], v11 offset:512
ds_read_b64_tr_b16 v[220:221], v11 offset:8192
ds_read_b64_tr_b16 v[222:223], v11 offset:8704
ds_read_b64_tr_b16 v[224:225], v11 offset:16384
ds_read_b64_tr_b16 v[226:227], v11 offset:16896
ds_read_b64_tr_b16 v[228:229], v11 offset:24576
ds_read_b64_tr_b16 v[230:231], v11 offset:25088
ds_read_b64_tr_b16 a[16:17], v12 offset:0
ds_read_b64_tr_b16 a[18:19], v12 offset:512
ds_read_b64_tr_b16 a[20:21], v12 offset:8192
ds_read_b64_tr_b16 a[22:23], v12 offset:8704
ds_read_b64_tr_b16 a[24:25], v12 offset:16384
ds_read_b64_tr_b16 a[26:27], v12 offset:16896
ds_read_b64_tr_b16 a[28:29], v12 offset:24576
ds_read_b64_tr_b16 a[30:31], v12 offset:25088
s_waitcnt lgkmcnt(0)
s_branch L_rec_c12e
L_rec_c12w3:
ds_read_b64_tr_b16 v[200:201], v11 offset:0
ds_read_b64_tr_b16 v[202:203], v11 offset:512
ds_read_b64_tr_b16 v[204:205], v11 offset:8192
ds_read_b64_tr_b16 v[206:207], v11 offset:8704
ds_read_b64_tr_b16 v[208:209], v11 offset:16384
ds_read_b64_tr_b16 v[210:211], v11 offset:16896
ds_read_b64_tr_b16 v[212:213], v11 offset:24576
ds_read_b64_tr_b16 v[214:215], v11 offset:25088
ds_read_b64_tr_b16 a[0:1], v12 offset:0
ds_read_b64_tr_b16 a[2:3], v12 offset:512
ds_read_b64_tr_b16 a[4:5], v12 offset:8192
ds_read_b64_tr_b16 a[6:7], v12 offset:8704
ds_read_b64_tr_b16 a[8:9], v12 offset:16384
ds_read_b64_tr_b16 a[10:11], v12 offset:16896
ds_read_b64_tr_b16 a[12:13], v12 offset:24576
ds_read_b64_tr_b16 a[14:15], v12 offset:25088
s_waitcnt lgkmcnt(0)
L_rec_c12e:
s_waitcnt vmcnt(16)
s_barrier
v_add_u32 v11, 0x0, v8
v_xor_b32 v12, 32, v11
s_cmp_eq_u32 s15, 8192
s_cbranch_scc1 L_rec_c13w1
s_cmp_eq_u32 s15, 16384
s_cbranch_scc1 L_rec_c13w2
s_cmp_eq_u32 s15, 24576
s_cbranch_scc1 L_rec_c13w3
L_rec_c13w0:
ds_read_b64_tr_b16 v[200:201], v11 offset:32768
ds_read_b64_tr_b16 v[202:203], v11 offset:33280
ds_read_b64_tr_b16 v[204:205], v11 offset:40960
ds_read_b64_tr_b16 v[206:207], v11 offset:41472
ds_read_b64_tr_b16 v[208:209], v11 offset:49152
ds_read_b64_tr_b16 v[210:211], v11 offset:49664
ds_read_b64_tr_b16 v[212:213], v11 offset:57344
ds_read_b64_tr_b16 v[214:215], v11 offset:57856
ds_read_b64_tr_b16 a[0:1], v12 offset:32768
ds_read_b64_tr_b16 a[2:3], v12 offset:33280
ds_read_b64_tr_b16 a[4:5], v12 offset:40960
ds_read_b64_tr_b16 a[6:7], v12 offset:41472
ds_read_b64_tr_b16 a[8:9], v12 offset:49152
ds_read_b64_tr_b16 a[10:11], v12 offset:49664
ds_read_b64_tr_b16 a[12:13], v12 offset:57344
ds_read_b64_tr_b16 a[14:15], v12 offset:57856
s_waitcnt lgkmcnt(0)
s_branch L_rec_c13e
L_rec_c13w1:
ds_read_b64_tr_b16 v[96:97], v11 offset:32768
ds_read_b64_tr_b16 v[98:99], v11 offset:33280
ds_read_b64_tr_b16 v[100:101], v11 offset:40960
ds_read_b64_tr_b16 v[102:103], v11 offset:41472
ds_read_b64_tr_b16 v[112:113], v11 offset:49152
ds_read_b64_tr_b16 v[114:115], v11 offset:49664
ds_read_b64_tr_b16 v[116:117], v11 offset:57344
ds_read_b64_tr_b16 v[118:119], v11 offset:57856
ds_read_b64_tr_b16 v[104:105], v12 offset:32768
ds_read_b64_tr_b16 v[106:107], v12 offset:33280
ds_read_b64_tr_b16 v[108:109], v12 offset:40960
ds_read_b64_tr_b16 v[110:111], v12 offset:41472
ds_read_b64_tr_b16 v[248:249], v12 offset:49152
ds_read_b64_tr_b16 v[250:251], v12 offset:49664
ds_read_b64_tr_b16 v[252:253], v12 offset:57344
ds_read_b64_tr_b16 v[254:255], v12 offset:57856
s_waitcnt lgkmcnt(0)
s_branch L_rec_c13e
L_rec_c13w2:
ds_read_b64_tr_b16 v[232:233], v11 offset:32768
ds_read_b64_tr_b16 v[234:235], v11 offset:33280
ds_read_b64_tr_b16 v[236:237], v11 offset:40960
ds_read_b64_tr_b16 v[238:239], v11 offset:41472
ds_read_b64_tr_b16 v[240:241], v11 offset:49152
ds_read_b64_tr_b16 v[242:243], v11 offset:49664
ds_read_b64_tr_b16 v[244:245], v11 offset:57344
ds_read_b64_tr_b16 v[246:247], v11 offset:57856
ds_read_b64_tr_b16 a[32:33], v12 offset:32768
ds_read_b64_tr_b16 a[34:35], v12 offset:33280
ds_read_b64_tr_b16 a[36:37], v12 offset:40960
ds_read_b64_tr_b16 a[38:39], v12 offset:41472
ds_read_b64_tr_b16 a[40:41], v12 offset:49152
ds_read_b64_tr_b16 a[42:43], v12 offset:49664
ds_read_b64_tr_b16 a[44:45], v12 offset:57344
ds_read_b64_tr_b16 a[46:47], v12 offset:57856
s_waitcnt lgkmcnt(0)
s_branch L_rec_c13e
L_rec_c13w3:
ds_read_b64_tr_b16 v[216:217], v11 offset:32768
ds_read_b64_tr_b16 v[218:219], v11 offset:33280
ds_read_b64_tr_b16 v[220:221], v11 offset:40960
ds_read_b64_tr_b16 v[222:223], v11 offset:41472
ds_read_b64_tr_b16 v[224:225], v11 offset:49152
ds_read_b64_tr_b16 v[226:227], v11 offset:49664
ds_read_b64_tr_b16 v[228:229], v11 offset:57344
ds_read_b64_tr_b16 v[230:231], v11 offset:57856
ds_read_b64_tr_b16 a[16:17], v12 offset:32768
ds_read_b64_tr_b16 a[18:19], v12 offset:33280
ds_read_b64_tr_b16 a[20:21], v12 offset:40960
ds_read_b64_tr_b16 a[22:23], v12 offset:41472
ds_read_b64_tr_b16 a[24:25], v12 offset:49152
ds_read_b64_tr_b16 a[26:27], v12 offset:49664
ds_read_b64_tr_b16 a[28:29], v12 offset:57344
ds_read_b64_tr_b16 a[30:31], v12 offset:57856
s_waitcnt lgkmcnt(0)
L_rec_c13e:
s_waitcnt vmcnt(8)
s_barrier
v_add_u32 v11, 0x10000, v8
v_xor_b32 v12, 32, v11
s_cmp_eq_u32 s15, 8192
s_cbranch_scc1 L_rec_c14w1
s_cmp_eq_u32 s15, 16384
s_cbranch_scc1 L_rec_c14w2
s_cmp_eq_u32 s15, 24576
s_cbranch_scc1 L_rec_c14w3
L_rec_c14w0:
ds_read_b64_tr_b16 v[216:217], v11 offset:0
ds_read_b64_tr_b16 v[218:219], v11 offset:512
ds_read_b64_tr_b16 v[220:221], v11 offset:8192
ds_read_b64_tr_b16 v[222:223], v11 offset:8704
ds_read_b64_tr_b16 v[224:225], v11 offset:16384
ds_read_b64_tr_b16 v[226:227], v11 offset:16896
ds_read_b64_tr_b16 v[228:229], v11 offset:24576
ds_read_b64_tr_b16 v[230:231], v11 offset:25088
ds_read_b64_tr_b16 a[16:17], v12 offset:0
ds_read_b64_tr_b16 a[18:19], v12 offset:512
ds_read_b64_tr_b16 a[20:21], v12 offset:8192
ds_read_b64_tr_b16 a[22:23], v12 offset:8704
ds_read_b64_tr_b16 a[24:25], v12 offset:16384
ds_read_b64_tr_b16 a[26:27], v12 offset:16896
ds_read_b64_tr_b16 a[28:29], v12 offset:24576
ds_read_b64_tr_b16 a[30:31], v12 offset:25088
s_waitcnt lgkmcnt(0)
s_branch L_rec_c14e
L_rec_c14w1:
ds_read_b64_tr_b16 v[200:201], v11 offset:0
ds_read_b64_tr_b16 v[202:203], v11 offset:512
ds_read_b64_tr_b16 v[204:205], v11 offset:8192
ds_read_b64_tr_b16 v[206:207], v11 offset:8704
ds_read_b64_tr_b16 v[208:209], v11 offset:16384
ds_read_b64_tr_b16 v[210:211], v11 offset:16896
ds_read_b64_tr_b16 v[212:213], v11 offset:24576
ds_read_b64_tr_b16 v[214:215], v11 offset:25088
ds_read_b64_tr_b16 a[0:1], v12 offset:0
ds_read_b64_tr_b16 a[2:3], v12 offset:512
ds_read_b64_tr_b16 a[4:5], v12 offset:8192
ds_read_b64_tr_b16 a[6:7], v12 offset:8704
ds_read_b64_tr_b16 a[8:9], v12 offset:16384
ds_read_b64_tr_b16 a[10:11], v12 offset:16896
ds_read_b64_tr_b16 a[12:13], v12 offset:24576
ds_read_b64_tr_b16 a[14:15], v12 offset:25088
s_waitcnt lgkmcnt(0)
s_branch L_rec_c14e
L_rec_c14w2:
ds_read_b64_tr_b16 v[96:97], v11 offset:0
ds_read_b64_tr_b16 v[98:99], v11 offset:512
ds_read_b64_tr_b16 v[100:101], v11 offset:8192
ds_read_b64_tr_b16 v[102:103], v11 offset:8704
ds_read_b64_tr_b16 v[112:113], v11 offset:16384
ds_read_b64_tr_b16 v[114:115], v11 offset:16896
ds_read_b64_tr_b16 v[116:117], v11 offset:24576
ds_read_b64_tr_b16 v[118:119], v11 offset:25088
ds_read_b64_tr_b16 v[104:105], v12 offset:0
ds_read_b64_tr_b16 v[106:107], v12 offset:512
ds_read_b64_tr_b16 v[108:109], v12 offset:8192
ds_read_b64_tr_b16 v[110:111], v12 offset:8704
ds_read_b64_tr_b16 v[248:249], v12 offset:16384
ds_read_b64_tr_b16 v[250:251], v12 offset:16896
ds_read_b64_tr_b16 v[252:253], v12 offset:24576
ds_read_b64_tr_b16 v[254:255], v12 offset:25088
s_waitcnt lgkmcnt(0)
s_branch L_rec_c14e
L_rec_c14w3:
ds_read_b64_tr_b16 v[232:233], v11 offset:0
ds_read_b64_tr_b16 v[234:235], v11 offset:512
ds_read_b64_tr_b16 v[236:237], v11 offset:8192
ds_read_b64_tr_b16 v[238:239], v11 offset:8704
ds_read_b64_tr_b16 v[240:241], v11 offset:16384
ds_read_b64_tr_b16 v[242:243], v11 offset:16896
ds_read_b64_tr_b16 v[244:245], v11 offset:24576
ds_read_b64_tr_b16 v[246:247], v11 offset:25088
ds_read_b64_tr_b16 a[32:33], v12 offset:0
ds_read_b64_tr_b16 a[34:35], v12 offset:512
ds_read_b64_tr_b16 a[36:37], v12 offset:8192
ds_read_b64_tr_b16 a[38:39], v12 offset:8704
ds_read_b64_tr_b16 a[40:41], v12 offset:16384
ds_read_b64_tr_b16 a[42:43], v12 offset:16896
ds_read_b64_tr_b16 a[44:45], v12 offset:24576
ds_read_b64_tr_b16 a[46:47], v12 offset:25088
s_waitcnt lgkmcnt(0)
L_rec_c14e:
v_lshrrev_b32 v2, 2, v20
global_load_dword v17, v2, s[36:37] sc1
v_mov_b32 v2, 0
global_load_dwordx2 v[14:15], v2, s[28:29] sc1
ds_write_b128 v3, v[32:35] offset:40960
ds_write_b128 v3, v[36:39] offset:41984
ds_write_b128 v3, v[40:43] offset:49152
ds_write_b128 v3, v[44:47] offset:50176
ds_write_b128 v3, v[48:51] offset:57344
ds_write_b128 v3, v[52:55] offset:58368
s_waitcnt vmcnt(0)
s_barrier
v_add_u32 v11, 0x10000, v8
v_xor_b32 v12, 32, v11
s_cmp_eq_u32 s15, 8192
s_cbranch_scc1 L_rec_c15w1
s_cmp_eq_u32 s15, 16384
s_cbranch_scc1 L_rec_c15w2
s_cmp_eq_u32 s15, 24576
s_cbranch_scc1 L_rec_c15w3
L_rec_c15w0:
ds_read_b64_tr_b16 v[232:233], v11 offset:32768
ds_read_b64_tr_b16 v[234:235], v11 offset:33280
ds_read_b64_tr_b16 v[236:237], v11 offset:40960
ds_read_b64_tr_b16 v[238:239], v11 offset:41472
ds_read_b64_tr_b16 v[240:241], v11 offset:49152
ds_read_b64_tr_b16 v[242:243], v11 offset:49664
ds_read_b64_tr_b16 v[244:245], v11 offset:57344
ds_read_b64_tr_b16 v[246:247], v11 offset:57856
ds_read_b64_tr_b16 a[32:33], v12 offset:32768
ds_read_b64_tr_b16 a[34:35], v12 offset:33280
ds_read_b64_tr_b16 a[36:37], v12 offset:40960
ds_read_b64_tr_b16 a[38:39], v12 offset:41472
ds_read_b64_tr_b16 a[40:41], v12 offset:49152
ds_read_b64_tr_b16 a[42:43], v12 offset:49664
ds_read_b64_tr_b16 a[44:45], v12 offset:57344
ds_read_b64_tr_b16 a[46:47], v12 offset:57856
s_waitcnt lgkmcnt(0)
s_branch L_rec_c15e
L_rec_c15w1:
ds_read_b64_tr_b16 v[216:217], v11 offset:32768
ds_read_b64_tr_b16 v[218:219], v11 offset:33280
ds_read_b64_tr_b16 v[220:221], v11 offset:40960
ds_read_b64_tr_b16 v[222:223], v11 offset:41472
ds_read_b64_tr_b16 v[224:225], v11 offset:49152
ds_read_b64_tr_b16 v[226:227], v11 offset:49664
ds_read_b64_tr_b16 v[228:229], v11 offset:57344
ds_read_b64_tr_b16 v[230:231], v11 offset:57856
ds_read_b64_tr_b16 a[16:17], v12 offset:32768
ds_read_b64_tr_b16 a[18:19], v12 offset:33280
ds_read_b64_tr_b16 a[20:21], v12 offset:40960
ds_read_b64_tr_b16 a[22:23], v12 offset:41472
ds_read_b64_tr_b16 a[24:25], v12 offset:49152
ds_read_b64_tr_b16 a[26:27], v12 offset:49664
ds_read_b64_tr_b16 a[28:29], v12 offset:57344
ds_read_b64_tr_b16 a[30:31], v12 offset:57856
s_waitcnt lgkmcnt(0)
s_branch L_rec_c15e
L_rec_c15w2:
ds_read_b64_tr_b16 v[200:201], v11 offset:32768
ds_read_b64_tr_b16 v[202:203], v11 offset:33280
ds_read_b64_tr_b16 v[204:205], v11 offset:40960
ds_read_b64_tr_b16 v[206:207], v11 offset:41472
ds_read_b64_tr_b16 v[208:209], v11 offset:49152
ds_read_b64_tr_b16 v[210:211], v11 offset:49664
ds_read_b64_tr_b16 v[212:213], v11 offset:57344
ds_read_b64_tr_b16 v[214:215], v11 offset:57856
ds_read_b64_tr_b16 a[0:1], v12 offset:32768
ds_read_b64_tr_b16 a[2:3], v12 offset:33280
ds_read_b64_tr_b16 a[4:5], v12 offset:40960
ds_read_b64_tr_b16 a[6:7], v12 offset:41472
ds_read_b64_tr_b16 a[8:9], v12 offset:49152
ds_read_b64_tr_b16 a[10:11], v12 offset:49664
ds_read_b64_tr_b16 a[12:13], v12 offset:57344
ds_read_b64_tr_b16 a[14:15], v12 offset:57856
s_waitcnt lgkmcnt(0)
s_branch L_rec_c15e
L_rec_c15w3:
ds_read_b64_tr_b16 v[96:97], v11 offset:32768
ds_read_b64_tr_b16 v[98:99], v11 offset:33280
ds_read_b64_tr_b16 v[100:101], v11 offset:40960
ds_read_b64_tr_b16 v[102:103], v11 offset:41472
ds_read_b64_tr_b16 v[112:113], v11 offset:49152
ds_read_b64_tr_b16 v[114:115], v11 offset:49664
ds_read_b64_tr_b16 v[116:117], v11 offset:57344
ds_read_b64_tr_b16 v[118:119], v11 offset:57856
ds_read_b64_tr_b16 v[104:105], v12 offset:32768
ds_read_b64_tr_b16 v[106:107], v12 offset:33280
ds_read_b64_tr_b16 v[108:109], v12 offset:40960
ds_read_b64_tr_b16 v[110:111], v12 offset:41472
ds_read_b64_tr_b16 v[248:249], v12 offset:49152
ds_read_b64_tr_b16 v[250:251], v12 offset:49664
ds_read_b64_tr_b16 v[252:253], v12 offset:57344
ds_read_b64_tr_b16 v[254:255], v12 offset:57856
s_waitcnt lgkmcnt(0)
L_rec_c15e:
ds_write_b128 v4, v[56:59] offset:0
ds_write_b128 v4, v[60:63] offset:1024
ds_write_b128 v4, v[64:67] offset:8192
ds_write_b128 v4, v[68:71] offset:9216
ds_write_b128 v4, v[72:75] offset:16384
ds_write_b128 v4, v[76:79] offset:17408
ds_write_b128 v4, v[80:83] offset:24576
ds_write_b128 v4, v[84:87] offset:25600
s_barrier
v_cmp_ne_u32 vcc, 0x01010101, v16
v_cmp_eq_u32 s[46:47], 1, v17
v_readfirstlane_b32 s3, v14
v_readfirstlane_b32 s13, v15
s_cmp_lg_u64 vcc, 0
s_cbranch_scc1 L_rec_w
s_bitcmp1_b64 s[46:47], 0
s_cbranch_scc0 L_rec_w
s_cmp_ge_u32 s3, 32
s_cbranch_scc1 L_rec_go
L_rec_w:
v_and_b32 v2, 31, v0
v_lshlrev_b32 v2, 2, v2
L_rec_xn:
global_load_dword v14, v2, s[28:29] offset:128 sc1
s_waitcnt vmcnt(0)
v_cmp_ne_u32 vcc, 0x01010101, v14
s_cmp_eq_u64 vcc, 0
s_cbranch_scc1 L_rec_xn_ok
s_sleep 4
s_sub_u32 s41, s41, 1
s_cbranch_scc0 L_rec_xn
s_mov_b32 s41, 0
L_rec_xn_ok:
v_lshrrev_b32 v2, 2, v20
L_rec_kv0:
global_load_dword v14, v2, s[36:37] sc1
s_waitcnt vmcnt(0)
v_cmp_eq_u32 s[46:47], 1, v14
s_bitcmp1_b64 s[46:47], 0
s_cbranch_scc1 L_rec_kv0_ok
s_sleep 2
s_sub_u32 s41, s41, 1
s_cbranch_scc0 L_rec_kv0
s_mov_b32 s41, 0
L_rec_kv0_ok:
v_mov_b32 v2, 0
L_rec_tb:
global_load_dwordx2 v[14:15], v2, s[28:29] sc1
s_waitcnt vmcnt(0)
v_readfirstlane_b32 s3, v14
v_readfirstlane_b32 s13, v15
s_cmp_ge_u32 s3, 32
s_cbranch_scc1 L_rec_tb_ok
s_sleep 2
s_sub_u32 s41, s41, 1
s_cbranch_scc0 L_rec_tb
s_mov_b32 s41, 0
L_rec_tb_ok:
L_rec_go:
s_mov_b32 m0, s42
s_nop 0
global_load_lds_dwordx4 v20, s[30:31] sc1
global_load_lds_dwordx4 v20, s[30:31] offset:1024 sc1
s_add_u32 m0, s42, 16384
s_nop 0
global_load_lds_dwordx4 v20, s[32:33] sc1
global_load_lds_dwordx4 v20, s[32:33] offset:1024 sc1
s_add_u32 s30, s30, 786432
s_addc_u32 s31, s31, 0
s_add_u32 s32, s32, 786432
s_addc_u32 s33, s33, 0
s_xor_b32 s42, s42, 8192
ds_write_b128 v4, v[88:91] offset:32768
ds_write_b128 v4, v[92:95] offset:33792
ds_write_b128 v4, v[96:99] offset:40960
ds_write_b128 v4, v[100:103] offset:41984
ds_write_b128 v4, v[104:107] offset:49152
ds_write_b128 v4, v[108:111] offset:50176
ds_write_b128 v4, v[112:115] offset:57344
ds_write_b128 v4, v[116:119] offset:58368
v_and_b32 v2, 1, v0
v_lshlrev_b32 v2, 4, v2
v_mov_b32 v14, 0x3f80
v_lshlrev_b32 v14, v2, v14
v_bfe_u32 v2, v0, 2, 2
v_cmp_eq_u32 vcc, 0, v2
s_nop 1
v_cndmask_b32 v6, 0, v14, vcc
v_cmp_eq_u32 vcc, 1, v2
s_nop 1
v_cndmask_b32 v7, 0, v14, vcc
v_cmp_eq_u32 vcc, 2, v2
s_nop 1
v_cndmask_b32 v8, 0, v14, vcc
v_cmp_eq_u32 vcc, 3, v2
s_nop 1
v_cndmask_b32 v9, 0, v14, vcc
ds_write_b128 v20, v[6:9] offset:39936
v_mov_b32 v2, 0
v_lshrrev_b32 v14, 2, v20
ds_write_b32 v14, v2 offset:37632
s_waitcnt lgkmcnt(0)
v_mov_b32 v6, 0x3f803f80
v_mov_b32 v7, 0x3f803f80
v_mov_b32 v8, 0x3f803f80
v_mov_b32 v9, 0x3f803f80
v_mov_b32 v16, 0
v_mov_b32 v17, 0
v_mov_b32 v19, 0
v_mov_b32 v10, 0
v_mov_b32 v11, 0
v_mov_b32 v12, 0
v_mov_b32 v13, 0
v_mov_b32 v14, 0
v_mov_b32 v15, 0
v_mov_b32 v0, v20
v_xor_b32 v25, 0x2000, v25
s_mov_b32 s18, 4
s_mov_b32 s19, 4
s_bcnt1_i32_b32 s13, s13
s_cmp_eq_u32 s13, 1
s_cbranch_scc0 L_rec_slow
s_cmp_eq_u32 s14, 1
s_cbranch_scc1 L_rec_f1
s_cmp_eq_u32 s14, 2
s_cbranch_scc1 L_rec_f2
s_cmp_eq_u32 s14, 3
s_cbranch_scc1 L_rec_f3
L_rec_f0:
v_mov_b32 v2, -1
v_xor_b32 v3, 0x6000, v25
global_store_dword v25, v2, s[4:5]
global_store_dword v3, v2, s[4:5]
ds_read_b128 v[40:43], v20 offset:57344
ds_read_b128 v[44:47], v20 offset:58368
ds_read_b128 v[48:51], v21 offset:0
ds_read_b128 v[52:55], v21 offset:1024
ds_read_b128 v[56:59], v21 offset:8192
ds_read_b128 v[60:63], v21 offset:9216
ds_read_b128 v[88:91], v21 offset:16384
ds_read_b128 v[92:95], v21 offset:17408
ds_read_b128 v[96:99], v21 offset:40960
ds_read_b128 v[100:103], v21 offset:41984
ds_read_b128 v[104:107], v21 offset:49152
ds_read_b128 v[108:111], v21 offset:50176
ds_read_b128 v[112:115], v21 offset:57344
ds_read_b128 v[116:119], v21 offset:58368
v_mov_b64 v[64:65], 0
v_mov_b64 v[66:67], 0
v_mov_b64 v[68:69], 0
v_mov_b64 v[70:71], 0
v_mov_b64 v[80:81], 0
v_mov_b64 v[82:83], 0
v_mov_b64 v[84:85], 0
v_mov_b64 v[86:87], 0
L_rec_f0_top:
v_mov_b64 v[76:77], 0
v_mov_b64 v[78:79], 0
v_mov_b64 v[72:73], 0
v_mov_b64 v[74:75], 0
s_mov_b32 m0, s42
s_add_u32 s3, s40, 1
v_and_b32 v5, 0x1fff, v25
v_lshrrev_b32 v4, 2, v20
s_bitcmp1_b64 s[46:47], s3
s_cbranch_scc0 L_rec_f0_kv
L_rec_f0_kv_ok:
s_nop 15
s_nop 1
global_load_dwordx4 v[32:35], v26, s[4:5] sc1
global_load_dwordx4 v[36:39], v26, s[4:5] offset:1024 sc1
s_nop 15
s_nop 13
global_load_dwordx4 v[32:35], v26, s[4:5] sc1
global_load_dwordx4 v[36:39], v26, s[4:5] offset:1024 sc1
s_waitcnt vmcnt(2) lgkmcnt(0)
L_rec_f0_b1:
v_max3_u32 v2, v32, v33, v34
v_max3_u32 v3, v35, v36, v37
v_max3_u32 v2, v2, v38, v39
v_max_u32 v2, v2, v3
v_cmp_le_u32 vcc, s59, v2
v_smfmac_f32_16x16x64_bf16 v[64:67], v[32:35], v[40:47], v1
ds_write_b64 v20, v[32:33] offset:24576
s_cbranch_vccnz L_rec_f0_b0
L_rec_f0_b0_ok:
v_smfmac_f32_16x16x64_bf16 v[68:71], v[32:35], v[48:55], v1
ds_write_b64 v20, v[34:35] offset:24584
v_smfmac_f32_16x16x64_bf16 v[64:67], v[36:39], v[56:63], v1
ds_write_b64 v20, v[36:37] offset:25600
v_smfmac_f32_16x16x64_bf16 v[68:71], v[36:39], v[88:95], v1
ds_write_b64 v20, v[38:39] offset:25608
v_smfmac_f32_16x16x64_bf16 v[72:75], v[32:35], v[96:103], v1
ds_read_b128 v[88:91], v21 offset:24576
ds_read_b128 v[92:95], v21 offset:25600
v_smfmac_f32_16x16x64_bf16 v[76:79], v[32:35], v[104:111], v1
ds_read_b128 v[96:99], v21 offset:32768
ds_read_b128 v[100:103], v21 offset:33792
v_smfmac_f32_16x16x64_bf16 v[72:75], v[36:39], v[112:119], v1
v_smfmac_f32_16x16x64_bf16 v[76:79], v[36:39], v[248:255], v1
v_smfmac_f32_16x16x64_bf16 v[80:83], v[32:35], a[48:55], v1
s_waitcnt lgkmcnt(4)
s_barrier
ds_read_b128 v[40:43], v20 offset:26624
v_smfmac_f32_16x16x64_bf16 v[84:87], v[32:35], a[112:119], v1
ds_read_b128 v[44:47], v20 offset:27648
ds_read_b128 v[48:51], v20 offset:28672
v_smfmac_f32_16x16x64_bf16 v[80:83], v[36:39], a[56:63], v1
ds_read_b128 v[52:55], v20 offset:29696
ds_read_b128 v[56:59], v20 offset:30720
v_smfmac_f32_16x16x64_bf16 v[84:87], v[36:39], a[120:127], v1
s_waitcnt lgkmcnt(4)
s_waitcnt vmcnt(0)
ds_read_b128 v[60:63], v20 offset:31744
global_load_lds_dwordx4 v20, s[30:31] offset:0 sc1
v_smfmac_f32_16x16x64_bf16 v[64:67], v[40:43], v[88:95], v1
global_load_lds_dwordx4 v20, s[30:31] offset:1024 sc1
global_store_dword v5, v18, s[34:35] sc1
v_smfmac_f32_16x16x64_bf16 v[68:71], v[40:43], v[96:103], v1
s_waitcnt lgkmcnt(4)
ds_read_b128 v[32:35], v20 offset:16384
ds_read_b128 v[36:39], v20 offset:17408
v_smfmac_f32_16x16x64_bf16 v[64:67], v[44:47], v[120:127], v1
s_mov_b32 m0, 37632
v_smfmac_f32_16x16x64_bf16 v[68:71], v[44:47], v[160:167], v1
s_waitcnt lgkmcnt(5)
global_load_lds_dword v4, s[36:37] sc1
v_smfmac_f32_16x16x64_bf16 v[64:67], v[48:51], v[128:135], v1
s_mov_b32 m0, 16384
v_smfmac_f32_16x16x64_bf16 v[68:71], v[48:51], v[168:175], v1
s_waitcnt lgkmcnt(4)
s_waitcnt lgkmcnt(0)
global_load_lds_dwordx4 v20, s[32:33] offset:0 sc1
v_smfmac_f32_16x16x64_bf16 v[64:67], v[52:55], v[136:143], v1
global_load_lds_dwordx4 v20, s[32:33] offset:1024 sc1
v_mov_b64 v[2:3], -1
v_smfmac_f32_16x16x64_bf16 v[68:71], v[52:55], v[176:183], v1
v_mov_b64 v[4:5], -1
v_smfmac_f32_16x16x64_bf16 v[64:67], v[56:59], v[144:151], v1
ds_read_b128 v[104:107], v0 offset:0
v_smfmac_f32_16x16x64_bf16 v[68:71], v[56:59], v[184:191], v1
ds_read_b128 v[108:111], v0 offset:1024
v_smfmac_f32_16x16x64_bf16 v[64:67], v[60:63], v[152:159], v1
ds_read_b128 v[112:115], v0 offset:2048
v_smfmac_f32_16x16x64_bf16 v[68:71], v[60:63], v[192:199], v1
ds_read_b128 v[116:119], v0 offset:3072
v_smfmac_f32_16x16x64_bf16 v[72:75], v[40:43], v[200:207], v1
v_add_f32 v64, v64, v66
v_smfmac_f32_16x16x64_bf16 v[76:79], v[40:43], a[0:7], v1
v_add_f32 v68, v68, v70
v_smfmac_f32_16x16x64_bf16 v[72:75], v[44:47], v[208:215], v1
v_cvt_pk_bf16_f32 v66, v64, v68
v_smfmac_f32_16x16x64_bf16 v[76:79], v[44:47], a[8:15], v1
ds_write_b32 v27, v66
v_add_f32 v65, v65, v67
v_smfmac_f32_16x16x64_bf16 v[72:75], v[48:51], v[216:223], v1
v_add_f32 v69, v69, v71
v_smfmac_f32_16x16x64_bf16 v[76:79], v[48:51], a[16:23], v1
v_cvt_pk_bf16_f32 v67, v65, v69
v_smfmac_f32_16x16x64_bf16 v[72:75], v[52:55], v[224:231], v1
ds_write_b32 v27, v67 offset:288
v_xor_b32 v16, 0x4000, v25
v_smfmac_f32_16x16x64_bf16 v[76:79], v[52:55], a[24:31], v1
global_store_dword v16, v2, s[4:5]
v_smfmac_f32_16x16x64_bf16 v[72:75], v[56:59], v[232:239], v1
v_smfmac_f32_16x16x64_bf16 v[76:79], v[56:59], a[32:39], v1
v_smfmac_f32_16x16x64_bf16 v[72:75], v[60:63], v[240:247], v1
s_waitcnt lgkmcnt(0)
s_barrier
ds_read_b128 v[88:91], v28 offset:0
v_smfmac_f32_16x16x64_bf16 v[76:79], v[60:63], a[40:47], v1
ds_read_b128 v[92:95], v28 offset:64
ds_read_b128 v[96:99], v28 offset:128
v_smfmac_f32_16x16x64_bf16 v[80:83], v[40:43], a[64:71], v1
ds_read_b128 v[100:103], v28 offset:192
v_add_f32 v72, v72, v74
v_smfmac_f32_16x16x64_bf16 v[84:87], v[40:43], a[128:135], v1
v_add_f32 v76, v76, v78
v_smfmac_f32_16x16x64_bf16 v[80:83], v[44:47], a[72:79], v1
v_cvt_pk_bf16_f32 v74, v72, v76
v_smfmac_f32_16x16x64_bf16 v[84:87], v[44:47], a[136:143], v1
s_waitcnt lgkmcnt(3)
ds_write_b32 v27, v74 offset:576
v_add_f32 v73, v73, v75
v_mfma_f32_16x16x32_bf16 v[64:67], v[104:107], v[88:91], 0
v_add_f32 v77, v77, v79
v_cvt_pk_bf16_f32 v75, v73, v77
v_smfmac_f32_16x16x64_bf16 v[80:83], v[48:51], a[80:87], v1
s_waitcnt lgkmcnt(3)
ds_write_b32 v27, v75 offset:864
ds_read_b128 v[104:107], v0 offset:4096
v_mfma_f32_16x16x32_bf16 v[64:67], v[108:111], v[92:95], v[64:67]
v_mov_b64 v[40:41], 0
v_mov_b64 v[42:43], 0
v_smfmac_f32_16x16x64_bf16 v[84:87], v[48:51], a[144:151], v1
s_waitcnt lgkmcnt(4)
ds_read_b128 v[108:111], v0 offset:5120
v_mov_b64 v[44:45], 0
v_mfma_f32_16x16x32_bf16 v[64:67], v[112:115], v[96:99], v[64:67]
v_mov_b64 v[46:47], 0
v_smfmac_f32_16x16x64_bf16 v[80:83], v[52:55], a[88:95], v1
s_waitcnt lgkmcnt(4)
ds_read_b128 v[112:115], v0 offset:6144
v_mfma_f32_16x16x32_bf16 v[64:67], v[116:119], v[100:103], v[64:67]
v_smfmac_f32_16x16x64_bf16 v[84:87], v[52:55], a[152:159], v1
s_waitcnt lgkmcnt(2)
ds_read_b128 v[116:119], v0 offset:7168
v_mfma_f32_16x16x32_bf16 v[68:71], v[104:107], v[88:91], 0
s_barrier
v_exp_f32 v64, v64
v_smfmac_f32_16x16x64_bf16 v[80:83], v[56:59], a[96:103], v1
s_waitcnt lgkmcnt(2)
ds_read_b128 v[104:107], v28 offset:576
v_mov_b64 v[48:49], 0
v_mfma_f32_16x16x32_bf16 v[68:71], v[108:111], v[92:95], v[68:71]
v_exp_f32 v65, v65
v_smfmac_f32_16x16x64_bf16 v[84:87], v[56:59], a[160:167], v1
s_waitcnt lgkmcnt(2)
ds_read_b128 v[108:111], v28 offset:640
v_cvt_pk_bf16_f32 v72, v64, v65
v_mfma_f32_16x16x32_bf16 v[68:71], v[112:115], v[96:99], v[68:71]
v_exp_f32 v66, v66
v_smfmac_f32_16x16x64_bf16 v[80:83], v[60:63], a[104:111], v1
s_waitcnt lgkmcnt(2)
ds_read_b128 v[112:115], v28 offset:704
v_mov_b64 v[50:51], 0
v_mfma_f32_16x16x32_bf16 v[68:71], v[116:119], v[100:103], v[68:71]
v_exp_f32 v67, v67
v_smfmac_f32_16x16x64_bf16 v[84:87], v[60:63], a[168:175], v1
s_waitcnt lgkmcnt(2)
ds_read_b128 v[116:119], v28 offset:768
v_cvt_pk_bf16_f32 v73, v66, v67
v_mfma_f32_16x16x32_bf16 v[76:79], v[104:107], v[88:91], 0
s_waitcnt lgkmcnt(2)
v_exp_f32 v68, v68
v_mfma_f32_16x16x32_bf16 v[76:79], v[108:111], v[92:95], v[76:79]
s_waitcnt lgkmcnt(1)
v_exp_f32 v69, v69
v_mfma_f32_16x16x32_bf16 v[76:79], v[112:115], v[96:99], v[76:79]
s_waitcnt lgkmcnt(0)
v_exp_f32 v70, v70
v_mfma_f32_16x16x32_bf16 v[76:79], v[116:119], v[100:103], v[76:79]
v_exp_f32 v71, v71
v_cvt_pk_bf16_f32 v74, v68, v69
v_cvt_pk_bf16_f32 v75, v70, v71
v_add_f32 v80, v80, v82
v_add_f32 v81, v81, v83
v_mfma_f32_16x16x32_bf16 v[88:91], v[72:75], v[6:9], 0
ds_read_b128 v[112:115], v20 offset:40960
v_mul_f32 v76, s38, v76
v_mul_f32 v77, s38, v77
v_mfma_f32_16x16x32_bf16 v[92:95], v[72:75], v[32:35], 0
v_exp_f32 v78, v76
v_add_f32 v84, v84, v86
v_mfma_f32_16x16x32_bf16 v[96:99], v[72:75], v[36:39], 0
v_exp_f32 v79, v77
v_add_f32 v85, v85, v87
v_cvt_pk_bf16_f32 v12, v78, v79
v_cvt_pk_bf16_f32 v16, v80, v81
v_cvt_pk_bf16_f32 v18, v84, v85
v_mfma_f32_16x16x32_bf16 v[88:91], v[12:15], v[6:9], v[88:91]
ds_read_b128 v[116:119], v20 offset:41984
v_mov_b64 v[52:53], 0
v_mfma_f32_16x16x32_bf16 v[92:95], v[12:15], v[16:19], v[92:95]
ds_read_b128 v[80:83], v20 offset:49152
v_mov_b64 v[54:55], 0
v_mfma_f32_16x16x32_bf16 v[96:99], v[10:13], v[16:19], v[96:99]
ds_read_b128 v[84:87], v20 offset:50176
v_rcp_f32 v90, v88
v_rcp_f32 v91, v89
v_mul_f32 v92, v92, v90
v_mul_f32 v93, v93, v91
s_nop 0
v_mul_f32 v96, v96, v90
v_mul_f32 v97, v97, v91
v_cvt_pk_bf16_f32 v100, v92, v96
v_cvt_pk_bf16_f32 v101, v93, v97
ds_write2_b32 v29, v100, v101 offset0:0 offset1:80
v_max3_f32 v102, v88, v89, v90
v_max_f32 v102, v102, v91
v_cmp_nge_f32 vcc, s39, v102
global_store_dwordx4 v24, v[2:5], s[4:5]
global_store_dwordx4 v24, v[2:5], s[4:5] offset:1024
s_cbranch_vccnz L_rec_f0_slow
L_rec_f0_join:
s_waitcnt lgkmcnt(0)
s_barrier
ds_read_b128 v[104:107], v30 offset:24576
ds_read_b128 v[108:111], v30 offset:24704
v_mov_b64 v[32:33], 0
v_mov_b64 v[34:35], 0
v_mov_b64 v[36:37], 0
v_mov_b64 v[38:39], 0
v_mov_b64 v[56:57], 0
v_mov_b64 v[58:59], 0
v_xor_b32 v24, 0x40000, v24
s_waitcnt lgkmcnt(1)
v_smfmac_f32_16x16x64_bf16 v[32:35], v[104:107], a[176:183], v1
s_waitcnt lgkmcnt(0)
ds_read_b128 v[88:91], v22 offset:0
v_mov_b64 v[60:61], 0
v_smfmac_f32_16x16x64_bf16 v[32:35], v[108:111], a[184:191], v1
ds_read_b128 v[92:95], v22 offset:1024
v_mov_b64 v[62:63], 0
v_smfmac_f32_16x16x64_bf16 v[36:39], v[104:107], v[112:119], v1
ds_read_b128 v[96:99], v22 offset:8192
v_smfmac_f32_16x16x64_bf16 v[36:39], v[108:111], v[80:87], v1
ds_read_b128 v[100:103], v22 offset:9216
v_add_f32 v32, v32, v34
v_smfmac_f32_16x16x64_bf16 v[40:43], v[104:107], a[192:199], v1
ds_read_b128 v[112:115], v22 offset:16384
v_add_f32 v33, v33, v35
v_smfmac_f32_16x16x64_bf16 v[40:43], v[108:111], a[200:207], v1
ds_read_b128 v[116:119], v22 offset:17408
v_add_f32 v36, v36, v38
v_add_f32 v37, v37, v39
v_smfmac_f32_16x16x64_bf16 v[44:47], v[104:107], a[208:215], v1
s_waitcnt lgkmcnt(4)
ds_read_b128 v[80:83], v22 offset:24576
v_cvt_pk_bf16_f32 v64, v32, v36
v_cvt_pk_bf16_f32 v65, v33, v37
v_smfmac_f32_16x16x64_bf16 v[44:47], v[108:111], v[88:95], v1
s_waitcnt lgkmcnt(3)
global_store_dwordx2 v23, v[64:65], s[20:21]
v_add_f32 v40, v40, v42
v_smfmac_f32_16x16x64_bf16 v[48:51], v[104:107], v[96:103], v1
ds_read_b128 v[84:87], v22 offset:25600
v_add_f32 v41, v41, v43
v_smfmac_f32_16x16x64_bf16 v[48:51], v[108:111], a[216:223], v1
ds_read_b128 v[72:75], v20 offset:39936
v_add_f32 v44, v44, v46
v_add_f32 v45, v45, v47
v_smfmac_f32_16x16x64_bf16 v[52:55], v[104:107], a[224:231], v1
v_cvt_pk_bf16_f32 v66, v40, v44
v_cvt_pk_bf16_f32 v67, v41, v45
v_smfmac_f32_16x16x64_bf16 v[52:55], v[108:111], a[232:239], v1
s_waitcnt lgkmcnt(3)
global_store_dwordx2 v23, v[66:67], s[22:23]
v_add_f32 v48, v48, v50
v_smfmac_f32_16x16x64_bf16 v[56:59], v[104:107], v[112:119], v1
s_waitcnt lgkmcnt(1)
v_add_f32 v49, v49, v51
v_smfmac_f32_16x16x64_bf16 v[56:59], v[108:111], v[80:87], v1
v_add_f32 v52, v52, v54
v_add_f32 v53, v53, v55
v_smfmac_f32_16x16x64_bf16 v[60:63], v[104:107], a[240:247], v1
v_cvt_pk_bf16_f32 v68, v48, v52
v_cvt_pk_bf16_f32 v69, v49, v53
v_smfmac_f32_16x16x64_bf16 v[60:63], v[108:111], a[248:255], v1
global_store_dwordx2 v23, v[68:69], s[24:25]
v_add_f32 v56, v56, v58
v_add_f32 v57, v57, v59
s_nop 4
v_pk_add_f32 v[60:61], v[60:61], v[62:63]
v_cvt_pk_bf16_f32 v70, v56, v60
v_cvt_pk_bf16_f32 v71, v57, v61
global_store_dwordx2 v23, v[70:71], s[26:27]
s_waitcnt lgkmcnt(0)
ds_read_b128 v[40:43], v20 offset:57344
ds_read_b128 v[44:47], v20 offset:58368
ds_read_b128 v[48:51], v21 offset:0
ds_read_b128 v[52:55], v21 offset:1024
ds_read_b128 v[56:59], v21 offset:8192
ds_read_b128 v[60:63], v21 offset:9216
ds_read_b128 v[88:91], v21 offset:16384
ds_read_b128 v[92:95], v21 offset:17408
ds_read_b128 v[96:99], v21 offset:40960
ds_read_b128 v[100:103], v21 offset:41984
ds_read_b128 v[104:107], v21 offset:49152
ds_read_b128 v[108:111], v21 offset:50176
ds_read_b128 v[112:115], v21 offset:57344
ds_read_b128 v[116:119], v21 offset:58368
global_load_dwordx4 v[32:35], v24, s[4:5] sc1
global_load_dwordx4 v[36:39], v24, s[4:5] offset:1024 sc1
v_mov_b64 v[64:65], 0
v_mov_b64 v[66:67], 0
v_mov_b64 v[68:69], 0
v_mov_b64 v[70:71], 0
v_mov_b64 v[80:81], 0
v_mov_b64 v[82:83], 0
v_mov_b64 v[84:85], 0
v_mov_b64 v[86:87], 0
s_add_u32 s30, s30, 786432
s_addc_u32 s31, s31, 0
s_add_u32 s32, s32, 786432
s_addc_u32 s33, s33, 0
s_add_u32 s34, s34, 8192
s_addc_u32 s35, s35, 0
s_add_u32 s40, s40, 1
s_xor_b32 s42, s42, 8192
v_add_u32 v2, 0x2000, v26
v_bfi_b32 v26, s43, v2, v26
v_xor_b32 v23, 0x40000, v23
v_xor_b32 v0, 8192, v0
s_nop 9
global_load_dwordx4 v[32:35], v24, s[4:5] sc1
global_load_dwordx4 v[36:39], v24, s[4:5] offset:1024 sc1
s_mov_b32 s3, 64
v_add_u32 v4, 0x2000, v25
s_waitcnt vmcnt(2)
L_rec_f0_a:
v_mfma_f32_16x16x32_bf16 v[76:79], v[72:75], v[32:35], 0
v_mfma_f32_16x16x32_bf16 v[76:79], v[72:75], v[36:39], v[76:79]
s_nop 7
v_add_f32_dpp v76, v76, v76 row_ror:4 row_mask:0xf bank_mask:0xf
v_add_f32_dpp v77, v77, v77 row_ror:4 row_mask:0xf bank_mask:0xf
v_cmp_u_f32 vcc, v78, v79
v_add_f32_dpp v76, v76, v76 row_ror:8 row_mask:0xf bank_mask:0xf
v_add_f32_dpp v77, v77, v77 row_ror:8 row_mask:0xf bank_mask:0xf
v_cvt_pk_bf16_f32 v18, v76, v77
s_mov_b64 exec, s[44:45]
global_store_dword v25, v18, s[4:5]
s_mov_b64 exec, -1
s_cbranch_vccnz L_rec_f0_a_fail
L_rec_f0_a_ok:
v_bfi_b32 v25, s43, v4, v25
s_cmp_lt_u32 s40, 63
s_cbranch_scc1 L_rec_f0_top
v_and_b32 v5, 0x1fff, v25
global_store_dword v5, v18, s[34:35] sc1
s_branch L_rec_done
L_rec_f0_kv:
ds_read_b32 v3, v4 offset:37632
s_waitcnt lgkmcnt(0)
L_rec_f0_kv2:
v_cmp_eq_u32 s[46:47], 1, v3
s_bitcmp1_b64 s[46:47], s3
s_cbranch_scc1 L_rec_f0_kv_ok
global_load_dword v3, v4, s[36:37] sc1
s_waitcnt vmcnt(0)
s_sub_u32 s41, s41, 1
s_cbranch_scc0 L_rec_f0_kv2
s_mov_b32 s41, 0
s_branch L_rec_f0_kv_ok
L_rec_f0_b0:
global_load_dwordx4 v[32:35], v26, s[4:5] sc1
global_load_dwordx4 v[36:39], v26, s[4:5] offset:1024 sc1
s_mov_b32 s18, 0
s_sub_u32 s41, s41, 1
s_cbranch_scc1 L_rec_f0_b0_dead
s_nop 1
v_mov_b64 v[64:65], 0
v_mov_b64 v[66:67], 0
s_waitcnt vmcnt(2)
s_branch L_rec_f0_b1
L_rec_f0_b0_dead:
s_mov_b32 s41, 0
s_branch L_rec_f0_b0_ok
L_rec_f0_slow:
s_waitcnt lgkmcnt(0)
ds_read_b128 v[88:91], v28 offset:0
ds_read_b128 v[92:95], v28 offset:64
ds_read_b128 v[96:99], v28 offset:128
ds_read_b128 v[100:103], v28 offset:192
ds_read_b128 v[104:107], v0 offset:0
ds_read_b128 v[108:111], v0 offset:1024
ds_read_b128 v[112:115], v0 offset:2048
ds_read_b128 v[116:119], v0 offset:3072
s_waitcnt lgkmcnt(0)
v_mfma_f32_16x16x32_bf16 v[64:67], v[104:107], v[88:91], 0
v_mfma_f32_16x16x32_bf16 v[64:67], v[108:111], v[92:95], v[64:67]
v_mfma_f32_16x16x32_bf16 v[64:67], v[112:115], v[96:99], v[64:67]
v_mfma_f32_16x16x32_bf16 v[64:67], v[116:119], v[100:103], v[64:67]
ds_read_b128 v[104:107], v0 offset:4096
ds_read_b128 v[108:111], v0 offset:5120
ds_read_b128 v[112:115], v0 offset:6144
ds_read_b128 v[116:119], v0 offset:7168
s_waitcnt lgkmcnt(0)
v_mfma_f32_16x16x32_bf16 v[68:71], v[104:107], v[88:91], 0
v_mfma_f32_16x16x32_bf16 v[68:71], v[108:111], v[92:95], v[68:71]
v_mfma_f32_16x16x32_bf16 v[68:71], v[112:115], v[96:99], v[68:71]
v_mfma_f32_16x16x32_bf16 v[68:71], v[116:119], v[100:103], v[68:71]
s_nop 7
v_max3_f32 v2, v64, v65, v66
v_max3_f32 v3, v67, v68, v69
v_max3_f32 v2, v2, v70, v71
v_max3_f32 v3, v3, v76, v77
v_max_f32 v2, v2, v3
v_mov_b32 v3, v2
s_nop 1
v_permlane32_swap_b32 v2, v3
v_max_f32 v2, v2, v3
v_mov_b32 v3, v2
s_nop 1
v_permlane16_swap_b32 v2, v3
v_max_f32 v2, v2, v3
v_sub_f32 v64, v64, v2
v_sub_f32 v65, v65, v2
v_sub_f32 v66, v66, v2
v_sub_f32 v67, v67, v2
v_sub_f32 v68, v68, v2
v_sub_f32 v69, v69, v2
v_sub_f32 v70, v70, v2
v_sub_f32 v71, v71, v2
v_sub_f32 v76, v76, v2
v_sub_f32 v77, v77, v2
v_exp_f32 v64, v64
v_exp_f32 v65, v65
v_exp_f32 v66, v66
v_exp_f32 v67, v67
v_exp_f32 v68, v68
v_exp_f32 v69, v69
v_exp_f32 v70, v70
v_exp_f32 v71, v71
v_exp_f32 v76, v76
v_exp_f32 v77, v77
v_cvt_pk_bf16_f32 v72, v64, v65
v_cvt_pk_bf16_f32 v73, v66, v67
v_cvt_pk_bf16_f32 v74, v68, v69
v_cvt_pk_bf16_f32 v75, v70, v71
v_cvt_pk_bf16_f32 v12, v76, v77
s_nop 0
v_mfma_f32_16x16x32_bf16 v[88:91], v[72:75], v[6:9], 0
v_mfma_f32_16x16x32_bf16 v[92:95], v[72:75], v[32:35], 0
v_mfma_f32_16x16x32_bf16 v[96:99], v[72:75], v[36:39], 0
v_mfma_f32_16x16x32_bf16 v[88:91], v[12:15], v[6:9], v[88:91]
v_mfma_f32_16x16x32_bf16 v[92:95], v[12:15], v[16:19], v[92:95]
v_mfma_f32_16x16x32_bf16 v[96:99], v[10:13], v[16:19], v[96:99]
s_nop 7
v_rcp_f32 v90, v88
v_rcp_f32 v91, v89
v_mul_f32 v92, v92, v90
v_mul_f32 v93, v93, v91
v_mul_f32 v96, v96, v90
v_mul_f32 v97, v97, v91
v_cvt_pk_bf16_f32 v100, v92, v96
v_cvt_pk_bf16_f32 v101, v93, v97
ds_write2_b32 v29, v100, v101 offset0:0 offset1:80
v_mov_b64 v[2:3], -1
ds_read_b128 v[112:115], v20 offset:40960
ds_read_b128 v[116:119], v20 offset:41984
s_branch L_rec_f0_join
L_rec_f0_a_fail:
s_cmp_gt_u32 s3, 60
s_cbranch_scc1 L_rec_f0_a_f2
s_sleep 6
L_rec_f0_a_f2:
global_load_dwordx4 v[32:35], v24, s[4:5] sc1
global_load_dwordx4 v[36:39], v24, s[4:5] offset:1024 sc1
s_mov_b32 s19, 0
s_sub_u32 s3, s3, 1
s_cbranch_scc1 L_rec_f0_a_chk
s_waitcnt vmcnt(3)
s_branch L_rec_f0_a
L_rec_f0_a_chk:
s_mov_b32 s3, 60
s_waitcnt vmcnt(0)
s_sub_u32 s41, s41, 64
s_cbranch_scc1 L_rec_f0_a_dead
v_max3_u32 v2, v32, v33, v34
v_max3_u32 v3, v35, v36, v37
v_max3_u32 v2, v2, v38, v39
v_max_u32 v2, v2, v3
v_cmp_eq_u32 vcc, -1, v2
s_cbranch_vccnz L_rec_f0_a_fail
s_branch L_rec_f0_a_now
L_rec_f0_a_dead:
s_mov_b32 s41, 0
L_rec_f0_a_now:
v_mfma_f32_16x16x32_bf16 v[76:79], v[72:75], v[32:35], 0
v_mfma_f32_16x16x32_bf16 v[76:79], v[72:75], v[36:39], v[76:79]
s_nop 7
v_add_f32_dpp v76, v76, v76 row_ror:4 row_mask:0xf bank_mask:0xf
v_add_f32_dpp v77, v77, v77 row_ror:4 row_mask:0xf bank_mask:0xf
v_cmp_u_f32 vcc, v78, v79
v_add_f32_dpp v76, v76, v76 row_ror:8 row_mask:0xf bank_mask:0xf
v_add_f32_dpp v77, v77, v77 row_ror:8 row_mask:0xf bank_mask:0xf
v_cvt_pk_bf16_f32 v18, v76, v77
v_cmp_u_f32 vcc, v76, v77
v_and_b32 v2, 0x7fff7fff, v18
s_nop 0
v_cndmask_b32 v18, v18, v2, vcc
s_mov_b64 exec, s[44:45]
global_store_dword v25, v18, s[4:5]
s_mov_b64 exec, -1
s_branch L_rec_f0_a_ok
L_rec_f1:
v_mov_b32 v2, -1
v_xor_b32 v3, 0x6000, v25
global_store_dword v25, v2, s[4:5]
global_store_dword v3, v2, s[4:5]
ds_read_b128 v[40:43], v20 offset:59392
ds_read_b128 v[44:47], v20 offset:60416
ds_read_b128 v[48:51], v21 offset:2048
ds_read_b128 v[52:55], v21 offset:3072
ds_read_b128 v[56:59], v21 offset:10240
ds_read_b128 v[60:63], v21 offset:11264
ds_read_b128 v[88:91], v21 offset:18432
ds_read_b128 v[92:95], v21 offset:19456
ds_read_b128 v[96:99], v21 offset:43008
ds_read_b128 v[100:103], v21 offset:44032
ds_read_b128 v[104:107], v21 offset:51200
ds_read_b128 v[108:111], v21 offset:52224
ds_read_b128 v[112:115], v21 offset:59392
ds_read_b128 v[116:119], v21 offset:60416
v_mov_b64 v[64:65], 0
v_mov_b64 v[66:67], 0
v_mov_b64 v[68:69], 0
v_mov_b64 v[70:71], 0
v_mov_b64 v[80:81], 0
v_mov_b64 v[82:83], 0
v_mov_b64 v[84:85], 0
v_mov_b64 v[86:87], 0
L_rec_f1_top:
v_mov_b64 v[76:77], 0
v_mov_b64 v[78:79], 0
v_mov_b64 v[72:73], 0
v_mov_b64 v[74:75], 0
s_mov_b32 m0, s42
s_add_u32 s3, s40, 1
v_and_b32 v5, 0x1fff, v25
v_lshrrev_b32 v4, 2, v20
s_bitcmp1_b64 s[46:47], s3
s_cbranch_scc0 L_rec_f1_kv
L_rec_f1_kv_ok:
s_nop 15
s_nop 1
global_load_dwordx4 v[32:35], v26, s[4:5] sc1
global_load_dwordx4 v[36:39], v26, s[4:5] offset:1024 sc1
s_nop 15
s_nop 13
global_load_dwordx4 v[32:35], v26, s[4:5] sc1
global_load_dwordx4 v[36:39], v26, s[4:5] offset:1024 sc1
s_waitcnt vmcnt(2) lgkmcnt(0)
L_rec_f1_b1:
v_max3_u32 v2, v32, v33, v34
v_max3_u32 v3, v35, v36, v37
v_max3_u32 v2, v2, v38, v39
v_max_u32 v2, v2, v3
v_cmp_le_u32 vcc, s59, v2
v_smfmac_f32_16x16x64_bf16 v[64:67], v[32:35], v[40:47], v1
ds_write_b64 v20, v[32:33] offset:26624
s_cbranch_vccnz L_rec_f1_b0
L_rec_f1_b0_ok:
v_smfmac_f32_16x16x64_bf16 v[68:71], v[32:35], v[48:55], v1
ds_write_b64 v20, v[34:35] offset:26632
v_smfmac_f32_16x16x64_bf16 v[64:67], v[36:39], v[56:63], v1
ds_write_b64 v20, v[36:37] offset:27648
v_smfmac_f32_16x16x64_bf16 v[68:71], v[36:39], v[88:95], v1
ds_write_b64 v20, v[38:39] offset:27656
v_smfmac_f32_16x16x64_bf16 v[72:75], v[32:35], v[96:103], v1
ds_read_b128 v[88:91], v21 offset:26624
ds_read_b128 v[92:95], v21 offset:27648
v_smfmac_f32_16x16x64_bf16 v[76:79], v[32:35], v[104:111], v1
ds_read_b128 v[96:99], v21 offset:34816
ds_read_b128 v[100:103], v21 offset:35840
v_smfmac_f32_16x16x64_bf16 v[72:75], v[36:39], v[112:119], v1
v_smfmac_f32_16x16x64_bf16 v[76:79], v[36:39], v[248:255], v1
v_smfmac_f32_16x16x64_bf16 v[80:83], v[32:35], a[48:55], v1
s_waitcnt lgkmcnt(4)
s_barrier
ds_read_b128 v[40:43], v20 offset:28672
v_smfmac_f32_16x16x64_bf16 v[84:87], v[32:35], a[112:119], v1
ds_read_b128 v[44:47], v20 offset:29696
ds_read_b128 v[48:51], v20 offset:30720
v_smfmac_f32_16x16x64_bf16 v[80:83], v[36:39], a[56:63], v1
ds_read_b128 v[52:55], v20 offset:31744
ds_read_b128 v[56:59], v20 offset:24576
v_smfmac_f32_16x16x64_bf16 v[84:87], v[36:39], a[120:127], v1
s_waitcnt lgkmcnt(4)
s_waitcnt vmcnt(0)
ds_read_b128 v[60:63], v20 offset:25600
global_load_lds_dwordx4 v20, s[30:31] offset:0 sc1
v_smfmac_f32_16x16x64_bf16 v[64:67], v[40:43], v[88:95], v1
global_load_lds_dwordx4 v20, s[30:31] offset:1024 sc1
global_store_dword v5, v18, s[34:35] sc1
v_smfmac_f32_16x16x64_bf16 v[68:71], v[40:43], v[96:103], v1
s_waitcnt lgkmcnt(4)
ds_read_b128 v[32:35], v20 offset:18432
ds_read_b128 v[36:39], v20 offset:19456
v_smfmac_f32_16x16x64_bf16 v[64:67], v[44:47], v[120:127], v1
s_mov_b32 m0, 37632
v_smfmac_f32_16x16x64_bf16 v[68:71], v[44:47], v[160:167], v1
s_waitcnt lgkmcnt(5)
global_load_lds_dword v4, s[36:37] sc1
v_smfmac_f32_16x16x64_bf16 v[64:67], v[48:51], v[128:135], v1
s_mov_b32 m0, 18432
v_smfmac_f32_16x16x64_bf16 v[68:71], v[48:51], v[168:175], v1
s_waitcnt lgkmcnt(4)
s_waitcnt lgkmcnt(0)
global_load_lds_dwordx4 v20, s[32:33] offset:0 sc1
v_smfmac_f32_16x16x64_bf16 v[64:67], v[52:55], v[136:143], v1
global_load_lds_dwordx4 v20, s[32:33] offset:1024 sc1
v_mov_b64 v[2:3], -1
v_smfmac_f32_16x16x64_bf16 v[68:71], v[52:55], v[176:183], v1
v_mov_b64 v[4:5], -1
v_smfmac_f32_16x16x64_bf16 v[64:67], v[56:59], v[144:151], v1
ds_read_b128 v[104:107], v0 offset:0
v_smfmac_f32_16x16x64_bf16 v[68:71], v[56:59], v[184:191], v1
ds_read_b128 v[108:111], v0 offset:1024
v_smfmac_f32_16x16x64_bf16 v[64:67], v[60:63], v[152:159], v1
ds_read_b128 v[112:115], v0 offset:2048
v_smfmac_f32_16x16x64_bf16 v[68:71], v[60:63], v[192:199], v1
ds_read_b128 v[116:119], v0 offset:3072
v_smfmac_f32_16x16x64_bf16 v[72:75], v[40:43], v[200:207], v1
v_add_f32 v64, v64, v66
v_smfmac_f32_16x16x64_bf16 v[76:79], v[40:43], a[0:7], v1
v_add_f32 v68, v68, v70
v_smfmac_f32_16x16x64_bf16 v[72:75], v[44:47], v[208:215], v1
v_cvt_pk_bf16_f32 v66, v64, v68
v_smfmac_f32_16x16x64_bf16 v[76:79], v[44:47], a[8:15], v1
ds_write_b32 v27, v66
v_add_f32 v65, v65, v67
v_smfmac_f32_16x16x64_bf16 v[72:75], v[48:51], v[216:223], v1
v_add_f32 v69, v69, v71
v_smfmac_f32_16x16x64_bf16 v[76:79], v[48:51], a[16:23], v1
v_cvt_pk_bf16_f32 v67, v65, v69
v_smfmac_f32_16x16x64_bf16 v[72:75], v[52:55], v[224:231], v1
ds_write_b32 v27, v67 offset:288
v_xor_b32 v16, 0x4000, v25
v_smfmac_f32_16x16x64_bf16 v[76:79], v[52:55], a[24:31], v1
global_store_dword v16, v2, s[4:5]
v_smfmac_f32_16x16x64_bf16 v[72:75], v[56:59], v[232:239], v1
v_smfmac_f32_16x16x64_bf16 v[76:79], v[56:59], a[32:39], v1
v_smfmac_f32_16x16x64_bf16 v[72:75], v[60:63], v[240:247], v1
s_waitcnt lgkmcnt(0)
s_barrier
ds_read_b128 v[88:91], v28 offset:0
v_smfmac_f32_16x16x64_bf16 v[76:79], v[60:63], a[40:47], v1
ds_read_b128 v[92:95], v28 offset:64
ds_read_b128 v[96:99], v28 offset:128
v_smfmac_f32_16x16x64_bf16 v[80:83], v[40:43], a[64:71], v1
ds_read_b128 v[100:103], v28 offset:192
v_add_f32 v72, v72, v74
v_smfmac_f32_16x16x64_bf16 v[84:87], v[40:43], a[128:135], v1
v_add_f32 v76, v76, v78
v_smfmac_f32_16x16x64_bf16 v[80:83], v[44:47], a[72:79], v1
v_cvt_pk_bf16_f32 v74, v72, v76
v_smfmac_f32_16x16x64_bf16 v[84:87], v[44:47], a[136:143], v1
s_waitcnt lgkmcnt(3)
ds_write_b32 v27, v74 offset:576
v_add_f32 v73, v73, v75
v_mfma_f32_16x16x32_bf16 v[64:67], v[104:107], v[88:91], 0
v_add_f32 v77, v77, v79
v_cvt_pk_bf16_f32 v75, v73, v77
v_smfmac_f32_16x16x64_bf16 v[80:83], v[48:51], a[80:87], v1
s_waitcnt lgkmcnt(3)
ds_write_b32 v27, v75 offset:864
ds_read_b128 v[104:107], v0 offset:4096
v_mfma_f32_16x16x32_bf16 v[64:67], v[108:111], v[92:95], v[64:67]
v_mov_b64 v[40:41], 0
v_mov_b64 v[42:43], 0
v_smfmac_f32_16x16x64_bf16 v[84:87], v[48:51], a[144:151], v1
s_waitcnt lgkmcnt(4)
ds_read_b128 v[108:111], v0 offset:5120
v_mov_b64 v[44:45], 0
v_mfma_f32_16x16x32_bf16 v[64:67], v[112:115], v[96:99], v[64:67]
v_mov_b64 v[46:47], 0
v_smfmac_f32_16x16x64_bf16 v[80:83], v[52:55], a[88:95], v1
s_waitcnt lgkmcnt(4)
ds_read_b128 v[112:115], v0 offset:6144
v_mfma_f32_16x16x32_bf16 v[64:67], v[116:119], v[100:103], v[64:67]
v_smfmac_f32_16x16x64_bf16 v[84:87], v[52:55], a[152:159], v1
s_waitcnt lgkmcnt(2)
ds_read_b128 v[116:119], v0 offset:7168
v_mfma_f32_16x16x32_bf16 v[68:71], v[104:107], v[88:91], 0
s_barrier
v_exp_f32 v64, v64
v_smfmac_f32_16x16x64_bf16 v[80:83], v[56:59], a[96:103], v1
s_waitcnt lgkmcnt(2)
ds_read_b128 v[104:107], v28 offset:576
v_mov_b64 v[48:49], 0
v_mfma_f32_16x16x32_bf16 v[68:71], v[108:111], v[92:95], v[68:71]
v_exp_f32 v65, v65
v_smfmac_f32_16x16x64_bf16 v[84:87], v[56:59], a[160:167], v1
s_waitcnt lgkmcnt(2)
ds_read_b128 v[108:111], v28 offset:640
v_cvt_pk_bf16_f32 v72, v64, v65
v_mfma_f32_16x16x32_bf16 v[68:71], v[112:115], v[96:99], v[68:71]
v_exp_f32 v66, v66
v_smfmac_f32_16x16x64_bf16 v[80:83], v[60:63], a[104:111], v1
s_waitcnt lgkmcnt(2)
ds_read_b128 v[112:115], v28 offset:704
v_mov_b64 v[50:51], 0
v_mfma_f32_16x16x32_bf16 v[68:71], v[116:119], v[100:103], v[68:71]
v_exp_f32 v67, v67
v_smfmac_f32_16x16x64_bf16 v[84:87], v[60:63], a[168:175], v1
s_waitcnt lgkmcnt(2)
ds_read_b128 v[116:119], v28 offset:768
v_cvt_pk_bf16_f32 v73, v66, v67
v_mfma_f32_16x16x32_bf16 v[76:79], v[104:107], v[88:91], 0
s_waitcnt lgkmcnt(2)
v_exp_f32 v68, v68
v_mfma_f32_16x16x32_bf16 v[76:79], v[108:111], v[92:95], v[76:79]
s_waitcnt lgkmcnt(1)
v_exp_f32 v69, v69
v_mfma_f32_16x16x32_bf16 v[76:79], v[112:115], v[96:99], v[76:79]
s_waitcnt lgkmcnt(0)
v_exp_f32 v70, v70
v_mfma_f32_16x16x32_bf16 v[76:79], v[116:119], v[100:103], v[76:79]
v_exp_f32 v71, v71
v_cvt_pk_bf16_f32 v74, v68, v69
v_cvt_pk_bf16_f32 v75, v70, v71
v_add_f32 v80, v80, v82
v_add_f32 v81, v81, v83
v_mfma_f32_16x16x32_bf16 v[88:91], v[72:75], v[6:9], 0
ds_read_b128 v[112:115], v20 offset:43008
v_mul_f32 v76, s38, v76
v_mul_f32 v77, s38, v77
v_mfma_f32_16x16x32_bf16 v[92:95], v[72:75], v[32:35], 0
v_exp_f32 v78, v76
v_add_f32 v84, v84, v86
v_mfma_f32_16x16x32_bf16 v[96:99], v[72:75], v[36:39], 0
v_exp_f32 v79, v77
v_add_f32 v85, v85, v87
v_cvt_pk_bf16_f32 v12, v78, v79
v_cvt_pk_bf16_f32 v16, v80, v81
v_cvt_pk_bf16_f32 v18, v84, v85
v_mfma_f32_16x16x32_bf16 v[88:91], v[12:15], v[6:9], v[88:91]
ds_read_b128 v[116:119], v20 offset:44032
v_mov_b64 v[52:53], 0
v_mfma_f32_16x16x32_bf16 v[92:95], v[12:15], v[16:19], v[92:95]
ds_read_b128 v[80:83], v20 offset:51200
v_mov_b64 v[54:55], 0
v_mfma_f32_16x16x32_bf16 v[96:99], v[10:13], v[16:19], v[96:99]
ds_read_b128 v[84:87], v20 offset:52224
v_rcp_f32 v90, v88
v_rcp_f32 v91, v89
v_mul_f32 v92, v92, v90
v_mul_f32 v93, v93, v91
s_nop 0
v_mul_f32 v96, v96, v90
v_mul_f32 v97, v97, v91
v_cvt_pk_bf16_f32 v100, v92, v96
v_cvt_pk_bf16_f32 v101, v93, v97
ds_write2_b32 v29, v100, v101 offset0:0 offset1:80
v_max3_f32 v102, v88, v89, v90
v_max_f32 v102, v102, v91
v_cmp_nge_f32 vcc, s39, v102
global_store_dwordx4 v24, v[2:5], s[4:5]
global_store_dwordx4 v24, v[2:5], s[4:5] offset:1024
s_cbranch_vccnz L_rec_f1_slow
L_rec_f1_join:
s_waitcnt lgkmcnt(0)
s_barrier
ds_read_b128 v[104:107], v30 offset:24576
ds_read_b128 v[108:111], v30 offset:24704
v_mov_b64 v[32:33], 0
v_mov_b64 v[34:35], 0
v_mov_b64 v[36:37], 0
v_mov_b64 v[38:39], 0
v_mov_b64 v[56:57], 0
v_mov_b64 v[58:59], 0
v_xor_b32 v24, 0x40000, v24
s_waitcnt lgkmcnt(1)
v_smfmac_f32_16x16x64_bf16 v[32:35], v[104:107], a[176:183], v1
s_waitcnt lgkmcnt(0)
ds_read_b128 v[88:91], v22 offset:2048
v_mov_b64 v[60:61], 0
v_smfmac_f32_16x16x64_bf16 v[32:35], v[108:111], a[184:191], v1
ds_read_b128 v[92:95], v22 offset:3072
v_mov_b64 v[62:63], 0
v_smfmac_f32_16x16x64_bf16 v[36:39], v[104:107], v[112:119], v1
ds_read_b128 v[96:99], v22 offset:10240
v_smfmac_f32_16x16x64_bf16 v[36:39], v[108:111], v[80:87], v1
ds_read_b128 v[100:103], v22 offset:11264
v_add_f32 v32, v32, v34
v_smfmac_f32_16x16x64_bf16 v[40:43], v[104:107], a[192:199], v1
ds_read_b128 v[112:115], v22 offset:18432
v_add_f32 v33, v33, v35
v_smfmac_f32_16x16x64_bf16 v[40:43], v[108:111], a[200:207], v1
ds_read_b128 v[116:119], v22 offset:19456
v_add_f32 v36, v36, v38
v_add_f32 v37, v37, v39
v_smfmac_f32_16x16x64_bf16 v[44:47], v[104:107], a[208:215], v1
s_waitcnt lgkmcnt(4)
ds_read_b128 v[80:83], v22 offset:26624
v_cvt_pk_bf16_f32 v64, v32, v36
v_cvt_pk_bf16_f32 v65, v33, v37
v_smfmac_f32_16x16x64_bf16 v[44:47], v[108:111], v[88:95], v1
s_waitcnt lgkmcnt(3)
global_store_dwordx2 v23, v[64:65], s[20:21]
v_add_f32 v40, v40, v42
v_smfmac_f32_16x16x64_bf16 v[48:51], v[104:107], v[96:103], v1
ds_read_b128 v[84:87], v22 offset:27648
v_add_f32 v41, v41, v43
v_smfmac_f32_16x16x64_bf16 v[48:51], v[108:111], a[216:223], v1
ds_read_b128 v[72:75], v20 offset:39936
v_add_f32 v44, v44, v46
v_add_f32 v45, v45, v47
v_smfmac_f32_16x16x64_bf16 v[52:55], v[104:107], a[224:231], v1
v_cvt_pk_bf16_f32 v66, v40, v44
v_cvt_pk_bf16_f32 v67, v41, v45
v_smfmac_f32_16x16x64_bf16 v[52:55], v[108:111], a[232:239], v1
s_waitcnt lgkmcnt(3)
global_store_dwordx2 v23, v[66:67], s[22:23]
v_add_f32 v48, v48, v50
v_smfmac_f32_16x16x64_bf16 v[56:59], v[104:107], v[112:119], v1
s_waitcnt lgkmcnt(1)
v_add_f32 v49, v49, v51
v_smfmac_f32_16x16x64_bf16 v[56:59], v[108:111], v[80:87], v1
v_add_f32 v52, v52, v54
v_add_f32 v53, v53, v55
v_smfmac_f32_16x16x64_bf16 v[60:63], v[104:107], a[240:247], v1
v_cvt_pk_bf16_f32 v68, v48, v52
v_cvt_pk_bf16_f32 v69, v49, v53
v_smfmac_f32_16x16x64_bf16 v[60:63], v[108:111], a[248:255], v1
global_store_dwordx2 v23, v[68:69], s[24:25]
v_add_f32 v56, v56, v58
v_add_f32 v57, v57, v59
s_nop 4
v_pk_add_f32 v[60:61], v[60:61], v[62:63]
v_cvt_pk_bf16_f32 v70, v56, v60
v_cvt_pk_bf16_f32 v71, v57, v61
global_store_dwordx2 v23, v[70:71], s[26:27]
s_waitcnt lgkmcnt(0)
ds_read_b128 v[40:43], v20 offset:59392
ds_read_b128 v[44:47], v20 offset:60416
ds_read_b128 v[48:51], v21 offset:2048
ds_read_b128 v[52:55], v21 offset:3072
ds_read_b128 v[56:59], v21 offset:10240
ds_read_b128 v[60:63], v21 offset:11264
ds_read_b128 v[88:91], v21 offset:18432
ds_read_b128 v[92:95], v21 offset:19456
ds_read_b128 v[96:99], v21 offset:43008
ds_read_b128 v[100:103], v21 offset:44032
ds_read_b128 v[104:107], v21 offset:51200
ds_read_b128 v[108:111], v21 offset:52224
ds_read_b128 v[112:115], v21 offset:59392
ds_read_b128 v[116:119], v21 offset:60416
global_load_dwordx4 v[32:35], v24, s[4:5] sc1
global_load_dwordx4 v[36:39], v24, s[4:5] offset:1024 sc1
v_mov_b64 v[64:65], 0
v_mov_b64 v[66:67], 0
v_mov_b64 v[68:69], 0
v_mov_b64 v[70:71], 0
v_mov_b64 v[80:81], 0
v_mov_b64 v[82:83], 0
v_mov_b64 v[84:85], 0
v_mov_b64 v[86:87], 0
s_add_u32 s30, s30, 786432
s_addc_u32 s31, s31, 0
s_add_u32 s32, s32, 786432
s_addc_u32 s33, s33, 0
s_add_u32 s34, s34, 8192
s_addc_u32 s35, s35, 0
s_add_u32 s40, s40, 1
s_xor_b32 s42, s42, 8192
v_add_u32 v2, 0x2000, v26
v_bfi_b32 v26, s43, v2, v26
v_xor_b32 v23, 0x40000, v23
v_xor_b32 v0, 8192, v0
s_nop 9
global_load_dwordx4 v[32:35], v24, s[4:5] sc1
global_load_dwordx4 v[36:39], v24, s[4:5] offset:1024 sc1
s_mov_b32 s3, 64
v_add_u32 v4, 0x2000, v25
s_waitcnt vmcnt(2)
L_rec_f1_a:
v_mfma_f32_16x16x32_bf16 v[76:79], v[72:75], v[32:35], 0
v_mfma_f32_16x16x32_bf16 v[76:79], v[72:75], v[36:39], v[76:79]
s_nop 7
v_add_f32_dpp v76, v76, v76 row_ror:4 row_mask:0xf bank_mask:0xf
v_add_f32_dpp v77, v77, v77 row_ror:4 row_mask:0xf bank_mask:0xf
v_cmp_u_f32 vcc, v78, v79
v_add_f32_dpp v76, v76, v76 row_ror:8 row_mask:0xf bank_mask:0xf
v_add_f32_dpp v77, v77, v77 row_ror:8 row_mask:0xf bank_mask:0xf
v_cvt_pk_bf16_f32 v18, v76, v77
s_mov_b64 exec, s[44:45]
global_store_dword v25, v18, s[4:5]
s_mov_b64 exec, -1
s_cbranch_vccnz L_rec_f1_a_fail
L_rec_f1_a_ok:
v_bfi_b32 v25, s43, v4, v25
s_cmp_lt_u32 s40, 63
s_cbranch_scc1 L_rec_f1_top
v_and_b32 v5, 0x1fff, v25
global_store_dword v5, v18, s[34:35] sc1
s_branch L_rec_done
L_rec_f1_kv:
ds_read_b32 v3, v4 offset:37632
s_waitcnt lgkmcnt(0)
L_rec_f1_kv2:
v_cmp_eq_u32 s[46:47], 1, v3
s_bitcmp1_b64 s[46:47], s3
s_cbranch_scc1 L_rec_f1_kv_ok
global_load_dword v3, v4, s[36:37] sc1
s_waitcnt vmcnt(0)
s_sub_u32 s41, s41, 1
s_cbranch_scc0 L_rec_f1_kv2
s_mov_b32 s41, 0
s_branch L_rec_f1_kv_ok
L_rec_f1_b0:
global_load_dwordx4 v[32:35], v26, s[4:5] sc1
global_load_dwordx4 v[36:39], v26, s[4:5] offset:1024 sc1
s_mov_b32 s18, 0
s_sub_u32 s41, s41, 1
s_cbranch_scc1 L_rec_f1_b0_dead
s_nop 1
v_mov_b64 v[64:65], 0
v_mov_b64 v[66:67], 0
s_waitcnt vmcnt(2)
s_branch L_rec_f1_b1
L_rec_f1_b0_dead:
s_mov_b32 s41, 0
s_branch L_rec_f1_b0_ok
L_rec_f1_slow:
s_waitcnt lgkmcnt(0)
ds_read_b128 v[88:91], v28 offset:0
ds_read_b128 v[92:95], v28 offset:64
ds_read_b128 v[96:99], v28 offset:128
ds_read_b128 v[100:103], v28 offset:192
ds_read_b128 v[104:107], v0 offset:0
ds_read_b128 v[108:111], v0 offset:1024
ds_read_b128 v[112:115], v0 offset:2048
ds_read_b128 v[116:119], v0 offset:3072
s_waitcnt lgkmcnt(0)
v_mfma_f32_16x16x32_bf16 v[64:67], v[104:107], v[88:91], 0
v_mfma_f32_16x16x32_bf16 v[64:67], v[108:111], v[92:95], v[64:67]
v_mfma_f32_16x16x32_bf16 v[64:67], v[112:115], v[96:99], v[64:67]
v_mfma_f32_16x16x32_bf16 v[64:67], v[116:119], v[100:103], v[64:67]
ds_read_b128 v[104:107], v0 offset:4096
ds_read_b128 v[108:111], v0 offset:5120
ds_read_b128 v[112:115], v0 offset:6144
ds_read_b128 v[116:119], v0 offset:7168
s_waitcnt lgkmcnt(0)
v_mfma_f32_16x16x32_bf16 v[68:71], v[104:107], v[88:91], 0
v_mfma_f32_16x16x32_bf16 v[68:71], v[108:111], v[92:95], v[68:71]
v_mfma_f32_16x16x32_bf16 v[68:71], v[112:115], v[96:99], v[68:71]
v_mfma_f32_16x16x32_bf16 v[68:71], v[116:119], v[100:103], v[68:71]
s_nop 7
v_max3_f32 v2, v64, v65, v66
v_max3_f32 v3, v67, v68, v69
v_max3_f32 v2, v2, v70, v71
v_max3_f32 v3, v3, v76, v77
v_max_f32 v2, v2, v3
v_mov_b32 v3, v2
s_nop 1
v_permlane32_swap_b32 v2, v3
v_max_f32 v2, v2, v3
v_mov_b32 v3, v2
s_nop 1
v_permlane16_swap_b32 v2, v3
v_max_f32 v2, v2, v3
v_sub_f32 v64, v64, v2
v_sub_f32 v65, v65, v2
v_sub_f32 v66, v66, v2
v_sub_f32 v67, v67, v2
v_sub_f32 v68, v68, v2
v_sub_f32 v69, v69, v2
v_sub_f32 v70, v70, v2
v_sub_f32 v71, v71, v2
v_sub_f32 v76, v76, v2
v_sub_f32 v77, v77, v2
v_exp_f32 v64, v64
v_exp_f32 v65, v65
v_exp_f32 v66, v66
v_exp_f32 v67, v67
v_exp_f32 v68, v68
v_exp_f32 v69, v69
v_exp_f32 v70, v70
v_exp_f32 v71, v71
v_exp_f32 v76, v76
v_exp_f32 v77, v77
v_cvt_pk_bf16_f32 v72, v64, v65
v_cvt_pk_bf16_f32 v73, v66, v67
v_cvt_pk_bf16_f32 v74, v68, v69
v_cvt_pk_bf16_f32 v75, v70, v71
v_cvt_pk_bf16_f32 v12, v76, v77
s_nop 0
v_mfma_f32_16x16x32_bf16 v[88:91], v[72:75], v[6:9], 0
v_mfma_f32_16x16x32_bf16 v[92:95], v[72:75], v[32:35], 0
v_mfma_f32_16x16x32_bf16 v[96:99], v[72:75], v[36:39], 0
v_mfma_f32_16x16x32_bf16 v[88:91], v[12:15], v[6:9], v[88:91]
v_mfma_f32_16x16x32_bf16 v[92:95], v[12:15], v[16:19], v[92:95]
v_mfma_f32_16x16x32_bf16 v[96:99], v[10:13], v[16:19], v[96:99]
s_nop 7
v_rcp_f32 v90, v88
v_rcp_f32 v91, v89
v_mul_f32 v92, v92, v90
v_mul_f32 v93, v93, v91
v_mul_f32 v96, v96, v90
v_mul_f32 v97, v97, v91
v_cvt_pk_bf16_f32 v100, v92, v96
v_cvt_pk_bf16_f32 v101, v93, v97
ds_write2_b32 v29, v100, v101 offset0:0 offset1:80
v_mov_b64 v[2:3], -1
ds_read_b128 v[112:115], v20 offset:43008
ds_read_b128 v[116:119], v20 offset:44032
s_branch L_rec_f1_join
L_rec_f1_a_fail:
s_cmp_gt_u32 s3, 60
s_cbranch_scc1 L_rec_f1_a_f2
s_sleep 6
L_rec_f1_a_f2:
global_load_dwordx4 v[32:35], v24, s[4:5] sc1
global_load_dwordx4 v[36:39], v24, s[4:5] offset:1024 sc1
s_mov_b32 s19, 0
s_sub_u32 s3, s3, 1
s_cbranch_scc1 L_rec_f1_a_chk
s_waitcnt vmcnt(3)
s_branch L_rec_f1_a
L_rec_f1_a_chk:
s_mov_b32 s3, 60
s_waitcnt vmcnt(0)
s_sub_u32 s41, s41, 64
s_cbranch_scc1 L_rec_f1_a_dead
v_max3_u32 v2, v32, v33, v34
v_max3_u32 v3, v35, v36, v37
v_max3_u32 v2, v2, v38, v39
v_max_u32 v2, v2, v3
v_cmp_eq_u32 vcc, -1, v2
s_cbranch_vccnz L_rec_f1_a_fail
s_branch L_rec_f1_a_now
L_rec_f1_a_dead:
s_mov_b32 s41, 0
L_rec_f1_a_now:
v_mfma_f32_16x16x32_bf16 v[76:79], v[72:75], v[32:35], 0
v_mfma_f32_16x16x32_bf16 v[76:79], v[72:75], v[36:39], v[76:79]
s_nop 7
v_add_f32_dpp v76, v76, v76 row_ror:4 row_mask:0xf bank_mask:0xf
v_add_f32_dpp v77, v77, v77 row_ror:4 row_mask:0xf bank_mask:0xf
v_cmp_u_f32 vcc, v78, v79
v_add_f32_dpp v76, v76, v76 row_ror:8 row_mask:0xf bank_mask:0xf
v_add_f32_dpp v77, v77, v77 row_ror:8 row_mask:0xf bank_mask:0xf
v_cvt_pk_bf16_f32 v18, v76, v77
v_cmp_u_f32 vcc, v76, v77
v_and_b32 v2, 0x7fff7fff, v18
s_nop 0
v_cndmask_b32 v18, v18, v2, vcc
s_mov_b64 exec, s[44:45]
global_store_dword v25, v18, s[4:5]
s_mov_b64 exec, -1
s_branch L_rec_f1_a_ok
L_rec_f2:
v_mov_b32 v2, -1
v_xor_b32 v3, 0x6000, v25
global_store_dword v25, v2, s[4:5]
global_store_dword v3, v2, s[4:5]
ds_read_b128 v[40:43], v20 offset:61440
ds_read_b128 v[44:47], v20 offset:62464
ds_read_b128 v[48:51], v21 offset:4096
ds_read_b128 v[52:55], v21 offset:5120
ds_read_b128 v[56:59], v21 offset:12288
ds_read_b128 v[60:63], v21 offset:13312
ds_read_b128 v[88:91], v21 offset:20480
ds_read_b128 v[92:95], v21 offset:21504
ds_read_b128 v[96:99], v21 offset:45056
ds_read_b128 v[100:103], v21 offset:46080
ds_read_b128 v[104:107], v21 offset:53248
ds_read_b128 v[108:111], v21 offset:54272
ds_read_b128 v[112:115], v21 offset:61440
ds_read_b128 v[116:119], v21 offset:62464
v_mov_b64 v[64:65], 0
v_mov_b64 v[66:67], 0
v_mov_b64 v[68:69], 0
v_mov_b64 v[70:71], 0
v_mov_b64 v[80:81], 0
v_mov_b64 v[82:83], 0
v_mov_b64 v[84:85], 0
v_mov_b64 v[86:87], 0
L_rec_f2_top:
v_mov_b64 v[76:77], 0
v_mov_b64 v[78:79], 0
v_mov_b64 v[72:73], 0
v_mov_b64 v[74:75], 0
s_mov_b32 m0, s42
s_add_u32 s3, s40, 1
v_and_b32 v5, 0x1fff, v25
v_lshrrev_b32 v4, 2, v20
s_bitcmp1_b64 s[46:47], s3
s_cbranch_scc0 L_rec_f2_kv
L_rec_f2_kv_ok:
s_nop 15
s_nop 1
global_load_dwordx4 v[32:35], v26, s[4:5] sc1
global_load_dwordx4 v[36:39], v26, s[4:5] offset:1024 sc1
s_nop 15
s_nop 13
global_load_dwordx4 v[32:35], v26, s[4:5] sc1
global_load_dwordx4 v[36:39], v26, s[4:5] offset:1024 sc1
s_waitcnt vmcnt(2) lgkmcnt(0)
L_rec_f2_b1:
v_max3_u32 v2, v32, v33, v34
v_max3_u32 v3, v35, v36, v37
v_max3_u32 v2, v2, v38, v39
v_max_u32 v2, v2, v3
v_cmp_le_u32 vcc, s59, v2
v_smfmac_f32_16x16x64_bf16 v[64:67], v[32:35], v[40:47], v1
ds_write_b64 v20, v[32:33] offset:28672
s_cbranch_vccnz L_rec_f2_b0
L_rec_f2_b0_ok:
v_smfmac_f32_16x16x64_bf16 v[68:71], v[32:35], v[48:55], v1
ds_write_b64 v20, v[34:35] offset:28680
v_smfmac_f32_16x16x64_bf16 v[64:67], v[36:39], v[56:63], v1
ds_write_b64 v20, v[36:37] offset:29696
v_smfmac_f32_16x16x64_bf16 v[68:71], v[36:39], v[88:95], v1
ds_write_b64 v20, v[38:39] offset:29704
v_smfmac_f32_16x16x64_bf16 v[72:75], v[32:35], v[96:103], v1
ds_read_b128 v[88:91], v21 offset:28672
ds_read_b128 v[92:95], v21 offset:29696
v_smfmac_f32_16x16x64_bf16 v[76:79], v[32:35], v[104:111], v1
ds_read_b128 v[96:99], v21 offset:36864
ds_read_b128 v[100:103], v21 offset:37888
v_smfmac_f32_16x16x64_bf16 v[72:75], v[36:39], v[112:119], v1
v_smfmac_f32_16x16x64_bf16 v[76:79], v[36:39], v[248:255], v1
s_waitcnt lgkmcnt(4)
s_barrier
ds_read_b128 v[40:43], v20 offset:30720
v_smfmac_f32_16x16x64_bf16 v[80:83], v[32:35], a[48:55], v1
ds_read_b128 v[44:47], v20 offset:31744
ds_read_b128 v[48:51], v20 offset:24576
v_smfmac_f32_16x16x64_bf16 v[84:87], v[32:35], a[112:119], v1
ds_read_b128 v[52:55], v20 offset:25600
ds_read_b128 v[56:59], v20 offset:26624
v_smfmac_f32_16x16x64_bf16 v[80:83], v[36:39], a[56:63], v1
s_waitcnt vmcnt(0)
ds_read_b128 v[60:63], v20 offset:27648
global_load_lds_dwordx4 v20, s[30:31] offset:0 sc1
v_smfmac_f32_16x16x64_bf16 v[84:87], v[36:39], a[120:127], v1
s_waitcnt lgkmcnt(5)
global_load_lds_dwordx4 v20, s[30:31] offset:1024 sc1
global_store_dword v5, v18, s[34:35] sc1
v_smfmac_f32_16x16x64_bf16 v[64:67], v[40:43], v[88:95], v1
ds_read_b128 v[32:35], v20 offset:20480
ds_read_b128 v[36:39], v20 offset:21504
v_smfmac_f32_16x16x64_bf16 v[68:71], v[40:43], v[96:103], v1
s_waitcnt lgkmcnt(6)
s_mov_b32 m0, 37632
v_smfmac_f32_16x16x64_bf16 v[64:67], v[44:47], v[120:127], v1
global_load_lds_dword v4, s[36:37] sc1
v_smfmac_f32_16x16x64_bf16 v[68:71], v[44:47], v[160:167], v1
s_waitcnt lgkmcnt(5)
s_mov_b32 m0, 20480
v_smfmac_f32_16x16x64_bf16 v[64:67], v[48:51], v[128:135], v1
s_waitcnt lgkmcnt(0)
global_load_lds_dwordx4 v20, s[32:33] offset:0 sc1
v_smfmac_f32_16x16x64_bf16 v[68:71], v[48:51], v[168:175], v1
global_load_lds_dwordx4 v20, s[32:33] offset:1024 sc1
v_mov_b64 v[2:3], -1
v_smfmac_f32_16x16x64_bf16 v[64:67], v[52:55], v[136:143], v1
v_mov_b64 v[4:5], -1
v_smfmac_f32_16x16x64_bf16 v[68:71], v[52:55], v[176:183], v1
v_smfmac_f32_16x16x64_bf16 v[64:67], v[56:59], v[144:151], v1
ds_read_b128 v[104:107], v0 offset:0
v_smfmac_f32_16x16x64_bf16 v[68:71], v[56:59], v[184:191], v1
ds_read_b128 v[108:111], v0 offset:1024
v_smfmac_f32_16x16x64_bf16 v[64:67], v[60:63], v[152:159], v1
ds_read_b128 v[112:115], v0 offset:2048
v_smfmac_f32_16x16x64_bf16 v[68:71], v[60:63], v[192:199], v1
ds_read_b128 v[116:119], v0 offset:3072
v_smfmac_f32_16x16x64_bf16 v[72:75], v[40:43], v[200:207], v1
v_add_f32 v64, v64, v66
v_smfmac_f32_16x16x64_bf16 v[76:79], v[40:43], a[0:7], v1
v_add_f32 v68, v68, v70
v_smfmac_f32_16x16x64_bf16 v[72:75], v[44:47], v[208:215], v1
v_cvt_pk_bf16_f32 v66, v64, v68
v_smfmac_f32_16x16x64_bf16 v[76:79], v[44:47], a[8:15], v1
ds_write_b32 v27, v66
v_add_f32 v65, v65, v67
v_smfmac_f32_16x16x64_bf16 v[72:75], v[48:51], v[216:223], v1
v_add_f32 v69, v69, v71
v_smfmac_f32_16x16x64_bf16 v[76:79], v[48:51], a[16:23], v1
v_cvt_pk_bf16_f32 v67, v65, v69
v_smfmac_f32_16x16x64_bf16 v[72:75], v[52:55], v[224:231], v1
ds_write_b32 v27, v67 offset:288
v_xor_b32 v16, 0x4000, v25
v_smfmac_f32_16x16x64_bf16 v[76:79], v[52:55], a[24:31], v1
global_store_dword v16, v2, s[4:5]
v_smfmac_f32_16x16x64_bf16 v[72:75], v[56:59], v[232:239], v1
v_smfmac_f32_16x16x64_bf16 v[76:79], v[56:59], a[32:39], v1
v_smfmac_f32_16x16x64_bf16 v[72:75], v[60:63], v[240:247], v1
s_waitcnt lgkmcnt(0)
s_barrier
ds_read_b128 v[88:91], v28 offset:0
v_smfmac_f32_16x16x64_bf16 v[76:79], v[60:63], a[40:47], v1
ds_read_b128 v[92:95], v28 offset:64
ds_read_b128 v[96:99], v28 offset:128
v_smfmac_f32_16x16x64_bf16 v[80:83], v[40:43], a[64:71], v1
ds_read_b128 v[100:103], v28 offset:192
v_add_f32 v72, v72, v74
v_smfmac_f32_16x16x64_bf16 v[84:87], v[40:43], a[128:135], v1
v_add_f32 v76, v76, v78
v_smfmac_f32_16x16x64_bf16 v[80:83], v[44:47], a[72:79], v1
v_cvt_pk_bf16_f32 v74, v72, v76
v_smfmac_f32_16x16x64_bf16 v[84:87], v[44:47], a[136:143], v1
s_waitcnt lgkmcnt(3)
ds_write_b32 v27, v74 offset:576
v_add_f32 v73, v73, v75
v_mfma_f32_16x16x32_bf16 v[64:67], v[104:107], v[88:91], 0
v_add_f32 v77, v77, v79
v_cvt_pk_bf16_f32 v75, v73, v77
v_smfmac_f32_16x16x64_bf16 v[80:83], v[48:51], a[80:87], v1
s_waitcnt lgkmcnt(3)
ds_write_b32 v27, v75 offset:864
ds_read_b128 v[104:107], v0 offset:4096
v_mfma_f32_16x16x32_bf16 v[64:67], v[108:111], v[92:95], v[64:67]
v_mov_b64 v[40:41], 0
v_mov_b64 v[42:43], 0
v_smfmac_f32_16x16x64_bf16 v[84:87], v[48:51], a[144:151], v1
s_waitcnt lgkmcnt(4)
ds_read_b128 v[108:111], v0 offset:5120
v_mov_b64 v[44:45], 0
v_mfma_f32_16x16x32_bf16 v[64:67], v[112:115], v[96:99], v[64:67]
v_mov_b64 v[46:47], 0
v_smfmac_f32_16x16x64_bf16 v[80:83], v[52:55], a[88:95], v1
s_waitcnt lgkmcnt(4)
ds_read_b128 v[112:115], v0 offset:6144
v_mfma_f32_16x16x32_bf16 v[64:67], v[116:119], v[100:103], v[64:67]
v_smfmac_f32_16x16x64_bf16 v[84:87], v[52:55], a[152:159], v1
s_waitcnt lgkmcnt(2)
ds_read_b128 v[116:119], v0 offset:7168
v_mfma_f32_16x16x32_bf16 v[68:71], v[104:107], v[88:91], 0
s_barrier
v_exp_f32 v64, v64
v_smfmac_f32_16x16x64_bf16 v[80:83], v[56:59], a[96:103], v1
s_waitcnt lgkmcnt(2)
ds_read_b128 v[104:107], v28 offset:576
v_mov_b64 v[48:49], 0
v_mfma_f32_16x16x32_bf16 v[68:71], v[108:111], v[92:95], v[68:71]
v_exp_f32 v65, v65
v_smfmac_f32_16x16x64_bf16 v[84:87], v[56:59], a[160:167], v1
s_waitcnt lgkmcnt(2)
ds_read_b128 v[108:111], v28 offset:640
v_cvt_pk_bf16_f32 v72, v64, v65
v_mfma_f32_16x16x32_bf16 v[68:71], v[112:115], v[96:99], v[68:71]
v_exp_f32 v66, v66
v_smfmac_f32_16x16x64_bf16 v[80:83], v[60:63], a[104:111], v1
s_waitcnt lgkmcnt(2)
ds_read_b128 v[112:115], v28 offset:704
v_mov_b64 v[50:51], 0
v_mfma_f32_16x16x32_bf16 v[68:71], v[116:119], v[100:103], v[68:71]
v_exp_f32 v67, v67
v_smfmac_f32_16x16x64_bf16 v[84:87], v[60:63], a[168:175], v1
s_waitcnt lgkmcnt(2)
ds_read_b128 v[116:119], v28 offset:768
v_cvt_pk_bf16_f32 v73, v66, v67
v_mfma_f32_16x16x32_bf16 v[76:79], v[104:107], v[88:91], 0
s_waitcnt lgkmcnt(2)
v_exp_f32 v68, v68
v_mfma_f32_16x16x32_bf16 v[76:79], v[108:111], v[92:95], v[76:79]
s_waitcnt lgkmcnt(1)
v_exp_f32 v69, v69
v_mfma_f32_16x16x32_bf16 v[76:79], v[112:115], v[96:99], v[76:79]
s_waitcnt lgkmcnt(0)
v_exp_f32 v70, v70
v_mfma_f32_16x16x32_bf16 v[76:79], v[116:119], v[100:103], v[76:79]
v_exp_f32 v71, v71
v_cvt_pk_bf16_f32 v74, v68, v69
v_cvt_pk_bf16_f32 v75, v70, v71
v_add_f32 v80, v80, v82
v_add_f32 v81, v81, v83
v_mfma_f32_16x16x32_bf16 v[88:91], v[72:75], v[6:9], 0
ds_read_b128 v[112:115], v20 offset:45056
v_mul_f32 v76, s38, v76
v_mul_f32 v77, s38, v77
v_mfma_f32_16x16x32_bf16 v[92:95], v[72:75], v[32:35], 0
v_exp_f32 v78, v76
v_add_f32 v84, v84, v86
v_mfma_f32_16x16x32_bf16 v[96:99], v[72:75], v[36:39], 0
v_exp_f32 v79, v77
v_add_f32 v85, v85, v87
v_cvt_pk_bf16_f32 v12, v78, v79
v_cvt_pk_bf16_f32 v16, v80, v81
v_cvt_pk_bf16_f32 v18, v84, v85
v_mfma_f32_16x16x32_bf16 v[88:91], v[12:15], v[6:9], v[88:91]
ds_read_b128 v[116:119], v20 offset:46080
v_mov_b64 v[52:53], 0
v_mfma_f32_16x16x32_bf16 v[92:95], v[12:15], v[16:19], v[92:95]
ds_read_b128 v[80:83], v20 offset:53248
v_mov_b64 v[54:55], 0
v_mfma_f32_16x16x32_bf16 v[96:99], v[10:13], v[16:19], v[96:99]
ds_read_b128 v[84:87], v20 offset:54272
v_rcp_f32 v90, v88
v_rcp_f32 v91, v89
v_mul_f32 v92, v92, v90
v_mul_f32 v93, v93, v91
s_nop 0
v_mul_f32 v96, v96, v90
v_mul_f32 v97, v97, v91
v_cvt_pk_bf16_f32 v100, v92, v96
v_cvt_pk_bf16_f32 v101, v93, v97
ds_write2_b32 v29, v100, v101 offset0:0 offset1:80
v_max3_f32 v102, v88, v89, v90
v_max_f32 v102, v102, v91
v_cmp_nge_f32 vcc, s39, v102
global_store_dwordx4 v24, v[2:5], s[4:5]
global_store_dwordx4 v24, v[2:5], s[4:5] offset:1024
s_cbranch_vccnz L_rec_f2_slow
L_rec_f2_join:
s_waitcnt lgkmcnt(0)
s_barrier
ds_read_b128 v[104:107], v30 offset:24576
ds_read_b128 v[108:111], v30 offset:24704
v_mov_b64 v[32:33], 0
v_mov_b64 v[34:35], 0
v_mov_b64 v[36:37], 0
v_mov_b64 v[38:39], 0
v_mov_b64 v[56:57], 0
v_mov_b64 v[58:59], 0
v_xor_b32 v24, 0x40000, v24
s_waitcnt lgkmcnt(1)
v_smfmac_f32_16x16x64_bf16 v[32:35], v[104:107], a[176:183], v1
s_waitcnt lgkmcnt(0)
ds_read_b128 v[88:91], v22 offset:4096
v_mov_b64 v[60:61], 0
v_smfmac_f32_16x16x64_bf16 v[32:35], v[108:111], a[184:191], v1
ds_read_b128 v[92:95], v22 offset:5120
v_mov_b64 v[62:63], 0
v_smfmac_f32_16x16x64_bf16 v[36:39], v[104:107], v[112:119], v1
ds_read_b128 v[96:99], v22 offset:12288
v_smfmac_f32_16x16x64_bf16 v[36:39], v[108:111], v[80:87], v1
ds_read_b128 v[100:103], v22 offset:13312
v_add_f32 v32, v32, v34
v_smfmac_f32_16x16x64_bf16 v[40:43], v[104:107], a[192:199], v1
ds_read_b128 v[112:115], v22 offset:20480
v_add_f32 v33, v33, v35
v_smfmac_f32_16x16x64_bf16 v[40:43], v[108:111], a[200:207], v1
ds_read_b128 v[116:119], v22 offset:21504
v_add_f32 v36, v36, v38
v_add_f32 v37, v37, v39
v_smfmac_f32_16x16x64_bf16 v[44:47], v[104:107], a[208:215], v1
s_waitcnt lgkmcnt(4)
ds_read_b128 v[80:83], v22 offset:28672
v_cvt_pk_bf16_f32 v64, v32, v36
v_cvt_pk_bf16_f32 v65, v33, v37
v_smfmac_f32_16x16x64_bf16 v[44:47], v[108:111], v[88:95], v1
s_waitcnt lgkmcnt(3)
global_store_dwordx2 v23, v[64:65], s[20:21]
v_add_f32 v40, v40, v42
v_smfmac_f32_16x16x64_bf16 v[48:51], v[104:107], v[96:103], v1
ds_read_b128 v[84:87], v22 offset:29696
v_add_f32 v41, v41, v43
v_smfmac_f32_16x16x64_bf16 v[48:51], v[108:111], a[216:223], v1
ds_read_b128 v[72:75], v20 offset:39936
v_add_f32 v44, v44, v46
v_add_f32 v45, v45, v47
v_smfmac_f32_16x16x64_bf16 v[52:55], v[104:107], a[224:231], v1
v_cvt_pk_bf16_f32 v66, v40, v44
v_cvt_pk_bf16_f32 v67, v41, v45
v_smfmac_f32_16x16x64_bf16 v[52:55], v[108:111], a[232:239], v1
s_waitcnt lgkmcnt(3)
global_store_dwordx2 v23, v[66:67], s[22:23]
v_add_f32 v48, v48, v50
v_smfmac_f32_16x16x64_bf16 v[56:59], v[104:107], v[112:119], v1
s_waitcnt lgkmcnt(1)
v_add_f32 v49, v49, v51
v_smfmac_f32_16x16x64_bf16 v[56:59], v[108:111], v[80:87], v1
v_add_f32 v52, v52, v54
v_add_f32 v53, v53, v55
v_smfmac_f32_16x16x64_bf16 v[60:63], v[104:107], a[240:247], v1
v_cvt_pk_bf16_f32 v68, v48, v52
v_cvt_pk_bf16_f32 v69, v49, v53
v_smfmac_f32_16x16x64_bf16 v[60:63], v[108:111], a[248:255], v1
global_store_dwordx2 v23, v[68:69], s[24:25]
v_add_f32 v56, v56, v58
v_add_f32 v57, v57, v59
s_nop 4
v_pk_add_f32 v[60:61], v[60:61], v[62:63]
v_cvt_pk_bf16_f32 v70, v56, v60
v_cvt_pk_bf16_f32 v71, v57, v61
global_store_dwordx2 v23, v[70:71], s[26:27]
s_waitcnt lgkmcnt(0)
ds_read_b128 v[40:43], v20 offset:61440
ds_read_b128 v[44:47], v20 offset:62464
ds_read_b128 v[48:51], v21 offset:4096
ds_read_b128 v[52:55], v21 offset:5120
ds_read_b128 v[56:59], v21 offset:12288
ds_read_b128 v[60:63], v21 offset:13312
ds_read_b128 v[88:91], v21 offset:20480
ds_read_b128 v[92:95], v21 offset:21504
ds_read_b128 v[96:99], v21 offset:45056
ds_read_b128 v[100:103], v21 offset:46080
ds_read_b128 v[104:107], v21 offset:53248
ds_read_b128 v[108:111], v21 offset:54272
ds_read_b128 v[112:115], v21 offset:61440
ds_read_b128 v[116:119], v21 offset:62464
v_mov_b64 v[64:65], 0
v_mov_b64 v[66:67], 0
v_mov_b64 v[68:69], 0
v_mov_b64 v[70:71], 0
v_mov_b64 v[80:81], 0
v_mov_b64 v[82:83], 0
v_mov_b64 v[84:85], 0
v_mov_b64 v[86:87], 0
s_add_u32 s30, s30, 786432
s_addc_u32 s31, s31, 0
global_load_dwordx4 v[32:35], v24, s[4:5] sc1
global_load_dwordx4 v[36:39], v24, s[4:5] offset:1024 sc1
s_add_u32 s32, s32, 786432
s_addc_u32 s33, s33, 0
s_add_u32 s34, s34, 8192
s_addc_u32 s35, s35, 0
s_add_u32 s40, s40, 1
s_xor_b32 s42, s42, 8192
v_add_u32 v2, 0x2000, v26
v_bfi_b32 v26, s43, v2, v26
v_xor_b32 v23, 0x40000, v23
v_xor_b32 v0, 8192, v0
s_nop 15
s_nop 3
global_load_dwordx4 v[32:35], v24, s[4:5] sc1
global_load_dwordx4 v[36:39], v24, s[4:5] offset:1024 sc1
s_mov_b32 s3, 64
v_add_u32 v4, 0x2000, v25
s_waitcnt vmcnt(2)
L_rec_f2_a:
v_mfma_f32_16x16x32_bf16 v[76:79], v[72:75], v[32:35], 0
v_mfma_f32_16x16x32_bf16 v[76:79], v[72:75], v[36:39], v[76:79]
s_nop 7
v_add_f32_dpp v76, v76, v76 row_ror:4 row_mask:0xf bank_mask:0xf
v_add_f32_dpp v77, v77, v77 row_ror:4 row_mask:0xf bank_mask:0xf
v_cmp_u_f32 vcc, v78, v79
v_add_f32_dpp v76, v76, v76 row_ror:8 row_mask:0xf bank_mask:0xf
v_add_f32_dpp v77, v77, v77 row_ror:8 row_mask:0xf bank_mask:0xf
v_cvt_pk_bf16_f32 v18, v76, v77
s_mov_b64 exec, s[44:45]
global_store_dword v25, v18, s[4:5]
s_mov_b64 exec, -1
s_cbranch_vccnz L_rec_f2_a_fail
L_rec_f2_a_ok:
v_bfi_b32 v25, s43, v4, v25
s_cmp_lt_u32 s40, 63
s_cbranch_scc1 L_rec_f2_top
v_and_b32 v5, 0x1fff, v25
global_store_dword v5, v18, s[34:35] sc1
s_branch L_rec_done
L_rec_f2_kv:
ds_read_b32 v3, v4 offset:37632
s_waitcnt lgkmcnt(0)
L_rec_f2_kv2:
v_cmp_eq_u32 s[46:47], 1, v3
s_bitcmp1_b64 s[46:47], s3
s_cbranch_scc1 L_rec_f2_kv_ok
global_load_dword v3, v4, s[36:37] sc1
s_waitcnt vmcnt(0)
s_sub_u32 s41, s41, 1
s_cbranch_scc0 L_rec_f2_kv2
s_mov_b32 s41, 0
s_branch L_rec_f2_kv_ok
L_rec_f2_b0:
global_load_dwordx4 v[32:35], v26, s[4:5] sc1
global_load_dwordx4 v[36:39], v26, s[4:5] offset:1024 sc1
s_mov_b32 s18, 0
s_sub_u32 s41, s41, 1
s_cbranch_scc1 L_rec_f2_b0_dead
s_nop 1
v_mov_b64 v[64:65], 0
v_mov_b64 v[66:67], 0
s_waitcnt vmcnt(2)
s_branch L_rec_f2_b1
L_rec_f2_b0_dead:
s_mov_b32 s41, 0
s_branch L_rec_f2_b0_ok
L_rec_f2_slow:
s_waitcnt lgkmcnt(0)
ds_read_b128 v[88:91], v28 offset:0
ds_read_b128 v[92:95], v28 offset:64
ds_read_b128 v[96:99], v28 offset:128
ds_read_b128 v[100:103], v28 offset:192
ds_read_b128 v[104:107], v0 offset:0
ds_read_b128 v[108:111], v0 offset:1024
ds_read_b128 v[112:115], v0 offset:2048
ds_read_b128 v[116:119], v0 offset:3072
s_waitcnt lgkmcnt(0)
v_mfma_f32_16x16x32_bf16 v[64:67], v[104:107], v[88:91], 0
v_mfma_f32_16x16x32_bf16 v[64:67], v[108:111], v[92:95], v[64:67]
v_mfma_f32_16x16x32_bf16 v[64:67], v[112:115], v[96:99], v[64:67]
v_mfma_f32_16x16x32_bf16 v[64:67], v[116:119], v[100:103], v[64:67]
ds_read_b128 v[104:107], v0 offset:4096
ds_read_b128 v[108:111], v0 offset:5120
ds_read_b128 v[112:115], v0 offset:6144
ds_read_b128 v[116:119], v0 offset:7168
s_waitcnt lgkmcnt(0)
v_mfma_f32_16x16x32_bf16 v[68:71], v[104:107], v[88:91], 0
v_mfma_f32_16x16x32_bf16 v[68:71], v[108:111], v[92:95], v[68:71]
v_mfma_f32_16x16x32_bf16 v[68:71], v[112:115], v[96:99], v[68:71]
v_mfma_f32_16x16x32_bf16 v[68:71], v[116:119], v[100:103], v[68:71]
s_nop 7
v_max3_f32 v2, v64, v65, v66
v_max3_f32 v3, v67, v68, v69
v_max3_f32 v2, v2, v70, v71
v_max3_f32 v3, v3, v76, v77
v_max_f32 v2, v2, v3
v_mov_b32 v3, v2
s_nop 1
v_permlane32_swap_b32 v2, v3
v_max_f32 v2, v2, v3
v_mov_b32 v3, v2
s_nop 1
v_permlane16_swap_b32 v2, v3
v_max_f32 v2, v2, v3
v_sub_f32 v64, v64, v2
v_sub_f32 v65, v65, v2
v_sub_f32 v66, v66, v2
v_sub_f32 v67, v67, v2
v_sub_f32 v68, v68, v2
v_sub_f32 v69, v69, v2
v_sub_f32 v70, v70, v2
v_sub_f32 v71, v71, v2
v_sub_f32 v76, v76, v2
v_sub_f32 v77, v77, v2
v_exp_f32 v64, v64
v_exp_f32 v65, v65
v_exp_f32 v66, v66
v_exp_f32 v67, v67
v_exp_f32 v68, v68
v_exp_f32 v69, v69
v_exp_f32 v70, v70
v_exp_f32 v71, v71
v_exp_f32 v76, v76
v_exp_f32 v77, v77
v_cvt_pk_bf16_f32 v72, v64, v65
v_cvt_pk_bf16_f32 v73, v66, v67
v_cvt_pk_bf16_f32 v74, v68, v69
v_cvt_pk_bf16_f32 v75, v70, v71
v_cvt_pk_bf16_f32 v12, v76, v77
s_nop 0
v_mfma_f32_16x16x32_bf16 v[88:91], v[72:75], v[6:9], 0
v_mfma_f32_16x16x32_bf16 v[92:95], v[72:75], v[32:35], 0
v_mfma_f32_16x16x32_bf16 v[96:99], v[72:75], v[36:39], 0
v_mfma_f32_16x16x32_bf16 v[88:91], v[12:15], v[6:9], v[88:91]
v_mfma_f32_16x16x32_bf16 v[92:95], v[12:15], v[16:19], v[92:95]
v_mfma_f32_16x16x32_bf16 v[96:99], v[10:13], v[16:19], v[96:99]
s_nop 7
v_rcp_f32 v90, v88
v_rcp_f32 v91, v89
v_mul_f32 v92, v92, v90
v_mul_f32 v93, v93, v91
v_mul_f32 v96, v96, v90
v_mul_f32 v97, v97, v91
v_cvt_pk_bf16_f32 v100, v92, v96
v_cvt_pk_bf16_f32 v101, v93, v97
ds_write2_b32 v29, v100, v101 offset0:0 offset1:80
v_mov_b64 v[2:3], -1
ds_read_b128 v[112:115], v20 offset:45056
ds_read_b128 v[116:119], v20 offset:46080
s_branch L_rec_f2_join
L_rec_f2_a_fail:
s_cmp_gt_u32 s3, 60
s_cbranch_scc1 L_rec_f2_a_f2
s_sleep 6
L_rec_f2_a_f2:
global_load_dwordx4 v[32:35], v24, s[4:5] sc1
global_load_dwordx4 v[36:39], v24, s[4:5] offset:1024 sc1
s_mov_b32 s19, 0
s_sub_u32 s3, s3, 1
s_cbranch_scc1 L_rec_f2_a_chk
s_waitcnt vmcnt(3)
s_branch L_rec_f2_a
L_rec_f2_a_chk:
s_mov_b32 s3, 60
s_waitcnt vmcnt(0)
s_sub_u32 s41, s41, 64
s_cbranch_scc1 L_rec_f2_a_dead
v_max3_u32 v2, v32, v33, v34
v_max3_u32 v3, v35, v36, v37
v_max3_u32 v2, v2, v38, v39
v_max_u32 v2, v2, v3
v_cmp_eq_u32 vcc, -1, v2
s_cbranch_vccnz L_rec_f2_a_fail
s_branch L_rec_f2_a_now
L_rec_f2_a_dead:
s_mov_b32 s41, 0
L_rec_f2_a_now:
v_mfma_f32_16x16x32_bf16 v[76:79], v[72:75], v[32:35], 0
v_mfma_f32_16x16x32_bf16 v[76:79], v[72:75], v[36:39], v[76:79]
s_nop 7
v_add_f32_dpp v76, v76, v76 row_ror:4 row_mask:0xf bank_mask:0xf
v_add_f32_dpp v77, v77, v77 row_ror:4 row_mask:0xf bank_mask:0xf
v_cmp_u_f32 vcc, v78, v79
v_add_f32_dpp v76, v76, v76 row_ror:8 row_mask:0xf bank_mask:0xf
v_add_f32_dpp v77, v77, v77 row_ror:8 row_mask:0xf bank_mask:0xf
v_cvt_pk_bf16_f32 v18, v76, v77
v_cmp_u_f32 vcc, v76, v77
v_and_b32 v2, 0x7fff7fff, v18
s_nop 0
v_cndmask_b32 v18, v18, v2, vcc
s_mov_b64 exec, s[44:45]
global_store_dword v25, v18, s[4:5]
s_mov_b64 exec, -1
s_branch L_rec_f2_a_ok
L_rec_f3:
v_mov_b32 v2, -1
v_xor_b32 v3, 0x6000, v25
global_store_dword v25, v2, s[4:5]
global_store_dword v3, v2, s[4:5]
ds_read_b128 v[40:43], v20 offset:63488
ds_read_b128 v[44:47], v20 offset:64512
ds_read_b128 v[48:51], v21 offset:6144
ds_read_b128 v[52:55], v21 offset:7168
ds_read_b128 v[56:59], v21 offset:14336
ds_read_b128 v[60:63], v21 offset:15360
ds_read_b128 v[88:91], v21 offset:22528
ds_read_b128 v[92:95], v21 offset:23552
ds_read_b128 v[96:99], v21 offset:47104
ds_read_b128 v[100:103], v21 offset:48128
ds_read_b128 v[104:107], v21 offset:55296
ds_read_b128 v[108:111], v21 offset:56320
ds_read_b128 v[112:115], v21 offset:63488
ds_read_b128 v[116:119], v21 offset:64512
v_mov_b64 v[64:65], 0
v_mov_b64 v[66:67], 0
v_mov_b64 v[68:69], 0
v_mov_b64 v[70:71], 0
v_mov_b64 v[80:81], 0
v_mov_b64 v[82:83], 0
v_mov_b64 v[84:85], 0
v_mov_b64 v[86:87], 0
L_rec_f3_top:
v_mov_b64 v[76:77], 0
v_mov_b64 v[78:79], 0
v_mov_b64 v[72:73], 0
v_mov_b64 v[74:75], 0
s_mov_b32 m0, s42
s_add_u32 s3, s40, 1
v_and_b32 v5, 0x1fff, v25
v_lshrrev_b32 v4, 2, v20
s_bitcmp1_b64 s[46:47], s3
s_cbranch_scc0 L_rec_f3_kv
L_rec_f3_kv_ok:
s_nop 15
s_nop 1
global_load_dwordx4 v[32:35], v26, s[4:5] sc1
global_load_dwordx4 v[36:39], v26, s[4:5] offset:1024 sc1
s_nop 15
s_nop 13
global_load_dwordx4 v[32:35], v26, s[4:5] sc1
global_load_dwordx4 v[36:39], v26, s[4:5] offset:1024 sc1
s_waitcnt vmcnt(2) lgkmcnt(0)
L_rec_f3_b1:
v_max3_u32 v2, v32, v33, v34
v_max3_u32 v3, v35, v36, v37
v_max3_u32 v2, v2, v38, v39
v_max_u32 v2, v2, v3
v_cmp_le_u32 vcc, s59, v2
v_smfmac_f32_16x16x64_bf16 v[64:67], v[32:35], v[40:47], v1
ds_write_b64 v20, v[32:33] offset:30720
s_cbranch_vccnz L_rec_f3_b0
L_rec_f3_b0_ok:
v_smfmac_f32_16x16x64_bf16 v[68:71], v[32:35], v[48:55], v1
ds_write_b64 v20, v[34:35] offset:30728
v_smfmac_f32_16x16x64_bf16 v[64:67], v[36:39], v[56:63], v1
ds_write_b64 v20, v[36:37] offset:31744
v_smfmac_f32_16x16x64_bf16 v[68:71], v[36:39], v[88:95], v1
ds_write_b64 v20, v[38:39] offset:31752
v_smfmac_f32_16x16x64_bf16 v[72:75], v[32:35], v[96:103], v1
ds_read_b128 v[88:91], v21 offset:30720
ds_read_b128 v[92:95], v21 offset:31744
v_smfmac_f32_16x16x64_bf16 v[76:79], v[32:35], v[104:111], v1
ds_read_b128 v[96:99], v21 offset:38912
ds_read_b128 v[100:103], v21 offset:39936
v_smfmac_f32_16x16x64_bf16 v[72:75], v[36:39], v[112:119], v1
s_waitcnt lgkmcnt(4)
s_barrier
ds_read_b128 v[40:43], v20 offset:24576
v_smfmac_f32_16x16x64_bf16 v[76:79], v[36:39], v[248:255], v1
ds_read_b128 v[44:47], v20 offset:25600
ds_read_b128 v[48:51], v20 offset:26624
v_smfmac_f32_16x16x64_bf16 v[80:83], v[32:35], a[48:55], v1
ds_read_b128 v[52:55], v20 offset:27648
ds_read_b128 v[56:59], v20 offset:28672
v_smfmac_f32_16x16x64_bf16 v[84:87], v[32:35], a[112:119], v1
s_waitcnt vmcnt(0)
ds_read_b128 v[60:63], v20 offset:29696
global_load_lds_dwordx4 v20, s[30:31] offset:0 sc1
v_smfmac_f32_16x16x64_bf16 v[80:83], v[36:39], a[56:63], v1
global_load_lds_dwordx4 v20, s[30:31] offset:1024 sc1
global_store_dword v5, v18, s[34:35] sc1
v_smfmac_f32_16x16x64_bf16 v[84:87], v[36:39], a[120:127], v1
s_waitcnt lgkmcnt(5)
ds_read_b128 v[32:35], v20 offset:22528
ds_read_b128 v[36:39], v20 offset:23552
v_smfmac_f32_16x16x64_bf16 v[64:67], v[40:43], v[88:95], v1
s_mov_b32 m0, 37632
v_smfmac_f32_16x16x64_bf16 v[68:71], v[40:43], v[96:103], v1
s_waitcnt lgkmcnt(6)
global_load_lds_dword v4, s[36:37] sc1
v_smfmac_f32_16x16x64_bf16 v[64:67], v[44:47], v[120:127], v1
s_mov_b32 m0, 22528
v_smfmac_f32_16x16x64_bf16 v[68:71], v[44:47], v[160:167], v1
s_waitcnt lgkmcnt(5)
s_waitcnt lgkmcnt(0)
global_load_lds_dwordx4 v20, s[32:33] offset:0 sc1
v_smfmac_f32_16x16x64_bf16 v[64:67], v[48:51], v[128:135], v1
global_load_lds_dwordx4 v20, s[32:33] offset:1024 sc1
v_mov_b64 v[2:3], -1
v_smfmac_f32_16x16x64_bf16 v[68:71], v[48:51], v[168:175], v1
v_mov_b64 v[4:5], -1
v_smfmac_f32_16x16x64_bf16 v[64:67], v[52:55], v[136:143], v1
v_smfmac_f32_16x16x64_bf16 v[68:71], v[52:55], v[176:183], v1
v_smfmac_f32_16x16x64_bf16 v[64:67], v[56:59], v[144:151], v1
ds_read_b128 v[104:107], v0 offset:0
v_smfmac_f32_16x16x64_bf16 v[68:71], v[56:59], v[184:191], v1
ds_read_b128 v[108:111], v0 offset:1024
v_smfmac_f32_16x16x64_bf16 v[64:67], v[60:63], v[152:159], v1
ds_read_b128 v[112:115], v0 offset:2048
v_smfmac_f32_16x16x64_bf16 v[68:71], v[60:63], v[192:199], v1
ds_read_b128 v[116:119], v0 offset:3072
v_smfmac_f32_16x16x64_bf16 v[72:75], v[40:43], v[200:207], v1
v_add_f32 v64, v64, v66
v_smfmac_f32_16x16x64_bf16 v[76:79], v[40:43], a[0:7], v1
v_add_f32 v68, v68, v70
v_smfmac_f32_16x16x64_bf16 v[72:75], v[44:47], v[208:215], v1
v_cvt_pk_bf16_f32 v66, v64, v68
v_smfmac_f32_16x16x64_bf16 v[76:79], v[44:47], a[8:15], v1
ds_write_b32 v27, v66
v_add_f32 v65, v65, v67
v_smfmac_f32_16x16x64_bf16 v[72:75], v[48:51], v[216:223], v1
v_add_f32 v69, v69, v71
v_smfmac_f32_16x16x64_bf16 v[76:79], v[48:51], a[16:23], v1
v_cvt_pk_bf16_f32 v67, v65, v69
v_smfmac_f32_16x16x64_bf16 v[72:75], v[52:55], v[224:231], v1
ds_write_b32 v27, v67 offset:288
v_xor_b32 v16, 0x4000, v25
v_smfmac_f32_16x16x64_bf16 v[76:79], v[52:55], a[24:31], v1
global_store_dword v16, v2, s[4:5]
v_smfmac_f32_16x16x64_bf16 v[72:75], v[56:59], v[232:239], v1
v_smfmac_f32_16x16x64_bf16 v[76:79], v[56:59], a[32:39], v1
v_smfmac_f32_16x16x64_bf16 v[72:75], v[60:63], v[240:247], v1
s_waitcnt lgkmcnt(0)
s_barrier
ds_read_b128 v[88:91], v28 offset:0
v_smfmac_f32_16x16x64_bf16 v[76:79], v[60:63], a[40:47], v1
ds_read_b128 v[92:95], v28 offset:64
ds_read_b128 v[96:99], v28 offset:128
v_smfmac_f32_16x16x64_bf16 v[80:83], v[40:43], a[64:71], v1
ds_read_b128 v[100:103], v28 offset:192
v_add_f32 v72, v72, v74
v_smfmac_f32_16x16x64_bf16 v[84:87], v[40:43], a[128:135], v1
v_add_f32 v76, v76, v78
v_smfmac_f32_16x16x64_bf16 v[80:83], v[44:47], a[72:79], v1
v_cvt_pk_bf16_f32 v74, v72, v76
v_smfmac_f32_16x16x64_bf16 v[84:87], v[44:47], a[136:143], v1
s_waitcnt lgkmcnt(3)
ds_write_b32 v27, v74 offset:576
v_add_f32 v73, v73, v75
v_mfma_f32_16x16x32_bf16 v[64:67], v[104:107], v[88:91], 0
v_add_f32 v77, v77, v79
v_cvt_pk_bf16_f32 v75, v73, v77
v_smfmac_f32_16x16x64_bf16 v[80:83], v[48:51], a[80:87], v1
s_waitcnt lgkmcnt(3)
ds_write_b32 v27, v75 offset:864
ds_read_b128 v[104:107], v0 offset:4096
v_mfma_f32_16x16x32_bf16 v[64:67], v[108:111], v[92:95], v[64:67]
v_mov_b64 v[40:41], 0
v_mov_b64 v[42:43], 0
v_smfmac_f32_16x16x64_bf16 v[84:87], v[48:51], a[144:151], v1
s_waitcnt lgkmcnt(4)
ds_read_b128 v[108:111], v0 offset:5120
v_mov_b64 v[44:45], 0
v_mfma_f32_16x16x32_bf16 v[64:67], v[112:115], v[96:99], v[64:67]
v_mov_b64 v[46:47], 0
v_smfmac_f32_16x16x64_bf16 v[80:83], v[52:55], a[88:95], v1
s_waitcnt lgkmcnt(4)
ds_read_b128 v[112:115], v0 offset:6144
v_mfma_f32_16x16x32_bf16 v[64:67], v[116:119], v[100:103], v[64:67]
v_smfmac_f32_16x16x64_bf16 v[84:87], v[52:55], a[152:159], v1
s_waitcnt lgkmcnt(2)
ds_read_b128 v[116:119], v0 offset:7168
v_mfma_f32_16x16x32_bf16 v[68:71], v[104:107], v[88:91], 0
s_barrier
v_exp_f32 v64, v64
v_smfmac_f32_16x16x64_bf16 v[80:83], v[56:59], a[96:103], v1
s_waitcnt lgkmcnt(2)
ds_read_b128 v[104:107], v28 offset:576
v_mov_b64 v[48:49], 0
v_mfma_f32_16x16x32_bf16 v[68:71], v[108:111], v[92:95], v[68:71]
v_exp_f32 v65, v65
v_smfmac_f32_16x16x64_bf16 v[84:87], v[56:59], a[160:167], v1
s_waitcnt lgkmcnt(2)
ds_read_b128 v[108:111], v28 offset:640
v_cvt_pk_bf16_f32 v72, v64, v65
v_mfma_f32_16x16x32_bf16 v[68:71], v[112:115], v[96:99], v[68:71]
v_exp_f32 v66, v66
v_smfmac_f32_16x16x64_bf16 v[80:83], v[60:63], a[104:111], v1
s_waitcnt lgkmcnt(2)
ds_read_b128 v[112:115], v28 offset:704
v_mov_b64 v[50:51], 0
v_mfma_f32_16x16x32_bf16 v[68:71], v[116:119], v[100:103], v[68:71]
v_exp_f32 v67, v67
v_smfmac_f32_16x16x64_bf16 v[84:87], v[60:63], a[168:175], v1
s_waitcnt lgkmcnt(2)
ds_read_b128 v[116:119], v28 offset:768
v_cvt_pk_bf16_f32 v73, v66, v67
v_mfma_f32_16x16x32_bf16 v[76:79], v[104:107], v[88:91], 0
s_waitcnt lgkmcnt(2)
v_exp_f32 v68, v68
v_mfma_f32_16x16x32_bf16 v[76:79], v[108:111], v[92:95], v[76:79]
s_waitcnt lgkmcnt(1)
v_exp_f32 v69, v69
v_mfma_f32_16x16x32_bf16 v[76:79], v[112:115], v[96:99], v[76:79]
s_waitcnt lgkmcnt(0)
v_exp_f32 v70, v70
v_mfma_f32_16x16x32_bf16 v[76:79], v[116:119], v[100:103], v[76:79]
v_exp_f32 v71, v71
v_cvt_pk_bf16_f32 v74, v68, v69
v_cvt_pk_bf16_f32 v75, v70, v71
v_add_f32 v80, v80, v82
v_add_f32 v81, v81, v83
v_mfma_f32_16x16x32_bf16 v[88:91], v[72:75], v[6:9], 0
ds_read_b128 v[112:115], v20 offset:47104
v_mul_f32 v76, s38, v76
v_mul_f32 v77, s38, v77
v_mfma_f32_16x16x32_bf16 v[92:95], v[72:75], v[32:35], 0
v_exp_f32 v78, v76
v_add_f32 v84, v84, v86
v_mfma_f32_16x16x32_bf16 v[96:99], v[72:75], v[36:39], 0
v_exp_f32 v79, v77
v_add_f32 v85, v85, v87
v_cvt_pk_bf16_f32 v12, v78, v79
v_cvt_pk_bf16_f32 v16, v80, v81
v_cvt_pk_bf16_f32 v18, v84, v85
v_mfma_f32_16x16x32_bf16 v[88:91], v[12:15], v[6:9], v[88:91]
ds_read_b128 v[116:119], v20 offset:48128
v_mov_b64 v[52:53], 0
v_mfma_f32_16x16x32_bf16 v[92:95], v[12:15], v[16:19], v[92:95]
ds_read_b128 v[80:83], v20 offset:55296
v_mov_b64 v[54:55], 0
v_mfma_f32_16x16x32_bf16 v[96:99], v[10:13], v[16:19], v[96:99]
ds_read_b128 v[84:87], v20 offset:56320
v_rcp_f32 v90, v88
v_rcp_f32 v91, v89
v_mul_f32 v92, v92, v90
v_mul_f32 v93, v93, v91
s_nop 0
v_mul_f32 v96, v96, v90
v_mul_f32 v97, v97, v91
v_cvt_pk_bf16_f32 v100, v92, v96
v_cvt_pk_bf16_f32 v101, v93, v97
ds_write2_b32 v29, v100, v101 offset0:0 offset1:80
v_max3_f32 v102, v88, v89, v90
v_max_f32 v102, v102, v91
v_cmp_nge_f32 vcc, s39, v102
global_store_dwordx4 v24, v[2:5], s[4:5]
global_store_dwordx4 v24, v[2:5], s[4:5] offset:1024
s_cbranch_vccnz L_rec_f3_slow
L_rec_f3_join:
s_waitcnt lgkmcnt(0)
s_barrier
ds_read_b128 v[104:107], v30 offset:24576
ds_read_b128 v[108:111], v30 offset:24704
v_mov_b64 v[32:33], 0
v_mov_b64 v[34:35], 0
v_mov_b64 v[36:37], 0
v_mov_b64 v[38:39], 0
v_mov_b64 v[56:57], 0
v_mov_b64 v[58:59], 0
v_xor_b32 v24, 0x40000, v24
s_waitcnt lgkmcnt(1)
v_smfmac_f32_16x16x64_bf16 v[32:35], v[104:107], a[176:183], v1
s_waitcnt lgkmcnt(0)
ds_read_b128 v[88:91], v22 offset:6144
v_mov_b64 v[60:61], 0
v_smfmac_f32_16x16x64_bf16 v[32:35], v[108:111], a[184:191], v1
ds_read_b128 v[92:95], v22 offset:7168
v_mov_b64 v[62:63], 0
v_smfmac_f32_16x16x64_bf16 v[36:39], v[104:107], v[112:119], v1
ds_read_b128 v[96:99], v22 offset:14336
v_smfmac_f32_16x16x64_bf16 v[36:39], v[108:111], v[80:87], v1
ds_read_b128 v[100:103], v22 offset:15360
v_add_f32 v32, v32, v34
v_smfmac_f32_16x16x64_bf16 v[40:43], v[104:107], a[192:199], v1
ds_read_b128 v[112:115], v22 offset:22528
v_add_f32 v33, v33, v35
v_smfmac_f32_16x16x64_bf16 v[40:43], v[108:111], a[200:207], v1
ds_read_b128 v[116:119], v22 offset:23552
v_add_f32 v36, v36, v38
v_add_f32 v37, v37, v39
v_smfmac_f32_16x16x64_bf16 v[44:47], v[104:107], a[208:215], v1
s_waitcnt lgkmcnt(4)
ds_read_b128 v[80:83], v22 offset:30720
v_cvt_pk_bf16_f32 v64, v32, v36
v_cvt_pk_bf16_f32 v65, v33, v37
v_smfmac_f32_16x16x64_bf16 v[44:47], v[108:111], v[88:95], v1
s_waitcnt lgkmcnt(3)
global_store_dwordx2 v23, v[64:65], s[20:21]
v_add_f32 v40, v40, v42
v_smfmac_f32_16x16x64_bf16 v[48:51], v[104:107], v[96:103], v1
ds_read_b128 v[84:87], v22 offset:31744
v_add_f32 v41, v41, v43
v_smfmac_f32_16x16x64_bf16 v[48:51], v[108:111], a[216:223], v1
ds_read_b128 v[72:75], v20 offset:39936
v_add_f32 v44, v44, v46
v_add_f32 v45, v45, v47
v_smfmac_f32_16x16x64_bf16 v[52:55], v[104:107], a[224:231], v1
v_cvt_pk_bf16_f32 v66, v40, v44
v_cvt_pk_bf16_f32 v67, v41, v45
v_smfmac_f32_16x16x64_bf16 v[52:55], v[108:111], a[232:239], v1
s_waitcnt lgkmcnt(3)
global_store_dwordx2 v23, v[66:67], s[22:23]
v_add_f32 v48, v48, v50
v_smfmac_f32_16x16x64_bf16 v[56:59], v[104:107], v[112:119], v1
s_waitcnt lgkmcnt(1)
v_add_f32 v49, v49, v51
v_smfmac_f32_16x16x64_bf16 v[56:59], v[108:111], v[80:87], v1
v_add_f32 v52, v52, v54
v_add_f32 v53, v53, v55
v_smfmac_f32_16x16x64_bf16 v[60:63], v[104:107], a[240:247], v1
v_cvt_pk_bf16_f32 v68, v48, v52
v_cvt_pk_bf16_f32 v69, v49, v53
v_smfmac_f32_16x16x64_bf16 v[60:63], v[108:111], a[248:255], v1
global_store_dwordx2 v23, v[68:69], s[24:25]
v_add_f32 v56, v56, v58
v_add_f32 v57, v57, v59
s_nop 4
v_pk_add_f32 v[60:61], v[60:61], v[62:63]
v_cvt_pk_bf16_f32 v70, v56, v60
v_cvt_pk_bf16_f32 v71, v57, v61
global_store_dwordx2 v23, v[70:71], s[26:27]
s_waitcnt lgkmcnt(0)
ds_read_b128 v[40:43], v20 offset:63488
ds_read_b128 v[44:47], v20 offset:64512
ds_read_b128 v[48:51], v21 offset:6144
ds_read_b128 v[52:55], v21 offset:7168
ds_read_b128 v[56:59], v21 offset:14336
ds_read_b128 v[60:63], v21 offset:15360
ds_read_b128 v[88:91], v21 offset:22528
ds_read_b128 v[92:95], v21 offset:23552
ds_read_b128 v[96:99], v21 offset:47104
ds_read_b128 v[100:103], v21 offset:48128
ds_read_b128 v[104:107], v21 offset:55296
ds_read_b128 v[108:111], v21 offset:56320
ds_read_b128 v[112:115], v21 offset:63488
ds_read_b128 v[116:119], v21 offset:64512
v_mov_b64 v[64:65], 0
v_mov_b64 v[66:67], 0
v_mov_b64 v[68:69], 0
v_mov_b64 v[70:71], 0
v_mov_b64 v[80:81], 0
v_mov_b64 v[82:83], 0
v_mov_b64 v[84:85], 0
v_mov_b64 v[86:87], 0
s_add_u32 s30, s30, 786432
s_addc_u32 s31, s31, 0
s_add_u32 s32, s32, 786432
s_addc_u32 s33, s33, 0
s_add_u32 s34, s34, 8192
s_addc_u32 s35, s35, 0
s_add_u32 s40, s40, 1
global_load_dwordx4 v[32:35], v24, s[4:5] sc1
global_load_dwordx4 v[36:39], v24, s[4:5] offset:1024 sc1
s_xor_b32 s42, s42, 8192
v_add_u32 v2, 0x2000, v26
v_bfi_b32 v26, s43, v2, v26
v_xor_b32 v23, 0x40000, v23
v_xor_b32 v0, 8192, v0
s_nop 15
s_nop 8
global_load_dwordx4 v[32:35], v24, s[4:5] sc1
global_load_dwordx4 v[36:39], v24, s[4:5] offset:1024 sc1
s_mov_b32 s3, 64
v_add_u32 v4, 0x2000, v25
s_waitcnt vmcnt(2)
L_rec_f3_a:
v_mfma_f32_16x16x32_bf16 v[76:79], v[72:75], v[32:35], 0
v_mfma_f32_16x16x32_bf16 v[76:79], v[72:75], v[36:39], v[76:79]
s_nop 7
v_add_f32_dpp v76, v76, v76 row_ror:4 row_mask:0xf bank_mask:0xf
v_add_f32_dpp v77, v77, v77 row_ror:4 row_mask:0xf bank_mask:0xf
v_cmp_u_f32 vcc, v78, v79
v_add_f32_dpp v76, v76, v76 row_ror:8 row_mask:0xf bank_mask:0xf
v_add_f32_dpp v77, v77, v77 row_ror:8 row_mask:0xf bank_mask:0xf
v_cvt_pk_bf16_f32 v18, v76, v77
s_mov_b64 exec, s[44:45]
global_store_dword v25, v18, s[4:5]
s_mov_b64 exec, -1
s_cbranch_vccnz L_rec_f3_a_fail
L_rec_f3_a_ok:
v_bfi_b32 v25, s43, v4, v25
s_cmp_lt_u32 s40, 63
s_cbranch_scc1 L_rec_f3_top
v_and_b32 v5, 0x1fff, v25
global_store_dword v5, v18, s[34:35] sc1
s_branch L_rec_done
L_rec_f3_kv:
ds_read_b32 v3, v4 offset:37632
s_waitcnt lgkmcnt(0)
L_rec_f3_kv2:
v_cmp_eq_u32 s[46:47], 1, v3
s_bitcmp1_b64 s[46:47], s3
s_cbranch_scc1 L_rec_f3_kv_ok
global_load_dword v3, v4, s[36:37] sc1
s_waitcnt vmcnt(0)
s_sub_u32 s41, s41, 1
s_cbranch_scc0 L_rec_f3_kv2
s_mov_b32 s41, 0
s_branch L_rec_f3_kv_ok
L_rec_f3_b0:
global_load_dwordx4 v[32:35], v26, s[4:5] sc1
global_load_dwordx4 v[36:39], v26, s[4:5] offset:1024 sc1
s_mov_b32 s18, 0
s_sub_u32 s41, s41, 1
s_cbranch_scc1 L_rec_f3_b0_dead
s_nop 1
v_mov_b64 v[64:65], 0
v_mov_b64 v[66:67], 0
s_waitcnt vmcnt(2)
s_branch L_rec_f3_b1
L_rec_f3_b0_dead:
s_mov_b32 s41, 0
s_branch L_rec_f3_b0_ok
L_rec_f3_slow:
s_waitcnt lgkmcnt(0)
ds_read_b128 v[88:91], v28 offset:0
ds_read_b128 v[92:95], v28 offset:64
ds_read_b128 v[96:99], v28 offset:128
ds_read_b128 v[100:103], v28 offset:192
ds_read_b128 v[104:107], v0 offset:0
ds_read_b128 v[108:111], v0 offset:1024
ds_read_b128 v[112:115], v0 offset:2048
ds_read_b128 v[116:119], v0 offset:3072
s_waitcnt lgkmcnt(0)
v_mfma_f32_16x16x32_bf16 v[64:67], v[104:107], v[88:91], 0
v_mfma_f32_16x16x32_bf16 v[64:67], v[108:111], v[92:95], v[64:67]
v_mfma_f32_16x16x32_bf16 v[64:67], v[112:115], v[96:99], v[64:67]
v_mfma_f32_16x16x32_bf16 v[64:67], v[116:119], v[100:103], v[64:67]
ds_read_b128 v[104:107], v0 offset:4096
ds_read_b128 v[108:111], v0 offset:5120
ds_read_b128 v[112:115], v0 offset:6144
ds_read_b128 v[116:119], v0 offset:7168
s_waitcnt lgkmcnt(0)
v_mfma_f32_16x16x32_bf16 v[68:71], v[104:107], v[88:91], 0
v_mfma_f32_16x16x32_bf16 v[68:71], v[108:111], v[92:95], v[68:71]
v_mfma_f32_16x16x32_bf16 v[68:71], v[112:115], v[96:99], v[68:71]
v_mfma_f32_16x16x32_bf16 v[68:71], v[116:119], v[100:103], v[68:71]
s_nop 7
v_max3_f32 v2, v64, v65, v66
v_max3_f32 v3, v67, v68, v69
v_max3_f32 v2, v2, v70, v71
v_max3_f32 v3, v3, v76, v77
v_max_f32 v2, v2, v3
v_mov_b32 v3, v2
s_nop 1
v_permlane32_swap_b32 v2, v3
v_max_f32 v2, v2, v3
v_mov_b32 v3, v2
s_nop 1
v_permlane16_swap_b32 v2, v3
v_max_f32 v2, v2, v3
v_sub_f32 v64, v64, v2
v_sub_f32 v65, v65, v2
v_sub_f32 v66, v66, v2
v_sub_f32 v67, v67, v2
v_sub_f32 v68, v68, v2
v_sub_f32 v69, v69, v2
v_sub_f32 v70, v70, v2
v_sub_f32 v71, v71, v2
v_sub_f32 v76, v76, v2
v_sub_f32 v77, v77, v2
v_exp_f32 v64, v64
v_exp_f32 v65, v65
v_exp_f32 v66, v66
v_exp_f32 v67, v67
v_exp_f32 v68, v68
v_exp_f32 v69, v69
v_exp_f32 v70, v70
v_exp_f32 v71, v71
v_exp_f32 v76, v76
v_exp_f32 v77, v77
v_cvt_pk_bf16_f32 v72, v64, v65
v_cvt_pk_bf16_f32 v73, v66, v67
v_cvt_pk_bf16_f32 v74, v68, v69
v_cvt_pk_bf16_f32 v75, v70, v71
v_cvt_pk_bf16_f32 v12, v76, v77
s_nop 0
v_mfma_f32_16x16x32_bf16 v[88:91], v[72:75], v[6:9], 0
v_mfma_f32_16x16x32_bf16 v[92:95], v[72:75], v[32:35], 0
v_mfma_f32_16x16x32_bf16 v[96:99], v[72:75], v[36:39], 0
v_mfma_f32_16x16x32_bf16 v[88:91], v[12:15], v[6:9], v[88:91]
v_mfma_f32_16x16x32_bf16 v[92:95], v[12:15], v[16:19], v[92:95]
v_mfma_f32_16x16x32_bf16 v[96:99], v[10:13], v[16:19], v[96:99]
s_nop 7
v_rcp_f32 v90, v88
v_rcp_f32 v91, v89
v_mul_f32 v92, v92, v90
v_mul_f32 v93, v93, v91
v_mul_f32 v96, v96, v90
v_mul_f32 v97, v97, v91
v_cvt_pk_bf16_f32 v100, v92, v96
v_cvt_pk_bf16_f32 v101, v93, v97
ds_write2_b32 v29, v100, v101 offset0:0 offset1:80
v_mov_b64 v[2:3], -1
ds_read_b128 v[112:115], v20 offset:47104
ds_read_b128 v[116:119], v20 offset:48128
s_branch L_rec_f3_join
L_rec_f3_a_fail:
s_cmp_gt_u32 s3, 60
s_cbranch_scc1 L_rec_f3_a_f2
s_sleep 6
L_rec_f3_a_f2:
global_load_dwordx4 v[32:35], v24, s[4:5] sc1
global_load_dwordx4 v[36:39], v24, s[4:5] offset:1024 sc1
s_mov_b32 s19, 0
s_sub_u32 s3, s3, 1
s_cbranch_scc1 L_rec_f3_a_chk
s_waitcnt vmcnt(3)
s_branch L_rec_f3_a
L_rec_f3_a_chk:
s_mov_b32 s3, 60
s_waitcnt vmcnt(0)
s_sub_u32 s41, s41, 64
s_cbranch_scc1 L_rec_f3_a_dead
v_max3_u32 v2, v32, v33, v34
v_max3_u32 v3, v35, v36, v37
v_max3_u32 v2, v2, v38, v39
v_max_u32 v2, v2, v3
v_cmp_eq_u32 vcc, -1, v2
s_cbranch_vccnz L_rec_f3_a_fail
s_branch L_rec_f3_a_now
L_rec_f3_a_dead:
s_mov_b32 s41, 0
L_rec_f3_a_now:
v_mfma_f32_16x16x32_bf16 v[76:79], v[72:75], v[32:35], 0
v_mfma_f32_16x16x32_bf16 v[76:79], v[72:75], v[36:39], v[76:79]
s_nop 7
v_add_f32_dpp v76, v76, v76 row_ror:4 row_mask:0xf bank_mask:0xf
v_add_f32_dpp v77, v77, v77 row_ror:4 row_mask:0xf bank_mask:0xf
v_cmp_u_f32 vcc, v78, v79
v_add_f32_dpp v76, v76, v76 row_ror:8 row_mask:0xf bank_mask:0xf
v_add_f32_dpp v77, v77, v77 row_ror:8 row_mask:0xf bank_mask:0xf
v_cvt_pk_bf16_f32 v18, v76, v77
v_cmp_u_f32 vcc, v76, v77
v_and_b32 v2, 0x7fff7fff, v18
s_nop 0
v_cndmask_b32 v18, v18, v2, vcc
s_mov_b64 exec, s[44:45]
global_store_dword v25, v18, s[4:5]
s_mov_b64 exec, -1
s_branch L_rec_f3_a_ok
L_rec_slow:
s_cmp_eq_u32 s14, 1
s_cbranch_scc1 L_rec_s1
s_cmp_eq_u32 s14, 2
s_cbranch_scc1 L_rec_s2
s_cmp_eq_u32 s14, 3
s_cbranch_scc1 L_rec_s3
L_rec_s0:
v_mov_b32 v2, -1
v_xor_b32 v3, 0x6000, v25
global_store_dword v25, v2, s[4:5] sc1
global_store_dword v3, v2, s[4:5] sc1
ds_read_b128 v[40:43], v20 offset:57344
ds_read_b128 v[44:47], v20 offset:58368
ds_read_b128 v[48:51], v21 offset:0
ds_read_b128 v[52:55], v21 offset:1024
ds_read_b128 v[56:59], v21 offset:8192
ds_read_b128 v[60:63], v21 offset:9216
ds_read_b128 v[88:91], v21 offset:16384
ds_read_b128 v[92:95], v21 offset:17408
ds_read_b128 v[96:99], v21 offset:40960
ds_read_b128 v[100:103], v21 offset:41984
ds_read_b128 v[104:107], v21 offset:49152
ds_read_b128 v[108:111], v21 offset:50176
ds_read_b128 v[112:115], v21 offset:57344
ds_read_b128 v[116:119], v21 offset:58368
v_mov_b64 v[64:65], 0
v_mov_b64 v[66:67], 0
v_mov_b64 v[68:69], 0
v_mov_b64 v[70:71], 0
v_mov_b64 v[80:81], 0
v_mov_b64 v[82:83], 0
v_mov_b64 v[84:85], 0
v_mov_b64 v[86:87], 0
L_rec_s0_top:
v_mov_b64 v[76:77], 0
v_mov_b64 v[78:79], 0
v_mov_b64 v[72:73], 0
v_mov_b64 v[74:75], 0
s_mov_b32 m0, s42
s_add_u32 s3, s40, 1
v_and_b32 v5, 0x1fff, v25
v_lshrrev_b32 v4, 2, v20
s_bitcmp1_b64 s[46:47], s3
s_cbranch_scc0 L_rec_s0_kv
L_rec_s0_kv_ok:
s_nop 15
s_nop 1
global_load_dwordx4 v[32:35], v26, s[4:5] sc1
global_load_dwordx4 v[36:39], v26, s[4:5] offset:1024 sc1
s_nop 15
s_nop 13
global_load_dwordx4 v[32:35], v26, s[4:5] sc1
global_load_dwordx4 v[36:39], v26, s[4:5] offset:1024 sc1
s_waitcnt vmcnt(2) lgkmcnt(0)
L_rec_s0_b1:
v_max3_u32 v2, v32, v33, v34
v_max3_u32 v3, v35, v36, v37
v_max3_u32 v2, v2, v38, v39
v_max_u32 v2, v2, v3
v_cmp_le_u32 vcc, s59, v2
v_smfmac_f32_16x16x64_bf16 v[64:67], v[32:35], v[40:47], v1
ds_write_b64 v20, v[32:33] offset:24576
s_cbranch_vccnz L_rec_s0_b0
L_rec_s0_b0_ok:
v_smfmac_f32_16x16x64_bf16 v[68:71], v[32:35], v[48:55], v1
ds_write_b64 v20, v[34:35] offset:24584
v_smfmac_f32_16x16x64_bf16 v[64:67], v[36:39], v[56:63], v1
ds_write_b64 v20, v[36:37] offset:25600
v_smfmac_f32_16x16x64_bf16 v[68:71], v[36:39], v[88:95], v1
ds_write_b64 v20, v[38:39] offset:25608
v_smfmac_f32_16x16x64_bf16 v[72:75], v[32:35], v[96:103], v1
ds_read_b128 v[88:91], v21 offset:24576
ds_read_b128 v[92:95], v21 offset:25600
v_smfmac_f32_16x16x64_bf16 v[76:79], v[32:35], v[104:111], v1
ds_read_b128 v[96:99], v21 offset:32768
ds_read_b128 v[100:103], v21 offset:33792
v_smfmac_f32_16x16x64_bf16 v[72:75], v[36:39], v[112:119], v1
v_smfmac_f32_16x16x64_bf16 v[76:79], v[36:39], v[248:255], v1
v_smfmac_f32_16x16x64_bf16 v[80:83], v[32:35], a[48:55], v1
s_waitcnt lgkmcnt(4)
s_barrier
ds_read_b128 v[40:43], v20 offset:26624
v_smfmac_f32_16x16x64_bf16 v[84:87], v[32:35], a[112:119], v1
ds_read_b128 v[44:47], v20 offset:27648
ds_read_b128 v[48:51], v20 offset:28672
v_smfmac_f32_16x16x64_bf16 v[80:83], v[36:39], a[56:63], v1
ds_read_b128 v[52:55], v20 offset:29696
ds_read_b128 v[56:59], v20 offset:30720
v_smfmac_f32_16x16x64_bf16 v[84:87], v[36:39], a[120:127], v1
s_waitcnt lgkmcnt(4)
s_waitcnt vmcnt(0)
ds_read_b128 v[60:63], v20 offset:31744
global_load_lds_dwordx4 v20, s[30:31] offset:0 sc1
v_smfmac_f32_16x16x64_bf16 v[64:67], v[40:43], v[88:95], v1
global_load_lds_dwordx4 v20, s[30:31] offset:1024 sc1
global_store_dword v5, v18, s[34:35] sc1
v_smfmac_f32_16x16x64_bf16 v[68:71], v[40:43], v[96:103], v1
s_waitcnt lgkmcnt(4)
ds_read_b128 v[32:35], v20 offset:16384
ds_read_b128 v[36:39], v20 offset:17408
v_smfmac_f32_16x16x64_bf16 v[64:67], v[44:47], v[120:127], v1
s_mov_b32 m0, 37632
v_smfmac_f32_16x16x64_bf16 v[68:71], v[44:47], v[160:167], v1
s_waitcnt lgkmcnt(5)
global_load_lds_dword v4, s[36:37] sc1
v_smfmac_f32_16x16x64_bf16 v[64:67], v[48:51], v[128:135], v1
s_mov_b32 m0, 16384
v_smfmac_f32_16x16x64_bf16 v[68:71], v[48:51], v[168:175], v1
s_waitcnt lgkmcnt(4)
s_waitcnt lgkmcnt(0)
global_load_lds_dwordx4 v20, s[32:33] offset:0 sc1
v_smfmac_f32_16x16x64_bf16 v[64:67], v[52:55], v[136:143], v1
global_load_lds_dwordx4 v20, s[32:33] offset:1024 sc1
v_mov_b64 v[2:3], -1
v_smfmac_f32_16x16x64_bf16 v[68:71], v[52:55], v[176:183], v1
v_mov_b64 v[4:5], -1
v_smfmac_f32_16x16x64_bf16 v[64:67], v[56:59], v[144:151], v1
ds_read_b128 v[104:107], v0 offset:0
v_smfmac_f32_16x16x64_bf16 v[68:71], v[56:59], v[184:191], v1
ds_read_b128 v[108:111], v0 offset:1024
v_smfmac_f32_16x16x64_bf16 v[64:67], v[60:63], v[152:159], v1
ds_read_b128 v[112:115], v0 offset:2048
v_smfmac_f32_16x16x64_bf16 v[68:71], v[60:63], v[192:199], v1
ds_read_b128 v[116:119], v0 offset:3072
v_smfmac_f32_16x16x64_bf16 v[72:75], v[40:43], v[200:207], v1
v_add_f32 v64, v64, v66
v_smfmac_f32_16x16x64_bf16 v[76:79], v[40:43], a[0:7], v1
v_add_f32 v68, v68, v70
v_smfmac_f32_16x16x64_bf16 v[72:75], v[44:47], v[208:215], v1
v_cvt_pk_bf16_f32 v66, v64, v68
v_smfmac_f32_16x16x64_bf16 v[76:79], v[44:47], a[8:15], v1
ds_write_b32 v27, v66
v_add_f32 v65, v65, v67
v_smfmac_f32_16x16x64_bf16 v[72:75], v[48:51], v[216:223], v1
v_add_f32 v69, v69, v71
v_smfmac_f32_16x16x64_bf16 v[76:79], v[48:51], a[16:23], v1
v_cvt_pk_bf16_f32 v67, v65, v69
v_smfmac_f32_16x16x64_bf16 v[72:75], v[52:55], v[224:231], v1
ds_write_b32 v27, v67 offset:288
v_xor_b32 v16, 0x4000, v25
v_smfmac_f32_16x16x64_bf16 v[76:79], v[52:55], a[24:31], v1
global_store_dword v16, v2, s[4:5] sc1
v_smfmac_f32_16x16x64_bf16 v[72:75], v[56:59], v[232:239], v1
v_smfmac_f32_16x16x64_bf16 v[76:79], v[56:59], a[32:39], v1
v_smfmac_f32_16x16x64_bf16 v[72:75], v[60:63], v[240:247], v1
s_waitcnt lgkmcnt(0)
s_barrier
ds_read_b128 v[88:91], v28 offset:0
v_smfmac_f32_16x16x64_bf16 v[76:79], v[60:63], a[40:47], v1
ds_read_b128 v[92:95], v28 offset:64
ds_read_b128 v[96:99], v28 offset:128
v_smfmac_f32_16x16x64_bf16 v[80:83], v[40:43], a[64:71], v1
ds_read_b128 v[100:103], v28 offset:192
v_add_f32 v72, v72, v74
v_smfmac_f32_16x16x64_bf16 v[84:87], v[40:43], a[128:135], v1
v_add_f32 v76, v76, v78
v_smfmac_f32_16x16x64_bf16 v[80:83], v[44:47], a[72:79], v1
v_cvt_pk_bf16_f32 v74, v72, v76
v_smfmac_f32_16x16x64_bf16 v[84:87], v[44:47], a[136:143], v1
s_waitcnt lgkmcnt(3)
ds_write_b32 v27, v74 offset:576
v_add_f32 v73, v73, v75
v_mfma_f32_16x16x32_bf16 v[64:67], v[104:107], v[88:91], 0
v_add_f32 v77, v77, v79
v_cvt_pk_bf16_f32 v75, v73, v77
v_smfmac_f32_16x16x64_bf16 v[80:83], v[48:51], a[80:87], v1
s_waitcnt lgkmcnt(3)
ds_write_b32 v27, v75 offset:864
ds_read_b128 v[104:107], v0 offset:4096
v_mfma_f32_16x16x32_bf16 v[64:67], v[108:111], v[92:95], v[64:67]
v_mov_b64 v[40:41], 0
v_mov_b64 v[42:43], 0
v_smfmac_f32_16x16x64_bf16 v[84:87], v[48:51], a[144:151], v1
s_waitcnt lgkmcnt(4)
ds_read_b128 v[108:111], v0 offset:5120
v_mov_b64 v[44:45], 0
v_mfma_f32_16x16x32_bf16 v[64:67], v[112:115], v[96:99], v[64:67]
v_mov_b64 v[46:47], 0
v_smfmac_f32_16x16x64_bf16 v[80:83], v[52:55], a[88:95], v1
s_waitcnt lgkmcnt(4)
ds_read_b128 v[112:115], v0 offset:6144
v_mfma_f32_16x16x32_bf16 v[64:67], v[116:119], v[100:103], v[64:67]
v_smfmac_f32_16x16x64_bf16 v[84:87], v[52:55], a[152:159], v1
s_waitcnt lgkmcnt(2)
ds_read_b128 v[116:119], v0 offset:7168
v_mfma_f32_16x16x32_bf16 v[68:71], v[104:107], v[88:91], 0
s_barrier
v_exp_f32 v64, v64
v_smfmac_f32_16x16x64_bf16 v[80:83], v[56:59], a[96:103], v1
s_waitcnt lgkmcnt(2)
ds_read_b128 v[104:107], v28 offset:576
v_mov_b64 v[48:49], 0
v_mfma_f32_16x16x32_bf16 v[68:71], v[108:111], v[92:95], v[68:71]
v_exp_f32 v65, v65
v_smfmac_f32_16x16x64_bf16 v[84:87], v[56:59], a[160:167], v1
s_waitcnt lgkmcnt(2)
ds_read_b128 v[108:111], v28 offset:640
v_cvt_pk_bf16_f32 v72, v64, v65
v_mfma_f32_16x16x32_bf16 v[68:71], v[112:115], v[96:99], v[68:71]
v_exp_f32 v66, v66
v_smfmac_f32_16x16x64_bf16 v[80:83], v[60:63], a[104:111], v1
s_waitcnt lgkmcnt(2)
ds_read_b128 v[112:115], v28 offset:704
v_mov_b64 v[50:51], 0
v_mfma_f32_16x16x32_bf16 v[68:71], v[116:119], v[100:103], v[68:71]
v_exp_f32 v67, v67
v_smfmac_f32_16x16x64_bf16 v[84:87], v[60:63], a[168:175], v1
s_waitcnt lgkmcnt(2)
ds_read_b128 v[116:119], v28 offset:768
v_cvt_pk_bf16_f32 v73, v66, v67
v_mfma_f32_16x16x32_bf16 v[76:79], v[104:107], v[88:91], 0
s_waitcnt lgkmcnt(2)
v_exp_f32 v68, v68
v_mfma_f32_16x16x32_bf16 v[76:79], v[108:111], v[92:95], v[76:79]
s_waitcnt lgkmcnt(1)
v_exp_f32 v69, v69
v_mfma_f32_16x16x32_bf16 v[76:79], v[112:115], v[96:99], v[76:79]
s_waitcnt lgkmcnt(0)
v_exp_f32 v70, v70
v_mfma_f32_16x16x32_bf16 v[76:79], v[116:119], v[100:103], v[76:79]
v_exp_f32 v71, v71
v_cvt_pk_bf16_f32 v74, v68, v69
v_cvt_pk_bf16_f32 v75, v70, v71
v_add_f32 v80, v80, v82
v_add_f32 v81, v81, v83
v_mfma_f32_16x16x32_bf16 v[88:91], v[72:75], v[6:9], 0
ds_read_b128 v[112:115], v20 offset:40960
v_mul_f32 v76, s38, v76
v_mul_f32 v77, s38, v77
v_mfma_f32_16x16x32_bf16 v[92:95], v[72:75], v[32:35], 0
v_exp_f32 v78, v76
v_add_f32 v84, v84, v86
v_mfma_f32_16x16x32_bf16 v[96:99], v[72:75], v[36:39], 0
v_exp_f32 v79, v77
v_add_f32 v85, v85, v87
v_cvt_pk_bf16_f32 v12, v78, v79
v_cvt_pk_bf16_f32 v16, v80, v81
v_cvt_pk_bf16_f32 v18, v84, v85
v_mfma_f32_16x16x32_bf16 v[88:91], v[12:15], v[6:9], v[88:91]
ds_read_b128 v[116:119], v20 offset:41984
v_mov_b64 v[52:53], 0
v_mfma_f32_16x16x32_bf16 v[92:95], v[12:15], v[16:19], v[92:95]
ds_read_b128 v[80:83], v20 offset:49152
v_mov_b64 v[54:55], 0
v_mfma_f32_16x16x32_bf16 v[96:99], v[10:13], v[16:19], v[96:99]
ds_read_b128 v[84:87], v20 offset:50176
v_rcp_f32 v90, v88
v_rcp_f32 v91, v89
v_mul_f32 v92, v92, v90
v_mul_f32 v93, v93, v91
s_nop 0
v_mul_f32 v96, v96, v90
v_mul_f32 v97, v97, v91
v_cvt_pk_bf16_f32 v100, v92, v96
v_cvt_pk_bf16_f32 v101, v93, v97
ds_write2_b32 v29, v100, v101 offset0:0 offset1:80
v_max3_f32 v102, v88, v89, v90
v_max_f32 v102, v102, v91
v_cmp_nge_f32 vcc, s39, v102
global_store_dwordx4 v24, v[2:5], s[4:5] sc1
global_store_dwordx4 v24, v[2:5], s[4:5] offset:1024 sc1
s_cbranch_vccnz L_rec_s0_slow
L_rec_s0_join:
s_waitcnt lgkmcnt(0)
s_barrier
ds_read_b128 v[104:107], v30 offset:24576
ds_read_b128 v[108:111], v30 offset:24704
v_mov_b64 v[32:33], 0
v_mov_b64 v[34:35], 0
v_mov_b64 v[36:37], 0
v_mov_b64 v[38:39], 0
v_mov_b64 v[56:57], 0
v_mov_b64 v[58:59], 0
v_xor_b32 v24, 0x40000, v24
s_waitcnt lgkmcnt(1)
v_smfmac_f32_16x16x64_bf16 v[32:35], v[104:107], a[176:183], v1
s_waitcnt lgkmcnt(0)
ds_read_b128 v[88:91], v22 offset:0
v_mov_b64 v[60:61], 0
v_smfmac_f32_16x16x64_bf16 v[32:35], v[108:111], a[184:191], v1
ds_read_b128 v[92:95], v22 offset:1024
v_mov_b64 v[62:63], 0
v_smfmac_f32_16x16x64_bf16 v[36:39], v[104:107], v[112:119], v1
ds_read_b128 v[96:99], v22 offset:8192
v_smfmac_f32_16x16x64_bf16 v[36:39], v[108:111], v[80:87], v1
ds_read_b128 v[100:103], v22 offset:9216
v_add_f32 v32, v32, v34
v_smfmac_f32_16x16x64_bf16 v[40:43], v[104:107], a[192:199], v1
ds_read_b128 v[112:115], v22 offset:16384
v_add_f32 v33, v33, v35
v_smfmac_f32_16x16x64_bf16 v[40:43], v[108:111], a[200:207], v1
ds_read_b128 v[116:119], v22 offset:17408
v_add_f32 v36, v36, v38
v_add_f32 v37, v37, v39
v_smfmac_f32_16x16x64_bf16 v[44:47], v[104:107], a[208:215], v1
s_waitcnt lgkmcnt(4)
ds_read_b128 v[80:83], v22 offset:24576
v_cvt_pk_bf16_f32 v64, v32, v36
v_cvt_pk_bf16_f32 v65, v33, v37
v_smfmac_f32_16x16x64_bf16 v[44:47], v[108:111], v[88:95], v1
s_waitcnt lgkmcnt(3)
global_store_dwordx2 v23, v[64:65], s[20:21] sc1
v_add_f32 v40, v40, v42
v_smfmac_f32_16x16x64_bf16 v[48:51], v[104:107], v[96:103], v1
ds_read_b128 v[84:87], v22 offset:25600
v_add_f32 v41, v41, v43
v_smfmac_f32_16x16x64_bf16 v[48:51], v[108:111], a[216:223], v1
ds_read_b128 v[72:75], v20 offset:39936
v_add_f32 v44, v44, v46
v_add_f32 v45, v45, v47
v_smfmac_f32_16x16x64_bf16 v[52:55], v[104:107], a[224:231], v1
v_cvt_pk_bf16_f32 v66, v40, v44
v_cvt_pk_bf16_f32 v67, v41, v45
v_smfmac_f32_16x16x64_bf16 v[52:55], v[108:111], a[232:239], v1
s_waitcnt lgkmcnt(3)
global_store_dwordx2 v23, v[66:67], s[22:23] sc1
v_add_f32 v48, v48, v50
v_smfmac_f32_16x16x64_bf16 v[56:59], v[104:107], v[112:119], v1
s_waitcnt lgkmcnt(1)
v_add_f32 v49, v49, v51
v_smfmac_f32_16x16x64_bf16 v[56:59], v[108:111], v[80:87], v1
v_add_f32 v52, v52, v54
v_add_f32 v53, v53, v55
v_smfmac_f32_16x16x64_bf16 v[60:63], v[104:107], a[240:247], v1
v_cvt_pk_bf16_f32 v68, v48, v52
v_cvt_pk_bf16_f32 v69, v49, v53
v_smfmac_f32_16x16x64_bf16 v[60:63], v[108:111], a[248:255], v1
global_store_dwordx2 v23, v[68:69], s[24:25] sc1
v_add_f32 v56, v56, v58
v_add_f32 v57, v57, v59
s_nop 4
v_pk_add_f32 v[60:61], v[60:61], v[62:63]
v_cvt_pk_bf16_f32 v70, v56, v60
v_cvt_pk_bf16_f32 v71, v57, v61
global_store_dwordx2 v23, v[70:71], s[26:27] sc1
s_waitcnt lgkmcnt(0)
ds_read_b128 v[40:43], v20 offset:57344
ds_read_b128 v[44:47], v20 offset:58368
ds_read_b128 v[48:51], v21 offset:0
ds_read_b128 v[52:55], v21 offset:1024
ds_read_b128 v[56:59], v21 offset:8192
ds_read_b128 v[60:63], v21 offset:9216
ds_read_b128 v[88:91], v21 offset:16384
ds_read_b128 v[92:95], v21 offset:17408
ds_read_b128 v[96:99], v21 offset:40960
ds_read_b128 v[100:103], v21 offset:41984
ds_read_b128 v[104:107], v21 offset:49152
ds_read_b128 v[108:111], v21 offset:50176
ds_read_b128 v[112:115], v21 offset:57344
ds_read_b128 v[116:119], v21 offset:58368
global_load_dwordx4 v[32:35], v24, s[4:5] sc1
global_load_dwordx4 v[36:39], v24, s[4:5] offset:1024 sc1
v_mov_b64 v[64:65], 0
v_mov_b64 v[66:67], 0
v_mov_b64 v[68:69], 0
v_mov_b64 v[70:71], 0
v_mov_b64 v[80:81], 0
v_mov_b64 v[82:83], 0
v_mov_b64 v[84:85], 0
v_mov_b64 v[86:87], 0
s_add_u32 s30, s30, 786432
s_addc_u32 s31, s31, 0
s_add_u32 s32, s32, 786432
s_addc_u32 s33, s33, 0
s_add_u32 s34, s34, 8192
s_addc_u32 s35, s35, 0
s_add_u32 s40, s40, 1
s_xor_b32 s42, s42, 8192
v_add_u32 v2, 0x2000, v26
v_bfi_b32 v26, s43, v2, v26
v_xor_b32 v23, 0x40000, v23
v_xor_b32 v0, 8192, v0
s_nop 9
global_load_dwordx4 v[32:35], v24, s[4:5] sc1
global_load_dwordx4 v[36:39], v24, s[4:5] offset:1024 sc1
s_mov_b32 s3, 64
v_add_u32 v4, 0x2000, v25
s_waitcnt vmcnt(2)
L_rec_s0_a:
v_mfma_f32_16x16x32_bf16 v[76:79], v[72:75], v[32:35], 0
v_mfma_f32_16x16x32_bf16 v[76:79], v[72:75], v[36:39], v[76:79]
s_nop 7
v_add_f32_dpp v76, v76, v76 row_ror:4 row_mask:0xf bank_mask:0xf
v_add_f32_dpp v77, v77, v77 row_ror:4 row_mask:0xf bank_mask:0xf
v_cmp_u_f32 vcc, v78, v79
v_add_f32_dpp v76, v76, v76 row_ror:8 row_mask:0xf bank_mask:0xf
v_add_f32_dpp v77, v77, v77 row_ror:8 row_mask:0xf bank_mask:0xf
v_cvt_pk_bf16_f32 v18, v76, v77
s_mov_b64 exec, s[44:45]
global_store_dword v25, v18, s[4:5] sc1
s_mov_b64 exec, -1
s_cbranch_vccnz L_rec_s0_a_fail
L_rec_s0_a_ok:
v_bfi_b32 v25, s43, v4, v25
s_cmp_lt_u32 s40, 63
s_cbranch_scc1 L_rec_s0_top
v_and_b32 v5, 0x1fff, v25
global_store_dword v5, v18, s[34:35] sc1
s_branch L_rec_done
L_rec_s0_kv:
ds_read_b32 v3, v4 offset:37632
s_waitcnt lgkmcnt(0)
L_rec_s0_kv2:
v_cmp_eq_u32 s[46:47], 1, v3
s_bitcmp1_b64 s[46:47], s3
s_cbranch_scc1 L_rec_s0_kv_ok
global_load_dword v3, v4, s[36:37] sc1
s_waitcnt vmcnt(0)
s_sub_u32 s41, s41, 1
s_cbranch_scc0 L_rec_s0_kv2
s_mov_b32 s41, 0
s_branch L_rec_s0_kv_ok
L_rec_s0_b0:
global_load_dwordx4 v[32:35], v26, s[4:5] sc1
global_load_dwordx4 v[36:39], v26, s[4:5] offset:1024 sc1
s_mov_b32 s18, 0
s_sub_u32 s41, s41, 1
s_cbranch_scc1 L_rec_s0_b0_dead
s_nop 1
v_mov_b64 v[64:65], 0
v_mov_b64 v[66:67], 0
s_waitcnt vmcnt(2)
s_branch L_rec_s0_b1
L_rec_s0_b0_dead:
s_mov_b32 s41, 0
s_branch L_rec_s0_b0_ok
L_rec_s0_slow:
s_waitcnt lgkmcnt(0)
ds_read_b128 v[88:91], v28 offset:0
ds_read_b128 v[92:95], v28 offset:64
ds_read_b128 v[96:99], v28 offset:128
ds_read_b128 v[100:103], v28 offset:192
ds_read_b128 v[104:107], v0 offset:0
ds_read_b128 v[108:111], v0 offset:1024
ds_read_b128 v[112:115], v0 offset:2048
ds_read_b128 v[116:119], v0 offset:3072
s_waitcnt lgkmcnt(0)
v_mfma_f32_16x16x32_bf16 v[64:67], v[104:107], v[88:91], 0
v_mfma_f32_16x16x32_bf16 v[64:67], v[108:111], v[92:95], v[64:67]
v_mfma_f32_16x16x32_bf16 v[64:67], v[112:115], v[96:99], v[64:67]
v_mfma_f32_16x16x32_bf16 v[64:67], v[116:119], v[100:103], v[64:67]
ds_read_b128 v[104:107], v0 offset:4096
ds_read_b128 v[108:111], v0 offset:5120
ds_read_b128 v[112:115], v0 offset:6144
ds_read_b128 v[116:119], v0 offset:7168
s_waitcnt lgkmcnt(0)
v_mfma_f32_16x16x32_bf16 v[68:71], v[104:107], v[88:91], 0
v_mfma_f32_16x16x32_bf16 v[68:71], v[108:111], v[92:95], v[68:71]
v_mfma_f32_16x16x32_bf16 v[68:71], v[112:115], v[96:99], v[68:71]
v_mfma_f32_16x16x32_bf16 v[68:71], v[116:119], v[100:103], v[68:71]
s_nop 7
v_max3_f32 v2, v64, v65, v66
v_max3_f32 v3, v67, v68, v69
v_max3_f32 v2, v2, v70, v71
v_max3_f32 v3, v3, v76, v77
v_max_f32 v2, v2, v3
v_mov_b32 v3, v2
s_nop 1
v_permlane32_swap_b32 v2, v3
v_max_f32 v2, v2, v3
v_mov_b32 v3, v2
s_nop 1
v_permlane16_swap_b32 v2, v3
v_max_f32 v2, v2, v3
v_sub_f32 v64, v64, v2
v_sub_f32 v65, v65, v2
v_sub_f32 v66, v66, v2
v_sub_f32 v67, v67, v2
v_sub_f32 v68, v68, v2
v_sub_f32 v69, v69, v2
v_sub_f32 v70, v70, v2
v_sub_f32 v71, v71, v2
v_sub_f32 v76, v76, v2
v_sub_f32 v77, v77, v2
v_exp_f32 v64, v64
v_exp_f32 v65, v65
v_exp_f32 v66, v66
v_exp_f32 v67, v67
v_exp_f32 v68, v68
v_exp_f32 v69, v69
v_exp_f32 v70, v70
v_exp_f32 v71, v71
v_exp_f32 v76, v76
v_exp_f32 v77, v77
v_cvt_pk_bf16_f32 v72, v64, v65
v_cvt_pk_bf16_f32 v73, v66, v67
v_cvt_pk_bf16_f32 v74, v68, v69
v_cvt_pk_bf16_f32 v75, v70, v71
v_cvt_pk_bf16_f32 v12, v76, v77
s_nop 0
v_mfma_f32_16x16x32_bf16 v[88:91], v[72:75], v[6:9], 0
v_mfma_f32_16x16x32_bf16 v[92:95], v[72:75], v[32:35], 0
v_mfma_f32_16x16x32_bf16 v[96:99], v[72:75], v[36:39], 0
v_mfma_f32_16x16x32_bf16 v[88:91], v[12:15], v[6:9], v[88:91]
v_mfma_f32_16x16x32_bf16 v[92:95], v[12:15], v[16:19], v[92:95]
v_mfma_f32_16x16x32_bf16 v[96:99], v[10:13], v[16:19], v[96:99]
s_nop 7
v_rcp_f32 v90, v88
v_rcp_f32 v91, v89
v_mul_f32 v92, v92, v90
v_mul_f32 v93, v93, v91
v_mul_f32 v96, v96, v90
v_mul_f32 v97, v97, v91
v_cvt_pk_bf16_f32 v100, v92, v96
v_cvt_pk_bf16_f32 v101, v93, v97
ds_write2_b32 v29, v100, v101 offset0:0 offset1:80
v_mov_b64 v[2:3], -1
ds_read_b128 v[112:115], v20 offset:40960
ds_read_b128 v[116:119], v20 offset:41984
s_branch L_rec_s0_join
L_rec_s0_a_fail:
s_cmp_gt_u32 s3, 60
s_cbranch_scc1 L_rec_s0_a_f2
s_sleep 6
L_rec_s0_a_f2:
global_load_dwordx4 v[32:35], v24, s[4:5] sc1
global_load_dwordx4 v[36:39], v24, s[4:5] offset:1024 sc1
s_mov_b32 s19, 0
s_sub_u32 s3, s3, 1
s_cbranch_scc1 L_rec_s0_a_chk
s_waitcnt vmcnt(3)
s_branch L_rec_s0_a
L_rec_s0_a_chk:
s_mov_b32 s3, 60
s_waitcnt vmcnt(0)
s_sub_u32 s41, s41, 64
s_cbranch_scc1 L_rec_s0_a_dead
v_max3_u32 v2, v32, v33, v34
v_max3_u32 v3, v35, v36, v37
v_max3_u32 v2, v2, v38, v39
v_max_u32 v2, v2, v3
v_cmp_eq_u32 vcc, -1, v2
s_cbranch_vccnz L_rec_s0_a_fail
s_branch L_rec_s0_a_now
L_rec_s0_a_dead:
s_mov_b32 s41, 0
L_rec_s0_a_now:
v_mfma_f32_16x16x32_bf16 v[76:79], v[72:75], v[32:35], 0
v_mfma_f32_16x16x32_bf16 v[76:79], v[72:75], v[36:39], v[76:79]
s_nop 7
v_add_f32_dpp v76, v76, v76 row_ror:4 row_mask:0xf bank_mask:0xf
v_add_f32_dpp v77, v77, v77 row_ror:4 row_mask:0xf bank_mask:0xf
v_cmp_u_f32 vcc, v78, v79
v_add_f32_dpp v76, v76, v76 row_ror:8 row_mask:0xf bank_mask:0xf
v_add_f32_dpp v77, v77, v77 row_ror:8 row_mask:0xf bank_mask:0xf
v_cvt_pk_bf16_f32 v18, v76, v77
v_cmp_u_f32 vcc, v76, v77
v_and_b32 v2, 0x7fff7fff, v18
s_nop 0
v_cndmask_b32 v18, v18, v2, vcc
s_mov_b64 exec, s[44:45]
global_store_dword v25, v18, s[4:5] sc1
s_mov_b64 exec, -1
s_branch L_rec_s0_a_ok
L_rec_s1:
v_mov_b32 v2, -1
v_xor_b32 v3, 0x6000, v25
global_store_dword v25, v2, s[4:5] sc1
global_store_dword v3, v2, s[4:5] sc1
ds_read_b128 v[40:43], v20 offset:59392
ds_read_b128 v[44:47], v20 offset:60416
ds_read_b128 v[48:51], v21 offset:2048
ds_read_b128 v[52:55], v21 offset:3072
ds_read_b128 v[56:59], v21 offset:10240
ds_read_b128 v[60:63], v21 offset:11264
ds_read_b128 v[88:91], v21 offset:18432
ds_read_b128 v[92:95], v21 offset:19456
ds_read_b128 v[96:99], v21 offset:43008
ds_read_b128 v[100:103], v21 offset:44032
ds_read_b128 v[104:107], v21 offset:51200
ds_read_b128 v[108:111], v21 offset:52224
ds_read_b128 v[112:115], v21 offset:59392
ds_read_b128 v[116:119], v21 offset:60416
v_mov_b64 v[64:65], 0
v_mov_b64 v[66:67], 0
v_mov_b64 v[68:69], 0
v_mov_b64 v[70:71], 0
v_mov_b64 v[80:81], 0
v_mov_b64 v[82:83], 0
v_mov_b64 v[84:85], 0
v_mov_b64 v[86:87], 0
L_rec_s1_top:
v_mov_b64 v[76:77], 0
v_mov_b64 v[78:79], 0
v_mov_b64 v[72:73], 0
v_mov_b64 v[74:75], 0
s_mov_b32 m0, s42
s_add_u32 s3, s40, 1
v_and_b32 v5, 0x1fff, v25
v_lshrrev_b32 v4, 2, v20
s_bitcmp1_b64 s[46:47], s3
s_cbranch_scc0 L_rec_s1_kv
L_rec_s1_kv_ok:
s_nop 15
s_nop 1
global_load_dwordx4 v[32:35], v26, s[4:5] sc1
global_load_dwordx4 v[36:39], v26, s[4:5] offset:1024 sc1
s_nop 15
s_nop 13
global_load_dwordx4 v[32:35], v26, s[4:5] sc1
global_load_dwordx4 v[36:39], v26, s[4:5] offset:1024 sc1
s_waitcnt vmcnt(2) lgkmcnt(0)
L_rec_s1_b1:
v_max3_u32 v2, v32, v33, v34
v_max3_u32 v3, v35, v36, v37
v_max3_u32 v2, v2, v38, v39
v_max_u32 v2, v2, v3
v_cmp_le_u32 vcc, s59, v2
v_smfmac_f32_16x16x64_bf16 v[64:67], v[32:35], v[40:47], v1
ds_write_b64 v20, v[32:33] offset:26624
s_cbranch_vccnz L_rec_s1_b0
L_rec_s1_b0_ok:
v_smfmac_f32_16x16x64_bf16 v[68:71], v[32:35], v[48:55], v1
ds_write_b64 v20, v[34:35] offset:26632
v_smfmac_f32_16x16x64_bf16 v[64:67], v[36:39], v[56:63], v1
ds_write_b64 v20, v[36:37] offset:27648
v_smfmac_f32_16x16x64_bf16 v[68:71], v[36:39], v[88:95], v1
ds_write_b64 v20, v[38:39] offset:27656
v_smfmac_f32_16x16x64_bf16 v[72:75], v[32:35], v[96:103], v1
ds_read_b128 v[88:91], v21 offset:26624
ds_read_b128 v[92:95], v21 offset:27648
v_smfmac_f32_16x16x64_bf16 v[76:79], v[32:35], v[104:111], v1
ds_read_b128 v[96:99], v21 offset:34816
ds_read_b128 v[100:103], v21 offset:35840
v_smfmac_f32_16x16x64_bf16 v[72:75], v[36:39], v[112:119], v1
v_smfmac_f32_16x16x64_bf16 v[76:79], v[36:39], v[248:255], v1
v_smfmac_f32_16x16x64_bf16 v[80:83], v[32:35], a[48:55], v1
s_waitcnt lgkmcnt(4)
s_barrier
ds_read_b128 v[40:43], v20 offset:28672
v_smfmac_f32_16x16x64_bf16 v[84:87], v[32:35], a[112:119], v1
ds_read_b128 v[44:47], v20 offset:29696
ds_read_b128 v[48:51], v20 offset:30720
v_smfmac_f32_16x16x64_bf16 v[80:83], v[36:39], a[56:63], v1
ds_read_b128 v[52:55], v20 offset:31744
ds_read_b128 v[56:59], v20 offset:24576
v_smfmac_f32_16x16x64_bf16 v[84:87], v[36:39], a[120:127], v1
s_waitcnt lgkmcnt(4)
s_waitcnt vmcnt(0)
ds_read_b128 v[60:63], v20 offset:25600
global_load_lds_dwordx4 v20, s[30:31] offset:0 sc1
v_smfmac_f32_16x16x64_bf16 v[64:67], v[40:43], v[88:95], v1
global_load_lds_dwordx4 v20, s[30:31] offset:1024 sc1
global_store_dword v5, v18, s[34:35] sc1
v_smfmac_f32_16x16x64_bf16 v[68:71], v[40:43], v[96:103], v1
s_waitcnt lgkmcnt(4)
ds_read_b128 v[32:35], v20 offset:18432
ds_read_b128 v[36:39], v20 offset:19456
v_smfmac_f32_16x16x64_bf16 v[64:67], v[44:47], v[120:127], v1
s_mov_b32 m0, 37632
v_smfmac_f32_16x16x64_bf16 v[68:71], v[44:47], v[160:167], v1
s_waitcnt lgkmcnt(5)
global_load_lds_dword v4, s[36:37] sc1
v_smfmac_f32_16x16x64_bf16 v[64:67], v[48:51], v[128:135], v1
s_mov_b32 m0, 18432
v_smfmac_f32_16x16x64_bf16 v[68:71], v[48:51], v[168:175], v1
s_waitcnt lgkmcnt(4)
s_waitcnt lgkmcnt(0)
global_load_lds_dwordx4 v20, s[32:33] offset:0 sc1
v_smfmac_f32_16x16x64_bf16 v[64:67], v[52:55], v[136:143], v1
global_load_lds_dwordx4 v20, s[32:33] offset:1024 sc1
v_mov_b64 v[2:3], -1
v_smfmac_f32_16x16x64_bf16 v[68:71], v[52:55], v[176:183], v1
v_mov_b64 v[4:5], -1
v_smfmac_f32_16x16x64_bf16 v[64:67], v[56:59], v[144:151], v1
ds_read_b128 v[104:107], v0 offset:0
v_smfmac_f32_16x16x64_bf16 v[68:71], v[56:59], v[184:191], v1
ds_read_b128 v[108:111], v0 offset:1024
v_smfmac_f32_16x16x64_bf16 v[64:67], v[60:63], v[152:159], v1
ds_read_b128 v[112:115], v0 offset:2048
v_smfmac_f32_16x16x64_bf16 v[68:71], v[60:63], v[192:199], v1
ds_read_b128 v[116:119], v0 offset:3072
v_smfmac_f32_16x16x64_bf16 v[72:75], v[40:43], v[200:207], v1
v_add_f32 v64, v64, v66
v_smfmac_f32_16x16x64_bf16 v[76:79], v[40:43], a[0:7], v1
v_add_f32 v68, v68, v70
v_smfmac_f32_16x16x64_bf16 v[72:75], v[44:47], v[208:215], v1
v_cvt_pk_bf16_f32 v66, v64, v68
v_smfmac_f32_16x16x64_bf16 v[76:79], v[44:47], a[8:15], v1
ds_write_b32 v27, v66
v_add_f32 v65, v65, v67
v_smfmac_f32_16x16x64_bf16 v[72:75], v[48:51], v[216:223], v1
v_add_f32 v69, v69, v71
v_smfmac_f32_16x16x64_bf16 v[76:79], v[48:51], a[16:23], v1
v_cvt_pk_bf16_f32 v67, v65, v69
v_smfmac_f32_16x16x64_bf16 v[72:75], v[52:55], v[224:231], v1
ds_write_b32 v27, v67 offset:288
v_xor_b32 v16, 0x4000, v25
v_smfmac_f32_16x16x64_bf16 v[76:79], v[52:55], a[24:31], v1
global_store_dword v16, v2, s[4:5] sc1
v_smfmac_f32_16x16x64_bf16 v[72:75], v[56:59], v[232:239], v1
v_smfmac_f32_16x16x64_bf16 v[76:79], v[56:59], a[32:39], v1
v_smfmac_f32_16x16x64_bf16 v[72:75], v[60:63], v[240:247], v1
s_waitcnt lgkmcnt(0)
s_barrier
ds_read_b128 v[88:91], v28 offset:0
v_smfmac_f32_16x16x64_bf16 v[76:79], v[60:63], a[40:47], v1
ds_read_b128 v[92:95], v28 offset:64
ds_read_b128 v[96:99], v28 offset:128
v_smfmac_f32_16x16x64_bf16 v[80:83], v[40:43], a[64:71], v1
ds_read_b128 v[100:103], v28 offset:192
v_add_f32 v72, v72, v74
v_smfmac_f32_16x16x64_bf16 v[84:87], v[40:43], a[128:135], v1
v_add_f32 v76, v76, v78
v_smfmac_f32_16x16x64_bf16 v[80:83], v[44:47], a[72:79], v1
v_cvt_pk_bf16_f32 v74, v72, v76
v_smfmac_f32_16x16x64_bf16 v[84:87], v[44:47], a[136:143], v1
s_waitcnt lgkmcnt(3)
ds_write_b32 v27, v74 offset:576
v_add_f32 v73, v73, v75
v_mfma_f32_16x16x32_bf16 v[64:67], v[104:107], v[88:91], 0
v_add_f32 v77, v77, v79
v_cvt_pk_bf16_f32 v75, v73, v77
v_smfmac_f32_16x16x64_bf16 v[80:83], v[48:51], a[80:87], v1
s_waitcnt lgkmcnt(3)
ds_write_b32 v27, v75 offset:864
ds_read_b128 v[104:107], v0 offset:4096
v_mfma_f32_16x16x32_bf16 v[64:67], v[108:111], v[92:95], v[64:67]
v_mov_b64 v[40:41], 0
v_mov_b64 v[42:43], 0
v_smfmac_f32_16x16x64_bf16 v[84:87], v[48:51], a[144:151], v1
s_waitcnt lgkmcnt(4)
ds_read_b128 v[108:111], v0 offset:5120
v_mov_b64 v[44:45], 0
v_mfma_f32_16x16x32_bf16 v[64:67], v[112:115], v[96:99], v[64:67]
v_mov_b64 v[46:47], 0
v_smfmac_f32_16x16x64_bf16 v[80:83], v[52:55], a[88:95], v1
s_waitcnt lgkmcnt(4)
ds_read_b128 v[112:115], v0 offset:6144
v_mfma_f32_16x16x32_bf16 v[64:67], v[116:119], v[100:103], v[64:67]
v_smfmac_f32_16x16x64_bf16 v[84:87], v[52:55], a[152:159], v1
s_waitcnt lgkmcnt(2)
ds_read_b128 v[116:119], v0 offset:7168
v_mfma_f32_16x16x32_bf16 v[68:71], v[104:107], v[88:91], 0
s_barrier
v_exp_f32 v64, v64
v_smfmac_f32_16x16x64_bf16 v[80:83], v[56:59], a[96:103], v1
s_waitcnt lgkmcnt(2)
ds_read_b128 v[104:107], v28 offset:576
v_mov_b64 v[48:49], 0
v_mfma_f32_16x16x32_bf16 v[68:71], v[108:111], v[92:95], v[68:71]
v_exp_f32 v65, v65
v_smfmac_f32_16x16x64_bf16 v[84:87], v[56:59], a[160:167], v1
s_waitcnt lgkmcnt(2)
ds_read_b128 v[108:111], v28 offset:640
v_cvt_pk_bf16_f32 v72, v64, v65
v_mfma_f32_16x16x32_bf16 v[68:71], v[112:115], v[96:99], v[68:71]
v_exp_f32 v66, v66
v_smfmac_f32_16x16x64_bf16 v[80:83], v[60:63], a[104:111], v1
s_waitcnt lgkmcnt(2)
ds_read_b128 v[112:115], v28 offset:704
v_mov_b64 v[50:51], 0
v_mfma_f32_16x16x32_bf16 v[68:71], v[116:119], v[100:103], v[68:71]
v_exp_f32 v67, v67
v_smfmac_f32_16x16x64_bf16 v[84:87], v[60:63], a[168:175], v1
s_waitcnt lgkmcnt(2)
ds_read_b128 v[116:119], v28 offset:768
v_cvt_pk_bf16_f32 v73, v66, v67
v_mfma_f32_16x16x32_bf16 v[76:79], v[104:107], v[88:91], 0
s_waitcnt lgkmcnt(2)
v_exp_f32 v68, v68
v_mfma_f32_16x16x32_bf16 v[76:79], v[108:111], v[92:95], v[76:79]
s_waitcnt lgkmcnt(1)
v_exp_f32 v69, v69
v_mfma_f32_16x16x32_bf16 v[76:79], v[112:115], v[96:99], v[76:79]
s_waitcnt lgkmcnt(0)
v_exp_f32 v70, v70
v_mfma_f32_16x16x32_bf16 v[76:79], v[116:119], v[100:103], v[76:79]
v_exp_f32 v71, v71
v_cvt_pk_bf16_f32 v74, v68, v69
v_cvt_pk_bf16_f32 v75, v70, v71
v_add_f32 v80, v80, v82
v_add_f32 v81, v81, v83
v_mfma_f32_16x16x32_bf16 v[88:91], v[72:75], v[6:9], 0
ds_read_b128 v[112:115], v20 offset:43008
v_mul_f32 v76, s38, v76
v_mul_f32 v77, s38, v77
v_mfma_f32_16x16x32_bf16 v[92:95], v[72:75], v[32:35], 0
v_exp_f32 v78, v76
v_add_f32 v84, v84, v86
v_mfma_f32_16x16x32_bf16 v[96:99], v[72:75], v[36:39], 0
v_exp_f32 v79, v77
v_add_f32 v85, v85, v87
v_cvt_pk_bf16_f32 v12, v78, v79
v_cvt_pk_bf16_f32 v16, v80, v81
v_cvt_pk_bf16_f32 v18, v84, v85
v_mfma_f32_16x16x32_bf16 v[88:91], v[12:15], v[6:9], v[88:91]
ds_read_b128 v[116:119], v20 offset:44032
v_mov_b64 v[52:53], 0
v_mfma_f32_16x16x32_bf16 v[92:95], v[12:15], v[16:19], v[92:95]
ds_read_b128 v[80:83], v20 offset:51200
v_mov_b64 v[54:55], 0
v_mfma_f32_16x16x32_bf16 v[96:99], v[10:13], v[16:19], v[96:99]
ds_read_b128 v[84:87], v20 offset:52224
v_rcp_f32 v90, v88
v_rcp_f32 v91, v89
v_mul_f32 v92, v92, v90
v_mul_f32 v93, v93, v91
s_nop 0
v_mul_f32 v96, v96, v90
v_mul_f32 v97, v97, v91
v_cvt_pk_bf16_f32 v100, v92, v96
v_cvt_pk_bf16_f32 v101, v93, v97
ds_write2_b32 v29, v100, v101 offset0:0 offset1:80
v_max3_f32 v102, v88, v89, v90
v_max_f32 v102, v102, v91
v_cmp_nge_f32 vcc, s39, v102
global_store_dwordx4 v24, v[2:5], s[4:5] sc1
global_store_dwordx4 v24, v[2:5], s[4:5] offset:1024 sc1
s_cbranch_vccnz L_rec_s1_slow
L_rec_s1_join:
s_waitcnt lgkmcnt(0)
s_barrier
ds_read_b128 v[104:107], v30 offset:24576
ds_read_b128 v[108:111], v30 offset:24704
v_mov_b64 v[32:33], 0
v_mov_b64 v[34:35], 0
v_mov_b64 v[36:37], 0
v_mov_b64 v[38:39], 0
v_mov_b64 v[56:57], 0
v_mov_b64 v[58:59], 0
v_xor_b32 v24, 0x40000, v24
s_waitcnt lgkmcnt(1)
v_smfmac_f32_16x16x64_bf16 v[32:35], v[104:107], a[176:183], v1
s_waitcnt lgkmcnt(0)
ds_read_b128 v[88:91], v22 offset:2048
v_mov_b64 v[60:61], 0
v_smfmac_f32_16x16x64_bf16 v[32:35], v[108:111], a[184:191], v1
ds_read_b128 v[92:95], v22 offset:3072
v_mov_b64 v[62:63], 0
v_smfmac_f32_16x16x64_bf16 v[36:39], v[104:107], v[112:119], v1
ds_read_b128 v[96:99], v22 offset:10240
v_smfmac_f32_16x16x64_bf16 v[36:39], v[108:111], v[80:87], v1
ds_read_b128 v[100:103], v22 offset:11264
v_add_f32 v32, v32, v34
v_smfmac_f32_16x16x64_bf16 v[40:43], v[104:107], a[192:199], v1
ds_read_b128 v[112:115], v22 offset:18432
v_add_f32 v33, v33, v35
v_smfmac_f32_16x16x64_bf16 v[40:43], v[108:111], a[200:207], v1
ds_read_b128 v[116:119], v22 offset:19456
v_add_f32 v36, v36, v38
v_add_f32 v37, v37, v39
v_smfmac_f32_16x16x64_bf16 v[44:47], v[104:107], a[208:215], v1
s_waitcnt lgkmcnt(4)
ds_read_b128 v[80:83], v22 offset:26624
v_cvt_pk_bf16_f32 v64, v32, v36
v_cvt_pk_bf16_f32 v65, v33, v37
v_smfmac_f32_16x16x64_bf16 v[44:47], v[108:111], v[88:95], v1
s_waitcnt lgkmcnt(3)
global_store_dwordx2 v23, v[64:65], s[20:21] sc1
v_add_f32 v40, v40, v42
v_smfmac_f32_16x16x64_bf16 v[48:51], v[104:107], v[96:103], v1
ds_read_b128 v[84:87], v22 offset:27648
v_add_f32 v41, v41, v43
v_smfmac_f32_16x16x64_bf16 v[48:51], v[108:111], a[216:223], v1
ds_read_b128 v[72:75], v20 offset:39936
v_add_f32 v44, v44, v46
v_add_f32 v45, v45, v47
v_smfmac_f32_16x16x64_bf16 v[52:55], v[104:107], a[224:231], v1
v_cvt_pk_bf16_f32 v66, v40, v44
v_cvt_pk_bf16_f32 v67, v41, v45
v_smfmac_f32_16x16x64_bf16 v[52:55], v[108:111], a[232:239], v1
s_waitcnt lgkmcnt(3)
global_store_dwordx2 v23, v[66:67], s[22:23] sc1
v_add_f32 v48, v48, v50
v_smfmac_f32_16x16x64_bf16 v[56:59], v[104:107], v[112:119], v1
s_waitcnt lgkmcnt(1)
v_add_f32 v49, v49, v51
v_smfmac_f32_16x16x64_bf16 v[56:59], v[108:111], v[80:87], v1
v_add_f32 v52, v52, v54
v_add_f32 v53, v53, v55
v_smfmac_f32_16x16x64_bf16 v[60:63], v[104:107], a[240:247], v1
v_cvt_pk_bf16_f32 v68, v48, v52
v_cvt_pk_bf16_f32 v69, v49, v53
v_smfmac_f32_16x16x64_bf16 v[60:63], v[108:111], a[248:255], v1
global_store_dwordx2 v23, v[68:69], s[24:25] sc1
v_add_f32 v56, v56, v58
v_add_f32 v57, v57, v59
s_nop 4
v_pk_add_f32 v[60:61], v[60:61], v[62:63]
v_cvt_pk_bf16_f32 v70, v56, v60
v_cvt_pk_bf16_f32 v71, v57, v61
global_store_dwordx2 v23, v[70:71], s[26:27] sc1
s_waitcnt lgkmcnt(0)
ds_read_b128 v[40:43], v20 offset:59392
ds_read_b128 v[44:47], v20 offset:60416
ds_read_b128 v[48:51], v21 offset:2048
ds_read_b128 v[52:55], v21 offset:3072
ds_read_b128 v[56:59], v21 offset:10240
ds_read_b128 v[60:63], v21 offset:11264
ds_read_b128 v[88:91], v21 offset:18432
ds_read_b128 v[92:95], v21 offset:19456
ds_read_b128 v[96:99], v21 offset:43008
ds_read_b128 v[100:103], v21 offset:44032
ds_read_b128 v[104:107], v21 offset:51200
ds_read_b128 v[108:111], v21 offset:52224
ds_read_b128 v[112:115], v21 offset:59392
ds_read_b128 v[116:119], v21 offset:60416
global_load_dwordx4 v[32:35], v24, s[4:5] sc1
global_load_dwordx4 v[36:39], v24, s[4:5] offset:1024 sc1
v_mov_b64 v[64:65], 0
v_mov_b64 v[66:67], 0
v_mov_b64 v[68:69], 0
v_mov_b64 v[70:71], 0
v_mov_b64 v[80:81], 0
v_mov_b64 v[82:83], 0
v_mov_b64 v[84:85], 0
v_mov_b64 v[86:87], 0
s_add_u32 s30, s30, 786432
s_addc_u32 s31, s31, 0
s_add_u32 s32, s32, 786432
s_addc_u32 s33, s33, 0
s_add_u32 s34, s34, 8192
s_addc_u32 s35, s35, 0
s_add_u32 s40, s40, 1
s_xor_b32 s42, s42, 8192
v_add_u32 v2, 0x2000, v26
v_bfi_b32 v26, s43, v2, v26
v_xor_b32 v23, 0x40000, v23
v_xor_b32 v0, 8192, v0
s_nop 9
global_load_dwordx4 v[32:35], v24, s[4:5] sc1
global_load_dwordx4 v[36:39], v24, s[4:5] offset:1024 sc1
s_mov_b32 s3, 64
v_add_u32 v4, 0x2000, v25
s_waitcnt vmcnt(2)
L_rec_s1_a:
v_mfma_f32_16x16x32_bf16 v[76:79], v[72:75], v[32:35], 0
v_mfma_f32_16x16x32_bf16 v[76:79], v[72:75], v[36:39], v[76:79]
s_nop 7
v_add_f32_dpp v76, v76, v76 row_ror:4 row_mask:0xf bank_mask:0xf
v_add_f32_dpp v77, v77, v77 row_ror:4 row_mask:0xf bank_mask:0xf
v_cmp_u_f32 vcc, v78, v79
v_add_f32_dpp v76, v76, v76 row_ror:8 row_mask:0xf bank_mask:0xf
v_add_f32_dpp v77, v77, v77 row_ror:8 row_mask:0xf bank_mask:0xf
v_cvt_pk_bf16_f32 v18, v76, v77
s_mov_b64 exec, s[44:45]
global_store_dword v25, v18, s[4:5] sc1
s_mov_b64 exec, -1
s_cbranch_vccnz L_rec_s1_a_fail
L_rec_s1_a_ok:
v_bfi_b32 v25, s43, v4, v25
s_cmp_lt_u32 s40, 63
s_cbranch_scc1 L_rec_s1_top
v_and_b32 v5, 0x1fff, v25
global_store_dword v5, v18, s[34:35] sc1
s_branch L_rec_done
L_rec_s1_kv:
ds_read_b32 v3, v4 offset:37632
s_waitcnt lgkmcnt(0)
L_rec_s1_kv2:
v_cmp_eq_u32 s[46:47], 1, v3
s_bitcmp1_b64 s[46:47], s3
s_cbranch_scc1 L_rec_s1_kv_ok
global_load_dword v3, v4, s[36:37] sc1
s_waitcnt vmcnt(0)
s_sub_u32 s41, s41, 1
s_cbranch_scc0 L_rec_s1_kv2
s_mov_b32 s41, 0
s_branch L_rec_s1_kv_ok
L_rec_s1_b0:
global_load_dwordx4 v[32:35], v26, s[4:5] sc1
global_load_dwordx4 v[36:39], v26, s[4:5] offset:1024 sc1
s_mov_b32 s18, 0
s_sub_u32 s41, s41, 1
s_cbranch_scc1 L_rec_s1_b0_dead
s_nop 1
v_mov_b64 v[64:65], 0
v_mov_b64 v[66:67], 0
s_waitcnt vmcnt(2)
s_branch L_rec_s1_b1
L_rec_s1_b0_dead:
s_mov_b32 s41, 0
s_branch L_rec_s1_b0_ok
L_rec_s1_slow:
s_waitcnt lgkmcnt(0)
ds_read_b128 v[88:91], v28 offset:0
ds_read_b128 v[92:95], v28 offset:64
ds_read_b128 v[96:99], v28 offset:128
ds_read_b128 v[100:103], v28 offset:192
ds_read_b128 v[104:107], v0 offset:0
ds_read_b128 v[108:111], v0 offset:1024
ds_read_b128 v[112:115], v0 offset:2048
ds_read_b128 v[116:119], v0 offset:3072
s_waitcnt lgkmcnt(0)
v_mfma_f32_16x16x32_bf16 v[64:67], v[104:107], v[88:91], 0
v_mfma_f32_16x16x32_bf16 v[64:67], v[108:111], v[92:95], v[64:67]
v_mfma_f32_16x16x32_bf16 v[64:67], v[112:115], v[96:99], v[64:67]
v_mfma_f32_16x16x32_bf16 v[64:67], v[116:119], v[100:103], v[64:67]
ds_read_b128 v[104:107], v0 offset:4096
ds_read_b128 v[108:111], v0 offset:5120
ds_read_b128 v[112:115], v0 offset:6144
ds_read_b128 v[116:119], v0 offset:7168
s_waitcnt lgkmcnt(0)
v_mfma_f32_16x16x32_bf16 v[68:71], v[104:107], v[88:91], 0
v_mfma_f32_16x16x32_bf16 v[68:71], v[108:111], v[92:95], v[68:71]
v_mfma_f32_16x16x32_bf16 v[68:71], v[112:115], v[96:99], v[68:71]
v_mfma_f32_16x16x32_bf16 v[68:71], v[116:119], v[100:103], v[68:71]
s_nop 7
v_max3_f32 v2, v64, v65, v66
v_max3_f32 v3, v67, v68, v69
v_max3_f32 v2, v2, v70, v71
v_max3_f32 v3, v3, v76, v77
v_max_f32 v2, v2, v3
v_mov_b32 v3, v2
s_nop 1
v_permlane32_swap_b32 v2, v3
v_max_f32 v2, v2, v3
v_mov_b32 v3, v2
s_nop 1
v_permlane16_swap_b32 v2, v3
v_max_f32 v2, v2, v3
v_sub_f32 v64, v64, v2
v_sub_f32 v65, v65, v2
v_sub_f32 v66, v66, v2
v_sub_f32 v67, v67, v2
v_sub_f32 v68, v68, v2
v_sub_f32 v69, v69, v2
v_sub_f32 v70, v70, v2
v_sub_f32 v71, v71, v2
v_sub_f32 v76, v76, v2
v_sub_f32 v77, v77, v2
v_exp_f32 v64, v64
v_exp_f32 v65, v65
v_exp_f32 v66, v66
v_exp_f32 v67, v67
v_exp_f32 v68, v68
v_exp_f32 v69, v69
v_exp_f32 v70, v70
v_exp_f32 v71, v71
v_exp_f32 v76, v76
v_exp_f32 v77, v77
v_cvt_pk_bf16_f32 v72, v64, v65
v_cvt_pk_bf16_f32 v73, v66, v67
v_cvt_pk_bf16_f32 v74, v68, v69
v_cvt_pk_bf16_f32 v75, v70, v71
v_cvt_pk_bf16_f32 v12, v76, v77
s_nop 0
v_mfma_f32_16x16x32_bf16 v[88:91], v[72:75], v[6:9], 0
v_mfma_f32_16x16x32_bf16 v[92:95], v[72:75], v[32:35], 0
v_mfma_f32_16x16x32_bf16 v[96:99], v[72:75], v[36:39], 0
v_mfma_f32_16x16x32_bf16 v[88:91], v[12:15], v[6:9], v[88:91]
v_mfma_f32_16x16x32_bf16 v[92:95], v[12:15], v[16:19], v[92:95]
v_mfma_f32_16x16x32_bf16 v[96:99], v[10:13], v[16:19], v[96:99]
s_nop 7
v_rcp_f32 v90, v88
v_rcp_f32 v91, v89
v_mul_f32 v92, v92, v90
v_mul_f32 v93, v93, v91
v_mul_f32 v96, v96, v90
v_mul_f32 v97, v97, v91
v_cvt_pk_bf16_f32 v100, v92, v96
v_cvt_pk_bf16_f32 v101, v93, v97
ds_write2_b32 v29, v100, v101 offset0:0 offset1:80
v_mov_b64 v[2:3], -1
ds_read_b128 v[112:115], v20 offset:43008
ds_read_b128 v[116:119], v20 offset:44032
s_branch L_rec_s1_join
L_rec_s1_a_fail:
s_cmp_gt_u32 s3, 60
s_cbranch_scc1 L_rec_s1_a_f2
s_sleep 6
L_rec_s1_a_f2:
global_load_dwordx4 v[32:35], v24, s[4:5] sc1
global_load_dwordx4 v[36:39], v24, s[4:5] offset:1024 sc1
s_mov_b32 s19, 0
s_sub_u32 s3, s3, 1
s_cbranch_scc1 L_rec_s1_a_chk
s_waitcnt vmcnt(3)
s_branch L_rec_s1_a
L_rec_s1_a_chk:
s_mov_b32 s3, 60
s_waitcnt vmcnt(0)
s_sub_u32 s41, s41, 64
s_cbranch_scc1 L_rec_s1_a_dead
v_max3_u32 v2, v32, v33, v34
v_max3_u32 v3, v35, v36, v37
v_max3_u32 v2, v2, v38, v39
v_max_u32 v2, v2, v3
v_cmp_eq_u32 vcc, -1, v2
s_cbranch_vccnz L_rec_s1_a_fail
s_branch L_rec_s1_a_now
L_rec_s1_a_dead:
s_mov_b32 s41, 0
L_rec_s1_a_now:
v_mfma_f32_16x16x32_bf16 v[76:79], v[72:75], v[32:35], 0
v_mfma_f32_16x16x32_bf16 v[76:79], v[72:75], v[36:39], v[76:79]
s_nop 7
v_add_f32_dpp v76, v76, v76 row_ror:4 row_mask:0xf bank_mask:0xf
v_add_f32_dpp v77, v77, v77 row_ror:4 row_mask:0xf bank_mask:0xf
v_cmp_u_f32 vcc, v78, v79
v_add_f32_dpp v76, v76, v76 row_ror:8 row_mask:0xf bank_mask:0xf
v_add_f32_dpp v77, v77, v77 row_ror:8 row_mask:0xf bank_mask:0xf
v_cvt_pk_bf16_f32 v18, v76, v77
v_cmp_u_f32 vcc, v76, v77
v_and_b32 v2, 0x7fff7fff, v18
s_nop 0
v_cndmask_b32 v18, v18, v2, vcc
s_mov_b64 exec, s[44:45]
global_store_dword v25, v18, s[4:5] sc1
s_mov_b64 exec, -1
s_branch L_rec_s1_a_ok
L_rec_s2:
v_mov_b32 v2, -1
v_xor_b32 v3, 0x6000, v25
global_store_dword v25, v2, s[4:5] sc1
global_store_dword v3, v2, s[4:5] sc1
ds_read_b128 v[40:43], v20 offset:61440
ds_read_b128 v[44:47], v20 offset:62464
ds_read_b128 v[48:51], v21 offset:4096
ds_read_b128 v[52:55], v21 offset:5120
ds_read_b128 v[56:59], v21 offset:12288
ds_read_b128 v[60:63], v21 offset:13312
ds_read_b128 v[88:91], v21 offset:20480
ds_read_b128 v[92:95], v21 offset:21504
ds_read_b128 v[96:99], v21 offset:45056
ds_read_b128 v[100:103], v21 offset:46080
ds_read_b128 v[104:107], v21 offset:53248
ds_read_b128 v[108:111], v21 offset:54272
ds_read_b128 v[112:115], v21 offset:61440
ds_read_b128 v[116:119], v21 offset:62464
v_mov_b64 v[64:65], 0
v_mov_b64 v[66:67], 0
v_mov_b64 v[68:69], 0
v_mov_b64 v[70:71], 0
v_mov_b64 v[80:81], 0
v_mov_b64 v[82:83], 0
v_mov_b64 v[84:85], 0
v_mov_b64 v[86:87], 0
L_rec_s2_top:
v_mov_b64 v[76:77], 0
v_mov_b64 v[78:79], 0
v_mov_b64 v[72:73], 0
v_mov_b64 v[74:75], 0
s_mov_b32 m0, s42
s_add_u32 s3, s40, 1
v_and_b32 v5, 0x1fff, v25
v_lshrrev_b32 v4, 2, v20
s_bitcmp1_b64 s[46:47], s3
s_cbranch_scc0 L_rec_s2_kv
L_rec_s2_kv_ok:
s_nop 15
s_nop 1
global_load_dwordx4 v[32:35], v26, s[4:5] sc1
global_load_dwordx4 v[36:39], v26, s[4:5] offset:1024 sc1
s_nop 15
s_nop 13
global_load_dwordx4 v[32:35], v26, s[4:5] sc1
global_load_dwordx4 v[36:39], v26, s[4:5] offset:1024 sc1
s_waitcnt vmcnt(2) lgkmcnt(0)
L_rec_s2_b1:
v_max3_u32 v2, v32, v33, v34
v_max3_u32 v3, v35, v36, v37
v_max3_u32 v2, v2, v38, v39
v_max_u32 v2, v2, v3
v_cmp_le_u32 vcc, s59, v2
v_smfmac_f32_16x16x64_bf16 v[64:67], v[32:35], v[40:47], v1
ds_write_b64 v20, v[32:33] offset:28672
s_cbranch_vccnz L_rec_s2_b0
L_rec_s2_b0_ok:
v_smfmac_f32_16x16x64_bf16 v[68:71], v[32:35], v[48:55], v1
ds_write_b64 v20, v[34:35] offset:28680
v_smfmac_f32_16x16x64_bf16 v[64:67], v[36:39], v[56:63], v1
ds_write_b64 v20, v[36:37] offset:29696
v_smfmac_f32_16x16x64_bf16 v[68:71], v[36:39], v[88:95], v1
ds_write_b64 v20, v[38:39] offset:29704
v_smfmac_f32_16x16x64_bf16 v[72:75], v[32:35], v[96:103], v1
ds_read_b128 v[88:91], v21 offset:28672
ds_read_b128 v[92:95], v21 offset:29696
v_smfmac_f32_16x16x64_bf16 v[76:79], v[32:35], v[104:111], v1
ds_read_b128 v[96:99], v21 offset:36864
ds_read_b128 v[100:103], v21 offset:37888
v_smfmac_f32_16x16x64_bf16 v[72:75], v[36:39], v[112:119], v1
v_smfmac_f32_16x16x64_bf16 v[76:79], v[36:39], v[248:255], v1
s_waitcnt lgkmcnt(4)
s_barrier
ds_read_b128 v[40:43], v20 offset:30720
v_smfmac_f32_16x16x64_bf16 v[80:83], v[32:35], a[48:55], v1
ds_read_b128 v[44:47], v20 offset:31744
ds_read_b128 v[48:51], v20 offset:24576
v_smfmac_f32_16x16x64_bf16 v[84:87], v[32:35], a[112:119], v1
ds_read_b128 v[52:55], v20 offset:25600
ds_read_b128 v[56:59], v20 offset:26624
v_smfmac_f32_16x16x64_bf16 v[80:83], v[36:39], a[56:63], v1
s_waitcnt vmcnt(0)
ds_read_b128 v[60:63], v20 offset:27648
global_load_lds_dwordx4 v20, s[30:31] offset:0 sc1
v_smfmac_f32_16x16x64_bf16 v[84:87], v[36:39], a[120:127], v1
s_waitcnt lgkmcnt(5)
global_load_lds_dwordx4 v20, s[30:31] offset:1024 sc1
global_store_dword v5, v18, s[34:35] sc1
v_smfmac_f32_16x16x64_bf16 v[64:67], v[40:43], v[88:95], v1
ds_read_b128 v[32:35], v20 offset:20480
ds_read_b128 v[36:39], v20 offset:21504
v_smfmac_f32_16x16x64_bf16 v[68:71], v[40:43], v[96:103], v1
s_waitcnt lgkmcnt(6)
s_mov_b32 m0, 37632
v_smfmac_f32_16x16x64_bf16 v[64:67], v[44:47], v[120:127], v1
global_load_lds_dword v4, s[36:37] sc1
v_smfmac_f32_16x16x64_bf16 v[68:71], v[44:47], v[160:167], v1
s_waitcnt lgkmcnt(5)
s_mov_b32 m0, 20480
v_smfmac_f32_16x16x64_bf16 v[64:67], v[48:51], v[128:135], v1
s_waitcnt lgkmcnt(0)
global_load_lds_dwordx4 v20, s[32:33] offset:0 sc1
v_smfmac_f32_16x16x64_bf16 v[68:71], v[48:51], v[168:175], v1
global_load_lds_dwordx4 v20, s[32:33] offset:1024 sc1
v_mov_b64 v[2:3], -1
v_smfmac_f32_16x16x64_bf16 v[64:67], v[52:55], v[136:143], v1
v_mov_b64 v[4:5], -1
v_smfmac_f32_16x16x64_bf16 v[68:71], v[52:55], v[176:183], v1
v_smfmac_f32_16x16x64_bf16 v[64:67], v[56:59], v[144:151], v1
ds_read_b128 v[104:107], v0 offset:0
v_smfmac_f32_16x16x64_bf16 v[68:71], v[56:59], v[184:191], v1
ds_read_b128 v[108:111], v0 offset:1024
v_smfmac_f32_16x16x64_bf16 v[64:67], v[60:63], v[152:159], v1
ds_read_b128 v[112:115], v0 offset:2048
v_smfmac_f32_16x16x64_bf16 v[68:71], v[60:63], v[192:199], v1
ds_read_b128 v[116:119], v0 offset:3072
v_smfmac_f32_16x16x64_bf16 v[72:75], v[40:43], v[200:207], v1
v_add_f32 v64, v64, v66
v_smfmac_f32_16x16x64_bf16 v[76:79], v[40:43], a[0:7], v1
v_add_f32 v68, v68, v70
v_smfmac_f32_16x16x64_bf16 v[72:75], v[44:47], v[208:215], v1
v_cvt_pk_bf16_f32 v66, v64, v68
v_smfmac_f32_16x16x64_bf16 v[76:79], v[44:47], a[8:15], v1
ds_write_b32 v27, v66
v_add_f32 v65, v65, v67
v_smfmac_f32_16x16x64_bf16 v[72:75], v[48:51], v[216:223], v1
v_add_f32 v69, v69, v71
v_smfmac_f32_16x16x64_bf16 v[76:79], v[48:51], a[16:23], v1
v_cvt_pk_bf16_f32 v67, v65, v69
v_smfmac_f32_16x16x64_bf16 v[72:75], v[52:55], v[224:231], v1
ds_write_b32 v27, v67 offset:288
v_xor_b32 v16, 0x4000, v25
v_smfmac_f32_16x16x64_bf16 v[76:79], v[52:55], a[24:31], v1
global_store_dword v16, v2, s[4:5] sc1
v_smfmac_f32_16x16x64_bf16 v[72:75], v[56:59], v[232:239], v1
v_smfmac_f32_16x16x64_bf16 v[76:79], v[56:59], a[32:39], v1
v_smfmac_f32_16x16x64_bf16 v[72:75], v[60:63], v[240:247], v1
s_waitcnt lgkmcnt(0)
s_barrier
ds_read_b128 v[88:91], v28 offset:0
v_smfmac_f32_16x16x64_bf16 v[76:79], v[60:63], a[40:47], v1
ds_read_b128 v[92:95], v28 offset:64
ds_read_b128 v[96:99], v28 offset:128
v_smfmac_f32_16x16x64_bf16 v[80:83], v[40:43], a[64:71], v1
ds_read_b128 v[100:103], v28 offset:192
v_add_f32 v72, v72, v74
v_smfmac_f32_16x16x64_bf16 v[84:87], v[40:43], a[128:135], v1
v_add_f32 v76, v76, v78
v_smfmac_f32_16x16x64_bf16 v[80:83], v[44:47], a[72:79], v1
v_cvt_pk_bf16_f32 v74, v72, v76
v_smfmac_f32_16x16x64_bf16 v[84:87], v[44:47], a[136:143], v1
s_waitcnt lgkmcnt(3)
ds_write_b32 v27, v74 offset:576
v_add_f32 v73, v73, v75
v_mfma_f32_16x16x32_bf16 v[64:67], v[104:107], v[88:91], 0
v_add_f32 v77, v77, v79
v_cvt_pk_bf16_f32 v75, v73, v77
v_smfmac_f32_16x16x64_bf16 v[80:83], v[48:51], a[80:87], v1
s_waitcnt lgkmcnt(3)
ds_write_b32 v27, v75 offset:864
ds_read_b128 v[104:107], v0 offset:4096
v_mfma_f32_16x16x32_bf16 v[64:67], v[108:111], v[92:95], v[64:67]
v_mov_b64 v[40:41], 0
v_mov_b64 v[42:43], 0
v_smfmac_f32_16x16x64_bf16 v[84:87], v[48:51], a[144:151], v1
s_waitcnt lgkmcnt(4)
ds_read_b128 v[108:111], v0 offset:5120
v_mov_b64 v[44:45], 0
v_mfma_f32_16x16x32_bf16 v[64:67], v[112:115], v[96:99], v[64:67]
v_mov_b64 v[46:47], 0
v_smfmac_f32_16x16x64_bf16 v[80:83], v[52:55], a[88:95], v1
s_waitcnt lgkmcnt(4)
ds_read_b128 v[112:115], v0 offset:6144
v_mfma_f32_16x16x32_bf16 v[64:67], v[116:119], v[100:103], v[64:67]
v_smfmac_f32_16x16x64_bf16 v[84:87], v[52:55], a[152:159], v1
s_waitcnt lgkmcnt(2)
ds_read_b128 v[116:119], v0 offset:7168
v_mfma_f32_16x16x32_bf16 v[68:71], v[104:107], v[88:91], 0
s_barrier
v_exp_f32 v64, v64
v_smfmac_f32_16x16x64_bf16 v[80:83], v[56:59], a[96:103], v1
s_waitcnt lgkmcnt(2)
ds_read_b128 v[104:107], v28 offset:576
v_mov_b64 v[48:49], 0
v_mfma_f32_16x16x32_bf16 v[68:71], v[108:111], v[92:95], v[68:71]
v_exp_f32 v65, v65
v_smfmac_f32_16x16x64_bf16 v[84:87], v[56:59], a[160:167], v1
s_waitcnt lgkmcnt(2)
ds_read_b128 v[108:111], v28 offset:640
v_cvt_pk_bf16_f32 v72, v64, v65
v_mfma_f32_16x16x32_bf16 v[68:71], v[112:115], v[96:99], v[68:71]
v_exp_f32 v66, v66
v_smfmac_f32_16x16x64_bf16 v[80:83], v[60:63], a[104:111], v1
s_waitcnt lgkmcnt(2)
ds_read_b128 v[112:115], v28 offset:704
v_mov_b64 v[50:51], 0
v_mfma_f32_16x16x32_bf16 v[68:71], v[116:119], v[100:103], v[68:71]
v_exp_f32 v67, v67
v_smfmac_f32_16x16x64_bf16 v[84:87], v[60:63], a[168:175], v1
s_waitcnt lgkmcnt(2)
ds_read_b128 v[116:119], v28 offset:768
v_cvt_pk_bf16_f32 v73, v66, v67
v_mfma_f32_16x16x32_bf16 v[76:79], v[104:107], v[88:91], 0
s_waitcnt lgkmcnt(2)
v_exp_f32 v68, v68
v_mfma_f32_16x16x32_bf16 v[76:79], v[108:111], v[92:95], v[76:79]
s_waitcnt lgkmcnt(1)
v_exp_f32 v69, v69
v_mfma_f32_16x16x32_bf16 v[76:79], v[112:115], v[96:99], v[76:79]
s_waitcnt lgkmcnt(0)
v_exp_f32 v70, v70
v_mfma_f32_16x16x32_bf16 v[76:79], v[116:119], v[100:103], v[76:79]
v_exp_f32 v71, v71
v_cvt_pk_bf16_f32 v74, v68, v69
v_cvt_pk_bf16_f32 v75, v70, v71
v_add_f32 v80, v80, v82
v_add_f32 v81, v81, v83
v_mfma_f32_16x16x32_bf16 v[88:91], v[72:75], v[6:9], 0
ds_read_b128 v[112:115], v20 offset:45056
v_mul_f32 v76, s38, v76
v_mul_f32 v77, s38, v77
v_mfma_f32_16x16x32_bf16 v[92:95], v[72:75], v[32:35], 0
v_exp_f32 v78, v76
v_add_f32 v84, v84, v86
v_mfma_f32_16x16x32_bf16 v[96:99], v[72:75], v[36:39], 0
v_exp_f32 v79, v77
v_add_f32 v85, v85, v87
v_cvt_pk_bf16_f32 v12, v78, v79
v_cvt_pk_bf16_f32 v16, v80, v81
v_cvt_pk_bf16_f32 v18, v84, v85
v_mfma_f32_16x16x32_bf16 v[88:91], v[12:15], v[6:9], v[88:91]
ds_read_b128 v[116:119], v20 offset:46080
v_mov_b64 v[52:53], 0
v_mfma_f32_16x16x32_bf16 v[92:95], v[12:15], v[16:19], v[92:95]
ds_read_b128 v[80:83], v20 offset:53248
v_mov_b64 v[54:55], 0
v_mfma_f32_16x16x32_bf16 v[96:99], v[10:13], v[16:19], v[96:99]
ds_read_b128 v[84:87], v20 offset:54272
v_rcp_f32 v90, v88
v_rcp_f32 v91, v89
v_mul_f32 v92, v92, v90
v_mul_f32 v93, v93, v91
s_nop 0
v_mul_f32 v96, v96, v90
v_mul_f32 v97, v97, v91
v_cvt_pk_bf16_f32 v100, v92, v96
v_cvt_pk_bf16_f32 v101, v93, v97
ds_write2_b32 v29, v100, v101 offset0:0 offset1:80
v_max3_f32 v102, v88, v89, v90
v_max_f32 v102, v102, v91
v_cmp_nge_f32 vcc, s39, v102
global_store_dwordx4 v24, v[2:5], s[4:5] sc1
global_store_dwordx4 v24, v[2:5], s[4:5] offset:1024 sc1
s_cbranch_vccnz L_rec_s2_slow
L_rec_s2_join:
s_waitcnt lgkmcnt(0)
s_barrier
ds_read_b128 v[104:107], v30 offset:24576
ds_read_b128 v[108:111], v30 offset:24704
v_mov_b64 v[32:33], 0
v_mov_b64 v[34:35], 0
v_mov_b64 v[36:37], 0
v_mov_b64 v[38:39], 0
v_mov_b64 v[56:57], 0
v_mov_b64 v[58:59], 0
v_xor_b32 v24, 0x40000, v24
s_waitcnt lgkmcnt(1)
v_smfmac_f32_16x16x64_bf16 v[32:35], v[104:107], a[176:183], v1
s_waitcnt lgkmcnt(0)
ds_read_b128 v[88:91], v22 offset:4096
v_mov_b64 v[60:61], 0
v_smfmac_f32_16x16x64_bf16 v[32:35], v[108:111], a[184:191], v1
ds_read_b128 v[92:95], v22 offset:5120
v_mov_b64 v[62:63], 0
v_smfmac_f32_16x16x64_bf16 v[36:39], v[104:107], v[112:119], v1
ds_read_b128 v[96:99], v22 offset:12288
v_smfmac_f32_16x16x64_bf16 v[36:39], v[108:111], v[80:87], v1
ds_read_b128 v[100:103], v22 offset:13312
v_add_f32 v32, v32, v34
v_smfmac_f32_16x16x64_bf16 v[40:43], v[104:107], a[192:199], v1
ds_read_b128 v[112:115], v22 offset:20480
v_add_f32 v33, v33, v35
v_smfmac_f32_16x16x64_bf16 v[40:43], v[108:111], a[200:207], v1
ds_read_b128 v[116:119], v22 offset:21504
v_add_f32 v36, v36, v38
v_add_f32 v37, v37, v39
v_smfmac_f32_16x16x64_bf16 v[44:47], v[104:107], a[208:215], v1
s_waitcnt lgkmcnt(4)
ds_read_b128 v[80:83], v22 offset:28672
v_cvt_pk_bf16_f32 v64, v32, v36
v_cvt_pk_bf16_f32 v65, v33, v37
v_smfmac_f32_16x16x64_bf16 v[44:47], v[108:111], v[88:95], v1
s_waitcnt lgkmcnt(3)
global_store_dwordx2 v23, v[64:65], s[20:21] sc1
v_add_f32 v40, v40, v42
v_smfmac_f32_16x16x64_bf16 v[48:51], v[104:107], v[96:103], v1
ds_read_b128 v[84:87], v22 offset:29696
v_add_f32 v41, v41, v43
v_smfmac_f32_16x16x64_bf16 v[48:51], v[108:111], a[216:223], v1
ds_read_b128 v[72:75], v20 offset:39936
v_add_f32 v44, v44, v46
v_add_f32 v45, v45, v47
v_smfmac_f32_16x16x64_bf16 v[52:55], v[104:107], a[224:231], v1
v_cvt_pk_bf16_f32 v66, v40, v44
v_cvt_pk_bf16_f32 v67, v41, v45
v_smfmac_f32_16x16x64_bf16 v[52:55], v[108:111], a[232:239], v1
s_waitcnt lgkmcnt(3)
global_store_dwordx2 v23, v[66:67], s[22:23] sc1
v_add_f32 v48, v48, v50
v_smfmac_f32_16x16x64_bf16 v[56:59], v[104:107], v[112:119], v1
s_waitcnt lgkmcnt(1)
v_add_f32 v49, v49, v51
v_smfmac_f32_16x16x64_bf16 v[56:59], v[108:111], v[80:87], v1
v_add_f32 v52, v52, v54
v_add_f32 v53, v53, v55
v_smfmac_f32_16x16x64_bf16 v[60:63], v[104:107], a[240:247], v1
v_cvt_pk_bf16_f32 v68, v48, v52
v_cvt_pk_bf16_f32 v69, v49, v53
v_smfmac_f32_16x16x64_bf16 v[60:63], v[108:111], a[248:255], v1
global_store_dwordx2 v23, v[68:69], s[24:25] sc1
v_add_f32 v56, v56, v58
v_add_f32 v57, v57, v59
s_nop 4
v_pk_add_f32 v[60:61], v[60:61], v[62:63]
v_cvt_pk_bf16_f32 v70, v56, v60
v_cvt_pk_bf16_f32 v71, v57, v61
global_store_dwordx2 v23, v[70:71], s[26:27] sc1
s_waitcnt lgkmcnt(0)
ds_read_b128 v[40:43], v20 offset:61440
ds_read_b128 v[44:47], v20 offset:62464
ds_read_b128 v[48:51], v21 offset:4096
ds_read_b128 v[52:55], v21 offset:5120
ds_read_b128 v[56:59], v21 offset:12288
ds_read_b128 v[60:63], v21 offset:13312
ds_read_b128 v[88:91], v21 offset:20480
ds_read_b128 v[92:95], v21 offset:21504
ds_read_b128 v[96:99], v21 offset:45056
ds_read_b128 v[100:103], v21 offset:46080
ds_read_b128 v[104:107], v21 offset:53248
ds_read_b128 v[108:111], v21 offset:54272
ds_read_b128 v[112:115], v21 offset:61440
ds_read_b128 v[116:119], v21 offset:62464
v_mov_b64 v[64:65], 0
v_mov_b64 v[66:67], 0
v_mov_b64 v[68:69], 0
v_mov_b64 v[70:71], 0
v_mov_b64 v[80:81], 0
v_mov_b64 v[82:83], 0
v_mov_b64 v[84:85], 0
v_mov_b64 v[86:87], 0
s_add_u32 s30, s30, 786432
s_addc_u32 s31, s31, 0
global_load_dwordx4 v[32:35], v24, s[4:5] sc1
global_load_dwordx4 v[36:39], v24, s[4:5] offset:1024 sc1
s_add_u32 s32, s32, 786432
s_addc_u32 s33, s33, 0
s_add_u32 s34, s34, 8192
s_addc_u32 s35, s35, 0
s_add_u32 s40, s40, 1
s_xor_b32 s42, s42, 8192
v_add_u32 v2, 0x2000, v26
v_bfi_b32 v26, s43, v2, v26
v_xor_b32 v23, 0x40000, v23
v_xor_b32 v0, 8192, v0
s_nop 15
s_nop 3
global_load_dwordx4 v[32:35], v24, s[4:5] sc1
global_load_dwordx4 v[36:39], v24, s[4:5] offset:1024 sc1
s_mov_b32 s3, 64
v_add_u32 v4, 0x2000, v25
s_waitcnt vmcnt(2)
L_rec_s2_a:
v_mfma_f32_16x16x32_bf16 v[76:79], v[72:75], v[32:35], 0
v_mfma_f32_16x16x32_bf16 v[76:79], v[72:75], v[36:39], v[76:79]
s_nop 7
v_add_f32_dpp v76, v76, v76 row_ror:4 row_mask:0xf bank_mask:0xf
v_add_f32_dpp v77, v77, v77 row_ror:4 row_mask:0xf bank_mask:0xf
v_cmp_u_f32 vcc, v78, v79
v_add_f32_dpp v76, v76, v76 row_ror:8 row_mask:0xf bank_mask:0xf
v_add_f32_dpp v77, v77, v77 row_ror:8 row_mask:0xf bank_mask:0xf
v_cvt_pk_bf16_f32 v18, v76, v77
s_mov_b64 exec, s[44:45]
global_store_dword v25, v18, s[4:5] sc1
s_mov_b64 exec, -1
s_cbranch_vccnz L_rec_s2_a_fail
L_rec_s2_a_ok:
v_bfi_b32 v25, s43, v4, v25
s_cmp_lt_u32 s40, 63
s_cbranch_scc1 L_rec_s2_top
v_and_b32 v5, 0x1fff, v25
global_store_dword v5, v18, s[34:35] sc1
s_branch L_rec_done
L_rec_s2_kv:
ds_read_b32 v3, v4 offset:37632
s_waitcnt lgkmcnt(0)
L_rec_s2_kv2:
v_cmp_eq_u32 s[46:47], 1, v3
s_bitcmp1_b64 s[46:47], s3
s_cbranch_scc1 L_rec_s2_kv_ok
global_load_dword v3, v4, s[36:37] sc1
s_waitcnt vmcnt(0)
s_sub_u32 s41, s41, 1
s_cbranch_scc0 L_rec_s2_kv2
s_mov_b32 s41, 0
s_branch L_rec_s2_kv_ok
L_rec_s2_b0:
global_load_dwordx4 v[32:35], v26, s[4:5] sc1
global_load_dwordx4 v[36:39], v26, s[4:5] offset:1024 sc1
s_mov_b32 s18, 0
s_sub_u32 s41, s41, 1
s_cbranch_scc1 L_rec_s2_b0_dead
s_nop 1
v_mov_b64 v[64:65], 0
v_mov_b64 v[66:67], 0
s_waitcnt vmcnt(2)
s_branch L_rec_s2_b1
L_rec_s2_b0_dead:
s_mov_b32 s41, 0
s_branch L_rec_s2_b0_ok
L_rec_s2_slow:
s_waitcnt lgkmcnt(0)
ds_read_b128 v[88:91], v28 offset:0
ds_read_b128 v[92:95], v28 offset:64
ds_read_b128 v[96:99], v28 offset:128
ds_read_b128 v[100:103], v28 offset:192
ds_read_b128 v[104:107], v0 offset:0
ds_read_b128 v[108:111], v0 offset:1024
ds_read_b128 v[112:115], v0 offset:2048
ds_read_b128 v[116:119], v0 offset:3072
s_waitcnt lgkmcnt(0)
v_mfma_f32_16x16x32_bf16 v[64:67], v[104:107], v[88:91], 0
v_mfma_f32_16x16x32_bf16 v[64:67], v[108:111], v[92:95], v[64:67]
v_mfma_f32_16x16x32_bf16 v[64:67], v[112:115], v[96:99], v[64:67]
v_mfma_f32_16x16x32_bf16 v[64:67], v[116:119], v[100:103], v[64:67]
ds_read_b128 v[104:107], v0 offset:4096
ds_read_b128 v[108:111], v0 offset:5120
ds_read_b128 v[112:115], v0 offset:6144
ds_read_b128 v[116:119], v0 offset:7168
s_waitcnt lgkmcnt(0)
v_mfma_f32_16x16x32_bf16 v[68:71], v[104:107], v[88:91], 0
v_mfma_f32_16x16x32_bf16 v[68:71], v[108:111], v[92:95], v[68:71]
v_mfma_f32_16x16x32_bf16 v[68:71], v[112:115], v[96:99], v[68:71]
v_mfma_f32_16x16x32_bf16 v[68:71], v[116:119], v[100:103], v[68:71]
s_nop 7
v_max3_f32 v2, v64, v65, v66
v_max3_f32 v3, v67, v68, v69
v_max3_f32 v2, v2, v70, v71
v_max3_f32 v3, v3, v76, v77
v_max_f32 v2, v2, v3
v_mov_b32 v3, v2
s_nop 1
v_permlane32_swap_b32 v2, v3
v_max_f32 v2, v2, v3
v_mov_b32 v3, v2
s_nop 1
v_permlane16_swap_b32 v2, v3
v_max_f32 v2, v2, v3
v_sub_f32 v64, v64, v2
v_sub_f32 v65, v65, v2
v_sub_f32 v66, v66, v2
v_sub_f32 v67, v67, v2
v_sub_f32 v68, v68, v2
v_sub_f32 v69, v69, v2
v_sub_f32 v70, v70, v2
v_sub_f32 v71, v71, v2
v_sub_f32 v76, v76, v2
v_sub_f32 v77, v77, v2
v_exp_f32 v64, v64
v_exp_f32 v65, v65
v_exp_f32 v66, v66
v_exp_f32 v67, v67
v_exp_f32 v68, v68
v_exp_f32 v69, v69
v_exp_f32 v70, v70
v_exp_f32 v71, v71
v_exp_f32 v76, v76
v_exp_f32 v77, v77
v_cvt_pk_bf16_f32 v72, v64, v65
v_cvt_pk_bf16_f32 v73, v66, v67
v_cvt_pk_bf16_f32 v74, v68, v69
v_cvt_pk_bf16_f32 v75, v70, v71
v_cvt_pk_bf16_f32 v12, v76, v77
s_nop 0
v_mfma_f32_16x16x32_bf16 v[88:91], v[72:75], v[6:9], 0
v_mfma_f32_16x16x32_bf16 v[92:95], v[72:75], v[32:35], 0
v_mfma_f32_16x16x32_bf16 v[96:99], v[72:75], v[36:39], 0
v_mfma_f32_16x16x32_bf16 v[88:91], v[12:15], v[6:9], v[88:91]
v_mfma_f32_16x16x32_bf16 v[92:95], v[12:15], v[16:19], v[92:95]
v_mfma_f32_16x16x32_bf16 v[96:99], v[10:13], v[16:19], v[96:99]
s_nop 7
v_rcp_f32 v90, v88
v_rcp_f32 v91, v89
v_mul_f32 v92, v92, v90
v_mul_f32 v93, v93, v91
v_mul_f32 v96, v96, v90
v_mul_f32 v97, v97, v91
v_cvt_pk_bf16_f32 v100, v92, v96
v_cvt_pk_bf16_f32 v101, v93, v97
ds_write2_b32 v29, v100, v101 offset0:0 offset1:80
v_mov_b64 v[2:3], -1
ds_read_b128 v[112:115], v20 offset:45056
ds_read_b128 v[116:119], v20 offset:46080
s_branch L_rec_s2_join
L_rec_s2_a_fail:
s_cmp_gt_u32 s3, 60
s_cbranch_scc1 L_rec_s2_a_f2
s_sleep 6
L_rec_s2_a_f2:
global_load_dwordx4 v[32:35], v24, s[4:5] sc1
global_load_dwordx4 v[36:39], v24, s[4:5] offset:1024 sc1
s_mov_b32 s19, 0
s_sub_u32 s3, s3, 1
s_cbranch_scc1 L_rec_s2_a_chk
s_waitcnt vmcnt(3)
s_branch L_rec_s2_a
L_rec_s2_a_chk:
s_mov_b32 s3, 60
s_waitcnt vmcnt(0)
s_sub_u32 s41, s41, 64
s_cbranch_scc1 L_rec_s2_a_dead
v_max3_u32 v2, v32, v33, v34
v_max3_u32 v3, v35, v36, v37
v_max3_u32 v2, v2, v38, v39
v_max_u32 v2, v2, v3
v_cmp_eq_u32 vcc, -1, v2
s_cbranch_vccnz L_rec_s2_a_fail
s_branch L_rec_s2_a_now
L_rec_s2_a_dead:
s_mov_b32 s41, 0
L_rec_s2_a_now:
v_mfma_f32_16x16x32_bf16 v[76:79], v[72:75], v[32:35], 0
v_mfma_f32_16x16x32_bf16 v[76:79], v[72:75], v[36:39], v[76:79]
s_nop 7
v_add_f32_dpp v76, v76, v76 row_ror:4 row_mask:0xf bank_mask:0xf
v_add_f32_dpp v77, v77, v77 row_ror:4 row_mask:0xf bank_mask:0xf
v_cmp_u_f32 vcc, v78, v79
v_add_f32_dpp v76, v76, v76 row_ror:8 row_mask:0xf bank_mask:0xf
v_add_f32_dpp v77, v77, v77 row_ror:8 row_mask:0xf bank_mask:0xf
v_cvt_pk_bf16_f32 v18, v76, v77
v_cmp_u_f32 vcc, v76, v77
v_and_b32 v2, 0x7fff7fff, v18
s_nop 0
v_cndmask_b32 v18, v18, v2, vcc
s_mov_b64 exec, s[44:45]
global_store_dword v25, v18, s[4:5] sc1
s_mov_b64 exec, -1
s_branch L_rec_s2_a_ok
L_rec_s3:
v_mov_b32 v2, -1
v_xor_b32 v3, 0x6000, v25
global_store_dword v25, v2, s[4:5] sc1
global_store_dword v3, v2, s[4:5] sc1
ds_read_b128 v[40:43], v20 offset:63488
ds_read_b128 v[44:47], v20 offset:64512
ds_read_b128 v[48:51], v21 offset:6144
ds_read_b128 v[52:55], v21 offset:7168
ds_read_b128 v[56:59], v21 offset:14336
ds_read_b128 v[60:63], v21 offset:15360
ds_read_b128 v[88:91], v21 offset:22528
ds_read_b128 v[92:95], v21 offset:23552
ds_read_b128 v[96:99], v21 offset:47104
ds_read_b128 v[100:103], v21 offset:48128
ds_read_b128 v[104:107], v21 offset:55296
ds_read_b128 v[108:111], v21 offset:56320
ds_read_b128 v[112:115], v21 offset:63488
ds_read_b128 v[116:119], v21 offset:64512
v_mov_b64 v[64:65], 0
v_mov_b64 v[66:67], 0
v_mov_b64 v[68:69], 0
v_mov_b64 v[70:71], 0
v_mov_b64 v[80:81], 0
v_mov_b64 v[82:83], 0
v_mov_b64 v[84:85], 0
v_mov_b64 v[86:87], 0
L_rec_s3_top:
v_mov_b64 v[76:77], 0
v_mov_b64 v[78:79], 0
v_mov_b64 v[72:73], 0
v_mov_b64 v[74:75], 0
s_mov_b32 m0, s42
s_add_u32 s3, s40, 1
v_and_b32 v5, 0x1fff, v25
v_lshrrev_b32 v4, 2, v20
s_bitcmp1_b64 s[46:47], s3
s_cbranch_scc0 L_rec_s3_kv
L_rec_s3_kv_ok:
s_nop 15
s_nop 1
global_load_dwordx4 v[32:35], v26, s[4:5] sc1
global_load_dwordx4 v[36:39], v26, s[4:5] offset:1024 sc1
s_nop 15
s_nop 13
global_load_dwordx4 v[32:35], v26, s[4:5] sc1
global_load_dwordx4 v[36:39], v26, s[4:5] offset:1024 sc1
s_waitcnt vmcnt(2) lgkmcnt(0)
L_rec_s3_b1:
v_max3_u32 v2, v32, v33, v34
v_max3_u32 v3, v35, v36, v37
v_max3_u32 v2, v2, v38, v39
v_max_u32 v2, v2, v3
v_cmp_le_u32 vcc, s59, v2
v_smfmac_f32_16x16x64_bf16 v[64:67], v[32:35], v[40:47], v1
ds_write_b64 v20, v[32:33] offset:30720
s_cbranch_vccnz L_rec_s3_b0
L_rec_s3_b0_ok:
v_smfmac_f32_16x16x64_bf16 v[68:71], v[32:35], v[48:55], v1
ds_write_b64 v20, v[34:35] offset:30728
v_smfmac_f32_16x16x64_bf16 v[64:67], v[36:39], v[56:63], v1
ds_write_b64 v20, v[36:37] offset:31744
v_smfmac_f32_16x16x64_bf16 v[68:71], v[36:39], v[88:95], v1
ds_write_b64 v20, v[38:39] offset:31752
v_smfmac_f32_16x16x64_bf16 v[72:75], v[32:35], v[96:103], v1
ds_read_b128 v[88:91], v21 offset:30720
ds_read_b128 v[92:95], v21 offset:31744
v_smfmac_f32_16x16x64_bf16 v[76:79], v[32:35], v[104:111], v1
ds_read_b128 v[96:99], v21 offset:38912
ds_read_b128 v[100:103], v21 offset:39936
v_smfmac_f32_16x16x64_bf16 v[72:75], v[36:39], v[112:119], v1
s_waitcnt lgkmcnt(4)
s_barrier
ds_read_b128 v[40:43], v20 offset:24576
v_smfmac_f32_16x16x64_bf16 v[76:79], v[36:39], v[248:255], v1
ds_read_b128 v[44:47], v20 offset:25600
ds_read_b128 v[48:51], v20 offset:26624
v_smfmac_f32_16x16x64_bf16 v[80:83], v[32:35], a[48:55], v1
ds_read_b128 v[52:55], v20 offset:27648
ds_read_b128 v[56:59], v20 offset:28672
v_smfmac_f32_16x16x64_bf16 v[84:87], v[32:35], a[112:119], v1
s_waitcnt vmcnt(0)
ds_read_b128 v[60:63], v20 offset:29696
global_load_lds_dwordx4 v20, s[30:31] offset:0 sc1
v_smfmac_f32_16x16x64_bf16 v[80:83], v[36:39], a[56:63], v1
global_load_lds_dwordx4 v20, s[30:31] offset:1024 sc1
global_store_dword v5, v18, s[34:35] sc1
v_smfmac_f32_16x16x64_bf16 v[84:87], v[36:39], a[120:127], v1
s_waitcnt lgkmcnt(5)
ds_read_b128 v[32:35], v20 offset:22528
ds_read_b128 v[36:39], v20 offset:23552
v_smfmac_f32_16x16x64_bf16 v[64:67], v[40:43], v[88:95], v1
s_mov_b32 m0, 37632
v_smfmac_f32_16x16x64_bf16 v[68:71], v[40:43], v[96:103], v1
s_waitcnt lgkmcnt(6)
global_load_lds_dword v4, s[36:37] sc1
v_smfmac_f32_16x16x64_bf16 v[64:67], v[44:47], v[120:127], v1
s_mov_b32 m0, 22528
v_smfmac_f32_16x16x64_bf16 v[68:71], v[44:47], v[160:167], v1
s_waitcnt lgkmcnt(5)
s_waitcnt lgkmcnt(0)
global_load_lds_dwordx4 v20, s[32:33] offset:0 sc1
v_smfmac_f32_16x16x64_bf16 v[64:67], v[48:51], v[128:135], v1
global_load_lds_dwordx4 v20, s[32:33] offset:1024 sc1
v_mov_b64 v[2:3], -1
v_smfmac_f32_16x16x64_bf16 v[68:71], v[48:51], v[168:175], v1
v_mov_b64 v[4:5], -1
v_smfmac_f32_16x16x64_bf16 v[64:67], v[52:55], v[136:143], v1
v_smfmac_f32_16x16x64_bf16 v[68:71], v[52:55], v[176:183], v1
v_smfmac_f32_16x16x64_bf16 v[64:67], v[56:59], v[144:151], v1
ds_read_b128 v[104:107], v0 offset:0
v_smfmac_f32_16x16x64_bf16 v[68:71], v[56:59], v[184:191], v1
ds_read_b128 v[108:111], v0 offset:1024
v_smfmac_f32_16x16x64_bf16 v[64:67], v[60:63], v[152:159], v1
ds_read_b128 v[112:115], v0 offset:2048
v_smfmac_f32_16x16x64_bf16 v[68:71], v[60:63], v[192:199], v1
ds_read_b128 v[116:119], v0 offset:3072
v_smfmac_f32_16x16x64_bf16 v[72:75], v[40:43], v[200:207], v1
v_add_f32 v64, v64, v66
v_smfmac_f32_16x16x64_bf16 v[76:79], v[40:43], a[0:7], v1
v_add_f32 v68, v68, v70
v_smfmac_f32_16x16x64_bf16 v[72:75], v[44:47], v[208:215], v1
v_cvt_pk_bf16_f32 v66, v64, v68
v_smfmac_f32_16x16x64_bf16 v[76:79], v[44:47], a[8:15], v1
ds_write_b32 v27, v66
v_add_f32 v65, v65, v67
v_smfmac_f32_16x16x64_bf16 v[72:75], v[48:51], v[216:223], v1
v_add_f32 v69, v69, v71
v_smfmac_f32_16x16x64_bf16 v[76:79], v[48:51], a[16:23], v1
v_cvt_pk_bf16_f32 v67, v65, v69
v_smfmac_f32_16x16x64_bf16 v[72:75], v[52:55], v[224:231], v1
ds_write_b32 v27, v67 offset:288
v_xor_b32 v16, 0x4000, v25
v_smfmac_f32_16x16x64_bf16 v[76:79], v[52:55], a[24:31], v1
global_store_dword v16, v2, s[4:5] sc1
v_smfmac_f32_16x16x64_bf16 v[72:75], v[56:59], v[232:239], v1
v_smfmac_f32_16x16x64_bf16 v[76:79], v[56:59], a[32:39], v1
v_smfmac_f32_16x16x64_bf16 v[72:75], v[60:63], v[240:247], v1
s_waitcnt lgkmcnt(0)
s_barrier
ds_read_b128 v[88:91], v28 offset:0
v_smfmac_f32_16x16x64_bf16 v[76:79], v[60:63], a[40:47], v1
ds_read_b128 v[92:95], v28 offset:64
ds_read_b128 v[96:99], v28 offset:128
v_smfmac_f32_16x16x64_bf16 v[80:83], v[40:43], a[64:71], v1
ds_read_b128 v[100:103], v28 offset:192
v_add_f32 v72, v72, v74
v_smfmac_f32_16x16x64_bf16 v[84:87], v[40:43], a[128:135], v1
v_add_f32 v76, v76, v78
v_smfmac_f32_16x16x64_bf16 v[80:83], v[44:47], a[72:79], v1
v_cvt_pk_bf16_f32 v74, v72, v76
v_smfmac_f32_16x16x64_bf16 v[84:87], v[44:47], a[136:143], v1
s_waitcnt lgkmcnt(3)
ds_write_b32 v27, v74 offset:576
v_add_f32 v73, v73, v75
v_mfma_f32_16x16x32_bf16 v[64:67], v[104:107], v[88:91], 0
v_add_f32 v77, v77, v79
v_cvt_pk_bf16_f32 v75, v73, v77
v_smfmac_f32_16x16x64_bf16 v[80:83], v[48:51], a[80:87], v1
s_waitcnt lgkmcnt(3)
ds_write_b32 v27, v75 offset:864
ds_read_b128 v[104:107], v0 offset:4096
v_mfma_f32_16x16x32_bf16 v[64:67], v[108:111], v[92:95], v[64:67]
v_mov_b64 v[40:41], 0
v_mov_b64 v[42:43], 0
v_smfmac_f32_16x16x64_bf16 v[84:87], v[48:51], a[144:151], v1
s_waitcnt lgkmcnt(4)
ds_read_b128 v[108:111], v0 offset:5120
v_mov_b64 v[44:45], 0
v_mfma_f32_16x16x32_bf16 v[64:67], v[112:115], v[96:99], v[64:67]
v_mov_b64 v[46:47], 0
v_smfmac_f32_16x16x64_bf16 v[80:83], v[52:55], a[88:95], v1
s_waitcnt lgkmcnt(4)
ds_read_b128 v[112:115], v0 offset:6144
v_mfma_f32_16x16x32_bf16 v[64:67], v[116:119], v[100:103], v[64:67]
v_smfmac_f32_16x16x64_bf16 v[84:87], v[52:55], a[152:159], v1
s_waitcnt lgkmcnt(2)
ds_read_b128 v[116:119], v0 offset:7168
v_mfma_f32_16x16x32_bf16 v[68:71], v[104:107], v[88:91], 0
s_barrier
v_exp_f32 v64, v64
v_smfmac_f32_16x16x64_bf16 v[80:83], v[56:59], a[96:103], v1
s_waitcnt lgkmcnt(2)
ds_read_b128 v[104:107], v28 offset:576
v_mov_b64 v[48:49], 0
v_mfma_f32_16x16x32_bf16 v[68:71], v[108:111], v[92:95], v[68:71]
v_exp_f32 v65, v65
v_smfmac_f32_16x16x64_bf16 v[84:87], v[56:59], a[160:167], v1
s_waitcnt lgkmcnt(2)
ds_read_b128 v[108:111], v28 offset:640
v_cvt_pk_bf16_f32 v72, v64, v65
v_mfma_f32_16x16x32_bf16 v[68:71], v[112:115], v[96:99], v[68:71]
v_exp_f32 v66, v66
v_smfmac_f32_16x16x64_bf16 v[80:83], v[60:63], a[104:111], v1
s_waitcnt lgkmcnt(2)
ds_read_b128 v[112:115], v28 offset:704
v_mov_b64 v[50:51], 0
v_mfma_f32_16x16x32_bf16 v[68:71], v[116:119], v[100:103], v[68:71]
v_exp_f32 v67, v67
v_smfmac_f32_16x16x64_bf16 v[84:87], v[60:63], a[168:175], v1
s_waitcnt lgkmcnt(2)
ds_read_b128 v[116:119], v28 offset:768
v_cvt_pk_bf16_f32 v73, v66, v67
v_mfma_f32_16x16x32_bf16 v[76:79], v[104:107], v[88:91], 0
s_waitcnt lgkmcnt(2)
v_exp_f32 v68, v68
v_mfma_f32_16x16x32_bf16 v[76:79], v[108:111], v[92:95], v[76:79]
s_waitcnt lgkmcnt(1)
v_exp_f32 v69, v69
v_mfma_f32_16x16x32_bf16 v[76:79], v[112:115], v[96:99], v[76:79]
s_waitcnt lgkmcnt(0)
v_exp_f32 v70, v70
v_mfma_f32_16x16x32_bf16 v[76:79], v[116:119], v[100:103], v[76:79]
v_exp_f32 v71, v71
v_cvt_pk_bf16_f32 v74, v68, v69
v_cvt_pk_bf16_f32 v75, v70, v71
v_add_f32 v80, v80, v82
v_add_f32 v81, v81, v83
v_mfma_f32_16x16x32_bf16 v[88:91], v[72:75], v[6:9], 0
ds_read_b128 v[112:115], v20 offset:47104
v_mul_f32 v76, s38, v76
v_mul_f32 v77, s38, v77
v_mfma_f32_16x16x32_bf16 v[92:95], v[72:75], v[32:35], 0
v_exp_f32 v78, v76
v_add_f32 v84, v84, v86
v_mfma_f32_16x16x32_bf16 v[96:99], v[72:75], v[36:39], 0
v_exp_f32 v79, v77
v_add_f32 v85, v85, v87
v_cvt_pk_bf16_f32 v12, v78, v79
v_cvt_pk_bf16_f32 v16, v80, v81
v_cvt_pk_bf16_f32 v18, v84, v85
v_mfma_f32_16x16x32_bf16 v[88:91], v[12:15], v[6:9], v[88:91]
ds_read_b128 v[116:119], v20 offset:48128
v_mov_b64 v[52:53], 0
v_mfma_f32_16x16x32_bf16 v[92:95], v[12:15], v[16:19], v[92:95]
ds_read_b128 v[80:83], v20 offset:55296
v_mov_b64 v[54:55], 0
v_mfma_f32_16x16x32_bf16 v[96:99], v[10:13], v[16:19], v[96:99]
ds_read_b128 v[84:87], v20 offset:56320
v_rcp_f32 v90, v88
v_rcp_f32 v91, v89
v_mul_f32 v92, v92, v90
v_mul_f32 v93, v93, v91
s_nop 0
v_mul_f32 v96, v96, v90
v_mul_f32 v97, v97, v91
v_cvt_pk_bf16_f32 v100, v92, v96
v_cvt_pk_bf16_f32 v101, v93, v97
ds_write2_b32 v29, v100, v101 offset0:0 offset1:80
v_max3_f32 v102, v88, v89, v90
v_max_f32 v102, v102, v91
v_cmp_nge_f32 vcc, s39, v102
global_store_dwordx4 v24, v[2:5], s[4:5] sc1
global_store_dwordx4 v24, v[2:5], s[4:5] offset:1024 sc1
s_cbranch_vccnz L_rec_s3_slow
L_rec_s3_join:
s_waitcnt lgkmcnt(0)
s_barrier
ds_read_b128 v[104:107], v30 offset:24576
ds_read_b128 v[108:111], v30 offset:24704
v_mov_b64 v[32:33], 0
v_mov_b64 v[34:35], 0
v_mov_b64 v[36:37], 0
v_mov_b64 v[38:39], 0
v_mov_b64 v[56:57], 0
v_mov_b64 v[58:59], 0
v_xor_b32 v24, 0x40000, v24
s_waitcnt lgkmcnt(1)
v_smfmac_f32_16x16x64_bf16 v[32:35], v[104:107], a[176:183], v1
s_waitcnt lgkmcnt(0)
ds_read_b128 v[88:91], v22 offset:6144
v_mov_b64 v[60:61], 0
v_smfmac_f32_16x16x64_bf16 v[32:35], v[108:111], a[184:191], v1
ds_read_b128 v[92:95], v22 offset:7168
v_mov_b64 v[62:63], 0
v_smfmac_f32_16x16x64_bf16 v[36:39], v[104:107], v[112:119], v1
ds_read_b128 v[96:99], v22 offset:14336
v_smfmac_f32_16x16x64_bf16 v[36:39], v[108:111], v[80:87], v1
ds_read_b128 v[100:103], v22 offset:15360
v_add_f32 v32, v32, v34
v_smfmac_f32_16x16x64_bf16 v[40:43], v[104:107], a[192:199], v1
ds_read_b128 v[112:115], v22 offset:22528
v_add_f32 v33, v33, v35
v_smfmac_f32_16x16x64_bf16 v[40:43], v[108:111], a[200:207], v1
ds_read_b128 v[116:119], v22 offset:23552
v_add_f32 v36, v36, v38
v_add_f32 v37, v37, v39
v_smfmac_f32_16x16x64_bf16 v[44:47], v[104:107], a[208:215], v1
s_waitcnt lgkmcnt(4)
ds_read_b128 v[80:83], v22 offset:30720
v_cvt_pk_bf16_f32 v64, v32, v36
v_cvt_pk_bf16_f32 v65, v33, v37
v_smfmac_f32_16x16x64_bf16 v[44:47], v[108:111], v[88:95], v1
s_waitcnt lgkmcnt(3)
global_store_dwordx2 v23, v[64:65], s[20:21] sc1
v_add_f32 v40, v40, v42
v_smfmac_f32_16x16x64_bf16 v[48:51], v[104:107], v[96:103], v1
ds_read_b128 v[84:87], v22 offset:31744
v_add_f32 v41, v41, v43
v_smfmac_f32_16x16x64_bf16 v[48:51], v[108:111], a[216:223], v1
ds_read_b128 v[72:75], v20 offset:39936
v_add_f32 v44, v44, v46
v_add_f32 v45, v45, v47
v_smfmac_f32_16x16x64_bf16 v[52:55], v[104:107], a[224:231], v1
v_cvt_pk_bf16_f32 v66, v40, v44
v_cvt_pk_bf16_f32 v67, v41, v45
v_smfmac_f32_16x16x64_bf16 v[52:55], v[108:111], a[232:239], v1
s_waitcnt lgkmcnt(3)
global_store_dwordx2 v23, v[66:67], s[22:23] sc1
v_add_f32 v48, v48, v50
v_smfmac_f32_16x16x64_bf16 v[56:59], v[104:107], v[112:119], v1
s_waitcnt lgkmcnt(1)
v_add_f32 v49, v49, v51
v_smfmac_f32_16x16x64_bf16 v[56:59], v[108:111], v[80:87], v1
v_add_f32 v52, v52, v54
v_add_f32 v53, v53, v55
v_smfmac_f32_16x16x64_bf16 v[60:63], v[104:107], a[240:247], v1
v_cvt_pk_bf16_f32 v68, v48, v52
v_cvt_pk_bf16_f32 v69, v49, v53
v_smfmac_f32_16x16x64_bf16 v[60:63], v[108:111], a[248:255], v1
global_store_dwordx2 v23, v[68:69], s[24:25] sc1
v_add_f32 v56, v56, v58
v_add_f32 v57, v57, v59
s_nop 4
v_pk_add_f32 v[60:61], v[60:61], v[62:63]
v_cvt_pk_bf16_f32 v70, v56, v60
v_cvt_pk_bf16_f32 v71, v57, v61
global_store_dwordx2 v23, v[70:71], s[26:27] sc1
s_waitcnt lgkmcnt(0)
ds_read_b128 v[40:43], v20 offset:63488
ds_read_b128 v[44:47], v20 offset:64512
ds_read_b128 v[48:51], v21 offset:6144
ds_read_b128 v[52:55], v21 offset:7168
ds_read_b128 v[56:59], v21 offset:14336
ds_read_b128 v[60:63], v21 offset:15360
ds_read_b128 v[88:91], v21 offset:22528
ds_read_b128 v[92:95], v21 offset:23552
ds_read_b128 v[96:99], v21 offset:47104
ds_read_b128 v[100:103], v21 offset:48128
ds_read_b128 v[104:107], v21 offset:55296
ds_read_b128 v[108:111], v21 offset:56320
ds_read_b128 v[112:115], v21 offset:63488
ds_read_b128 v[116:119], v21 offset:64512
v_mov_b64 v[64:65], 0
v_mov_b64 v[66:67], 0
v_mov_b64 v[68:69], 0
v_mov_b64 v[70:71], 0
v_mov_b64 v[80:81], 0
v_mov_b64 v[82:83], 0
v_mov_b64 v[84:85], 0
v_mov_b64 v[86:87], 0
s_add_u32 s30, s30, 786432
s_addc_u32 s31, s31, 0
s_add_u32 s32, s32, 786432
s_addc_u32 s33, s33, 0
s_add_u32 s34, s34, 8192
s_addc_u32 s35, s35, 0
s_add_u32 s40, s40, 1
global_load_dwordx4 v[32:35], v24, s[4:5] sc1
global_load_dwordx4 v[36:39], v24, s[4:5] offset:1024 sc1
s_xor_b32 s42, s42, 8192
v_add_u32 v2, 0x2000, v26
v_bfi_b32 v26, s43, v2, v26
v_xor_b32 v23, 0x40000, v23
v_xor_b32 v0, 8192, v0
s_nop 15
s_nop 8
global_load_dwordx4 v[32:35], v24, s[4:5] sc1
global_load_dwordx4 v[36:39], v24, s[4:5] offset:1024 sc1
s_mov_b32 s3, 64
v_add_u32 v4, 0x2000, v25
s_waitcnt vmcnt(2)
L_rec_s3_a:
v_mfma_f32_16x16x32_bf16 v[76:79], v[72:75], v[32:35], 0
v_mfma_f32_16x16x32_bf16 v[76:79], v[72:75], v[36:39], v[76:79]
s_nop 7
v_add_f32_dpp v76, v76, v76 row_ror:4 row_mask:0xf bank_mask:0xf
v_add_f32_dpp v77, v77, v77 row_ror:4 row_mask:0xf bank_mask:0xf
v_cmp_u_f32 vcc, v78, v79
v_add_f32_dpp v76, v76, v76 row_ror:8 row_mask:0xf bank_mask:0xf
v_add_f32_dpp v77, v77, v77 row_ror:8 row_mask:0xf bank_mask:0xf
v_cvt_pk_bf16_f32 v18, v76, v77
s_mov_b64 exec, s[44:45]
global_store_dword v25, v18, s[4:5] sc1
s_mov_b64 exec, -1
s_cbranch_vccnz L_rec_s3_a_fail
L_rec_s3_a_ok:
v_bfi_b32 v25, s43, v4, v25
s_cmp_lt_u32 s40, 63
s_cbranch_scc1 L_rec_s3_top
v_and_b32 v5, 0x1fff, v25
global_store_dword v5, v18, s[34:35] sc1
s_branch L_rec_done
L_rec_s3_kv:
ds_read_b32 v3, v4 offset:37632
s_waitcnt lgkmcnt(0)
L_rec_s3_kv2:
v_cmp_eq_u32 s[46:47], 1, v3
s_bitcmp1_b64 s[46:47], s3
s_cbranch_scc1 L_rec_s3_kv_ok
global_load_dword v3, v4, s[36:37] sc1
s_waitcnt vmcnt(0)
s_sub_u32 s41, s41, 1
s_cbranch_scc0 L_rec_s3_kv2
s_mov_b32 s41, 0
s_branch L_rec_s3_kv_ok
L_rec_s3_b0:
global_load_dwordx4 v[32:35], v26, s[4:5] sc1
global_load_dwordx4 v[36:39], v26, s[4:5] offset:1024 sc1
s_mov_b32 s18, 0
s_sub_u32 s41, s41, 1
s_cbranch_scc1 L_rec_s3_b0_dead
s_nop 1
v_mov_b64 v[64:65], 0
v_mov_b64 v[66:67], 0
s_waitcnt vmcnt(2)
s_branch L_rec_s3_b1
L_rec_s3_b0_dead:
s_mov_b32 s41, 0
s_branch L_rec_s3_b0_ok
L_rec_s3_slow:
s_waitcnt lgkmcnt(0)
ds_read_b128 v[88:91], v28 offset:0
ds_read_b128 v[92:95], v28 offset:64
ds_read_b128 v[96:99], v28 offset:128
ds_read_b128 v[100:103], v28 offset:192
ds_read_b128 v[104:107], v0 offset:0
ds_read_b128 v[108:111], v0 offset:1024
ds_read_b128 v[112:115], v0 offset:2048
ds_read_b128 v[116:119], v0 offset:3072
s_waitcnt lgkmcnt(0)
v_mfma_f32_16x16x32_bf16 v[64:67], v[104:107], v[88:91], 0
v_mfma_f32_16x16x32_bf16 v[64:67], v[108:111], v[92:95], v[64:67]
v_mfma_f32_16x16x32_bf16 v[64:67], v[112:115], v[96:99], v[64:67]
v_mfma_f32_16x16x32_bf16 v[64:67], v[116:119], v[100:103], v[64:67]
ds_read_b128 v[104:107], v0 offset:4096
ds_read_b128 v[108:111], v0 offset:5120
ds_read_b128 v[112:115], v0 offset:6144
ds_read_b128 v[116:119], v0 offset:7168
s_waitcnt lgkmcnt(0)
v_mfma_f32_16x16x32_bf16 v[68:71], v[104:107], v[88:91], 0
v_mfma_f32_16x16x32_bf16 v[68:71], v[108:111], v[92:95], v[68:71]
v_mfma_f32_16x16x32_bf16 v[68:71], v[112:115], v[96:99], v[68:71]
v_mfma_f32_16x16x32_bf16 v[68:71], v[116:119], v[100:103], v[68:71]
s_nop 7
v_max3_f32 v2, v64, v65, v66
v_max3_f32 v3, v67, v68, v69
v_max3_f32 v2, v2, v70, v71
v_max3_f32 v3, v3, v76, v77
v_max_f32 v2, v2, v3
v_mov_b32 v3, v2
s_nop 1
v_permlane32_swap_b32 v2, v3
v_max_f32 v2, v2, v3
v_mov_b32 v3, v2
s_nop 1
v_permlane16_swap_b32 v2, v3
v_max_f32 v2, v2, v3
v_sub_f32 v64, v64, v2
v_sub_f32 v65, v65, v2
v_sub_f32 v66, v66, v2
v_sub_f32 v67, v67, v2
v_sub_f32 v68, v68, v2
v_sub_f32 v69, v69, v2
v_sub_f32 v70, v70, v2
v_sub_f32 v71, v71, v2
v_sub_f32 v76, v76, v2
v_sub_f32 v77, v77, v2
v_exp_f32 v64, v64
v_exp_f32 v65, v65
v_exp_f32 v66, v66
v_exp_f32 v67, v67
v_exp_f32 v68, v68
v_exp_f32 v69, v69
v_exp_f32 v70, v70
v_exp_f32 v71, v71
v_exp_f32 v76, v76
v_exp_f32 v77, v77
v_cvt_pk_bf16_f32 v72, v64, v65
v_cvt_pk_bf16_f32 v73, v66, v67
v_cvt_pk_bf16_f32 v74, v68, v69
v_cvt_pk_bf16_f32 v75, v70, v71
v_cvt_pk_bf16_f32 v12, v76, v77
s_nop 0
v_mfma_f32_16x16x32_bf16 v[88:91], v[72:75], v[6:9], 0
v_mfma_f32_16x16x32_bf16 v[92:95], v[72:75], v[32:35], 0
v_mfma_f32_16x16x32_bf16 v[96:99], v[72:75], v[36:39], 0
v_mfma_f32_16x16x32_bf16 v[88:91], v[12:15], v[6:9], v[88:91]
v_mfma_f32_16x16x32_bf16 v[92:95], v[12:15], v[16:19], v[92:95]
v_mfma_f32_16x16x32_bf16 v[96:99], v[10:13], v[16:19], v[96:99]
s_nop 7
v_rcp_f32 v90, v88
v_rcp_f32 v91, v89
v_mul_f32 v92, v92, v90
v_mul_f32 v93, v93, v91
v_mul_f32 v96, v96, v90
v_mul_f32 v97, v97, v91
v_cvt_pk_bf16_f32 v100, v92, v96
v_cvt_pk_bf16_f32 v101, v93, v97
ds_write2_b32 v29, v100, v101 offset0:0 offset1:80
v_mov_b64 v[2:3], -1
ds_read_b128 v[112:115], v20 offset:47104
ds_read_b128 v[116:119], v20 offset:48128
s_branch L_rec_s3_join
L_rec_s3_a_fail:
s_cmp_gt_u32 s3, 60
s_cbranch_scc1 L_rec_s3_a_f2
s_sleep 6
L_rec_s3_a_f2:
global_load_dwordx4 v[32:35], v24, s[4:5] sc1
global_load_dwordx4 v[36:39], v24, s[4:5] offset:1024 sc1
s_mov_b32 s19, 0
s_sub_u32 s3, s3, 1
s_cbranch_scc1 L_rec_s3_a_chk
s_waitcnt vmcnt(3)
s_branch L_rec_s3_a
L_rec_s3_a_chk:
s_mov_b32 s3, 60
s_waitcnt vmcnt(0)
s_sub_u32 s41, s41, 64
s_cbranch_scc1 L_rec_s3_a_dead
v_max3_u32 v2, v32, v33, v34
v_max3_u32 v3, v35, v36, v37
v_max3_u32 v2, v2, v38, v39
v_max_u32 v2, v2, v3
v_cmp_eq_u32 vcc, -1, v2
s_cbranch_vccnz L_rec_s3_a_fail
s_branch L_rec_s3_a_now
L_rec_s3_a_dead:
s_mov_b32 s41, 0
L_rec_s3_a_now:
v_mfma_f32_16x16x32_bf16 v[76:79], v[72:75], v[32:35], 0
v_mfma_f32_16x16x32_bf16 v[76:79], v[72:75], v[36:39], v[76:79]
s_nop 7
v_add_f32_dpp v76, v76, v76 row_ror:4 row_mask:0xf bank_mask:0xf
v_add_f32_dpp v77, v77, v77 row_ror:4 row_mask:0xf bank_mask:0xf
v_cmp_u_f32 vcc, v78, v79
v_add_f32_dpp v76, v76, v76 row_ror:8 row_mask:0xf bank_mask:0xf
v_add_f32_dpp v77, v77, v77 row_ror:8 row_mask:0xf bank_mask:0xf
v_cvt_pk_bf16_f32 v18, v76, v77
v_cmp_u_f32 vcc, v76, v77
v_and_b32 v2, 0x7fff7fff, v18
s_nop 0
v_cndmask_b32 v18, v18, v2, vcc
s_mov_b64 exec, s[44:45]
global_store_dword v25, v18, s[4:5] sc1
s_mov_b64 exec, -1
s_branch L_rec_s3_a_ok
L_rec_done:
L_exit:
s_endpgm
L_bulk:
s_load_dwordx2 s[4:5], s[0:1], 112
s_load_dwordx2 s[28:29], s[0:1], 104
s_sub_u32 s30, s3, 1
s_lshl_b32 s31, s30, 5
s_lshr_b32 s32, s2, 3
s_add_u32 s33, s31, s32
s_mul_i32 s12, s33, 9363
s_lshr_b32 s12, s12, 16
s_mul_i32 s13, s12, 7
s_sub_u32 s13, s33, s13
v_lshrrev_b32 v1, 6, v0
s_nop 0
v_readfirstlane_b32 s14, v1
s_lshl_b32 s15, s14, 13
s_waitcnt lgkmcnt(0)
s_load_dwordx2 s[6:7], s[0:1], 40
s_mul_i32 s3, s12, 3
s_add_u32 s3, s3, s13
s_waitcnt lgkmcnt(0)
s_cmp_ge_u32 s13, 3
s_cbranch_scc1 L_nowopf
s_cmp_ge_u32 s3, 64
s_cbranch_scc1 L_nowopf
s_lshl_b32 s3, s3, 16
v_lshlrev_b32 v2, 7, v0
v_add_u32 v2, s3, v2
global_load_dword v3, v2, s[6:7]
v_add_u32 v2, 0x8000, v2
global_load_dword v4, v2, s[6:7]
L_nowopf:
s_cmp_lt_u32 s13, 3
s_cbranch_scc1 L_noprep
s_lshl_b32 s34, s12, 2
s_add_u32 s34, s34, s13
s_sub_u32 s34, s34, 3
s_load_dwordx2 s[6:7], s[0:1], 0
s_load_dwordx2 s[8:9], s[0:1], 64
v_mov_b32 v1, 0x0
v_bfe_i32 v5, v0, 4, 1
v_and_b32 v5, 0x8, v5
v_xor_b32 v1, v1, v5
v_bfe_i32 v5, v0, 5, 1
v_and_b32 v5, 0x10, v5
v_xor_b32 v1, v1, v5
v_bfe_i32 v5, v0, 6, 1
v_and_b32 v5, 0x100, v5
v_xor_b32 v1, v1, v5
v_bfe_i32 v5, v0, 7, 1
v_and_b32 v5, 0x200, v5
v_xor_b32 v1, v1, v5
v_mov_b32 v2, 0x0
v_bfe_i32 v5, v0, 0, 1
v_and_b32 v5, 0x400, v5
v_xor_b32 v2, v2, v5
v_bfe_i32 v5, v0, 1, 1
v_and_b32 v5, 0x800, v5
v_xor_b32 v2, v2, v5
v_bfe_i32 v5, v0, 2, 1
v_and_b32 v5, 0x1000, v5
v_xor_b32 v2, v2, v5
v_bfe_i32 v5, v0, 3, 1
v_and_b32 v5, 0x2000, v5
v_xor_b32 v2, v2, v5
v_bfe_i32 v5, v0, 4, 1
v_and_b32 v5, 0x8, v5
v_xor_b32 v2, v2, v5
v_bfe_i32 v5, v0, 5, 1
v_and_b32 v5, 0x10, v5
v_xor_b32 v2, v2, v5
v_bfe_i32 v5, v0, 6, 1
v_and_b32 v5, 0x100, v5
v_xor_b32 v2, v2, v5
v_bfe_i32 v5, v0, 7, 1
v_and_b32 v5, 0x200, v5
v_xor_b32 v2, v2, v5
s_lshl_b32 s3, s34, 14
v_add_u32 v2, s3, v2
s_waitcnt lgkmcnt(0)
global_load_dwordx2 v[16:17], v2, s[6:7] offset:0
global_load_dwordx2 v[18:19], v2, s[6:7] offset:32
global_load_dwordx2 v[20:21], v2, s[6:7] offset:64
global_load_dwordx2 v[22:23], v2, s[6:7] offset:96
global_load_dwordx2 v[24:25], v2, s[6:7] offset:128
global_load_dwordx2 v[26:27], v2, s[6:7] offset:160
global_load_dwordx2 v[28:29], v2, s[6:7] offset:192
global_load_dwordx2 v[30:31], v2, s[6:7] offset:224
global_load_dwordx2 v[32:33], v1, s[8:9] offset:0
global_load_dwordx2 v[34:35], v1, s[8:9] offset:32
global_load_dwordx2 v[36:37], v1, s[8:9] offset:64
global_load_dwordx2 v[38:39], v1, s[8:9] offset:96
global_load_dwordx2 v[40:41], v1, s[8:9] offset:128
global_load_dwordx2 v[42:43], v1, s[8:9] offset:160
global_load_dwordx2 v[44:45], v1, s[8:9] offset:192
global_load_dwordx2 v[46:47], v1, s[8:9] offset:224
s_lshr_b32 s11, s34, 1
v_mov_b32 v7, 0
v_and_b32 v3, 31, v0
v_lshlrev_b32 v3, 8, v3
s_lshl_b32 s10, s11, 2
s_add_u32 s10, s10, 0x3a0000
v_add_u32 v3, s10, v3
v_and_b32 v4, 63, v0
v_lshlrev_b32 v6, 7, v4
v_lshlrev_b32 v4, 2, v4
s_lshl_b32 s10, s34, 13
s_add_u32 s10, s10, 0x500000
v_add_u32 v6, s10, v6
v_add_u32 v4, 0x3aa000, v4
s_cmp_lg_u32 s14, 0
s_cbranch_scc1 L_prep_nz
global_store_dword v3, v7, s[4:5] sc1
global_store_dword v6, v7, s[4:5] sc1
s_cmp_lg_u32 s34, 0
s_cbranch_scc1 L_prep_nz
global_store_dword v4, v7, s[4:5] sc1
global_store_dword v4, v7, s[4:5] offset:256 sc1
L_prep_nz:
v_mov_b32 v3, 0x27c00
v_bfe_i32 v5, v0, 0, 1
v_and_b32 v5, 0x10, v5
v_xor_b32 v3, v3, v5
v_bfe_i32 v5, v0, 1, 1
v_and_b32 v5, 0x20, v5
v_xor_b32 v3, v3, v5
v_bfe_i32 v5, v0, 2, 1
v_and_b32 v5, 0x40, v5
v_xor_b32 v3, v3, v5
v_bfe_i32 v5, v0, 3, 1
v_and_b32 v5, 0x80, v5
v_xor_b32 v3, v3, v5
v_bfe_i32 v5, v0, 6, 1
v_and_b32 v5, 0x4, v5
v_xor_b32 v3, v3, v5
v_bfe_i32 v5, v0, 7, 1
v_and_b32 v5, 0x8, v5
v_xor_b32 v3, v3, v5
v_mov_b32 v4, 0x27c00
v_bfe_i32 v5, v0, 0, 1
v_and_b32 v5, 0x10, v5
v_xor_b32 v4, v4, v5
v_bfe_i32 v5, v0, 1, 1
v_and_b32 v5, 0x20, v5
v_xor_b32 v4, v4, v5
v_bfe_i32 v5, v0, 2, 1
v_and_b32 v5, 0x40, v5
v_xor_b32 v4, v4, v5
v_bfe_i32 v5, v0, 3, 1
v_and_b32 v5, 0x80, v5
v_xor_b32 v4, v4, v5
v_mov_b32 v6, 0x0
v_bfe_i32 v5, v0, 0, 1
v_and_b32 v5, 0x10, v5
v_xor_b32 v6, v6, v5
v_bfe_i32 v5, v0, 1, 1
v_and_b32 v5, 0x20, v5
v_xor_b32 v6, v6, v5
v_bfe_i32 v5, v0, 2, 1
v_and_b32 v5, 0x40, v5
v_xor_b32 v6, v6, v5
v_bfe_i32 v5, v0, 3, 1
v_and_b32 v5, 0x80, v5
v_xor_b32 v6, v6, v5
v_bfe_i32 v5, v0, 4, 1
v_and_b32 v5, 0x100, v5
v_xor_b32 v6, v6, v5
v_bfe_i32 v5, v0, 5, 1
v_and_b32 v5, 0x200, v5
v_xor_b32 v6, v6, v5
v_bfe_i32 v5, v0, 6, 1
v_and_b32 v5, 0x1000, v5
v_xor_b32 v6, v6, v5
v_bfe_i32 v5, v0, 7, 1
v_and_b32 v5, 0x2000, v5
v_xor_b32 v6, v6, v5
v_add_u32 v6, s3, v6
s_mov_b32 s10, 0xffff0000
s_waitcnt vmcnt(0)
v_lshlrev_b32 v48, 16, v16
v_and_b32 v49, s10, v16
v_lshlrev_b32 v50, 16, v17
v_and_b32 v51, s10, v17
v_lshlrev_b32 v52, 16, v18
v_and_b32 v53, s10, v18
v_lshlrev_b32 v54, 16, v19
v_and_b32 v55, s10, v19
v_lshlrev_b32 v56, 16, v20
v_and_b32 v57, s10, v20
v_lshlrev_b32 v58, 16, v21
v_and_b32 v59, s10, v21
v_lshlrev_b32 v60, 16, v22
v_and_b32 v61, s10, v22
v_lshlrev_b32 v62, 16, v23
v_and_b32 v63, s10, v23
v_lshlrev_b32 v64, 16, v24
v_and_b32 v65, s10, v24
v_lshlrev_b32 v66, 16, v25
v_and_b32 v67, s10, v25
v_lshlrev_b32 v68, 16, v26
v_and_b32 v69, s10, v26
v_lshlrev_b32 v70, 16, v27
v_and_b32 v71, s10, v27
v_lshlrev_b32 v72, 16, v28
v_and_b32 v73, s10, v28
v_lshlrev_b32 v74, 16, v29
v_and_b32 v75, s10, v29
v_lshlrev_b32 v76, 16, v30
v_and_b32 v77, s10, v30
v_lshlrev_b32 v78, 16, v31
v_and_b32 v79, s10, v31
v_add_f32 v12, v48, v49
v_add_f32 v13, v50, v51
v_add_f32 v12, v12, v52
v_add_f32 v13, v13, v53
v_add_f32 v12, v12, v54
v_add_f32 v13, v13, v55
v_add_f32 v12, v12, v56
v_add_f32 v13, v13, v57
v_add_f32 v12, v12, v58
v_add_f32 v13, v13, v59
v_add_f32 v12, v12, v60
v_add_f32 v13, v13, v61
v_add_f32 v12, v12, v62
v_add_f32 v13, v13, v63
v_add_f32 v12, v12, v64
v_add_f32 v13, v13, v65
v_add_f32 v12, v12, v66
v_add_f32 v13, v13, v67
v_add_f32 v12, v12, v68
v_add_f32 v13, v13, v69
v_add_f32 v12, v12, v70
v_add_f32 v13, v13, v71
v_add_f32 v12, v12, v72
v_add_f32 v13, v13, v73
v_add_f32 v12, v12, v74
v_add_f32 v13, v13, v75
v_add_f32 v12, v12, v76
v_add_f32 v13, v13, v77
v_add_f32 v12, v12, v78
v_add_f32 v13, v13, v79
v_add_f32 v12, v12, v13
v_mov_b32 v5, v12
s_nop 1
v_permlane32_swap_b32 v12, v5
v_add_f32 v12, v12, v5
v_mov_b32 v5, v12
s_nop 1
v_permlane16_swap_b32 v12, v5
v_add_f32 v12, v12, v5
ds_write_b32 v3, v12 offset:0
s_waitcnt lgkmcnt(0)
s_barrier
ds_read_b128 v[8:11], v4 offset:0
s_waitcnt lgkmcnt(0)
v_add_f32 v8, v8, v9
v_add_f32 v10, v10, v11
v_add_f32 v12, v8, v10
v_mul_f32 v12, 0x3b000000, v12
v_mov_b32 v13, 0
v_mov_b32 v14, 0
v_sub_f32 v8, v48, v12
v_sub_f32 v9, v49, v12
v_fmac_f32 v13, v8, v8
v_fmac_f32 v14, v9, v9
v_sub_f32 v8, v50, v12
v_sub_f32 v9, v51, v12
v_fmac_f32 v13, v8, v8
v_fmac_f32 v14, v9, v9
v_sub_f32 v8, v52, v12
v_sub_f32 v9, v53, v12
v_fmac_f32 v13, v8, v8
v_fmac_f32 v14, v9, v9
v_sub_f32 v8, v54, v12
v_sub_f32 v9, v55, v12
v_fmac_f32 v13, v8, v8
v_fmac_f32 v14, v9, v9
v_sub_f32 v8, v56, v12
v_sub_f32 v9, v57, v12
v_fmac_f32 v13, v8, v8
v_fmac_f32 v14, v9, v9
v_sub_f32 v8, v58, v12
v_sub_f32 v9, v59, v12
v_fmac_f32 v13, v8, v8
v_fmac_f32 v14, v9, v9
v_sub_f32 v8, v60, v12
v_sub_f32 v9, v61, v12
v_fmac_f32 v13, v8, v8
v_fmac_f32 v14, v9, v9
v_sub_f32 v8, v62, v12
v_sub_f32 v9, v63, v12
v_fmac_f32 v13, v8, v8
v_fmac_f32 v14, v9, v9
v_sub_f32 v8, v64, v12
v_sub_f32 v9, v65, v12
v_fmac_f32 v13, v8, v8
v_fmac_f32 v14, v9, v9
v_sub_f32 v8, v66, v12
v_sub_f32 v9, v67, v12
v_fmac_f32 v13, v8, v8
v_fmac_f32 v14, v9, v9
v_sub_f32 v8, v68, v12
v_sub_f32 v9, v69, v12
v_fmac_f32 v13, v8, v8
v_fmac_f32 v14, v9, v9
v_sub_f32 v8, v70, v12
v_sub_f32 v9, v71, v12
v_fmac_f32 v13, v8, v8
v_fmac_f32 v14, v9, v9
v_sub_f32 v8, v72, v12
v_sub_f32 v9, v73, v12
v_fmac_f32 v13, v8, v8
v_fmac_f32 v14, v9, v9
v_sub_f32 v8, v74, v12
v_sub_f32 v9, v75, v12
v_fmac_f32 v13, v8, v8
v_fmac_f32 v14, v9, v9
v_sub_f32 v8, v76, v12
v_sub_f32 v9, v77, v12
v_fmac_f32 v13, v8, v8
v_fmac_f32 v14, v9, v9
v_sub_f32 v8, v78, v12
v_sub_f32 v9, v79, v12
v_fmac_f32 v13, v8, v8
v_fmac_f32 v14, v9, v9
v_add_f32 v13, v13, v14
v_mov_b32 v5, v13
s_nop 1
v_permlane32_swap_b32 v13, v5
v_add_f32 v13, v13, v5
v_mov_b32 v5, v13
s_nop 1
v_permlane16_swap_b32 v13, v5
v_add_f32 v13, v13, v5
ds_write_b32 v3, v13 offset:256
s_waitcnt lgkmcnt(0)
s_barrier
ds_read_b128 v[8:11], v4 offset:256
s_waitcnt lgkmcnt(0)
v_add_f32 v8, v8, v9
v_add_f32 v10, v10, v11
v_add_f32 v13, v8, v10
v_mul_f32 v13, 0x3b000000, v13
v_cvt_pk_bf16_f32 v14, v12, v13
v_lshlrev_b32 v12, 16, v14
v_and_b32 v13, s10, v14
v_add_f32 v13, 0x3727c5ac, v13
v_cvt_pk_bf16_f32 v13, v13, v13
v_and_b32 v13, s10, v13
v_sqrt_f32 v13, v13
s_nop 0
v_cvt_pk_bf16_f32 v13, v13, v13
v_and_b32 v13, s10, v13
v_rcp_f32 v13, v13
s_mov_b32 s11, 0x05040100
s_mov_b32 s3, 0x07060302
v_perm_b32 v80, v34, v32, s11
v_perm_b32 v81, v34, v32, s3
v_perm_b32 v82, v35, v33, s11
v_perm_b32 v83, v35, v33, s3
v_perm_b32 v84, v38, v36, s11
v_perm_b32 v85, v38, v36, s3
v_perm_b32 v86, v39, v37, s11
v_perm_b32 v87, v39, v37, s3
v_perm_b32 v88, v42, v40, s11
v_perm_b32 v89, v42, v40, s3
v_perm_b32 v90, v43, v41, s11
v_perm_b32 v91, v43, v41, s3
v_perm_b32 v92, v46, v44, s11
v_perm_b32 v93, v46, v44, s3
v_perm_b32 v94, v47, v45, s11
v_perm_b32 v95, v47, v45, s3
v_mov_b32 v14, 0
v_sub_f32 v8, v48, v12
v_sub_f32 v9, v52, v12
v_cvt_pk_bf16_f32 v10, v8, v9
v_lshlrev_b32 v8, 16, v10
v_and_b32 v9, s10, v10
v_mul_f32 v8, v8, v13
v_mul_f32 v9, v9, v13
v_cvt_pk_bf16_f32 v16, v8, v9
v_dot2_f32_bf16 v14, v16, v80, v14
v_sub_f32 v8, v49, v12
v_sub_f32 v9, v53, v12
v_cvt_pk_bf16_f32 v10, v8, v9
v_lshlrev_b32 v8, 16, v10
v_and_b32 v9, s10, v10
v_mul_f32 v8, v8, v13
v_mul_f32 v9, v9, v13
v_cvt_pk_bf16_f32 v17, v8, v9
v_dot2_f32_bf16 v14, v17, v81, v14
v_sub_f32 v8, v50, v12
v_sub_f32 v9, v54, v12
v_cvt_pk_bf16_f32 v10, v8, v9
v_lshlrev_b32 v8, 16, v10
v_and_b32 v9, s10, v10
v_mul_f32 v8, v8, v13
v_mul_f32 v9, v9, v13
v_cvt_pk_bf16_f32 v18, v8, v9
v_dot2_f32_bf16 v14, v18, v82, v14
v_sub_f32 v8, v51, v12
v_sub_f32 v9, v55, v12
v_cvt_pk_bf16_f32 v10, v8, v9
v_lshlrev_b32 v8, 16, v10
v_and_b32 v9, s10, v10
v_mul_f32 v8, v8, v13
v_mul_f32 v9, v9, v13
v_cvt_pk_bf16_f32 v19, v8, v9
v_dot2_f32_bf16 v14, v19, v83, v14
global_store_dwordx4 v6, v[16:19], s[4:5] offset:0 sc1
v_sub_f32 v8, v56, v12
v_sub_f32 v9, v60, v12
v_cvt_pk_bf16_f32 v10, v8, v9
v_lshlrev_b32 v8, 16, v10
v_and_b32 v9, s10, v10
v_mul_f32 v8, v8, v13
v_mul_f32 v9, v9, v13
v_cvt_pk_bf16_f32 v20, v8, v9
v_dot2_f32_bf16 v14, v20, v84, v14
v_sub_f32 v8, v57, v12
v_sub_f32 v9, v61, v12
v_cvt_pk_bf16_f32 v10, v8, v9
v_lshlrev_b32 v8, 16, v10
v_and_b32 v9, s10, v10
v_mul_f32 v8, v8, v13
v_mul_f32 v9, v9, v13
v_cvt_pk_bf16_f32 v21, v8, v9
v_dot2_f32_bf16 v14, v21, v85, v14
v_sub_f32 v8, v58, v12
v_sub_f32 v9, v62, v12
v_cvt_pk_bf16_f32 v10, v8, v9
v_lshlrev_b32 v8, 16, v10
v_and_b32 v9, s10, v10
v_mul_f32 v8, v8, v13
v_mul_f32 v9, v9, v13
v_cvt_pk_bf16_f32 v22, v8, v9
v_dot2_f32_bf16 v14, v22, v86, v14
v_sub_f32 v8, v59, v12
v_sub_f32 v9, v63, v12
v_cvt_pk_bf16_f32 v10, v8, v9
v_lshlrev_b32 v8, 16, v10
v_and_b32 v9, s10, v10
v_mul_f32 v8, v8, v13
v_mul_f32 v9, v9, v13
v_cvt_pk_bf16_f32 v23, v8, v9
v_dot2_f32_bf16 v14, v23, v87, v14
global_store_dwordx4 v6, v[20:23], s[4:5] offset:1024 sc1
v_sub_f32 v8, v64, v12
v_sub_f32 v9, v68, v12
v_cvt_pk_bf16_f32 v10, v8, v9
v_lshlrev_b32 v8, 16, v10
v_and_b32 v9, s10, v10
v_mul_f32 v8, v8, v13
v_mul_f32 v9, v9, v13
v_cvt_pk_bf16_f32 v24, v8, v9
v_dot2_f32_bf16 v14, v24, v88, v14
v_sub_f32 v8, v65, v12
v_sub_f32 v9, v69, v12
v_cvt_pk_bf16_f32 v10, v8, v9
v_lshlrev_b32 v8, 16, v10
v_and_b32 v9, s10, v10
v_mul_f32 v8, v8, v13
v_mul_f32 v9, v9, v13
v_cvt_pk_bf16_f32 v25, v8, v9
v_dot2_f32_bf16 v14, v25, v89, v14
v_sub_f32 v8, v66, v12
v_sub_f32 v9, v70, v12
v_cvt_pk_bf16_f32 v10, v8, v9
v_lshlrev_b32 v8, 16, v10
v_and_b32 v9, s10, v10
v_mul_f32 v8, v8, v13
v_mul_f32 v9, v9, v13
v_cvt_pk_bf16_f32 v26, v8, v9
v_dot2_f32_bf16 v14, v26, v90, v14
v_sub_f32 v8, v67, v12
v_sub_f32 v9, v71, v12
v_cvt_pk_bf16_f32 v10, v8, v9
v_lshlrev_b32 v8, 16, v10
v_and_b32 v9, s10, v10
v_mul_f32 v8, v8, v13
v_mul_f32 v9, v9, v13
v_cvt_pk_bf16_f32 v27, v8, v9
v_dot2_f32_bf16 v14, v27, v91, v14
global_store_dwordx4 v6, v[24:27], s[4:5] offset:2048 sc1
v_sub_f32 v8, v72, v12
v_sub_f32 v9, v76, v12
v_cvt_pk_bf16_f32 v10, v8, v9
v_lshlrev_b32 v8, 16, v10
v_and_b32 v9, s10, v10
v_mul_f32 v8, v8, v13
v_mul_f32 v9, v9, v13
v_cvt_pk_bf16_f32 v28, v8, v9
v_dot2_f32_bf16 v14, v28, v92, v14
v_sub_f32 v8, v73, v12
v_sub_f32 v9, v77, v12
v_cvt_pk_bf16_f32 v10, v8, v9
v_lshlrev_b32 v8, 16, v10
v_and_b32 v9, s10, v10
v_mul_f32 v8, v8, v13
v_mul_f32 v9, v9, v13
v_cvt_pk_bf16_f32 v29, v8, v9
v_dot2_f32_bf16 v14, v29, v93, v14
v_sub_f32 v8, v74, v12
v_sub_f32 v9, v78, v12
v_cvt_pk_bf16_f32 v10, v8, v9
v_lshlrev_b32 v8, 16, v10
v_and_b32 v9, s10, v10
v_mul_f32 v8, v8, v13
v_mul_f32 v9, v9, v13
v_cvt_pk_bf16_f32 v30, v8, v9
v_dot2_f32_bf16 v14, v30, v94, v14
v_sub_f32 v8, v75, v12
v_sub_f32 v9, v79, v12
v_cvt_pk_bf16_f32 v10, v8, v9
v_lshlrev_b32 v8, 16, v10
v_and_b32 v9, s10, v10
v_mul_f32 v8, v8, v13
v_mul_f32 v9, v9, v13
v_cvt_pk_bf16_f32 v31, v8, v9
v_dot2_f32_bf16 v14, v31, v95, v14
global_store_dwordx4 v6, v[28:31], s[4:5] offset:3072 sc1
s_nop 1
v_mov_b32 v5, v14
s_nop 1
v_permlane32_swap_b32 v14, v5
v_add_f32 v14, v14, v5
v_mov_b32 v5, v14
s_nop 1
v_permlane16_swap_b32 v14, v5
v_add_f32 v14, v14, v5
ds_write_b32 v3, v14 offset:512
s_waitcnt lgkmcnt(0)
s_barrier
ds_read_b128 v[8:11], v4 offset:512
s_waitcnt lgkmcnt(0)
v_add_f32 v8, v8, v9
v_add_f32 v10, v10, v11
v_add_f32 v14, v8, v10
v_cvt_pk_bf16_f32 v14, v14, v14
v_and_b32 v14, s10, v14
v_ashrrev_i32 v8, 31, v14
v_or_b32 v8, 0x80000000, v8
v_xor_b32 v14, v14, v8
v_and_b32 v14, s10, v14
s_lshl_b32 s3, s34, 4
v_and_b32 v8, 15, v0
v_add_u32 v8, s3, v8
v_sub_u32 v9, 0xffff, v8
v_or_b32 v14, v14, v9
v_lshlrev_b32 v8, 2, v8
v_add_u32 v8, 0x200000, v8
s_cmp_lg_u32 s14, 0
s_cbranch_scc1 L_prep_nk
global_store_dword v8, v14, s[4:5] sc1
L_prep_nk:
s_waitcnt vmcnt(0)
s_barrier
s_cmp_lg_u32 s14, 0
s_cbranch_scc1 L_prep_nf
s_mov_b64 exec, 1
v_mov_b32 v8, s34
v_mov_b32 v9, 1
global_store_byte v8, v9, s[28:29] offset:128 sc1
s_mov_b64 exec, -1
L_prep_nf:
L_noprep:
s_load_dwordx2 s[6:7], s[0:1], 16
s_load_dwordx2 s[8:9], s[0:1], 24
s_load_dwordx2 s[10:11], s[0:1], 32
v_mov_b32 v8, 0x0
v_bfe_i32 v5, v0, 0, 1
v_and_b32 v5, 0x10, v5
v_xor_b32 v8, v8, v5
v_bfe_i32 v5, v0, 1, 1
v_and_b32 v5, 0x20, v5
v_xor_b32 v8, v8, v5
v_bfe_i32 v5, v0, 2, 1
v_and_b32 v5, 0x40, v5
v_xor_b32 v8, v8, v5
v_bfe_i32 v5, v0, 3, 1
v_and_b32 v5, 0x80, v5
v_xor_b32 v8, v8, v5
v_bfe_i32 v5, v0, 4, 1
v_and_b32 v5, 0x2020, v5
v_xor_b32 v8, v8, v5
v_bfe_i32 v5, v0, 5, 1
v_and_b32 v5, 0x4000, v5
v_xor_b32 v8, v8, v5
v_bfe_i32 v5, v0, 6, 1
v_and_b32 v5, 0x40000, v5
v_xor_b32 v8, v8, v5
v_bfe_i32 v5, v0, 7, 1
v_and_b32 v5, 0x80000, v5
v_xor_b32 v8, v8, v5
v_mov_b32 v9, 0x0
v_bfe_i32 v5, v0, 0, 1
v_and_b32 v5, 0x8, v5
v_xor_b32 v9, v9, v5
v_bfe_i32 v5, v0, 1, 1
v_and_b32 v5, 0x10, v5
v_xor_b32 v9, v9, v5
v_bfe_i32 v5, v0, 2, 1
v_and_b32 v5, 0x1080, v5
v_xor_b32 v9, v9, v5
v_bfe_i32 v5, v0, 3, 1
v_and_b32 v5, 0x120, v5
v_xor_b32 v9, v9, v5
v_bfe_i32 v5, v0, 4, 1
v_and_b32 v5, 0x440, v5
v_xor_b32 v9, v9, v5
v_bfe_i32 v5, v0, 5, 1
v_and_b32 v5, 0x800, v5
v_xor_b32 v9, v9, v5
v_bfe_i32 v5, v0, 6, 1
v_and_b32 v5, 0x40, v5
v_xor_b32 v9, v9, v5
v_bfe_i32 v5, v0, 7, 1
v_and_b32 v5, 0x80, v5
v_xor_b32 v9, v9, v5
s_waitcnt lgkmcnt(0)
s_lshl_b32 s16, s12, 8
s_add_u32 s6, s6, s16
s_addc_u32 s7, s7, 0
s_add_u32 s8, s8, s16
s_addc_u32 s9, s9, 0
s_add_u32 s10, s10, s16
s_addc_u32 s11, s11, 0
s_mov_b32 s17, 0
s_cmp_eq_u32 s13, 0
s_cbranch_scc1 L_qw9
s_cmp_eq_u32 s13, 1
s_cbranch_scc1 L_qw10
s_cmp_eq_u32 s13, 2
s_cbranch_scc1 L_qw0
s_cmp_eq_u32 s13, 3
s_cbranch_scc1 L_qw2
s_cmp_eq_u32 s13, 4
s_cbranch_scc1 L_qw3
s_cmp_eq_u32 s13, 5
s_cbranch_scc1 L_qw5
s_cmp_eq_u32 s13, 6
s_cbranch_scc1 L_qw7
L_qw0:
s_cmp_lt_u32 s17, 3
s_cbranch_scc1 L_qw0_i
s_cmp_lt_u32 s17, 13
s_cbranch_scc1 L_qw0_w
s_waitcnt vmcnt(0)
L_qw0_w:
s_waitcnt vmcnt(16)
s_barrier
s_cmp_ge_u32 s17, 12
s_cbranch_scc1 L_qw0_r
L_qw0_i:
s_add_u32 m0, s15, 0x18000
v_xor_b32 v10, 0x0, v8
v_add_u32 v10, 0x300000, v10
global_load_lds_dwordx4 v10, s[6:7]
s_add_u32 m0, s15, 0x18400
v_xor_b32 v10, 0x40, v8
v_add_u32 v10, 0x308000, v10
global_load_lds_dwordx4 v10, s[6:7]
s_add_u32 m0, s15, 0x18800
v_xor_b32 v10, 0x0, v8
v_add_u32 v10, 0x310000, v10
global_load_lds_dwordx4 v10, s[6:7]
s_add_u32 m0, s15, 0x18c00
v_xor_b32 v10, 0x40, v8
v_add_u32 v10, 0x318000, v10
global_load_lds_dwordx4 v10, s[6:7]
s_add_u32 m0, s15, 0x19000
v_xor_b32 v10, 0x80, v8
v_add_u32 v10, 0x320000, v10
global_load_lds_dwordx4 v10, s[6:7]
s_add_u32 m0, s15, 0x19400
v_xor_b32 v10, 0xc0, v8
v_add_u32 v10, 0x328000, v10
global_load_lds_dwordx4 v10, s[6:7]
s_add_u32 m0, s15, 0x19800
v_xor_b32 v10, 0x80, v8
v_add_u32 v10, 0x330000, v10
global_load_lds_dwordx4 v10, s[6:7]
s_add_u32 m0, s15, 0x19c00
v_xor_b32 v10, 0xc0, v8
v_add_u32 v10, 0x338000, v10
global_load_lds_dwordx4 v10, s[6:7]
s_cmp_lt_u32 s17, 3
s_cbranch_scc1 L_qw0_e
L_qw0_r:
v_add_u32 v11, 0x0, v9
v_xor_b32 v12, 32, v11
ds_read_b64_tr_b16 a[0:1], v11 offset:0
ds_read_b64_tr_b16 a[2:3], v11 offset:512
ds_read_b64_tr_b16 a[4:5], v11 offset:8192
ds_read_b64_tr_b16 a[6:7], v11 offset:8704
ds_read_b64_tr_b16 a[8:9], v11 offset:16384
ds_read_b64_tr_b16 a[10:11], v11 offset:16896
ds_read_b64_tr_b16 a[12:13], v11 offset:24576
ds_read_b64_tr_b16 a[14:15], v11 offset:25088
ds_read_b64_tr_b16 a[64:65], v12 offset:0
ds_read_b64_tr_b16 a[66:67], v12 offset:512
ds_read_b64_tr_b16 a[68:69], v12 offset:8192
ds_read_b64_tr_b16 a[70:71], v12 offset:8704
ds_read_b64_tr_b16 a[72:73], v12 offset:16384
ds_read_b64_tr_b16 a[74:75], v12 offset:16896
ds_read_b64_tr_b16 a[76:77], v12 offset:24576
ds_read_b64_tr_b16 a[78:79], v12 offset:25088
s_waitcnt lgkmcnt(0)
L_qw0_e:
s_add_u32 s17, s17, 1
s_cmp_eq_u32 s17, 15
s_cbranch_scc1 L_qw_done
L_qw1:
s_cmp_lt_u32 s17, 3
s_cbranch_scc1 L_qw1_i
s_cmp_lt_u32 s17, 13
s_cbranch_scc1 L_qw1_w
s_waitcnt vmcnt(0)
L_qw1_w:
s_waitcnt vmcnt(16)
s_barrier
s_cmp_ge_u32 s17, 12
s_cbranch_scc1 L_qw1_r
L_qw1_i:
s_add_u32 m0, s15, 0x0
v_xor_b32 v10, 0x0, v8
v_add_u32 v10, 0x0, v10
global_load_lds_dwordx4 v10, s[8:9]
s_add_u32 m0, s15, 0x400
v_xor_b32 v10, 0x40, v8
v_add_u32 v10, 0x8000, v10
global_load_lds_dwordx4 v10, s[8:9]
s_add_u32 m0, s15, 0x800
v_xor_b32 v10, 0x0, v8
v_add_u32 v10, 0x10000, v10
global_load_lds_dwordx4 v10, s[8:9]
s_add_u32 m0, s15, 0xc00
v_xor_b32 v10, 0x40, v8
v_add_u32 v10, 0x18000, v10
global_load_lds_dwordx4 v10, s[8:9]
s_add_u32 m0, s15, 0x1000
v_xor_b32 v10, 0x80, v8
v_add_u32 v10, 0x20000, v10
global_load_lds_dwordx4 v10, s[8:9]
s_add_u32 m0, s15, 0x1400
v_xor_b32 v10, 0xc0, v8
v_add_u32 v10, 0x28000, v10
global_load_lds_dwordx4 v10, s[8:9]
s_add_u32 m0, s15, 0x1800
v_xor_b32 v10, 0x80, v8
v_add_u32 v10, 0x30000, v10
global_load_lds_dwordx4 v10, s[8:9]
s_add_u32 m0, s15, 0x1c00
v_xor_b32 v10, 0xc0, v8
v_add_u32 v10, 0x38000, v10
global_load_lds_dwordx4 v10, s[8:9]
s_cmp_lt_u32 s17, 3
s_cbranch_scc1 L_qw1_e
L_qw1_r:
v_add_u32 v11, 0x0, v9
v_xor_b32 v12, 32, v11
ds_read_b64_tr_b16 a[16:17], v11 offset:32768
ds_read_b64_tr_b16 a[18:19], v11 offset:33280
ds_read_b64_tr_b16 a[20:21], v11 offset:40960
ds_read_b64_tr_b16 a[22:23], v11 offset:41472
ds_read_b64_tr_b16 a[24:25], v11 offset:49152
ds_read_b64_tr_b16 a[26:27], v11 offset:49664
ds_read_b64_tr_b16 a[28:29], v11 offset:57344
ds_read_b64_tr_b16 a[30:31], v11 offset:57856
ds_read_b64_tr_b16 a[80:81], v12 offset:32768
ds_read_b64_tr_b16 a[82:83], v12 offset:33280
ds_read_b64_tr_b16 a[84:85], v12 offset:40960
ds_read_b64_tr_b16 a[86:87], v12 offset:41472
ds_read_b64_tr_b16 a[88:89], v12 offset:49152
ds_read_b64_tr_b16 a[90:91], v12 offset:49664
ds_read_b64_tr_b16 a[92:93], v12 offset:57344
ds_read_b64_tr_b16 a[94:95], v12 offset:57856
s_waitcnt lgkmcnt(0)
L_qw1_e:
s_add_u32 s17, s17, 1
s_cmp_eq_u32 s17, 15
s_cbranch_scc1 L_qw_done
L_qw2:
s_cmp_lt_u32 s17, 3
s_cbranch_scc1 L_qw2_i
s_cmp_lt_u32 s17, 13
s_cbranch_scc1 L_qw2_w
s_waitcnt vmcnt(0)
L_qw2_w:
s_waitcnt vmcnt(16)
s_barrier
s_cmp_ge_u32 s17, 12
s_cbranch_scc1 L_qw2_r
L_qw2_i:
s_add_u32 m0, s15, 0x8000
v_xor_b32 v10, 0x0, v8
v_add_u32 v10, 0x100000, v10
global_load_lds_dwordx4 v10, s[8:9]
s_add_u32 m0, s15, 0x8400
v_xor_b32 v10, 0x40, v8
v_add_u32 v10, 0x108000, v10
global_load_lds_dwordx4 v10, s[8:9]
s_add_u32 m0, s15, 0x8800
v_xor_b32 v10, 0x0, v8
v_add_u32 v10, 0x110000, v10
global_load_lds_dwordx4 v10, s[8:9]
s_add_u32 m0, s15, 0x8c00
v_xor_b32 v10, 0x40, v8
v_add_u32 v10, 0x118000, v10
global_load_lds_dwordx4 v10, s[8:9]
s_add_u32 m0, s15, 0x9000
v_xor_b32 v10, 0x80, v8
v_add_u32 v10, 0x120000, v10
global_load_lds_dwordx4 v10, s[8:9]
s_add_u32 m0, s15, 0x9400
v_xor_b32 v10, 0xc0, v8
v_add_u32 v10, 0x128000, v10
global_load_lds_dwordx4 v10, s[8:9]
s_add_u32 m0, s15, 0x9800
v_xor_b32 v10, 0x80, v8
v_add_u32 v10, 0x130000, v10
global_load_lds_dwordx4 v10, s[8:9]
s_add_u32 m0, s15, 0x9c00
v_xor_b32 v10, 0xc0, v8
v_add_u32 v10, 0x138000, v10
global_load_lds_dwordx4 v10, s[8:9]
s_cmp_lt_u32 s17, 3
s_cbranch_scc1 L_qw2_e
L_qw2_r:
v_add_u32 v11, 0x10000, v9
v_xor_b32 v12, 32, v11
ds_read_b64_tr_b16 a[32:33], v11 offset:0
ds_read_b64_tr_b16 a[34:35], v11 offset:512
ds_read_b64_tr_b16 a[36:37], v11 offset:8192
ds_read_b64_tr_b16 a[38:39], v11 offset:8704
ds_read_b64_tr_b16 a[40:41], v11 offset:16384
ds_read_b64_tr_b16 a[42:43], v11 offset:16896
ds_read_b64_tr_b16 a[44:45], v11 offset:24576
ds_read_b64_tr_b16 a[46:47], v11 offset:25088
ds_read_b64_tr_b16 a[96:97], v12 offset:0
ds_read_b64_tr_b16 a[98:99], v12 offset:512
ds_read_b64_tr_b16 a[100:101], v12 offset:8192
ds_read_b64_tr_b16 a[102:103], v12 offset:8704
ds_read_b64_tr_b16 a[104:105], v12 offset:16384
ds_read_b64_tr_b16 a[106:107], v12 offset:16896
ds_read_b64_tr_b16 a[108:109], v12 offset:24576
ds_read_b64_tr_b16 a[110:111], v12 offset:25088
s_waitcnt lgkmcnt(0)
L_qw2_e:
s_add_u32 s17, s17, 1
s_cmp_eq_u32 s17, 15
s_cbranch_scc1 L_qw_done
L_qw3:
s_cmp_lt_u32 s17, 3
s_cbranch_scc1 L_qw3_i
s_cmp_lt_u32 s17, 13
s_cbranch_scc1 L_qw3_w
s_waitcnt vmcnt(0)
L_qw3_w:
s_waitcnt vmcnt(16)
s_barrier
s_cmp_ge_u32 s17, 12
s_cbranch_scc1 L_qw3_r
L_qw3_i:
s_add_u32 m0, s15, 0x10000
v_xor_b32 v10, 0x0, v8
v_add_u32 v10, 0x200000, v10
global_load_lds_dwordx4 v10, s[8:9]
s_add_u32 m0, s15, 0x10400
v_xor_b32 v10, 0x40, v8
v_add_u32 v10, 0x208000, v10
global_load_lds_dwordx4 v10, s[8:9]
s_add_u32 m0, s15, 0x10800
v_xor_b32 v10, 0x0, v8
v_add_u32 v10, 0x210000, v10
global_load_lds_dwordx4 v10, s[8:9]
s_add_u32 m0, s15, 0x10c00
v_xor_b32 v10, 0x40, v8
v_add_u32 v10, 0x218000, v10
global_load_lds_dwordx4 v10, s[8:9]
s_add_u32 m0, s15, 0x11000
v_xor_b32 v10, 0x80, v8
v_add_u32 v10, 0x220000, v10
global_load_lds_dwordx4 v10, s[8:9]
s_add_u32 m0, s15, 0x11400
v_xor_b32 v10, 0xc0, v8
v_add_u32 v10, 0x228000, v10
global_load_lds_dwordx4 v10, s[8:9]
s_add_u32 m0, s15, 0x11800
v_xor_b32 v10, 0x80, v8
v_add_u32 v10, 0x230000, v10
global_load_lds_dwordx4 v10, s[8:9]
s_add_u32 m0, s15, 0x11c00
v_xor_b32 v10, 0xc0, v8
v_add_u32 v10, 0x238000, v10
global_load_lds_dwordx4 v10, s[8:9]
s_cmp_lt_u32 s17, 3
s_cbranch_scc1 L_qw3_e
L_qw3_r:
v_add_u32 v11, 0x10000, v9
v_xor_b32 v12, 32, v11
ds_read_b64_tr_b16 a[48:49], v11 offset:32768
ds_read_b64_tr_b16 a[50:51], v11 offset:33280
ds_read_b64_tr_b16 a[52:53], v11 offset:40960
ds_read_b64_tr_b16 a[54:55], v11 offset:41472
ds_read_b64_tr_b16 a[56:57], v11 offset:49152
ds_read_b64_tr_b16 a[58:59], v11 offset:49664
ds_read_b64_tr_b16 a[60:61], v11 offset:57344
ds_read_b64_tr_b16 a[62:63], v11 offset:57856
ds_read_b64_tr_b16 a[112:113], v12 offset:32768
ds_read_b64_tr_b16 a[114:115], v12 offset:33280
ds_read_b64_tr_b16 a[116:117], v12 offset:40960
ds_read_b64_tr_b16 a[118:119], v12 offset:41472
ds_read_b64_tr_b16 a[120:121], v12 offset:49152
ds_read_b64_tr_b16 a[122:123], v12 offset:49664
ds_read_b64_tr_b16 a[124:125], v12 offset:57344
ds_read_b64_tr_b16 a[126:127], v12 offset:57856
s_waitcnt lgkmcnt(0)
L_qw3_e:
s_add_u32 s17, s17, 1
s_cmp_eq_u32 s17, 15
s_cbranch_scc1 L_qw_done
L_qw4:
s_cmp_lt_u32 s17, 3
s_cbranch_scc1 L_qw4_i
s_cmp_lt_u32 s17, 13
s_cbranch_scc1 L_qw4_w
s_waitcnt vmcnt(0)
L_qw4_w:
s_waitcnt vmcnt(16)
s_barrier
s_cmp_ge_u32 s17, 12
s_cbranch_scc1 L_qw4_r
L_qw4_i:
s_add_u32 m0, s15, 0x18000
v_xor_b32 v10, 0x0, v8
v_add_u32 v10, 0x300000, v10
global_load_lds_dwordx4 v10, s[8:9]
s_add_u32 m0, s15, 0x18400
v_xor_b32 v10, 0x40, v8
v_add_u32 v10, 0x308000, v10
global_load_lds_dwordx4 v10, s[8:9]
s_add_u32 m0, s15, 0x18800
v_xor_b32 v10, 0x0, v8
v_add_u32 v10, 0x310000, v10
global_load_lds_dwordx4 v10, s[8:9]
s_add_u32 m0, s15, 0x18c00
v_xor_b32 v10, 0x40, v8
v_add_u32 v10, 0x318000, v10
global_load_lds_dwordx4 v10, s[8:9]
s_add_u32 m0, s15, 0x19000
v_xor_b32 v10, 0x80, v8
v_add_u32 v10, 0x320000, v10
global_load_lds_dwordx4 v10, s[8:9]
s_add_u32 m0, s15, 0x19400
v_xor_b32 v10, 0xc0, v8
v_add_u32 v10, 0x328000, v10
global_load_lds_dwordx4 v10, s[8:9]
s_add_u32 m0, s15, 0x19800
v_xor_b32 v10, 0x80, v8
v_add_u32 v10, 0x330000, v10
global_load_lds_dwordx4 v10, s[8:9]
s_add_u32 m0, s15, 0x19c00
v_xor_b32 v10, 0xc0, v8
v_add_u32 v10, 0x338000, v10
global_load_lds_dwordx4 v10, s[8:9]
s_cmp_lt_u32 s17, 3
s_cbranch_scc1 L_qw4_e
L_qw4_r:
v_add_u32 v11, 0x0, v9
v_xor_b32 v12, 32, v11
ds_read_b64_tr_b16 a[128:129], v11 offset:0
ds_read_b64_tr_b16 a[130:131], v11 offset:512
ds_read_b64_tr_b16 a[132:133], v11 offset:8192
ds_read_b64_tr_b16 a[134:135], v11 offset:8704
ds_read_b64_tr_b16 a[136:137], v11 offset:16384
ds_read_b64_tr_b16 a[138:139], v11 offset:16896
ds_read_b64_tr_b16 a[140:141], v11 offset:24576
ds_read_b64_tr_b16 a[142:143], v11 offset:25088
ds_read_b64_tr_b16 a[192:193], v12 offset:0
ds_read_b64_tr_b16 a[194:195], v12 offset:512
ds_read_b64_tr_b16 a[196:197], v12 offset:8192
ds_read_b64_tr_b16 a[198:199], v12 offset:8704
ds_read_b64_tr_b16 a[200:201], v12 offset:16384
ds_read_b64_tr_b16 a[202:203], v12 offset:16896
ds_read_b64_tr_b16 a[204:205], v12 offset:24576
ds_read_b64_tr_b16 a[206:207], v12 offset:25088
s_waitcnt lgkmcnt(0)
L_qw4_e:
s_add_u32 s17, s17, 1
s_cmp_eq_u32 s17, 15
s_cbranch_scc1 L_qw_done
L_qw5:
s_cmp_lt_u32 s17, 3
s_cbranch_scc1 L_qw5_i
s_cmp_lt_u32 s17, 13
s_cbranch_scc1 L_qw5_w
s_waitcnt vmcnt(0)
L_qw5_w:
s_waitcnt vmcnt(16)
s_barrier
s_cmp_ge_u32 s17, 12
s_cbranch_scc1 L_qw5_r
L_qw5_i:
s_add_u32 m0, s15, 0x0
v_xor_b32 v10, 0x0, v8
v_add_u32 v10, 0x0, v10
global_load_lds_dwordx4 v10, s[10:11]
s_add_u32 m0, s15, 0x400
v_xor_b32 v10, 0x40, v8
v_add_u32 v10, 0x8000, v10
global_load_lds_dwordx4 v10, s[10:11]
s_add_u32 m0, s15, 0x800
v_xor_b32 v10, 0x0, v8
v_add_u32 v10, 0x10000, v10
global_load_lds_dwordx4 v10, s[10:11]
s_add_u32 m0, s15, 0xc00
v_xor_b32 v10, 0x40, v8
v_add_u32 v10, 0x18000, v10
global_load_lds_dwordx4 v10, s[10:11]
s_add_u32 m0, s15, 0x1000
v_xor_b32 v10, 0x80, v8
v_add_u32 v10, 0x20000, v10
global_load_lds_dwordx4 v10, s[10:11]
s_add_u32 m0, s15, 0x1400
v_xor_b32 v10, 0xc0, v8
v_add_u32 v10, 0x28000, v10
global_load_lds_dwordx4 v10, s[10:11]
s_add_u32 m0, s15, 0x1800
v_xor_b32 v10, 0x80, v8
v_add_u32 v10, 0x30000, v10
global_load_lds_dwordx4 v10, s[10:11]
s_add_u32 m0, s15, 0x1c00
v_xor_b32 v10, 0xc0, v8
v_add_u32 v10, 0x38000, v10
global_load_lds_dwordx4 v10, s[10:11]
s_cmp_lt_u32 s17, 3
s_cbranch_scc1 L_qw5_e
L_qw5_r:
v_add_u32 v11, 0x0, v9
v_xor_b32 v12, 32, v11
ds_read_b64_tr_b16 a[144:145], v11 offset:32768
ds_read_b64_tr_b16 a[146:147], v11 offset:33280
ds_read_b64_tr_b16 a[148:149], v11 offset:40960
ds_read_b64_tr_b16 a[150:151], v11 offset:41472
ds_read_b64_tr_b16 a[152:153], v11 offset:49152
ds_read_b64_tr_b16 a[154:155], v11 offset:49664
ds_read_b64_tr_b16 a[156:157], v11 offset:57344
ds_read_b64_tr_b16 a[158:159], v11 offset:57856
ds_read_b64_tr_b16 a[208:209], v12 offset:32768
ds_read_b64_tr_b16 a[210:211], v12 offset:33280
ds_read_b64_tr_b16 a[212:213], v12 offset:40960
ds_read_b64_tr_b16 a[214:215], v12 offset:41472
ds_read_b64_tr_b16 a[216:217], v12 offset:49152
ds_read_b64_tr_b16 a[218:219], v12 offset:49664
ds_read_b64_tr_b16 a[220:221], v12 offset:57344
ds_read_b64_tr_b16 a[222:223], v12 offset:57856
s_waitcnt lgkmcnt(0)
L_qw5_e:
s_add_u32 s17, s17, 1
s_cmp_eq_u32 s17, 15
s_cbranch_scc1 L_qw_done
L_qw6:
s_cmp_lt_u32 s17, 3
s_cbranch_scc1 L_qw6_i
s_cmp_lt_u32 s17, 13
s_cbranch_scc1 L_qw6_w
s_waitcnt vmcnt(0)
L_qw6_w:
s_waitcnt vmcnt(16)
s_barrier
s_cmp_ge_u32 s17, 12
s_cbranch_scc1 L_qw6_r
L_qw6_i:
s_add_u32 m0, s15, 0x8000
v_xor_b32 v10, 0x0, v8
v_add_u32 v10, 0x100000, v10
global_load_lds_dwordx4 v10, s[10:11]
s_add_u32 m0, s15, 0x8400
v_xor_b32 v10, 0x40, v8
v_add_u32 v10, 0x108000, v10
global_load_lds_dwordx4 v10, s[10:11]
s_add_u32 m0, s15, 0x8800
v_xor_b32 v10, 0x0, v8
v_add_u32 v10, 0x110000, v10
global_load_lds_dwordx4 v10, s[10:11]
s_add_u32 m0, s15, 0x8c00
v_xor_b32 v10, 0x40, v8
v_add_u32 v10, 0x118000, v10
global_load_lds_dwordx4 v10, s[10:11]
s_add_u32 m0, s15, 0x9000
v_xor_b32 v10, 0x80, v8
v_add_u32 v10, 0x120000, v10
global_load_lds_dwordx4 v10, s[10:11]
s_add_u32 m0, s15, 0x9400
v_xor_b32 v10, 0xc0, v8
v_add_u32 v10, 0x128000, v10
global_load_lds_dwordx4 v10, s[10:11]
s_add_u32 m0, s15, 0x9800
v_xor_b32 v10, 0x80, v8
v_add_u32 v10, 0x130000, v10
global_load_lds_dwordx4 v10, s[10:11]
s_add_u32 m0, s15, 0x9c00
v_xor_b32 v10, 0xc0, v8
v_add_u32 v10, 0x138000, v10
global_load_lds_dwordx4 v10, s[10:11]
s_cmp_lt_u32 s17, 3
s_cbranch_scc1 L_qw6_e
L_qw6_r:
v_add_u32 v11, 0x10000, v9
v_xor_b32 v12, 32, v11
ds_read_b64_tr_b16 a[160:161], v11 offset:0
ds_read_b64_tr_b16 a[162:163], v11 offset:512
ds_read_b64_tr_b16 a[164:165], v11 offset:8192
ds_read_b64_tr_b16 a[166:167], v11 offset:8704
ds_read_b64_tr_b16 a[168:169], v11 offset:16384
ds_read_b64_tr_b16 a[170:171], v11 offset:16896
ds_read_b64_tr_b16 a[172:173], v11 offset:24576
ds_read_b64_tr_b16 a[174:175], v11 offset:25088
ds_read_b64_tr_b16 a[224:225], v12 offset:0
ds_read_b64_tr_b16 a[226:227], v12 offset:512
ds_read_b64_tr_b16 a[228:229], v12 offset:8192
ds_read_b64_tr_b16 a[230:231], v12 offset:8704
ds_read_b64_tr_b16 a[232:233], v12 offset:16384
ds_read_b64_tr_b16 a[234:235], v12 offset:16896
ds_read_b64_tr_b16 a[236:237], v12 offset:24576
ds_read_b64_tr_b16 a[238:239], v12 offset:25088
s_waitcnt lgkmcnt(0)
L_qw6_e:
s_add_u32 s17, s17, 1
s_cmp_eq_u32 s17, 15
s_cbranch_scc1 L_qw_done
L_qw7:
s_cmp_lt_u32 s17, 3
s_cbranch_scc1 L_qw7_i
s_cmp_lt_u32 s17, 13
s_cbranch_scc1 L_qw7_w
s_waitcnt vmcnt(0)
L_qw7_w:
s_waitcnt vmcnt(16)
s_barrier
s_cmp_ge_u32 s17, 12
s_cbranch_scc1 L_qw7_r
L_qw7_i:
s_add_u32 m0, s15, 0x10000
v_xor_b32 v10, 0x0, v8
v_add_u32 v10, 0x200000, v10
global_load_lds_dwordx4 v10, s[10:11]
s_add_u32 m0, s15, 0x10400
v_xor_b32 v10, 0x40, v8
v_add_u32 v10, 0x208000, v10
global_load_lds_dwordx4 v10, s[10:11]
s_add_u32 m0, s15, 0x10800
v_xor_b32 v10, 0x0, v8
v_add_u32 v10, 0x210000, v10
global_load_lds_dwordx4 v10, s[10:11]
s_add_u32 m0, s15, 0x10c00
v_xor_b32 v10, 0x40, v8
v_add_u32 v10, 0x218000, v10
global_load_lds_dwordx4 v10, s[10:11]
s_add_u32 m0, s15, 0x11000
v_xor_b32 v10, 0x80, v8
v_add_u32 v10, 0x220000, v10
global_load_lds_dwordx4 v10, s[10:11]
s_add_u32 m0, s15, 0x11400
v_xor_b32 v10, 0xc0, v8
v_add_u32 v10, 0x228000, v10
global_load_lds_dwordx4 v10, s[10:11]
s_add_u32 m0, s15, 0x11800
v_xor_b32 v10, 0x80, v8
v_add_u32 v10, 0x230000, v10
global_load_lds_dwordx4 v10, s[10:11]
s_add_u32 m0, s15, 0x11c00
v_xor_b32 v10, 0xc0, v8
v_add_u32 v10, 0x238000, v10
global_load_lds_dwordx4 v10, s[10:11]
s_cmp_lt_u32 s17, 3
s_cbranch_scc1 L_qw7_e
L_qw7_r:
v_add_u32 v11, 0x10000, v9
v_xor_b32 v12, 32, v11
ds_read_b64_tr_b16 a[176:177], v11 offset:32768
ds_read_b64_tr_b16 a[178:179], v11 offset:33280
ds_read_b64_tr_b16 a[180:181], v11 offset:40960
ds_read_b64_tr_b16 a[182:183], v11 offset:41472
ds_read_b64_tr_b16 a[184:185], v11 offset:49152
ds_read_b64_tr_b16 a[186:187], v11 offset:49664
ds_read_b64_tr_b16 a[188:189], v11 offset:57344
ds_read_b64_tr_b16 a[190:191], v11 offset:57856
ds_read_b64_tr_b16 a[240:241], v12 offset:32768
ds_read_b64_tr_b16 a[242:243], v12 offset:33280
ds_read_b64_tr_b16 a[244:245], v12 offset:40960
ds_read_b64_tr_b16 a[246:247], v12 offset:41472
ds_read_b64_tr_b16 a[248:249], v12 offset:49152
ds_read_b64_tr_b16 a[250:251], v12 offset:49664
ds_read_b64_tr_b16 a[252:253], v12 offset:57344
ds_read_b64_tr_b16 a[254:255], v12 offset:57856
s_waitcnt lgkmcnt(0)
L_qw7_e:
s_add_u32 s17, s17, 1
s_cmp_eq_u32 s17, 15
s_cbranch_scc1 L_qw_done
L_qw8:
s_cmp_lt_u32 s17, 3
s_cbranch_scc1 L_qw8_i
s_cmp_lt_u32 s17, 13
s_cbranch_scc1 L_qw8_w
s_waitcnt vmcnt(0)
L_qw8_w:
s_waitcnt vmcnt(16)
s_barrier
s_cmp_ge_u32 s17, 12
s_cbranch_scc1 L_qw8_r
L_qw8_i:
s_add_u32 m0, s15, 0x18000
v_xor_b32 v10, 0x0, v8
v_add_u32 v10, 0x300000, v10
global_load_lds_dwordx4 v10, s[10:11]
s_add_u32 m0, s15, 0x18400
v_xor_b32 v10, 0x40, v8
v_add_u32 v10, 0x308000, v10
global_load_lds_dwordx4 v10, s[10:11]
s_add_u32 m0, s15, 0x18800
v_xor_b32 v10, 0x0, v8
v_add_u32 v10, 0x310000, v10
global_load_lds_dwordx4 v10, s[10:11]
s_add_u32 m0, s15, 0x18c00
v_xor_b32 v10, 0x40, v8
v_add_u32 v10, 0x318000, v10
global_load_lds_dwordx4 v10, s[10:11]
s_add_u32 m0, s15, 0x19000
v_xor_b32 v10, 0x80, v8
v_add_u32 v10, 0x320000, v10
global_load_lds_dwordx4 v10, s[10:11]
s_add_u32 m0, s15, 0x19400
v_xor_b32 v10, 0xc0, v8
v_add_u32 v10, 0x328000, v10
global_load_lds_dwordx4 v10, s[10:11]
s_add_u32 m0, s15, 0x19800
v_xor_b32 v10, 0x80, v8
v_add_u32 v10, 0x330000, v10
global_load_lds_dwordx4 v10, s[10:11]
s_add_u32 m0, s15, 0x19c00
v_xor_b32 v10, 0xc0, v8
v_add_u32 v10, 0x338000, v10
global_load_lds_dwordx4 v10, s[10:11]
s_cmp_lt_u32 s17, 3
s_cbranch_scc1 L_qw8_e
L_qw8_r:
v_add_u32 v11, 0x0, v9
v_xor_b32 v12, 32, v11
ds_read_b64_tr_b16 v[128:129], v11 offset:0
ds_read_b64_tr_b16 v[130:131], v11 offset:512
ds_read_b64_tr_b16 v[132:133], v11 offset:8192
ds_read_b64_tr_b16 v[134:135], v11 offset:8704
ds_read_b64_tr_b16 v[136:137], v11 offset:16384
ds_read_b64_tr_b16 v[138:139], v11 offset:16896
ds_read_b64_tr_b16 v[140:141], v11 offset:24576
ds_read_b64_tr_b16 v[142:143], v11 offset:25088
ds_read_b64_tr_b16 v[192:193], v12 offset:0
ds_read_b64_tr_b16 v[194:195], v12 offset:512
ds_read_b64_tr_b16 v[196:197], v12 offset:8192
ds_read_b64_tr_b16 v[198:199], v12 offset:8704
ds_read_b64_tr_b16 v[200:201], v12 offset:16384
ds_read_b64_tr_b16 v[202:203], v12 offset:16896
ds_read_b64_tr_b16 v[204:205], v12 offset:24576
ds_read_b64_tr_b16 v[206:207], v12 offset:25088
s_waitcnt lgkmcnt(0)
L_qw8_e:
s_add_u32 s17, s17, 1
s_cmp_eq_u32 s17, 15
s_cbranch_scc1 L_qw_done
L_qw9:
s_cmp_lt_u32 s17, 3
s_cbranch_scc1 L_qw9_i
s_cmp_lt_u32 s17, 13
s_cbranch_scc1 L_qw9_w
s_waitcnt vmcnt(0)
L_qw9_w:
s_waitcnt vmcnt(16)
s_barrier
s_cmp_ge_u32 s17, 12
s_cbranch_scc1 L_qw9_r
L_qw9_i:
s_add_u32 m0, s15, 0x0
v_xor_b32 v10, 0x0, v8
v_add_u32 v10, 0x0, v10
global_load_lds_dwordx4 v10, s[6:7]
s_add_u32 m0, s15, 0x400
v_xor_b32 v10, 0x40, v8
v_add_u32 v10, 0x8000, v10
global_load_lds_dwordx4 v10, s[6:7]
s_add_u32 m0, s15, 0x800
v_xor_b32 v10, 0x0, v8
v_add_u32 v10, 0x10000, v10
global_load_lds_dwordx4 v10, s[6:7]
s_add_u32 m0, s15, 0xc00
v_xor_b32 v10, 0x40, v8
v_add_u32 v10, 0x18000, v10
global_load_lds_dwordx4 v10, s[6:7]
s_add_u32 m0, s15, 0x1000
v_xor_b32 v10, 0x80, v8
v_add_u32 v10, 0x20000, v10
global_load_lds_dwordx4 v10, s[6:7]
s_add_u32 m0, s15, 0x1400
v_xor_b32 v10, 0xc0, v8
v_add_u32 v10, 0x28000, v10
global_load_lds_dwordx4 v10, s[6:7]
s_add_u32 m0, s15, 0x1800
v_xor_b32 v10, 0x80, v8
v_add_u32 v10, 0x30000, v10
global_load_lds_dwordx4 v10, s[6:7]
s_add_u32 m0, s15, 0x1c00
v_xor_b32 v10, 0xc0, v8
v_add_u32 v10, 0x38000, v10
global_load_lds_dwordx4 v10, s[6:7]
s_cmp_lt_u32 s17, 3
s_cbranch_scc1 L_qw9_e
L_qw9_r:
v_add_u32 v11, 0x0, v9
v_xor_b32 v12, 32, v11
ds_read_b64_tr_b16 v[144:145], v11 offset:32768
ds_read_b64_tr_b16 v[146:147], v11 offset:33280
ds_read_b64_tr_b16 v[148:149], v11 offset:40960
ds_read_b64_tr_b16 v[150:151], v11 offset:41472
ds_read_b64_tr_b16 v[152:153], v11 offset:49152
ds_read_b64_tr_b16 v[154:155], v11 offset:49664
ds_read_b64_tr_b16 v[156:157], v11 offset:57344
ds_read_b64_tr_b16 v[158:159], v11 offset:57856
ds_read_b64_tr_b16 v[208:209], v12 offset:32768
ds_read_b64_tr_b16 v[210:211], v12 offset:33280
ds_read_b64_tr_b16 v[212:213], v12 offset:40960
ds_read_b64_tr_b16 v[214:215], v12 offset:41472
ds_read_b64_tr_b16 v[216:217], v12 offset:49152
ds_read_b64_tr_b16 v[218:219], v12 offset:49664
ds_read_b64_tr_b16 v[220:221], v12 offset:57344
ds_read_b64_tr_b16 v[222:223], v12 offset:57856
s_waitcnt lgkmcnt(0)
L_qw9_e:
s_add_u32 s17, s17, 1
s_cmp_eq_u32 s17, 15
s_cbranch_scc1 L_qw_done
L_qw10:
s_cmp_lt_u32 s17, 3
s_cbranch_scc1 L_qw10_i
s_cmp_lt_u32 s17, 13
s_cbranch_scc1 L_qw10_w
s_waitcnt vmcnt(0)
L_qw10_w:
s_waitcnt vmcnt(16)
s_barrier
s_cmp_ge_u32 s17, 12
s_cbranch_scc1 L_qw10_r
L_qw10_i:
s_add_u32 m0, s15, 0x8000
v_xor_b32 v10, 0x0, v8
v_add_u32 v10, 0x100000, v10
global_load_lds_dwordx4 v10, s[6:7]
s_add_u32 m0, s15, 0x8400
v_xor_b32 v10, 0x40, v8
v_add_u32 v10, 0x108000, v10
global_load_lds_dwordx4 v10, s[6:7]
s_add_u32 m0, s15, 0x8800
v_xor_b32 v10, 0x0, v8
v_add_u32 v10, 0x110000, v10
global_load_lds_dwordx4 v10, s[6:7]
s_add_u32 m0, s15, 0x8c00
v_xor_b32 v10, 0x40, v8
v_add_u32 v10, 0x118000, v10
global_load_lds_dwordx4 v10, s[6:7]
s_add_u32 m0, s15, 0x9000
v_xor_b32 v10, 0x80, v8
v_add_u32 v10, 0x120000, v10
global_load_lds_dwordx4 v10, s[6:7]
s_add_u32 m0, s15, 0x9400
v_xor_b32 v10, 0xc0, v8
v_add_u32 v10, 0x128000, v10
global_load_lds_dwordx4 v10, s[6:7]
s_add_u32 m0, s15, 0x9800
v_xor_b32 v10, 0x80, v8
v_add_u32 v10, 0x130000, v10
global_load_lds_dwordx4 v10, s[6:7]
s_add_u32 m0, s15, 0x9c00
v_xor_b32 v10, 0xc0, v8
v_add_u32 v10, 0x138000, v10
global_load_lds_dwordx4 v10, s[6:7]
s_cmp_lt_u32 s17, 3
s_cbranch_scc1 L_qw10_e
L_qw10_r:
v_add_u32 v11, 0x10000, v9
v_xor_b32 v12, 32, v11
ds_read_b64_tr_b16 v[160:161], v11 offset:0
ds_read_b64_tr_b16 v[162:163], v11 offset:512
ds_read_b64_tr_b16 v[164:165], v11 offset:8192
ds_read_b64_tr_b16 v[166:167], v11 offset:8704
ds_read_b64_tr_b16 v[168:169], v11 offset:16384
ds_read_b64_tr_b16 v[170:171], v11 offset:16896
ds_read_b64_tr_b16 v[172:173], v11 offset:24576
ds_read_b64_tr_b16 v[174:175], v11 offset:25088
ds_read_b64_tr_b16 v[224:225], v12 offset:0
ds_read_b64_tr_b16 v[226:227], v12 offset:512
ds_read_b64_tr_b16 v[228:229], v12 offset:8192
ds_read_b64_tr_b16 v[230:231], v12 offset:8704
ds_read_b64_tr_b16 v[232:233], v12 offset:16384
ds_read_b64_tr_b16 v[234:235], v12 offset:16896
ds_read_b64_tr_b16 v[236:237], v12 offset:24576
ds_read_b64_tr_b16 v[238:239], v12 offset:25088
s_waitcnt lgkmcnt(0)
L_qw10_e:
s_add_u32 s17, s17, 1
s_cmp_eq_u32 s17, 15
s_cbranch_scc1 L_qw_done
L_qw11:
s_cmp_lt_u32 s17, 3
s_cbranch_scc1 L_qw11_i
s_cmp_lt_u32 s17, 13
s_cbranch_scc1 L_qw11_w
s_waitcnt vmcnt(0)
L_qw11_w:
s_waitcnt vmcnt(16)
s_barrier
s_cmp_ge_u32 s17, 12
s_cbranch_scc1 L_qw11_r
L_qw11_i:
s_add_u32 m0, s15, 0x10000
v_xor_b32 v10, 0x0, v8
v_add_u32 v10, 0x200000, v10
global_load_lds_dwordx4 v10, s[6:7]
s_add_u32 m0, s15, 0x10400
v_xor_b32 v10, 0x40, v8
v_add_u32 v10, 0x208000, v10
global_load_lds_dwordx4 v10, s[6:7]
s_add_u32 m0, s15, 0x10800
v_xor_b32 v10, 0x0, v8
v_add_u32 v10, 0x210000, v10
global_load_lds_dwordx4 v10, s[6:7]
s_add_u32 m0, s15, 0x10c00
v_xor_b32 v10, 0x40, v8
v_add_u32 v10, 0x218000, v10
global_load_lds_dwordx4 v10, s[6:7]
s_add_u32 m0, s15, 0x11000
v_xor_b32 v10, 0x80, v8
v_add_u32 v10, 0x220000, v10
global_load_lds_dwordx4 v10, s[6:7]
s_add_u32 m0, s15, 0x11400
v_xor_b32 v10, 0xc0, v8
v_add_u32 v10, 0x228000, v10
global_load_lds_dwordx4 v10, s[6:7]
s_add_u32 m0, s15, 0x11800
v_xor_b32 v10, 0x80, v8
v_add_u32 v10, 0x230000, v10
global_load_lds_dwordx4 v10, s[6:7]
s_add_u32 m0, s15, 0x11c00
v_xor_b32 v10, 0xc0, v8
v_add_u32 v10, 0x238000, v10
global_load_lds_dwordx4 v10, s[6:7]
s_cmp_lt_u32 s17, 3
s_cbranch_scc1 L_qw11_e
L_qw11_r:
v_add_u32 v11, 0x10000, v9
v_xor_b32 v12, 32, v11
ds_read_b64_tr_b16 v[176:177], v11 offset:32768
ds_read_b64_tr_b16 v[178:179], v11 offset:33280
ds_read_b64_tr_b16 v[180:181], v11 offset:40960
ds_read_b64_tr_b16 v[182:183], v11 offset:41472
ds_read_b64_tr_b16 v[184:185], v11 offset:49152
ds_read_b64_tr_b16 v[186:187], v11 offset:49664
ds_read_b64_tr_b16 v[188:189], v11 offset:57344
ds_read_b64_tr_b16 v[190:191], v11 offset:57856
ds_read_b64_tr_b16 v[240:241], v12 offset:32768
ds_read_b64_tr_b16 v[242:243], v12 offset:33280
ds_read_b64_tr_b16 v[244:245], v12 offset:40960
ds_read_b64_tr_b16 v[246:247], v12 offset:41472
ds_read_b64_tr_b16 v[248:249], v12 offset:49152
ds_read_b64_tr_b16 v[250:251], v12 offset:49664
ds_read_b64_tr_b16 v[252:253], v12 offset:57344
ds_read_b64_tr_b16 v[254:255], v12 offset:57856
s_waitcnt lgkmcnt(0)
L_qw11_e:
s_add_u32 s17, s17, 1
s_cmp_eq_u32 s17, 15
s_cbranch_scc1 L_qw_done
s_branch L_qw0
L_qw_done:
v_mov_b32 v2, 0x0
v_bfe_i32 v5, v0, 0, 1
v_and_b32 v5, 0x10, v5
v_xor_b32 v2, v2, v5
v_bfe_i32 v5, v0, 1, 1
v_and_b32 v5, 0x20, v5
v_xor_b32 v2, v2, v5
v_bfe_i32 v5, v0, 2, 1
v_and_b32 v5, 0x40, v5
v_xor_b32 v2, v2, v5
v_bfe_i32 v5, v0, 3, 1
v_and_b32 v5, 0x80, v5
v_xor_b32 v2, v2, v5
v_bfe_i32 v5, v0, 4, 1
v_and_b32 v5, 0x100, v5
v_xor_b32 v2, v2, v5
v_bfe_i32 v5, v0, 5, 1
v_and_b32 v5, 0x200, v5
v_xor_b32 v2, v2, v5
v_bfe_i32 v5, v0, 6, 1
v_and_b32 v5, 0x2000, v5
v_xor_b32 v2, v2, v5
v_bfe_i32 v5, v0, 7, 1
v_and_b32 v5, 0x4000, v5
v_xor_b32 v2, v2, v5
v_mov_b32 v3, 0x20000
v_bfe_i32 v5, v0, 0, 1
v_and_b32 v5, 0x10, v5
v_xor_b32 v3, v3, v5
v_bfe_i32 v5, v0, 1, 1
v_and_b32 v5, 0x20, v5
v_xor_b32 v3, v3, v5
v_bfe_i32 v5, v0, 2, 1
v_and_b32 v5, 0x40, v5
v_xor_b32 v3, v3, v5
v_bfe_i32 v5, v0, 3, 1
v_and_b32 v5, 0x80, v5
v_xor_b32 v3, v3, v5
v_bfe_i32 v5, v0, 4, 1
v_and_b32 v5, 0x100, v5
v_xor_b32 v3, v3, v5
v_bfe_i32 v5, v0, 5, 1
v_and_b32 v5, 0x200, v5
v_xor_b32 v3, v3, v5
v_mov_b32 v4, 0x0
v_bfe_i32 v5, v0, 0, 1
v_and_b32 v5, 0x10, v5
v_xor_b32 v4, v4, v5
v_bfe_i32 v5, v0, 1, 1
v_and_b32 v5, 0x20, v5
v_xor_b32 v4, v4, v5
v_bfe_i32 v5, v0, 2, 1
v_and_b32 v5, 0x40, v5
v_xor_b32 v4, v4, v5
v_bfe_i32 v5, v0, 3, 1
v_and_b32 v5, 0x80, v5
v_xor_b32 v4, v4, v5
v_bfe_i32 v5, v0, 4, 1
v_and_b32 v5, 0x100, v5
v_xor_b32 v4, v4, v5
v_bfe_i32 v5, v0, 5, 1
v_and_b32 v5, 0x200, v5
v_xor_b32 v4, v4, v5
v_bfe_i32 v5, v0, 6, 1
v_and_b32 v5, 0x400, v5
v_xor_b32 v4, v4, v5
v_bfe_i32 v5, v0, 7, 1
v_and_b32 v5, 0x800, v5
v_xor_b32 v4, v4, v5
v_mov_b32 v6, 0x2000
v_bfe_i32 v5, v0, 0, 1
v_and_b32 v5, 0x10, v5
v_xor_b32 v6, v6, v5
v_bfe_i32 v5, v0, 1, 1
v_and_b32 v5, 0x20, v5
v_xor_b32 v6, v6, v5
v_bfe_i32 v5, v0, 2, 1
v_and_b32 v5, 0x40, v5
v_xor_b32 v6, v6, v5
v_bfe_i32 v5, v0, 3, 1
v_and_b32 v5, 0x80, v5
v_xor_b32 v6, v6, v5
v_bfe_i32 v5, v0, 4, 1
v_and_b32 v5, 0x100, v5
v_xor_b32 v6, v6, v5
v_bfe_i32 v5, v0, 5, 1
v_and_b32 v5, 0x200, v5
v_xor_b32 v6, v6, v5
v_bfe_i32 v5, v0, 6, 1
v_and_b32 v5, 0x800, v5
v_xor_b32 v6, v6, v5
v_bfe_i32 v5, v0, 7, 1
v_and_b32 v5, 0x1000, v5
v_xor_b32 v6, v6, v5
v_and_b32 v7, 31, v0
v_lshlrev_b32 v7, 2, v7
L_qkv_xn:
global_load_dword v8, v7, s[28:29] offset:128 sc1
s_waitcnt vmcnt(0)
v_cmp_ne_u32 vcc, 0x01010101, v8
s_cmp_eq_u64 vcc, 0
s_cbranch_scc1 L_qkv_xn_ok
s_sleep 4
s_sub_u32 s41, s41, 1
s_cbranch_scc0 L_qkv_xn
s_mov_b32 s41, 0
L_qkv_xn_ok:
s_add_u32 s18, s15, 0x20000
s_lshl_b32 s20, s13, 15
v_add_u32 v7, s20, v2
s_add_u32 m0, s18, 0
s_nop 0
global_load_lds_dwordx4 v7, s[4:5] offset:0 sc1
global_load_lds_dwordx4 v7, s[4:5] offset:1024 sc1
global_load_lds_dwordx4 v7, s[4:5] offset:2048 sc1
global_load_lds_dwordx4 v7, s[4:5] offset:3072 sc1
s_add_u32 m0, s18, 4096
v_add_u32 v7, 4096, v7
global_load_lds_dwordx4 v7, s[4:5] offset:0 sc1
global_load_lds_dwordx4 v7, s[4:5] offset:1024 sc1
global_load_lds_dwordx4 v7, s[4:5] offset:2048 sc1
global_load_lds_dwordx4 v7, s[4:5] offset:3072 sc1
s_mov_b32 s17, s13
s_mov_b32 s22, 0x3e0293ee
s_lshl_b32 s23, s12, 8
s_add_u32 s23, s23, 0x3a0000
v_mov_b32 v14, 1
s_waitcnt vmcnt(0)
L_qkv_loop:
s_waitcnt vmcnt(6)
s_barrier
s_add_u32 s19, s17, 7
s_xor_b32 s18, s18, 0x20000
s_cmp_ge_u32 s19, 64
s_cbranch_scc1 L_qkv_nodma
s_lshl_b32 s20, s19, 15
v_add_u32 v7, s20, v2
s_add_u32 m0, s18, 0
s_nop 0
global_load_lds_dwordx4 v7, s[4:5] offset:0 sc1
global_load_lds_dwordx4 v7, s[4:5] offset:1024 sc1
global_load_lds_dwordx4 v7, s[4:5] offset:2048 sc1
global_load_lds_dwordx4 v7, s[4:5] offset:3072 sc1
s_add_u32 m0, s18, 4096
v_add_u32 v7, 4096, v7
global_load_lds_dwordx4 v7, s[4:5] offset:0 sc1
global_load_lds_dwordx4 v7, s[4:5] offset:1024 sc1
global_load_lds_dwordx4 v7, s[4:5] offset:2048 sc1
global_load_lds_dwordx4 v7, s[4:5] offset:3072 sc1
L_qkv_nodma:
ds_read_b128 v[112:115], v3 offset:0
ds_read_b128 v[116:119], v3 offset:16384
ds_read_b128 v[120:123], v3 offset:1024
ds_read_b128 v[124:127], v3 offset:17408
s_waitcnt lgkmcnt(2)
v_mfma_f32_16x16x32_bf16 v[80:83], a[128:131], v[112:115], 0
v_mfma_f32_16x16x32_bf16 v[84:87], a[128:131], v[116:119], 0
v_mfma_f32_16x16x32_bf16 v[88:91], a[192:195], v[112:115], 0
v_mfma_f32_16x16x32_bf16 v[92:95], a[192:195], v[116:119], 0
v_mfma_f32_16x16x32_bf16 v[96:99], v[112:115], v[128:131], 0
v_mfma_f32_16x16x32_bf16 v[100:103], v[116:119], v[128:131], 0
v_mfma_f32_16x16x32_bf16 v[104:107], v[112:115], v[192:195], 0
v_mfma_f32_16x16x32_bf16 v[108:111], v[116:119], v[192:195], 0
v_mfma_f32_16x16x32_bf16 v[64:67], a[0:3], v[112:115], 0
v_mfma_f32_16x16x32_bf16 v[68:71], a[0:3], v[116:119], 0
v_mfma_f32_16x16x32_bf16 v[72:75], a[64:67], v[112:115], 0
v_mfma_f32_16x16x32_bf16 v[76:79], a[64:67], v[116:119], 0
ds_read_b128 v[112:115], v3 offset:2048
ds_read_b128 v[116:119], v3 offset:18432
s_waitcnt lgkmcnt(2)
v_mfma_f32_16x16x32_bf16 v[80:83], a[132:135], v[120:123], v[80:83]
v_mfma_f32_16x16x32_bf16 v[84:87], a[132:135], v[124:127], v[84:87]
v_mfma_f32_16x16x32_bf16 v[88:91], a[196:199], v[120:123], v[88:91]
v_mfma_f32_16x16x32_bf16 v[92:95], a[196:199], v[124:127], v[92:95]
v_mfma_f32_16x16x32_bf16 v[96:99], v[120:123], v[132:135], v[96:99]
v_mfma_f32_16x16x32_bf16 v[100:103], v[124:127], v[132:135], v[100:103]
v_mfma_f32_16x16x32_bf16 v[104:107], v[120:123], v[196:199], v[104:107]
v_mfma_f32_16x16x32_bf16 v[108:111], v[124:127], v[196:199], v[108:111]
v_mfma_f32_16x16x32_bf16 v[64:67], a[4:7], v[120:123], v[64:67]
v_mfma_f32_16x16x32_bf16 v[68:71], a[4:7], v[124:127], v[68:71]
v_mfma_f32_16x16x32_bf16 v[72:75], a[68:71], v[120:123], v[72:75]
v_mfma_f32_16x16x32_bf16 v[76:79], a[68:71], v[124:127], v[76:79]
ds_read_b128 v[120:123], v3 offset:3072
ds_read_b128 v[124:127], v3 offset:19456
s_waitcnt lgkmcnt(2)
v_mfma_f32_16x16x32_bf16 v[80:83], a[136:139], v[112:115], v[80:83]
v_mfma_f32_16x16x32_bf16 v[84:87], a[136:139], v[116:119], v[84:87]
v_mfma_f32_16x16x32_bf16 v[88:91], a[200:203], v[112:115], v[88:91]
v_mfma_f32_16x16x32_bf16 v[92:95], a[200:203], v[116:119], v[92:95]
v_mfma_f32_16x16x32_bf16 v[96:99], v[112:115], v[136:139], v[96:99]
v_mfma_f32_16x16x32_bf16 v[100:103], v[116:119], v[136:139], v[100:103]
v_mfma_f32_16x16x32_bf16 v[104:107], v[112:115], v[200:203], v[104:107]
v_mfma_f32_16x16x32_bf16 v[108:111], v[116:119], v[200:203], v[108:111]
v_mfma_f32_16x16x32_bf16 v[64:67], a[8:11], v[112:115], v[64:67]
v_mfma_f32_16x16x32_bf16 v[68:71], a[8:11], v[116:119], v[68:71]
v_mfma_f32_16x16x32_bf16 v[72:75], a[72:75], v[112:115], v[72:75]
v_mfma_f32_16x16x32_bf16 v[76:79], a[72:75], v[116:119], v[76:79]
ds_read_b128 v[112:115], v3 offset:4096
ds_read_b128 v[116:119], v3 offset:20480
s_waitcnt lgkmcnt(2)
v_mfma_f32_16x16x32_bf16 v[80:83], a[140:143], v[120:123], v[80:83]
v_mfma_f32_16x16x32_bf16 v[84:87], a[140:143], v[124:127], v[84:87]
v_mfma_f32_16x16x32_bf16 v[88:91], a[204:207], v[120:123], v[88:91]
v_mfma_f32_16x16x32_bf16 v[92:95], a[204:207], v[124:127], v[92:95]
v_mfma_f32_16x16x32_bf16 v[96:99], v[120:123], v[140:143], v[96:99]
v_mfma_f32_16x16x32_bf16 v[100:103], v[124:127], v[140:143], v[100:103]
v_mfma_f32_16x16x32_bf16 v[104:107], v[120:123], v[204:207], v[104:107]
v_mfma_f32_16x16x32_bf16 v[108:111], v[124:127], v[204:207], v[108:111]
v_mfma_f32_16x16x32_bf16 v[64:67], a[12:15], v[120:123], v[64:67]
v_mfma_f32_16x16x32_bf16 v[68:71], a[12:15], v[124:127], v[68:71]
v_mfma_f32_16x16x32_bf16 v[72:75], a[76:79], v[120:123], v[72:75]
v_mfma_f32_16x16x32_bf16 v[76:79], a[76:79], v[124:127], v[76:79]
ds_read_b128 v[120:123], v3 offset:5120
ds_read_b128 v[124:127], v3 offset:21504
s_waitcnt lgkmcnt(2)
v_mfma_f32_16x16x32_bf16 v[80:83], a[144:147], v[112:115], v[80:83]
v_mfma_f32_16x16x32_bf16 v[84:87], a[144:147], v[116:119], v[84:87]
v_mfma_f32_16x16x32_bf16 v[88:91], a[208:211], v[112:115], v[88:91]
v_mfma_f32_16x16x32_bf16 v[92:95], a[208:211], v[116:119], v[92:95]
v_mfma_f32_16x16x32_bf16 v[96:99], v[112:115], v[144:147], v[96:99]
v_mfma_f32_16x16x32_bf16 v[100:103], v[116:119], v[144:147], v[100:103]
v_mfma_f32_16x16x32_bf16 v[104:107], v[112:115], v[208:211], v[104:107]
v_mfma_f32_16x16x32_bf16 v[108:111], v[116:119], v[208:211], v[108:111]
v_mfma_f32_16x16x32_bf16 v[64:67], a[16:19], v[112:115], v[64:67]
v_mfma_f32_16x16x32_bf16 v[68:71], a[16:19], v[116:119], v[68:71]
v_mfma_f32_16x16x32_bf16 v[72:75], a[80:83], v[112:115], v[72:75]
v_mfma_f32_16x16x32_bf16 v[76:79], a[80:83], v[116:119], v[76:79]
ds_read_b128 v[112:115], v3 offset:6144
ds_read_b128 v[116:119], v3 offset:22528
s_waitcnt lgkmcnt(2)
v_mfma_f32_16x16x32_bf16 v[80:83], a[148:151], v[120:123], v[80:83]
v_mfma_f32_16x16x32_bf16 v[84:87], a[148:151], v[124:127], v[84:87]
v_mfma_f32_16x16x32_bf16 v[88:91], a[212:215], v[120:123], v[88:91]
v_mfma_f32_16x16x32_bf16 v[92:95], a[212:215], v[124:127], v[92:95]
v_mfma_f32_16x16x32_bf16 v[96:99], v[120:123], v[148:151], v[96:99]
v_mfma_f32_16x16x32_bf16 v[100:103], v[124:127], v[148:151], v[100:103]
v_mfma_f32_16x16x32_bf16 v[104:107], v[120:123], v[212:215], v[104:107]
v_mfma_f32_16x16x32_bf16 v[108:111], v[124:127], v[212:215], v[108:111]
v_mfma_f32_16x16x32_bf16 v[64:67], a[20:23], v[120:123], v[64:67]
v_mfma_f32_16x16x32_bf16 v[68:71], a[20:23], v[124:127], v[68:71]
v_mfma_f32_16x16x32_bf16 v[72:75], a[84:87], v[120:123], v[72:75]
v_mfma_f32_16x16x32_bf16 v[76:79], a[84:87], v[124:127], v[76:79]
ds_read_b128 v[120:123], v3 offset:7168
ds_read_b128 v[124:127], v3 offset:23552
s_waitcnt lgkmcnt(2)
v_mfma_f32_16x16x32_bf16 v[80:83], a[152:155], v[112:115], v[80:83]
v_mfma_f32_16x16x32_bf16 v[84:87], a[152:155], v[116:119], v[84:87]
v_mfma_f32_16x16x32_bf16 v[88:91], a[216:219], v[112:115], v[88:91]
v_mfma_f32_16x16x32_bf16 v[92:95], a[216:219], v[116:119], v[92:95]
v_mfma_f32_16x16x32_bf16 v[96:99], v[112:115], v[152:155], v[96:99]
v_mfma_f32_16x16x32_bf16 v[100:103], v[116:119], v[152:155], v[100:103]
v_mfma_f32_16x16x32_bf16 v[104:107], v[112:115], v[216:219], v[104:107]
v_mfma_f32_16x16x32_bf16 v[108:111], v[116:119], v[216:219], v[108:111]
v_mfma_f32_16x16x32_bf16 v[64:67], a[24:27], v[112:115], v[64:67]
v_mfma_f32_16x16x32_bf16 v[68:71], a[24:27], v[116:119], v[68:71]
v_mfma_f32_16x16x32_bf16 v[72:75], a[88:91], v[112:115], v[72:75]
v_mfma_f32_16x16x32_bf16 v[76:79], a[88:91], v[116:119], v[76:79]
ds_read_b128 v[112:115], v3 offset:8192
ds_read_b128 v[116:119], v3 offset:24576
s_waitcnt lgkmcnt(2)
v_mfma_f32_16x16x32_bf16 v[80:83], a[156:159], v[120:123], v[80:83]
v_mfma_f32_16x16x32_bf16 v[84:87], a[156:159], v[124:127], v[84:87]
v_mfma_f32_16x16x32_bf16 v[88:91], a[220:223], v[120:123], v[88:91]
v_mfma_f32_16x16x32_bf16 v[92:95], a[220:223], v[124:127], v[92:95]
v_mfma_f32_16x16x32_bf16 v[96:99], v[120:123], v[156:159], v[96:99]
v_mfma_f32_16x16x32_bf16 v[100:103], v[124:127], v[156:159], v[100:103]
v_mfma_f32_16x16x32_bf16 v[104:107], v[120:123], v[220:223], v[104:107]
v_mfma_f32_16x16x32_bf16 v[108:111], v[124:127], v[220:223], v[108:111]
v_mfma_f32_16x16x32_bf16 v[64:67], a[28:31], v[120:123], v[64:67]
v_mfma_f32_16x16x32_bf16 v[68:71], a[28:31], v[124:127], v[68:71]
v_mfma_f32_16x16x32_bf16 v[72:75], a[92:95], v[120:123], v[72:75]
v_mfma_f32_16x16x32_bf16 v[76:79], a[92:95], v[124:127], v[76:79]
s_waitcnt vmcnt(0)
s_barrier
s_cmp_lt_u32 s17, 7
s_cbranch_scc1 L_qkv_nf
s_sub_u32 s21, s17, 7
s_cmp_lg_u32 s14, 0
s_cbranch_scc1 L_qkv_nf
s_lshl_b32 s20, s21, 2
s_add_u32 s20, s20, s23
v_mov_b32 v13, s20
s_mov_b64 exec, 1
global_store_dword v13, v14, s[4:5] sc1
s_mov_b64 exec, -1
L_qkv_nf:
ds_read_b128 v[120:123], v3 offset:9216
ds_read_b128 v[124:127], v3 offset:25600
s_waitcnt lgkmcnt(2)
v_mfma_f32_16x16x32_bf16 v[80:83], a[160:163], v[112:115], v[80:83]
v_mfma_f32_16x16x32_bf16 v[84:87], a[160:163], v[116:119], v[84:87]
v_mfma_f32_16x16x32_bf16 v[88:91], a[224:227], v[112:115], v[88:91]
v_mfma_f32_16x16x32_bf16 v[92:95], a[224:227], v[116:119], v[92:95]
v_mfma_f32_16x16x32_bf16 v[96:99], v[112:115], v[160:163], v[96:99]
v_mfma_f32_16x16x32_bf16 v[100:103], v[116:119], v[160:163], v[100:103]
v_mfma_f32_16x16x32_bf16 v[104:107], v[112:115], v[224:227], v[104:107]
v_mfma_f32_16x16x32_bf16 v[108:111], v[116:119], v[224:227], v[108:111]
v_mfma_f32_16x16x32_bf16 v[64:67], a[32:35], v[112:115], v[64:67]
v_mfma_f32_16x16x32_bf16 v[68:71], a[32:35], v[116:119], v[68:71]
v_mfma_f32_16x16x32_bf16 v[72:75], a[96:99], v[112:115], v[72:75]
v_mfma_f32_16x16x32_bf16 v[76:79], a[96:99], v[116:119], v[76:79]
ds_read_b128 v[112:115], v3 offset:10240
ds_read_b128 v[116:119], v3 offset:26624
s_waitcnt lgkmcnt(2)
v_mfma_f32_16x16x32_bf16 v[80:83], a[164:167], v[120:123], v[80:83]
v_mfma_f32_16x16x32_bf16 v[84:87], a[164:167], v[124:127], v[84:87]
v_mfma_f32_16x16x32_bf16 v[88:91], a[228:231], v[120:123], v[88:91]
v_mfma_f32_16x16x32_bf16 v[92:95], a[228:231], v[124:127], v[92:95]
v_mfma_f32_16x16x32_bf16 v[96:99], v[120:123], v[164:167], v[96:99]
v_mfma_f32_16x16x32_bf16 v[100:103], v[124:127], v[164:167], v[100:103]
v_mfma_f32_16x16x32_bf16 v[104:107], v[120:123], v[228:231], v[104:107]
v_mfma_f32_16x16x32_bf16 v[108:111], v[124:127], v[228:231], v[108:111]
v_mfma_f32_16x16x32_bf16 v[64:67], a[36:39], v[120:123], v[64:67]
v_mfma_f32_16x16x32_bf16 v[68:71], a[36:39], v[124:127], v[68:71]
v_mfma_f32_16x16x32_bf16 v[72:75], a[100:103], v[120:123], v[72:75]
v_mfma_f32_16x16x32_bf16 v[76:79], a[100:103], v[124:127], v[76:79]
ds_read_b128 v[120:123], v3 offset:11264
ds_read_b128 v[124:127], v3 offset:27648
s_waitcnt lgkmcnt(2)
v_mfma_f32_16x16x32_bf16 v[80:83], a[168:171], v[112:115], v[80:83]
v_mfma_f32_16x16x32_bf16 v[84:87], a[168:171], v[116:119], v[84:87]
v_mfma_f32_16x16x32_bf16 v[88:91], a[232:235], v[112:115], v[88:91]
v_mfma_f32_16x16x32_bf16 v[92:95], a[232:235], v[116:119], v[92:95]
v_mfma_f32_16x16x32_bf16 v[96:99], v[112:115], v[168:171], v[96:99]
v_mfma_f32_16x16x32_bf16 v[100:103], v[116:119], v[168:171], v[100:103]
v_mfma_f32_16x16x32_bf16 v[104:107], v[112:115], v[232:235], v[104:107]
v_mfma_f32_16x16x32_bf16 v[108:111], v[116:119], v[232:235], v[108:111]
v_mfma_f32_16x16x32_bf16 v[64:67], a[40:43], v[112:115], v[64:67]
v_mfma_f32_16x16x32_bf16 v[68:71], a[40:43], v[116:119], v[68:71]
v_mfma_f32_16x16x32_bf16 v[72:75], a[104:107], v[112:115], v[72:75]
v_mfma_f32_16x16x32_bf16 v[76:79], a[104:107], v[116:119], v[76:79]
ds_read_b128 v[112:115], v3 offset:12288
ds_read_b128 v[116:119], v3 offset:28672
s_waitcnt lgkmcnt(2)
v_mfma_f32_16x16x32_bf16 v[80:83], a[172:175], v[120:123], v[80:83]
v_mfma_f32_16x16x32_bf16 v[84:87], a[172:175], v[124:127], v[84:87]
v_mfma_f32_16x16x32_bf16 v[88:91], a[236:239], v[120:123], v[88:91]
v_mfma_f32_16x16x32_bf16 v[92:95], a[236:239], v[124:127], v[92:95]
v_mfma_f32_16x16x32_bf16 v[96:99], v[120:123], v[172:175], v[96:99]
v_mfma_f32_16x16x32_bf16 v[100:103], v[124:127], v[172:175], v[100:103]
v_mfma_f32_16x16x32_bf16 v[104:107], v[120:123], v[236:239], v[104:107]
v_mfma_f32_16x16x32_bf16 v[108:111], v[124:127], v[236:239], v[108:111]
v_mfma_f32_16x16x32_bf16 v[64:67], a[44:47], v[120:123], v[64:67]
v_mfma_f32_16x16x32_bf16 v[68:71], a[44:47], v[124:127], v[68:71]
v_mfma_f32_16x16x32_bf16 v[72:75], a[108:111], v[120:123], v[72:75]
v_mfma_f32_16x16x32_bf16 v[76:79], a[108:111], v[124:127], v[76:79]
ds_read_b128 v[120:123], v3 offset:13312
ds_read_b128 v[124:127], v3 offset:29696
s_waitcnt lgkmcnt(2)
v_mfma_f32_16x16x32_bf16 v[80:83], a[176:179], v[112:115], v[80:83]
v_mfma_f32_16x16x32_bf16 v[84:87], a[176:179], v[116:119], v[84:87]
v_mfma_f32_16x16x32_bf16 v[88:91], a[240:243], v[112:115], v[88:91]
v_mfma_f32_16x16x32_bf16 v[92:95], a[240:243], v[116:119], v[92:95]
v_mfma_f32_16x16x32_bf16 v[96:99], v[112:115], v[176:179], v[96:99]
v_mfma_f32_16x16x32_bf16 v[100:103], v[116:119], v[176:179], v[100:103]
v_mfma_f32_16x16x32_bf16 v[104:107], v[112:115], v[240:243], v[104:107]
v_mfma_f32_16x16x32_bf16 v[108:111], v[116:119], v[240:243], v[108:111]
v_mfma_f32_16x16x32_bf16 v[64:67], a[48:51], v[112:115], v[64:67]
v_mfma_f32_16x16x32_bf16 v[68:71], a[48:51], v[116:119], v[68:71]
v_mfma_f32_16x16x32_bf16 v[72:75], a[112:115], v[112:115], v[72:75]
v_mfma_f32_16x16x32_bf16 v[76:79], a[112:115], v[116:119], v[76:79]
ds_read_b128 v[112:115], v3 offset:14336
ds_read_b128 v[116:119], v3 offset:30720
s_waitcnt lgkmcnt(2)
v_mfma_f32_16x16x32_bf16 v[80:83], a[180:183], v[120:123], v[80:83]
v_mfma_f32_16x16x32_bf16 v[84:87], a[180:183], v[124:127], v[84:87]
v_mfma_f32_16x16x32_bf16 v[88:91], a[244:247], v[120:123], v[88:91]
v_mfma_f32_16x16x32_bf16 v[92:95], a[244:247], v[124:127], v[92:95]
v_mfma_f32_16x16x32_bf16 v[96:99], v[120:123], v[180:183], v[96:99]
v_mfma_f32_16x16x32_bf16 v[100:103], v[124:127], v[180:183], v[100:103]
v_mfma_f32_16x16x32_bf16 v[104:107], v[120:123], v[244:247], v[104:107]
v_mfma_f32_16x16x32_bf16 v[108:111], v[124:127], v[244:247], v[108:111]
v_mfma_f32_16x16x32_bf16 v[64:67], a[52:55], v[120:123], v[64:67]
v_mfma_f32_16x16x32_bf16 v[68:71], a[52:55], v[124:127], v[68:71]
v_mfma_f32_16x16x32_bf16 v[72:75], a[116:119], v[120:123], v[72:75]
v_mfma_f32_16x16x32_bf16 v[76:79], a[116:119], v[124:127], v[76:79]
ds_read_b128 v[120:123], v3 offset:15360
ds_read_b128 v[124:127], v3 offset:31744
s_waitcnt lgkmcnt(2)
v_mfma_f32_16x16x32_bf16 v[80:83], a[184:187], v[112:115], v[80:83]
v_mfma_f32_16x16x32_bf16 v[84:87], a[184:187], v[116:119], v[84:87]
v_mfma_f32_16x16x32_bf16 v[88:91], a[248:251], v[112:115], v[88:91]
v_mfma_f32_16x16x32_bf16 v[92:95], a[248:251], v[116:119], v[92:95]
v_mfma_f32_16x16x32_bf16 v[96:99], v[112:115], v[184:187], v[96:99]
v_mfma_f32_16x16x32_bf16 v[100:103], v[116:119], v[184:187], v[100:103]
v_mfma_f32_16x16x32_bf16 v[104:107], v[112:115], v[248:251], v[104:107]
v_mfma_f32_16x16x32_bf16 v[108:111], v[116:119], v[248:251], v[108:111]
v_mfma_f32_16x16x32_bf16 v[64:67], a[56:59], v[112:115], v[64:67]
v_mfma_f32_16x16x32_bf16 v[68:71], a[56:59], v[116:119], v[68:71]
v_mfma_f32_16x16x32_bf16 v[72:75], a[120:123], v[112:115], v[72:75]
v_mfma_f32_16x16x32_bf16 v[76:79], a[120:123], v[116:119], v[76:79]
s_waitcnt lgkmcnt(0)
v_mfma_f32_16x16x32_bf16 v[80:83], a[188:191], v[120:123], v[80:83]
v_mfma_f32_16x16x32_bf16 v[84:87], a[188:191], v[124:127], v[84:87]
v_mfma_f32_16x16x32_bf16 v[88:91], a[252:255], v[120:123], v[88:91]
v_mfma_f32_16x16x32_bf16 v[92:95], a[252:255], v[124:127], v[92:95]
v_mfma_f32_16x16x32_bf16 v[96:99], v[120:123], v[188:191], v[96:99]
v_mfma_f32_16x16x32_bf16 v[100:103], v[124:127], v[188:191], v[100:103]
v_mfma_f32_16x16x32_bf16 v[104:107], v[120:123], v[252:255], v[104:107]
v_mfma_f32_16x16x32_bf16 v[108:111], v[124:127], v[252:255], v[108:111]
v_mfma_f32_16x16x32_bf16 v[64:67], a[60:63], v[120:123], v[64:67]
v_mfma_f32_16x16x32_bf16 v[68:71], a[60:63], v[124:127], v[68:71]
v_mfma_f32_16x16x32_bf16 v[72:75], a[124:127], v[120:123], v[72:75]
v_mfma_f32_16x16x32_bf16 v[76:79], a[124:127], v[124:127], v[76:79]
s_lshl_b32 s20, s17, 5
s_add_u32 s20, s20, s12
s_mul_i32 s20, s20, 24576
s_add_u32 s20, s20, 0x1000000
v_add_u32 v8, s20, v4
v_add_u32 v9, s20, v6
v_add_u32 v10, 4096, v8
v_add_u32 v11, 16384, v8
v_add_u32 v12, 20480, v8
v_mul_f32 v80, s22, v80
v_mul_f32 v81, s22, v81
v_mul_f32 v82, s22, v82
v_mul_f32 v83, s22, v83
v_mul_f32 v84, s22, v84
v_mul_f32 v85, s22, v85
v_mul_f32 v86, s22, v86
v_mul_f32 v87, s22, v87
v_mul_f32 v88, s22, v88
v_mul_f32 v89, s22, v89
v_mul_f32 v90, s22, v90
v_mul_f32 v91, s22, v91
v_mul_f32 v92, s22, v92
v_mul_f32 v93, s22, v93
v_mul_f32 v94, s22, v94
v_mul_f32 v95, s22, v95
v_cvt_pk_bf16_f32 v40, v80, v88
v_cvt_pk_bf16_f32 v41, v81, v89
v_cvt_pk_bf16_f32 v42, v82, v90
v_cvt_pk_bf16_f32 v43, v83, v91
global_store_dwordx4 v8, v[40:43], s[4:5] sc1
v_cvt_pk_bf16_f32 v44, v84, v92
v_cvt_pk_bf16_f32 v45, v85, v93
v_cvt_pk_bf16_f32 v46, v86, v94
v_cvt_pk_bf16_f32 v47, v87, v95
global_store_dwordx4 v10, v[44:47], s[4:5] sc1
v_cvt_pk_bf16_f32 v48, v96, v97
v_cvt_pk_bf16_f32 v49, v98, v99
v_cvt_pk_bf16_f32 v50, v100, v101
v_cvt_pk_bf16_f32 v51, v102, v103
global_store_dwordx4 v9, v[48:51], s[4:5] offset:0 sc1
v_cvt_pk_bf16_f32 v52, v104, v105
v_cvt_pk_bf16_f32 v53, v106, v107
v_cvt_pk_bf16_f32 v54, v108, v109
v_cvt_pk_bf16_f32 v55, v110, v111
global_store_dwordx4 v9, v[52:55], s[4:5] offset:1024 sc1
v_cvt_pk_bf16_f32 v56, v64, v72
v_cvt_pk_bf16_f32 v57, v65, v73
v_cvt_pk_bf16_f32 v58, v66, v74
v_cvt_pk_bf16_f32 v59, v67, v75
global_store_dwordx4 v11, v[56:59], s[4:5] sc1
v_cvt_pk_bf16_f32 v60, v68, v76
v_cvt_pk_bf16_f32 v61, v69, v77
v_cvt_pk_bf16_f32 v62, v70, v78
v_cvt_pk_bf16_f32 v63, v71, v79
global_store_dwordx4 v12, v[60:63], s[4:5] sc1
v_xor_b32 v3, 0x20000, v3
s_mov_b32 s21, s17
s_mov_b32 s17, s19
s_cmp_lt_u32 s17, 64
s_cbranch_scc1 L_qkv_loop
s_waitcnt vmcnt(0)
s_barrier
s_cmp_lg_u32 s14, 0
s_cbranch_scc1 L_qkv_nf2
s_lshl_b32 s20, s21, 2
s_add_u32 s20, s20, s23
v_mov_b32 v13, s20
s_mov_b64 exec, 1
global_store_dword v13, v14, s[4:5] sc1
s_mov_b64 exec, -1
L_qkv_nf2:
s_cmp_lt_u32 s13, 5
s_cbranch_scc1 L_notatt
s_sub_u32 s34, s13, 5
v_mov_b32 v18, 0x0
v_bfe_i32 v2, v0, 0, 1
v_and_b32 v2, 0x10, v2
v_xor_b32 v18, v18, v2
v_bfe_i32 v2, v0, 1, 1
v_and_b32 v2, 0x20, v2
v_xor_b32 v18, v18, v2
v_bfe_i32 v2, v0, 2, 1
v_and_b32 v2, 0x40, v2
v_xor_b32 v18, v18, v2
v_bfe_i32 v2, v0, 3, 1
v_and_b32 v2, 0x80, v2
v_xor_b32 v18, v18, v2
v_bfe_i32 v2, v0, 4, 1
v_and_b32 v2, 0x100, v2
v_xor_b32 v18, v18, v2
v_bfe_i32 v2, v0, 5, 1
v_and_b32 v2, 0x200, v2
v_xor_b32 v18, v18, v2
v_mov_b32 v19, 0x0
v_bfe_i32 v2, v0, 0, 1
v_and_b32 v2, 0x10, v2
v_xor_b32 v19, v19, v2
v_bfe_i32 v2, v0, 1, 1
v_and_b32 v2, 0x20, v2
v_xor_b32 v19, v19, v2
v_bfe_i32 v2, v0, 2, 1
v_and_b32 v2, 0x40, v2
v_xor_b32 v19, v19, v2
v_bfe_i32 v2, v0, 3, 1
v_and_b32 v2, 0x80, v2
v_xor_b32 v19, v19, v2
v_bfe_i32 v2, v0, 4, 1
v_and_b32 v2, 0x100, v2
v_xor_b32 v19, v19, v2
v_bfe_i32 v2, v0, 5, 1
v_and_b32 v2, 0x200, v2
v_xor_b32 v19, v19, v2
v_bfe_i32 v2, v0, 6, 1
v_and_b32 v2, 0x800, v2
v_xor_b32 v19, v19, v2
v_bfe_i32 v2, v0, 7, 1
v_and_b32 v2, 0x1000, v2
v_xor_b32 v19, v19, v2
v_mov_b32 v20, 0x0
v_bfe_i32 v2, v0, 0, 1
v_and_b32 v2, 0x10, v2
v_xor_b32 v20, v20, v2
v_bfe_i32 v2, v0, 1, 1
v_and_b32 v2, 0x20, v2
v_xor_b32 v20, v20, v2
v_bfe_i32 v2, v0, 2, 1
v_and_b32 v2, 0x40, v2
v_xor_b32 v20, v20, v2
v_bfe_i32 v2, v0, 3, 1
v_and_b32 v2, 0x80, v2
v_xor_b32 v20, v20, v2
v_bfe_i32 v2, v0, 4, 1
v_and_b32 v2, 0x100, v2
v_xor_b32 v20, v20, v2
v_bfe_i32 v2, v0, 5, 1
v_and_b32 v2, 0x200, v2
v_xor_b32 v20, v20, v2
v_bfe_i32 v2, v0, 6, 1
v_and_b32 v2, 0x400, v2
v_xor_b32 v20, v20, v2
v_bfe_i32 v2, v0, 7, 1
v_and_b32 v2, 0x800, v2
v_xor_b32 v20, v20, v2
v_mov_b32 v21, 0x0
v_bfe_i32 v2, v0, 0, 1
v_and_b32 v2, 0x4, v2
v_xor_b32 v21, v21, v2
v_bfe_i32 v2, v0, 1, 1
v_and_b32 v2, 0x8, v2
v_xor_b32 v21, v21, v2
v_bfe_i32 v2, v0, 2, 1
v_and_b32 v2, 0x10, v2
v_xor_b32 v21, v21, v2
v_bfe_i32 v2, v0, 3, 1
v_and_b32 v2, 0x20, v2
v_xor_b32 v21, v21, v2
v_bfe_i32 v2, v0, 6, 1
v_and_b32 v2, 0x40, v2
v_xor_b32 v21, v21, v2
v_bfe_i32 v2, v0, 7, 1
v_and_b32 v2, 0x80, v2
v_xor_b32 v21, v21, v2
v_bfe_u32 v2, v0, 4, 2
v_mul_u32_u24 v2, 576, v2
v_add_u32 v21, v21, v2
v_add_u32 v21, 8192, v21
v_mov_b32 v22, 0x0
v_bfe_i32 v2, v0, 4, 1
v_and_b32 v2, 0x10, v2
v_xor_b32 v22, v22, v2
v_bfe_i32 v2, v0, 5, 1
v_and_b32 v2, 0x20, v2
v_xor_b32 v22, v22, v2
v_mov_b32 v23, 0x0
v_bfe_i32 v2, v0, 0, 1
v_and_b32 v2, 0x1, v2
v_xor_b32 v23, v23, v2
v_bfe_i32 v2, v0, 2, 1
v_and_b32 v2, 0x2, v2
v_xor_b32 v23, v23, v2
v_bfe_i32 v2, v0, 3, 1
v_and_b32 v2, 0x4, v2
v_xor_b32 v23, v23, v2
v_mul_u32_u24 v23, 288, v23
v_add_u32 v22, v22, v23
v_add_u32 v22, 8192, v22
v_mov_b32 v1, 0x4444
v_bfe_i32 v2, v0, 1, 1
v_and_b32 v2, 0xaaaa, v2
v_xor_b32 v1, v1, v2
v_and_b32 v2, 15, v0
v_bfe_u32 v23, v0, 4, 2
v_lshlrev_b32 v23, 2, v23
v_add_u32 v24, 0, v23
v_cmp_gt_u32 s[60:61], v24, v2
v_add_u32 v24, 1, v23
v_cmp_gt_u32 s[62:63], v24, v2
v_add_u32 v24, 2, v23
v_cmp_gt_u32 s[64:65], v24, v2
v_add_u32 v24, 3, v23
v_cmp_gt_u32 s[66:67], v24, v2
v_mov_b32 v4, 0x3f803f80
v_mov_b32 v14, 0
v_mov_b32 v5, 0x3f803f80
v_mov_b32 v15, 0
v_mov_b32 v6, 0x3f803f80
v_mov_b32 v16, 0
v_mov_b32 v7, 0x3f803f80
v_mov_b32 v17, 0
v_mov_b32 v8, 0
v_mov_b32 v9, 0
v_mov_b32 v10, 0
v_mov_b32 v11, 0
v_mov_b32 v12, 0
v_mov_b32 v13, 0
v_mov_b32 v3, 0xff800000
v_mov_b32 v27, 1
v_mov_b32 v2, 0
v_mov_b32 v32, -1
v_mov_b32 v33, -1
v_mov_b32 v34, -1
v_mov_b32 v35, -1
s_add_u32 s3, s34, 60
s_lshl_b32 s3, s3, 18
s_lshl_b32 s10, s12, 12
s_add_u32 s3, s3, s10
s_add_u32 s3, s3, 0x5200000
v_add_u32 v24, s3, v20
v_mov_b32 v28, 2
v_add_u32 v25, 0x0, v24
global_store_dwordx4 v25, v[32:35], s[4:5] sc1
v_add_u32 v25, 0x20000, v24
global_store_dwordx4 v25, v[32:35], s[4:5] sc1
v_add_u32 v25, 0x80000, v24
global_store_dwordx4 v25, v[32:35], s[4:5] sc1
v_add_u32 v25, 0xa0000, v24
global_store_dwordx4 v25, v[32:35], s[4:5] sc1
L_att_tb:
global_load_dword v24, v2, s[28:29] sc1
s_waitcnt vmcnt(0)
v_readfirstlane_b32 s3, v24
s_cmp_ge_u32 s3, 32
s_cbranch_scc1 L_att_tb_ok
s_sleep 8
s_sub_u32 s41, s41, 1
s_cbranch_scc0 L_att_tb
s_mov_b32 s41, 0
L_att_tb_ok:
s_mov_b32 s17, s34
s_mov_b64 s[46:47], 0
s_lshl_b32 s3, s12, 8
s_add_u32 s3, s3, 0x3a0000
v_lshrrev_b32 v26, 2, v18
v_add_u32 v26, s3, v26
s_bitcmp1_b64 s[46:47], s17
s_cbranch_scc1 L_att_kv0_ok
L_att_kv0:
global_load_dword v25, v26, s[4:5] sc1
s_waitcnt vmcnt(0)
v_cmp_eq_u32 s[46:47], 1, v25
s_bitcmp1_b64 s[46:47], s17
s_cbranch_scc1 L_att_kv0_ok
s_sleep 8
s_sub_u32 s41, s41, 1
s_cbranch_scc0 L_att_kv0
s_mov_b32 s41, 0
L_att_kv0_ok:
s_lshl_b32 s3, s17, 5
s_add_u32 s3, s3, s12
s_mul_i32 s3, s3, 24576
s_add_u32 s3, s3, 0x1000000
s_add_u32 s6, s4, s3
s_addc_u32 s7, s5, 0
v_add_u32 v24, 0, v18
global_load_dwordx4 a[0:3], v24, s[6:7] offset:0 sc1
global_load_dwordx4 a[4:7], v24, s[6:7] offset:1024 sc1
global_load_dwordx4 a[8:11], v24, s[6:7] offset:2048 sc1
global_load_dwordx4 a[12:15], v24, s[6:7] offset:3072 sc1
v_add_u32 v24, 4096, v18
global_load_dwordx4 a[16:19], v24, s[6:7] offset:0 sc1
global_load_dwordx4 a[20:23], v24, s[6:7] offset:1024 sc1
global_load_dwordx4 a[24:27], v24, s[6:7] offset:2048 sc1
global_load_dwordx4 a[28:31], v24, s[6:7] offset:3072 sc1
v_add_u32 v24, 16384, v18
global_load_dwordx4 a[32:35], v24, s[6:7] offset:0 sc1
global_load_dwordx4 a[36:39], v24, s[6:7] offset:1024 sc1
global_load_dwordx4 a[40:43], v24, s[6:7] offset:2048 sc1
global_load_dwordx4 a[44:47], v24, s[6:7] offset:3072 sc1
v_add_u32 v24, 20480, v18
global_load_dwordx4 a[48:51], v24, s[6:7] offset:0 sc1
global_load_dwordx4 a[52:55], v24, s[6:7] offset:1024 sc1
global_load_dwordx4 a[56:59], v24, s[6:7] offset:2048 sc1
global_load_dwordx4 a[60:63], v24, s[6:7] offset:3072 sc1
v_add_u32 v24, 8192, v19
global_load_dwordx4 a[64:67], v24, s[6:7] offset:0 sc1
global_load_dwordx4 a[68:71], v24, s[6:7] offset:1024 sc1
s_waitcnt vmcnt(0)
L_att_loop:
s_lshl_b32 s3, s17, 13
s_add_u32 s3, s3, 0x400000
s_add_u32 s8, s4, s3
s_addc_u32 s9, s5, 0
s_lshl_b32 s3, s17, 18
s_lshl_b32 s10, s12, 12
s_add_u32 s3, s3, s10
s_add_u32 s3, s3, 0x5200000
s_add_u32 s10, s4, s3
s_addc_u32 s11, s5, 0
s_add_u32 s18, s17, 2
s_lshl_b32 s3, s17, 7
s_lshl_b32 s19, s12, 2
s_add_u32 s3, s3, s19
s_add_u32 s3, s3, s14
s_lshl_b32 s3, s3, 7
s_add_u32 s3, s3, 0x500000
v_mov_b32 v29, s3
v_mov_b64 v[64:65], 0
v_mov_b64 v[66:67], 0
v_mov_b64 v[68:69], 0
v_mov_b64 v[70:71], 0
v_mov_b64 v[72:73], 0
v_mov_b64 v[74:75], 0
v_mov_b64 v[76:77], 0
v_mov_b64 v[78:79], 0
v_mfma_f32_16x16x32_bf16 v[96:99], a[0:3], a[32:35], 0
v_mfma_f32_16x16x32_bf16 v[100:103], a[0:3], a[48:51], 0
v_mfma_f32_16x16x32_bf16 v[104:107], a[16:19], a[48:51], 0
v_mfma_f32_16x16x32_bf16 v[96:99], a[4:7], a[36:39], v[96:99]
v_mfma_f32_16x16x32_bf16 v[100:103], a[4:7], a[52:55], v[100:103]
v_mfma_f32_16x16x32_bf16 v[104:107], a[20:23], a[52:55], v[104:107]
v_mfma_f32_16x16x32_bf16 v[96:99], a[8:11], a[40:43], v[96:99]
v_mfma_f32_16x16x32_bf16 v[100:103], a[8:11], a[56:59], v[100:103]
v_mfma_f32_16x16x32_bf16 v[104:107], a[24:27], a[56:59], v[104:107]
v_mfma_f32_16x16x32_bf16 v[96:99], a[12:15], a[44:47], v[96:99]
v_mfma_f32_16x16x32_bf16 v[100:103], a[12:15], a[60:63], v[100:103]
v_mfma_f32_16x16x32_bf16 v[104:107], a[28:31], a[60:63], v[104:107]
global_load_dwordx4 v[116:119], v19, s[8:9] sc1
global_load_dwordx4 v[120:123], v19, s[8:9] offset:1024 sc1
s_cmp_ge_u32 s18, 64
s_cbranch_scc1 L_att_nl1
s_bitcmp1_b64 s[46:47], s18
s_cbranch_scc1 L_att_kv1_ok
L_att_kv1:
global_load_dword v25, v26, s[4:5] sc1
s_waitcnt vmcnt(0)
v_cmp_eq_u32 s[46:47], 1, v25
s_bitcmp1_b64 s[46:47], s18
s_cbranch_scc1 L_att_kv1_ok
s_sleep 8
s_sub_u32 s41, s41, 1
s_cbranch_scc0 L_att_kv1
s_mov_b32 s41, 0
L_att_kv1_ok:
s_lshl_b32 s3, s18, 5
s_add_u32 s3, s3, s12
s_mul_i32 s3, s3, 24576
s_add_u32 s3, s3, 0x1000000
s_add_u32 s6, s4, s3
s_addc_u32 s7, s5, 0
v_add_u32 v24, 0, v18
global_load_dwordx4 a[0:3], v24, s[6:7] offset:0 sc1
global_load_dwordx4 a[4:7], v24, s[6:7] offset:1024 sc1
global_load_dwordx4 a[8:11], v24, s[6:7] offset:2048 sc1
global_load_dwordx4 a[12:15], v24, s[6:7] offset:3072 sc1
v_add_u32 v24, 4096, v18
global_load_dwordx4 a[16:19], v24, s[6:7] offset:0 sc1
global_load_dwordx4 a[20:23], v24, s[6:7] offset:1024 sc1
global_load_dwordx4 a[24:27], v24, s[6:7] offset:2048 sc1
global_load_dwordx4 a[28:31], v24, s[6:7] offset:3072 sc1
v_add_u32 v24, 16384, v18
global_load_dwordx4 a[72:75], v24, s[6:7] offset:0 sc1
global_load_dwordx4 a[76:79], v24, s[6:7] offset:1024 sc1
global_load_dwordx4 a[80:83], v24, s[6:7] offset:2048 sc1
global_load_dwordx4 a[84:87], v24, s[6:7] offset:3072 sc1
v_add_u32 v24, 20480, v18
global_load_dwordx4 a[88:91], v24, s[6:7] offset:0 sc1
global_load_dwordx4 a[92:95], v24, s[6:7] offset:1024 sc1
global_load_dwordx4 a[96:99], v24, s[6:7] offset:2048 sc1
global_load_dwordx4 a[100:103], v24, s[6:7] offset:3072 sc1
v_add_u32 v24, 8192, v19
global_load_dwordx4 a[104:107], v24, s[6:7] offset:0 sc1
global_load_dwordx4 a[108:111], v24, s[6:7] offset:1024 sc1
s_waitcnt vmcnt(18)
s_branch L_att_nl2
L_att_nl1:
s_waitcnt vmcnt(0)
L_att_nl2:
v_cndmask_b32 v96, v96, v3, s[60:61]
v_cndmask_b32 v97, v97, v3, s[62:63]
v_cndmask_b32 v98, v98, v3, s[64:65]
v_cndmask_b32 v99, v99, v3, s[66:67]
v_cndmask_b32 v104, v104, v3, s[60:61]
v_cndmask_b32 v105, v105, v3, s[62:63]
v_cndmask_b32 v106, v106, v3, s[64:65]
v_cndmask_b32 v107, v107, v3, s[66:67]
v_max3_f32 v124, v96, v97, v98
v_max_f32 v124, v124, v99
v_max3_f32 v125, v100, v101, v102
v_max3_f32 v125, v125, v103, v104
v_max3_f32 v125, v125, v105, v106
v_max_f32 v125, v125, v107
v_max3_u32 v24, v116, v117, v118
v_max3_u32 v25, v119, v120, v121
v_max3_u32 v24, v24, v122, v123
v_max_u32 v24, v24, v25
v_cmp_eq_u32 vcc, -1, v24
s_cmp_eq_u64 vcc, 0
s_cbranch_scc1 L_att_mem_ok
s_cmp_ge_u32 s17, 62
s_cbranch_scc1 L_att_fast
L_att_mem:
global_load_dwordx4 v[116:119], v19, s[8:9] sc1
global_load_dwordx4 v[120:123], v19, s[8:9] offset:1024 sc1
s_waitcnt vmcnt(0)
v_max3_u32 v24, v116, v117, v118
v_max3_u32 v25, v119, v120, v121
v_max3_u32 v24, v24, v122, v123
v_max_u32 v24, v24, v25
v_cmp_eq_u32 vcc, -1, v24
s_cmp_eq_u64 vcc, 0
s_cbranch_scc1 L_att_mem_ok
s_sleep 12
s_sub_u32 s41, s41, 1
s_cbranch_scc0 L_att_mem
s_mov_b32 s41, 0
L_att_mem_ok:
s_branch L_att_go
L_att_fast:
global_load_dwordx4 v[116:119], v19, s[8:9] sc1
global_load_dwordx4 v[120:123], v19, s[8:9] offset:1024 sc1
s_nop 15
s_nop 15
s_nop 15
global_load_dwordx4 v[116:119], v19, s[8:9] sc1
global_load_dwordx4 v[120:123], v19, s[8:9] offset:1024 sc1
s_nop 15
s_nop 15
s_nop 15
L_att_f1:
global_load_dwordx4 v[116:119], v19, s[8:9] sc1
global_load_dwordx4 v[120:123], v19, s[8:9] offset:1024 sc1
s_waitcnt vmcnt(4)
v_max3_u32 v24, v116, v117, v118
v_max3_u32 v25, v119, v120, v121
v_max3_u32 v24, v24, v122, v123
v_max_u32 v24, v24, v25
v_cmp_eq_u32 vcc, -1, v24
s_cmp_eq_u64 vcc, 0
s_cbranch_scc1 L_att_go
s_sub_u32 s41, s41, 1
s_cbranch_scc0 L_att_f1
s_mov_b32 s41, 0
L_att_go:
ds_write_b128 v19, v[116:119] offset:0
ds_write_b128 v19, v[120:123] offset:1024
s_waitcnt lgkmcnt(0)
s_barrier
ds_read_b128 v[32:35], v18 offset:0
ds_read_b128 v[36:39], v18 offset:1024
ds_read_b128 v[40:43], v18 offset:2048
ds_read_b128 v[44:47], v18 offset:3072
ds_read_b128 v[48:51], v18 offset:4096
ds_read_b128 v[52:55], v18 offset:5120
ds_read_b128 v[56:59], v18 offset:6144
ds_read_b128 v[60:63], v18 offset:7168
s_waitcnt lgkmcnt(7)
v_smfmac_f32_16x16x64_bf16 v[64:67], v[32:35], a[128:135], v1
v_smfmac_f32_16x16x64_bf16 v[68:71], v[32:35], a[192:199], v1
s_waitcnt lgkmcnt(6)
v_smfmac_f32_16x16x64_bf16 v[64:67], v[36:39], a[136:143], v1
v_smfmac_f32_16x16x64_bf16 v[68:71], v[36:39], a[200:207], v1
s_waitcnt lgkmcnt(5)
v_smfmac_f32_16x16x64_bf16 v[64:67], v[40:43], a[144:151], v1
v_smfmac_f32_16x16x64_bf16 v[68:71], v[40:43], a[208:215], v1
s_waitcnt lgkmcnt(4)
v_smfmac_f32_16x16x64_bf16 v[64:67], v[44:47], a[152:159], v1
v_smfmac_f32_16x16x64_bf16 v[68:71], v[44:47], a[216:223], v1
s_waitcnt lgkmcnt(3)
v_smfmac_f32_16x16x64_bf16 v[64:67], v[48:51], a[160:167], v1
v_smfmac_f32_16x16x64_bf16 v[68:71], v[48:51], a[224:231], v1
s_waitcnt lgkmcnt(2)
v_smfmac_f32_16x16x64_bf16 v[64:67], v[52:55], a[168:175], v1
v_smfmac_f32_16x16x64_bf16 v[68:71], v[52:55], a[232:239], v1
s_waitcnt lgkmcnt(1)
v_smfmac_f32_16x16x64_bf16 v[64:67], v[56:59], a[176:183], v1
v_smfmac_f32_16x16x64_bf16 v[68:71], v[56:59], a[240:247], v1
s_waitcnt lgkmcnt(0)
v_smfmac_f32_16x16x64_bf16 v[64:67], v[60:63], a[184:191], v1
v_smfmac_f32_16x16x64_bf16 v[68:71], v[60:63], a[248:255], v1
v_smfmac_f32_16x16x64_bf16 v[72:75], v[32:35], v[128:135], v1
v_smfmac_f32_16x16x64_bf16 v[76:79], v[32:35], v[192:199], v1
v_add_f32 v64, v64, v66
v_add_f32 v65, v65, v67
v_add_f32 v68, v68, v70
v_add_f32 v69, v69, v71
v_mul_f32 v64, s22, v64
v_mul_f32 v65, s22, v65
v_mul_f32 v68, s22, v68
v_mul_f32 v69, s22, v69
v_cvt_pk_bf16_f32 v66, v64, v68
v_cvt_pk_bf16_f32 v67, v65, v69
ds_write2_b32 v21, v66, v67 offset0:0 offset1:72
v_smfmac_f32_16x16x64_bf16 v[72:75], v[36:39], v[136:143], v1
v_smfmac_f32_16x16x64_bf16 v[76:79], v[36:39], v[200:207], v1
v_smfmac_f32_16x16x64_bf16 v[72:75], v[40:43], v[144:151], v1
v_smfmac_f32_16x16x64_bf16 v[76:79], v[40:43], v[208:215], v1
s_waitcnt lgkmcnt(0)
s_barrier
v_smfmac_f32_16x16x64_bf16 v[72:75], v[44:47], v[152:159], v1
ds_read_b128 v[80:83], v22 offset:0
ds_read_b128 v[84:87], v22 offset:64
v_smfmac_f32_16x16x64_bf16 v[76:79], v[44:47], v[216:223], v1
ds_read_b128 v[88:91], v22 offset:128
ds_read_b128 v[92:95], v22 offset:192
v_smfmac_f32_16x16x64_bf16 v[72:75], v[48:51], v[160:167], v1
v_smfmac_f32_16x16x64_bf16 v[76:79], v[48:51], v[224:231], v1
v_smfmac_f32_16x16x64_bf16 v[72:75], v[52:55], v[168:175], v1
s_waitcnt lgkmcnt(0)
v_mfma_f32_16x16x32_bf16 v[108:111], v[80:83], a[32:35], 0
v_mfma_f32_16x16x32_bf16 v[112:115], v[80:83], a[48:51], 0
v_mfma_f32_16x16x32_bf16 v[108:111], v[84:87], a[36:39], v[108:111]
v_mfma_f32_16x16x32_bf16 v[112:115], v[84:87], a[52:55], v[112:115]
v_mfma_f32_16x16x32_bf16 v[108:111], v[88:91], a[40:43], v[108:111]
v_mfma_f32_16x16x32_bf16 v[112:115], v[88:91], a[56:59], v[112:115]
v_mfma_f32_16x16x32_bf16 v[108:111], v[92:95], a[44:47], v[108:111]
v_mfma_f32_16x16x32_bf16 v[112:115], v[92:95], a[60:63], v[112:115]
v_smfmac_f32_16x16x64_bf16 v[76:79], v[52:55], v[232:239], v1
v_smfmac_f32_16x16x64_bf16 v[72:75], v[56:59], v[176:183], v1
v_smfmac_f32_16x16x64_bf16 v[76:79], v[56:59], v[240:247], v1
v_smfmac_f32_16x16x64_bf16 v[72:75], v[60:63], v[184:191], v1
v_smfmac_f32_16x16x64_bf16 v[76:79], v[60:63], v[248:255], v1
s_cmp_lt_u32 s17, 62
s_cbranch_scc1 L_att_nw
s_waitcnt vmcnt(0)
L_att_nw:
s_cmp_lt_u32 s17, 60
s_cbranch_scc1 L_att_nh
s_mov_b64 exec, 1
global_store_dword v29, v27, s[4:5] sc1
s_mov_b64 exec, -1
L_att_nh:
v_max3_f32 v124, v124, v108, v109
v_max3_f32 v125, v125, v112, v113
v_mov_b32 v126, v124
s_nop 1
v_permlane32_swap_b32 v124, v126
v_max_f32 v124, v124, v126
v_mov_b32 v126, v124
s_nop 1
v_permlane16_swap_b32 v124, v126
v_max_f32 v124, v124, v126
v_mov_b32 v126, v125
s_nop 1
v_permlane32_swap_b32 v125, v126
v_max_f32 v125, v125, v126
v_mov_b32 v126, v125
s_nop 1
v_permlane16_swap_b32 v125, v126
v_max_f32 v125, v125, v126
v_add_f32 v72, v72, v74
v_add_f32 v73, v73, v75
v_add_f32 v76, v76, v78
v_add_f32 v77, v77, v79
v_cvt_pk_bf16_f32 v14, v72, v73
v_cvt_pk_bf16_f32 v16, v76, v77
v_sub_f32 v96, v96, v124
v_sub_f32 v97, v97, v124
v_sub_f32 v98, v98, v124
v_sub_f32 v99, v99, v124
v_sub_f32 v108, v108, v124
v_sub_f32 v109, v109, v124
v_exp_f32 v96, v96
v_exp_f32 v97, v97
v_exp_f32 v98, v98
v_exp_f32 v99, v99
v_exp_f32 v108, v108
v_exp_f32 v109, v109
v_cvt_pk_bf16_f32 v116, v96, v97
v_cvt_pk_bf16_f32 v117, v98, v99
v_mov_b32 v118, 0
v_mov_b32 v119, 0
v_cvt_pk_bf16_f32 v10, v108, v109
s_nop 0
v_mfma_f32_16x16x32_bf16 v[48:51], v[4:7], v[116:119], 0
v_mfma_f32_16x16x32_bf16 v[32:35], a[64:67], v[116:119], 0
v_mfma_f32_16x16x32_bf16 v[36:39], a[68:71], v[116:119], 0
v_mfma_f32_16x16x32_bf16 v[48:51], v[4:7], v[10:13], v[48:51]
v_mfma_f32_16x16x32_bf16 v[32:35], v[14:17], v[10:13], v[32:35]
v_mfma_f32_16x16x32_bf16 v[36:39], v[14:17], v[8:11], v[36:39]
v_sub_f32 v100, v100, v125
v_sub_f32 v101, v101, v125
v_sub_f32 v102, v102, v125
v_sub_f32 v103, v103, v125
v_sub_f32 v104, v104, v125
v_sub_f32 v105, v105, v125
v_sub_f32 v106, v106, v125
v_sub_f32 v107, v107, v125
v_sub_f32 v112, v112, v125
v_sub_f32 v113, v113, v125
v_exp_f32 v100, v100
v_exp_f32 v101, v101
v_exp_f32 v102, v102
v_exp_f32 v103, v103
v_exp_f32 v104, v104
v_exp_f32 v105, v105
v_exp_f32 v106, v106
v_exp_f32 v107, v107
v_exp_f32 v112, v112
v_exp_f32 v113, v113
v_cvt_pk_bf16_f32 v120, v100, v101
v_cvt_pk_bf16_f32 v121, v102, v103
v_cvt_pk_bf16_f32 v122, v104, v105
v_cvt_pk_bf16_f32 v123, v106, v107
v_cvt_pk_bf16_f32 v10, v112, v113
s_nop 0
v_mfma_f32_16x16x32_bf16 v[52:55], v[4:7], v[120:123], 0
v_mfma_f32_16x16x32_bf16 v[40:43], a[64:67], v[120:123], 0
v_mfma_f32_16x16x32_bf16 v[44:47], a[68:71], v[120:123], 0
v_mfma_f32_16x16x32_bf16 v[52:55], v[4:7], v[10:13], v[52:55]
v_mfma_f32_16x16x32_bf16 v[40:43], v[14:17], v[10:13], v[40:43]
v_mfma_f32_16x16x32_bf16 v[44:47], v[14:17], v[8:11], v[44:47]
v_add_u32 v24, 0x20000, v20
v_rcp_f32 v48, v48
s_nop 0
v_mul_f32 v32, v32, v48
v_mul_f32 v33, v33, v48
v_mul_f32 v34, v34, v48
v_mul_f32 v35, v35, v48
v_mul_f32 v36, v36, v48
v_mul_f32 v37, v37, v48
v_mul_f32 v38, v38, v48
v_mul_f32 v39, v39, v48
v_cvt_pk_bf16_f32 v56, v32, v33
v_cvt_pk_bf16_f32 v57, v34, v35
v_cvt_pk_bf16_f32 v58, v36, v37
v_cvt_pk_bf16_f32 v59, v38, v39
global_store_dwordx4 v20, v[56:59], s[10:11] sc1
v_rcp_f32 v52, v52
s_nop 0
v_mul_f32 v40, v40, v52
v_mul_f32 v41, v41, v52
v_mul_f32 v42, v42, v52
v_mul_f32 v43, v43, v52
v_mul_f32 v44, v44, v52
v_mul_f32 v45, v45, v52
v_mul_f32 v46, v46, v52
v_mul_f32 v47, v47, v52
v_cvt_pk_bf16_f32 v60, v40, v41
v_cvt_pk_bf16_f32 v61, v42, v43
v_cvt_pk_bf16_f32 v62, v44, v45
v_cvt_pk_bf16_f32 v63, v46, v47
global_store_dwordx4 v24, v[60:63], s[10:11] sc1
s_waitcnt vmcnt(2)
v_accvgpr_mov_b32 a32, a72
v_accvgpr_mov_b32 a33, a73
v_accvgpr_mov_b32 a34, a74
v_accvgpr_mov_b32 a35, a75
v_accvgpr_mov_b32 a36, a76
v_accvgpr_mov_b32 a37, a77
v_accvgpr_mov_b32 a38, a78
v_accvgpr_mov_b32 a39, a79
v_accvgpr_mov_b32 a40, a80
v_accvgpr_mov_b32 a41, a81
v_accvgpr_mov_b32 a42, a82
v_accvgpr_mov_b32 a43, a83
v_accvgpr_mov_b32 a44, a84
v_accvgpr_mov_b32 a45, a85
v_accvgpr_mov_b32 a46, a86
v_accvgpr_mov_b32 a47, a87
v_accvgpr_mov_b32 a48, a88
v_accvgpr_mov_b32 a49, a89
v_accvgpr_mov_b32 a50, a90
v_accvgpr_mov_b32 a51, a91
v_accvgpr_mov_b32 a52, a92
v_accvgpr_mov_b32 a53, a93
v_accvgpr_mov_b32 a54, a94
v_accvgpr_mov_b32 a55, a95
v_accvgpr_mov_b32 a56, a96
v_accvgpr_mov_b32 a57, a97
v_accvgpr_mov_b32 a58, a98
v_accvgpr_mov_b32 a59, a99
v_accvgpr_mov_b32 a60, a100
v_accvgpr_mov_b32 a61, a101
v_accvgpr_mov_b32 a62, a102
v_accvgpr_mov_b32 a63, a103
v_accvgpr_mov_b32 a64, a104
v_accvgpr_mov_b32 a65, a105
v_accvgpr_mov_b32 a66, a106
v_accvgpr_mov_b32 a67, a107
v_accvgpr_mov_b32 a68, a108
v_accvgpr_mov_b32 a69, a109
v_accvgpr_mov_b32 a70, a110
v_accvgpr_mov_b32 a71, a111
s_waitcnt vmcnt(0)
s_mov_b64 exec, 1
global_store_dword v29, v28, s[4:5] sc1
s_mov_b64 exec, -1
s_mov_b32 s17, s18
s_cmp_lt_u32 s17, 64
s_cbranch_scc1 L_att_loop
s_endpgm
L_notatt:
s_mul_i32 s34, s12, 5
s_add_u32 s34, s34, s13
s_mul_i32 s35, s31, 9363
s_lshr_b32 s35, s35, 16
s_mul_i32 s36, s35, 7
s_sub_u32 s36, s31, s36
s_min_u32 s36, s36, 5
s_mul_i32 s35, s35, 5
s_add_u32 s35, s35, s36
s_sub_u32 s34, s34, s35
s_cmp_ge_u32 s34, 16
s_cbranch_scc1 L_notout
s_load_dwordx2 s[6:7], s[0:1], 40
s_load_dwordx2 s[8:9], s[0:1], 0
s_load_dwordx2 s[10:11], s[0:1], 96
s_lshl_b32 s15, s14, 15
s_waitcnt lgkmcnt(0)
s_lshl_b32 s3, s34, 6
s_add_u32 s6, s6, s3
s_addc_u32 s7, s7, 0
s_add_u32 s8, s8, s3
s_addc_u32 s9, s9, 0
s_add_u32 s10, s10, s3
s_addc_u32 s11, s11, 0
v_mov_b32 v1, 0x0
v_bfe_i32 v4, v0, 0, 1
v_and_b32 v4, 0x10, v4
v_xor_b32 v1, v1, v4
v_bfe_i32 v4, v0, 1, 1
v_and_b32 v4, 0x20, v4
v_xor_b32 v1, v1, v4
v_bfe_i32 v4, v0, 2, 1
v_and_b32 v4, 0x400, v4
v_xor_b32 v1, v1, v4
v_bfe_i32 v4, v0, 3, 1
v_and_b32 v4, 0x800, v4
v_xor_b32 v1, v1, v4
v_bfe_i32 v4, v0, 4, 1
v_and_b32 v4, 0x1020, v4
v_xor_b32 v1, v1, v4
v_bfe_i32 v4, v0, 5, 1
v_and_b32 v4, 0x2000, v4
v_xor_b32 v1, v1, v4
v_bfe_i32 v4, v0, 6, 1
v_and_b32 v4, 0x100000, v4
v_xor_b32 v1, v1, v4
v_bfe_i32 v4, v0, 7, 1
v_and_b32 v4, 0x200000, v4
v_xor_b32 v1, v1, v4
v_mov_b32 v2, 0x0
v_bfe_i32 v4, v0, 0, 1
v_and_b32 v4, 0x8, v4
v_xor_b32 v2, v2, v4
v_bfe_i32 v4, v0, 1, 1
v_and_b32 v4, 0x10, v4
v_xor_b32 v2, v2, v4
v_bfe_i32 v4, v0, 2, 1
v_and_b32 v4, 0x40, v4
v_xor_b32 v2, v2, v4
v_bfe_i32 v4, v0, 3, 1
v_and_b32 v4, 0x80, v4
v_xor_b32 v2, v2, v4
v_bfe_i32 v4, v0, 4, 1
v_and_b32 v4, 0x120, v4
v_xor_b32 v2, v2, v4
v_bfe_i32 v4, v0, 5, 1
v_and_b32 v4, 0x200, v4
v_xor_b32 v2, v2, v4
v_bfe_i32 v4, v0, 6, 1
v_and_b32 v4, 0x8000, v4
v_xor_b32 v2, v2, v4
v_bfe_i32 v4, v0, 7, 1
v_and_b32 v4, 0x10000, v4
v_xor_b32 v2, v2, v4
v_xor_b32 v3, 32, v2
s_add_u32 m0, s15, 0
v_add_u32 v4, 0x0, v1
global_load_lds_dwordx4 v4, s[6:7]
s_add_u32 m0, s15, 1024
v_add_u32 v4, 0x4000, v1
global_load_lds_dwordx4 v4, s[6:7]
s_add_u32 m0, s15, 2048
v_add_u32 v4, 0x8000, v1
global_load_lds_dwordx4 v4, s[6:7]
s_add_u32 m0, s15, 3072
v_add_u32 v4, 0xc000, v1
global_load_lds_dwordx4 v4, s[6:7]
s_add_u32 m0, s15, 4096
v_add_u32 v4, 0x10000, v1
global_load_lds_dwordx4 v4, s[6:7]
s_add_u32 m0, s15, 5120
v_add_u32 v4, 0x14000, v1
global_load_lds_dwordx4 v4, s[6:7]
s_add_u32 m0, s15, 6144
v_add_u32 v4, 0x18000, v1
global_load_lds_dwordx4 v4, s[6:7]
s_add_u32 m0, s15, 7168
v_add_u32 v4, 0x1c000, v1
global_load_lds_dwordx4 v4, s[6:7]
s_add_u32 m0, s15, 8192
v_add_u32 v4, 0x20000, v1
global_load_lds_dwordx4 v4, s[6:7]
s_add_u32 m0, s15, 9216
v_add_u32 v4, 0x24000, v1
global_load_lds_dwordx4 v4, s[6:7]
s_add_u32 m0, s15, 10240
v_add_u32 v4, 0x28000, v1
global_load_lds_dwordx4 v4, s[6:7]
s_add_u32 m0, s15, 11264
v_add_u32 v4, 0x2c000, v1
global_load_lds_dwordx4 v4, s[6:7]
s_add_u32 m0, s15, 12288
v_add_u32 v4, 0x30000, v1
global_load_lds_dwordx4 v4, s[6:7]
s_add_u32 m0, s15, 13312
v_add_u32 v4, 0x34000, v1
global_load_lds_dwordx4 v4, s[6:7]
s_add_u32 m0, s15, 14336
v_add_u32 v4, 0x38000, v1
global_load_lds_dwordx4 v4, s[6:7]
s_add_u32 m0, s15, 15360
v_add_u32 v4, 0x3c000, v1
global_load_lds_dwordx4 v4, s[6:7]
s_add_u32 m0, s15, 16384
v_add_u32 v4, 0x40000, v1
global_load_lds_dwordx4 v4, s[6:7]
s_add_u32 m0, s15, 17408
v_add_u32 v4, 0x44000, v1
global_load_lds_dwordx4 v4, s[6:7]
s_add_u32 m0, s15, 18432
v_add_u32 v4, 0x48000, v1
global_load_lds_dwordx4 v4, s[6:7]
s_add_u32 m0, s15, 19456
v_add_u32 v4, 0x4c000, v1
global_load_lds_dwordx4 v4, s[6:7]
s_add_u32 m0, s15, 20480
v_add_u32 v4, 0x50000, v1
global_load_lds_dwordx4 v4, s[6:7]
s_add_u32 m0, s15, 21504
v_add_u32 v4, 0x54000, v1
global_load_lds_dwordx4 v4, s[6:7]
s_add_u32 m0, s15, 22528
v_add_u32 v4, 0x58000, v1
global_load_lds_dwordx4 v4, s[6:7]
s_add_u32 m0, s15, 23552
v_add_u32 v4, 0x5c000, v1
global_load_lds_dwordx4 v4, s[6:7]
s_add_u32 m0, s15, 24576
v_add_u32 v4, 0x60000, v1
global_load_lds_dwordx4 v4, s[6:7]
s_add_u32 m0, s15, 25600
v_add_u32 v4, 0x64000, v1
global_load_lds_dwordx4 v4, s[6:7]
s_add_u32 m0, s15, 26624
v_add_u32 v4, 0x68000, v1
global_load_lds_dwordx4 v4, s[6:7]
s_add_u32 m0, s15, 27648
v_add_u32 v4, 0x6c000, v1
global_load_lds_dwordx4 v4, s[6:7]
s_add_u32 m0, s15, 28672
v_add_u32 v4, 0x70000, v1
global_load_lds_dwordx4 v4, s[6:7]
s_add_u32 m0, s15, 29696
v_add_u32 v4, 0x74000, v1
global_load_lds_dwordx4 v4, s[6:7]
s_add_u32 m0, s15, 30720
v_add_u32 v4, 0x78000, v1
global_load_lds_dwordx4 v4, s[6:7]
s_add_u32 m0, s15, 31744
v_add_u32 v4, 0x7c000, v1
global_load_lds_dwordx4 v4, s[6:7]
s_waitcnt vmcnt(30)
ds_read_b64_tr_b16 a[0:1], v2 offset:0
ds_read_b64_tr_b16 a[2:3], v2 offset:1024
ds_read_b64_tr_b16 a[4:5], v3 offset:0
ds_read_b64_tr_b16 a[6:7], v3 offset:1024
s_waitcnt vmcnt(28)
ds_read_b64_tr_b16 a[8:9], v2 offset:2048
ds_read_b64_tr_b16 a[10:11], v2 offset:3072
ds_read_b64_tr_b16 a[12:13], v3 offset:2048
ds_read_b64_tr_b16 a[14:15], v3 offset:3072
s_waitcnt vmcnt(26)
ds_read_b64_tr_b16 a[16:17], v2 offset:4096
ds_read_b64_tr_b16 a[18:19], v2 offset:5120
ds_read_b64_tr_b16 a[20:21], v3 offset:4096
ds_read_b64_tr_b16 a[22:23], v3 offset:5120
s_waitcnt vmcnt(24)
ds_read_b64_tr_b16 a[24:25], v2 offset:6144
ds_read_b64_tr_b16 a[26:27], v2 offset:7168
ds_read_b64_tr_b16 a[28:29], v3 offset:6144
ds_read_b64_tr_b16 a[30:31], v3 offset:7168
s_waitcnt vmcnt(22)
ds_read_b64_tr_b16 a[32:33], v2 offset:8192
ds_read_b64_tr_b16 a[34:35], v2 offset:9216
ds_read_b64_tr_b16 a[36:37], v3 offset:8192
ds_read_b64_tr_b16 a[38:39], v3 offset:9216
s_waitcnt vmcnt(20)
ds_read_b64_tr_b16 a[40:41], v2 offset:10240
ds_read_b64_tr_b16 a[42:43], v2 offset:11264
ds_read_b64_tr_b16 a[44:45], v3 offset:10240
ds_read_b64_tr_b16 a[46:47], v3 offset:11264
s_waitcnt vmcnt(18)
ds_read_b64_tr_b16 a[48:49], v2 offset:12288
ds_read_b64_tr_b16 a[50:51], v2 offset:13312
ds_read_b64_tr_b16 a[52:53], v3 offset:12288
ds_read_b64_tr_b16 a[54:55], v3 offset:13312
s_waitcnt vmcnt(16)
ds_read_b64_tr_b16 a[56:57], v2 offset:14336
ds_read_b64_tr_b16 a[58:59], v2 offset:15360
ds_read_b64_tr_b16 a[60:61], v3 offset:14336
ds_read_b64_tr_b16 a[62:63], v3 offset:15360
s_waitcnt vmcnt(14)
ds_read_b64_tr_b16 a[64:65], v2 offset:16384
ds_read_b64_tr_b16 a[66:67], v2 offset:17408
ds_read_b64_tr_b16 a[68:69], v3 offset:16384
ds_read_b64_tr_b16 a[70:71], v3 offset:17408
s_waitcnt vmcnt(12)
ds_read_b64_tr_b16 a[72:73], v2 offset:18432
ds_read_b64_tr_b16 a[74:75], v2 offset:19456
ds_read_b64_tr_b16 a[76:77], v3 offset:18432
ds_read_b64_tr_b16 a[78:79], v3 offset:19456
s_waitcnt vmcnt(10)
ds_read_b64_tr_b16 a[80:81], v2 offset:20480
ds_read_b64_tr_b16 a[82:83], v2 offset:21504
ds_read_b64_tr_b16 a[84:85], v3 offset:20480
ds_read_b64_tr_b16 a[86:87], v3 offset:21504
s_waitcnt vmcnt(8)
ds_read_b64_tr_b16 a[88:89], v2 offset:22528
ds_read_b64_tr_b16 a[90:91], v2 offset:23552
ds_read_b64_tr_b16 a[92:93], v3 offset:22528
ds_read_b64_tr_b16 a[94:95], v3 offset:23552
s_waitcnt vmcnt(6)
ds_read_b64_tr_b16 a[96:97], v2 offset:24576
ds_read_b64_tr_b16 a[98:99], v2 offset:25600
ds_read_b64_tr_b16 a[100:101], v3 offset:24576
ds_read_b64_tr_b16 a[102:103], v3 offset:25600
s_waitcnt vmcnt(4)
ds_read_b64_tr_b16 a[104:105], v2 offset:26624
ds_read_b64_tr_b16 a[106:107], v2 offset:27648
ds_read_b64_tr_b16 a[108:109], v3 offset:26624
ds_read_b64_tr_b16 a[110:111], v3 offset:27648
s_waitcnt vmcnt(2)
ds_read_b64_tr_b16 a[112:113], v2 offset:28672
ds_read_b64_tr_b16 a[114:115], v2 offset:29696
ds_read_b64_tr_b16 a[116:117], v3 offset:28672
ds_read_b64_tr_b16 a[118:119], v3 offset:29696
s_waitcnt vmcnt(0)
ds_read_b64_tr_b16 a[120:121], v2 offset:30720
ds_read_b64_tr_b16 a[122:123], v2 offset:31744
ds_read_b64_tr_b16 a[124:125], v3 offset:30720
ds_read_b64_tr_b16 a[126:127], v3 offset:31744
s_waitcnt lgkmcnt(0)
s_add_u32 m0, s15, 0
v_add_u32 v4, 0x80000, v1
global_load_lds_dwordx4 v4, s[6:7]
s_add_u32 m0, s15, 1024
v_add_u32 v4, 0x84000, v1
global_load_lds_dwordx4 v4, s[6:7]
s_add_u32 m0, s15, 2048
v_add_u32 v4, 0x88000, v1
global_load_lds_dwordx4 v4, s[6:7]
s_add_u32 m0, s15, 3072
v_add_u32 v4, 0x8c000, v1
global_load_lds_dwordx4 v4, s[6:7]
s_add_u32 m0, s15, 4096
v_add_u32 v4, 0x90000, v1
global_load_lds_dwordx4 v4, s[6:7]
s_add_u32 m0, s15, 5120
v_add_u32 v4, 0x94000, v1
global_load_lds_dwordx4 v4, s[6:7]
s_add_u32 m0, s15, 6144
v_add_u32 v4, 0x98000, v1
global_load_lds_dwordx4 v4, s[6:7]
s_add_u32 m0, s15, 7168
v_add_u32 v4, 0x9c000, v1
global_load_lds_dwordx4 v4, s[6:7]
s_add_u32 m0, s15, 8192
v_add_u32 v4, 0xa0000, v1
global_load_lds_dwordx4 v4, s[6:7]
s_add_u32 m0, s15, 9216
v_add_u32 v4, 0xa4000, v1
global_load_lds_dwordx4 v4, s[6:7]
s_add_u32 m0, s15, 10240
v_add_u32 v4, 0xa8000, v1
global_load_lds_dwordx4 v4, s[6:7]
s_add_u32 m0, s15, 11264
v_add_u32 v4, 0xac000, v1
global_load_lds_dwordx4 v4, s[6:7]
s_add_u32 m0, s15, 12288
v_add_u32 v4, 0xb0000, v1
global_load_lds_dwordx4 v4, s[6:7]
s_add_u32 m0, s15, 13312
v_add_u32 v4, 0xb4000, v1
global_load_lds_dwordx4 v4, s[6:7]
s_add_u32 m0, s15, 14336
v_add_u32 v4, 0xb8000, v1
global_load_lds_dwordx4 v4, s[6:7]
s_add_u32 m0, s15, 15360
v_add_u32 v4, 0xbc000, v1
global_load_lds_dwordx4 v4, s[6:7]
s_add_u32 m0, s15, 16384
v_add_u32 v4, 0xc0000, v1
global_load_lds_dwordx4 v4, s[6:7]
s_add_u32 m0, s15, 17408
v_add_u32 v4, 0xc4000, v1
global_load_lds_dwordx4 v4, s[6:7]
s_add_u32 m0, s15, 18432
v_add_u32 v4, 0xc8000, v1
global_load_lds_dwordx4 v4, s[6:7]
s_add_u32 m0, s15, 19456
v_add_u32 v4, 0xcc000, v1
global_load_lds_dwordx4 v4, s[6:7]
s_add_u32 m0, s15, 20480
v_add_u32 v4, 0xd0000, v1
global_load_lds_dwordx4 v4, s[6:7]
s_add_u32 m0, s15, 21504
v_add_u32 v4, 0xd4000, v1
global_load_lds_dwordx4 v4, s[6:7]
s_add_u32 m0, s15, 22528
v_add_u32 v4, 0xd8000, v1
global_load_lds_dwordx4 v4, s[6:7]
s_add_u32 m0, s15, 23552
v_add_u32 v4, 0xdc000, v1
global_load_lds_dwordx4 v4, s[6:7]
s_add_u32 m0, s15, 24576
v_add_u32 v4, 0xe0000, v1
global_load_lds_dwordx4 v4, s[6:7]
s_add_u32 m0, s15, 25600
v_add_u32 v4, 0xe4000, v1
global_load_lds_dwordx4 v4, s[6:7]
s_add_u32 m0, s15, 26624
v_add_u32 v4, 0xe8000, v1
global_load_lds_dwordx4 v4, s[6:7]
s_add_u32 m0, s15, 27648
v_add_u32 v4, 0xec000, v1
global_load_lds_dwordx4 v4, s[6:7]
s_add_u32 m0, s15, 28672
v_add_u32 v4, 0xf0000, v1
global_load_lds_dwordx4 v4, s[6:7]
s_add_u32 m0, s15, 29696
v_add_u32 v4, 0xf4000, v1
global_load_lds_dwordx4 v4, s[6:7]
s_add_u32 m0, s15, 30720
v_add_u32 v4, 0xf8000, v1
global_load_lds_dwordx4 v4, s[6:7]
s_add_u32 m0, s15, 31744
v_add_u32 v4, 0xfc000, v1
global_load_lds_dwordx4 v4, s[6:7]
s_waitcnt vmcnt(30)
ds_read_b64_tr_b16 a[128:129], v2 offset:0
ds_read_b64_tr_b16 a[130:131], v2 offset:1024
ds_read_b64_tr_b16 a[132:133], v3 offset:0
ds_read_b64_tr_b16 a[134:135], v3 offset:1024
s_waitcnt vmcnt(28)
ds_read_b64_tr_b16 a[136:137], v2 offset:2048
ds_read_b64_tr_b16 a[138:139], v2 offset:3072
ds_read_b64_tr_b16 a[140:141], v3 offset:2048
ds_read_b64_tr_b16 a[142:143], v3 offset:3072
s_waitcnt vmcnt(26)
ds_read_b64_tr_b16 a[144:145], v2 offset:4096
ds_read_b64_tr_b16 a[146:147], v2 offset:5120
ds_read_b64_tr_b16 a[148:149], v3 offset:4096
ds_read_b64_tr_b16 a[150:151], v3 offset:5120
s_waitcnt vmcnt(24)
ds_read_b64_tr_b16 a[152:153], v2 offset:6144
ds_read_b64_tr_b16 a[154:155], v2 offset:7168
ds_read_b64_tr_b16 a[156:157], v3 offset:6144
ds_read_b64_tr_b16 a[158:159], v3 offset:7168
s_waitcnt vmcnt(22)
ds_read_b64_tr_b16 a[160:161], v2 offset:8192
ds_read_b64_tr_b16 a[162:163], v2 offset:9216
ds_read_b64_tr_b16 a[164:165], v3 offset:8192
ds_read_b64_tr_b16 a[166:167], v3 offset:9216
s_waitcnt vmcnt(20)
ds_read_b64_tr_b16 a[168:169], v2 offset:10240
ds_read_b64_tr_b16 a[170:171], v2 offset:11264
ds_read_b64_tr_b16 a[172:173], v3 offset:10240
ds_read_b64_tr_b16 a[174:175], v3 offset:11264
s_waitcnt vmcnt(18)
ds_read_b64_tr_b16 a[176:177], v2 offset:12288
ds_read_b64_tr_b16 a[178:179], v2 offset:13312
ds_read_b64_tr_b16 a[180:181], v3 offset:12288
ds_read_b64_tr_b16 a[182:183], v3 offset:13312
s_waitcnt vmcnt(16)
ds_read_b64_tr_b16 a[184:185], v2 offset:14336
ds_read_b64_tr_b16 a[186:187], v2 offset:15360
ds_read_b64_tr_b16 a[188:189], v3 offset:14336
ds_read_b64_tr_b16 a[190:191], v3 offset:15360
s_waitcnt vmcnt(14)
ds_read_b64_tr_b16 a[192:193], v2 offset:16384
ds_read_b64_tr_b16 a[194:195], v2 offset:17408
ds_read_b64_tr_b16 a[196:197], v3 offset:16384
ds_read_b64_tr_b16 a[198:199], v3 offset:17408
s_waitcnt vmcnt(12)
ds_read_b64_tr_b16 a[200:201], v2 offset:18432
ds_read_b64_tr_b16 a[202:203], v2 offset:19456
ds_read_b64_tr_b16 a[204:205], v3 offset:18432
ds_read_b64_tr_b16 a[206:207], v3 offset:19456
s_waitcnt vmcnt(10)
ds_read_b64_tr_b16 a[208:209], v2 offset:20480
ds_read_b64_tr_b16 a[210:211], v2 offset:21504
ds_read_b64_tr_b16 a[212:213], v3 offset:20480
ds_read_b64_tr_b16 a[214:215], v3 offset:21504
s_waitcnt vmcnt(8)
ds_read_b64_tr_b16 a[216:217], v2 offset:22528
ds_read_b64_tr_b16 a[218:219], v2 offset:23552
ds_read_b64_tr_b16 a[220:221], v3 offset:22528
ds_read_b64_tr_b16 a[222:223], v3 offset:23552
s_waitcnt vmcnt(6)
ds_read_b64_tr_b16 a[224:225], v2 offset:24576
ds_read_b64_tr_b16 a[226:227], v2 offset:25600
ds_read_b64_tr_b16 a[228:229], v3 offset:24576
ds_read_b64_tr_b16 a[230:231], v3 offset:25600
s_waitcnt vmcnt(4)
ds_read_b64_tr_b16 a[232:233], v2 offset:26624
ds_read_b64_tr_b16 a[234:235], v2 offset:27648
ds_read_b64_tr_b16 a[236:237], v3 offset:26624
ds_read_b64_tr_b16 a[238:239], v3 offset:27648
s_waitcnt vmcnt(2)
ds_read_b64_tr_b16 a[240:241], v2 offset:28672
ds_read_b64_tr_b16 a[242:243], v2 offset:29696
ds_read_b64_tr_b16 a[244:245], v3 offset:28672
ds_read_b64_tr_b16 a[246:247], v3 offset:29696
s_waitcnt vmcnt(0)
ds_read_b64_tr_b16 a[248:249], v2 offset:30720
ds_read_b64_tr_b16 a[250:251], v2 offset:31744
ds_read_b64_tr_b16 a[252:253], v3 offset:30720
ds_read_b64_tr_b16 a[254:255], v3 offset:31744
s_waitcnt lgkmcnt(0)
v_mov_b32 v1, 0x0
v_bfe_i32 v4, v0, 0, 1
v_and_b32 v4, 0x10, v4
v_xor_b32 v1, v1, v4
v_bfe_i32 v4, v0, 1, 1
v_and_b32 v4, 0x20, v4
v_xor_b32 v1, v1, v4
v_bfe_i32 v4, v0, 2, 1
v_and_b32 v4, 0x40, v4
v_xor_b32 v1, v1, v4
v_bfe_i32 v4, v0, 3, 1
v_and_b32 v4, 0x80, v4
v_xor_b32 v1, v1, v4
v_bfe_i32 v4, v0, 4, 1
v_and_b32 v4, 0x100, v4
v_xor_b32 v1, v1, v4
v_bfe_i32 v4, v0, 5, 1
v_and_b32 v4, 0x200, v4
v_xor_b32 v1, v1, v4
v_bfe_i32 v4, v0, 6, 1
v_and_b32 v4, 0x8000, v4
v_xor_b32 v1, v1, v4
v_bfe_i32 v4, v0, 7, 1
v_and_b32 v4, 0x10000, v4
v_xor_b32 v1, v1, v4
v_mov_b32 v2, 0x0
v_bfe_i32 v4, v0, 0, 1
v_and_b32 v4, 0x10, v4
v_xor_b32 v2, v2, v4
v_bfe_i32 v4, v0, 1, 1
v_and_b32 v4, 0x20, v4
v_xor_b32 v2, v2, v4
v_bfe_i32 v4, v0, 2, 1
v_and_b32 v4, 0x40, v4
v_xor_b32 v2, v2, v4
v_bfe_i32 v4, v0, 3, 1
v_and_b32 v4, 0x80, v4
v_xor_b32 v2, v2, v4
v_bfe_i32 v4, v0, 4, 1
v_and_b32 v4, 0x100, v4
v_xor_b32 v2, v2, v4
v_bfe_i32 v4, v0, 5, 1
v_and_b32 v4, 0x200, v4
v_xor_b32 v2, v2, v4
v_bfe_i32 v4, v0, 6, 1
v_and_b32 v4, 0x800, v4
v_xor_b32 v2, v2, v4
v_bfe_i32 v4, v0, 7, 1
v_and_b32 v4, 0x1000, v4
v_xor_b32 v2, v2, v4
v_mov_b32 v3, 0x0
v_bfe_i32 v4, v0, 0, 1
v_and_b32 v4, 0x10, v4
v_xor_b32 v3, v3, v4
v_bfe_i32 v4, v0, 1, 1
v_and_b32 v4, 0x20, v4
v_xor_b32 v3, v3, v4
v_bfe_i32 v4, v0, 2, 1
v_and_b32 v4, 0x40, v4
v_xor_b32 v3, v3, v4
v_bfe_i32 v4, v0, 3, 1
v_and_b32 v4, 0x80, v4
v_xor_b32 v3, v3, v4
v_bfe_i32 v4, v0, 4, 1
v_and_b32 v4, 0x100, v4
v_xor_b32 v3, v3, v4
v_bfe_i32 v4, v0, 5, 1
v_and_b32 v4, 0x200, v4
v_xor_b32 v3, v3, v4
v_bfe_i32 v4, v0, 6, 1
v_and_b32 v4, 0x400, v4
v_xor_b32 v3, v3, v4
v_mov_b32 v5, 0x0
v_bfe_i32 v4, v0, 0, 1
v_and_b32 v4, 0x400, v4
v_xor_b32 v5, v5, v4
v_bfe_i32 v4, v0, 1, 1
v_and_b32 v4, 0x800, v4
v_xor_b32 v5, v5, v4
v_bfe_i32 v4, v0, 2, 1
v_and_b32 v4, 0x1000, v4
v_xor_b32 v5, v5, v4
v_bfe_i32 v4, v0, 3, 1
v_and_b32 v4, 0x2000, v4
v_xor_b32 v5, v5, v4
v_bfe_i32 v4, v0, 4, 1
v_and_b32 v4, 0x8, v4
v_xor_b32 v5, v5, v4
v_bfe_i32 v4, v0, 5, 1
v_and_b32 v4, 0x10, v4
v_xor_b32 v5, v5, v4
v_bfe_i32 v4, v0, 6, 1
v_and_b32 v4, 0x20, v4
v_xor_b32 v5, v5, v4
v_mov_b32 v6, 0x0
v_bfe_i32 v4, v0, 0, 1
v_and_b32 v4, 0x10, v4
v_xor_b32 v6, v6, v4
v_bfe_i32 v4, v0, 1, 1
v_and_b32 v4, 0x20, v4
v_xor_b32 v6, v6, v4
v_bfe_i32 v4, v0, 2, 1
v_and_b32 v4, 0x40, v4
v_xor_b32 v6, v6, v4
v_bfe_i32 v4, v0, 3, 1
v_and_b32 v4, 0x80, v4
v_xor_b32 v6, v6, v4
v_bfe_i32 v4, v0, 4, 1
v_and_b32 v4, 0x100, v4
v_xor_b32 v6, v6, v4
v_bfe_i32 v4, v0, 5, 1
v_and_b32 v4, 0x200, v4
v_xor_b32 v6, v6, v4
v_mov_b32 v7, 0x398000
v_bfe_i32 v4, v0, 4, 1
v_and_b32 v4, 0x10, v4
v_xor_b32 v7, v7, v4
v_bfe_i32 v4, v0, 5, 1
v_and_b32 v4, 0x20, v4
v_xor_b32 v7, v7, v4
v_bfe_i32 v4, v0, 6, 1
v_and_b32 v4, 0x40, v4
v_xor_b32 v7, v7, v4
v_mov_b32 v8, 0x0
v_bfe_i32 v4, v0, 0, 1
v_and_b32 v4, 0x1, v4
v_xor_b32 v8, v8, v4
v_bfe_i32 v4, v0, 1, 1
v_and_b32 v4, 0x2, v4
v_xor_b32 v8, v8, v4
v_bfe_i32 v4, v0, 2, 1
v_and_b32 v4, 0x4, v4
v_xor_b32 v8, v8, v4
v_bfe_i32 v4, v0, 3, 1
v_and_b32 v4, 0x8, v4
v_xor_b32 v8, v8, v4
v_mov_b32 v46, 0x500000
v_bfe_i32 v4, v0, 0, 1
v_and_b32 v4, 0x80, v4
v_xor_b32 v46, v46, v4
v_bfe_i32 v4, v0, 1, 1
v_and_b32 v4, 0x100, v4
v_xor_b32 v46, v46, v4
v_bfe_i32 v4, v0, 2, 1
v_and_b32 v4, 0x200, v4
v_xor_b32 v46, v46, v4
v_bfe_i32 v4, v0, 3, 1
v_and_b32 v4, 0x400, v4
v_xor_b32 v46, v46, v4
v_bfe_i32 v4, v0, 4, 1
v_and_b32 v4, 0x800, v4
v_xor_b32 v46, v46, v4
v_bfe_i32 v4, v0, 6, 1
v_and_b32 v4, 0x1000, v4
v_xor_b32 v46, v46, v4
v_bfe_i32 v4, v0, 7, 1
v_and_b32 v4, 0x2000, v4
v_xor_b32 v46, v46, v4
s_lshl_b32 s3, s34, 10
v_add_u32 v6, s3, v6
s_lshl_b32 s3, s34, 7
v_add_u32 v7, s3, v7
s_and_b32 s21, s14, 1
s_xor_b32 s21, s21, 1
s_lshl_b32 s21, s21, 4
v_and_b32 v4, 7, v0
v_lshlrev_b32 v4, 2, v4
v_add_u32 v4, 0x3aa100, v4
L_out_my:
global_load_dword v9, v4, s[4:5] sc1
s_waitcnt vmcnt(0)
v_cmp_ne_u32 vcc, 1, v9
s_cmp_eq_u64 vcc, 0
s_cbranch_scc1 L_out_my_ok
s_sleep 64
s_sub_u32 s41, s41, 1
s_cbranch_scc0 L_out_my
s_mov_b32 s41, 0
L_out_my_ok:
v_mov_b32 v4, 0x399000
global_load_dwordx4 v[32:35], v7, s[4:5] sc1
global_load_dwordx4 v[36:39], v7, s[4:5] offset:2048 sc1
global_load_dwordx2 v[40:41], v4, s[4:5] sc1
s_mov_b32 s20, 0xffff0000
s_mov_b32 s13, s30
s_barrier
L_out_loop:
s_lshl_b32 s3, s13, 17
s_add_u32 s3, s3, 0x5200000
s_add_u32 s16, s4, s3
s_addc_u32 s17, s5, 0
s_lshl_b32 s3, s13, 14
v_add_u32 v9, s3, v5
v_add_u32 v10, s3, v6
global_load_dwordx2 v[42:43], v9, s[8:9]
global_load_dwordx4 v[28:31], v10, s[4:5] sc1
s_lshr_b32 s3, s13, 1
s_lshl_b32 s3, s3, 14
v_add_u32 v47, s3, v46
s_mov_b32 s26, 1
s_mov_b32 s27, 0
L_out_again:
s_cmp_ge_u32 s13, 124
s_cbranch_scc1 L_out_fq
L_out_fo:
global_load_dword v11, v47, s[4:5] sc1
s_waitcnt vmcnt(0)
v_cmp_gt_u32 vcc, s26, v11
s_cmp_eq_u64 vcc, 0
s_cbranch_scc1 L_out_fo_ok
s_sleep 32
s_sub_u32 s41, s41, 1
s_cbranch_scc0 L_out_fo
s_mov_b32 s41, 0
L_out_fo_ok:
s_branch L_out_fq_ok
L_out_fq:
v_subrev_u32 v44, 0x8000, v47
L_out_fp:
global_load_dword v11, v44, s[4:5] sc1
s_waitcnt vmcnt(0)
v_cmp_gt_u32 vcc, s26, v11
s_cmp_eq_u64 vcc, 0
s_cbranch_scc1 L_out_fp_ok
s_sleep 32
s_sub_u32 s41, s41, 1
s_cbranch_scc0 L_out_fp
s_mov_b32 s41, 0
L_out_fp_ok:
L_out_fq2:
global_load_dword v11, v47, s[4:5] sc1
s_waitcnt vmcnt(0)
v_cmp_gt_u32 vcc, s26, v11
s_cmp_eq_u64 vcc, 0
s_cbranch_scc1 L_out_fq2_ok
s_sleep 1
s_sub_u32 s41, s41, 1
s_cbranch_scc0 L_out_fq2
s_mov_b32 s41, 0
L_out_fq2_ok:
L_out_fq_ok:
L_out_retry:
v_add_u32 v45, 0, v1
global_load_dwordx4 v[48:51], v45, s[16:17] offset:0 sc1
global_load_dwordx4 v[52:55], v45, s[16:17] offset:1024 sc1
global_load_dwordx4 v[56:59], v45, s[16:17] offset:2048 sc1
global_load_dwordx4 v[60:63], v45, s[16:17] offset:3072 sc1
v_add_u32 v45, 4096, v1
global_load_dwordx4 v[64:67], v45, s[16:17] offset:0 sc1
global_load_dwordx4 v[68:71], v45, s[16:17] offset:1024 sc1
global_load_dwordx4 v[72:75], v45, s[16:17] offset:2048 sc1
global_load_dwordx4 v[76:79], v45, s[16:17] offset:3072 sc1
v_add_u32 v45, 8192, v1
global_load_dwordx4 v[80:83], v45, s[16:17] offset:0 sc1
global_load_dwordx4 v[84:87], v45, s[16:17] offset:1024 sc1
global_load_dwordx4 v[88:91], v45, s[16:17] offset:2048 sc1
global_load_dwordx4 v[92:95], v45, s[16:17] offset:3072 sc1
v_add_u32 v45, 12288, v1
global_load_dwordx4 v[96:99], v45, s[16:17] offset:0 sc1
global_load_dwordx4 v[100:103], v45, s[16:17] offset:1024 sc1
global_load_dwordx4 v[104:107], v45, s[16:17] offset:2048 sc1
global_load_dwordx4 v[108:111], v45, s[16:17] offset:3072 sc1
v_add_u32 v45, 16384, v1
global_load_dwordx4 v[112:115], v45, s[16:17] offset:0 sc1
global_load_dwordx4 v[116:119], v45, s[16:17] offset:1024 sc1
global_load_dwordx4 v[120:123], v45, s[16:17] offset:2048 sc1
global_load_dwordx4 v[124:127], v45, s[16:17] offset:3072 sc1
v_add_u32 v45, 20480, v1
global_load_dwordx4 v[128:131], v45, s[16:17] offset:0 sc1
global_load_dwordx4 v[132:135], v45, s[16:17] offset:1024 sc1
global_load_dwordx4 v[136:139], v45, s[16:17] offset:2048 sc1
global_load_dwordx4 v[140:143], v45, s[16:17] offset:3072 sc1
v_add_u32 v45, 24576, v1
global_load_dwordx4 v[144:147], v45, s[16:17] offset:0 sc1
global_load_dwordx4 v[148:151], v45, s[16:17] offset:1024 sc1
global_load_dwordx4 v[152:155], v45, s[16:17] offset:2048 sc1
global_load_dwordx4 v[156:159], v45, s[16:17] offset:3072 sc1
v_add_u32 v45, 28672, v1
global_load_dwordx4 v[160:163], v45, s[16:17] offset:0 sc1
global_load_dwordx4 v[164:167], v45, s[16:17] offset:1024 sc1
global_load_dwordx4 v[168:171], v45, s[16:17] offset:2048 sc1
global_load_dwordx4 v[172:175], v45, s[16:17] offset:3072 sc1
s_lshl_b32 s3, s13, 4
v_add_u32 v12, s3, v8
v_cmp_eq_u32 s[22:23], v12, v40
v_cmp_eq_u32 s[24:25], v12, v41
s_nop 0
v_cndmask_b32 v240, 0, v32, s[22:23]
v_cndmask_b32 v240, v240, v36, s[24:25]
v_lshlrev_b32 v244, s21, v28
v_and_b32 v244, s20, v244
v_add_f32 v244, v244, v240
v_cndmask_b32 v241, 0, v33, s[22:23]
v_cndmask_b32 v241, v241, v37, s[24:25]
v_lshlrev_b32 v245, s21, v29
v_and_b32 v245, s20, v245
v_add_f32 v245, v245, v241
v_cndmask_b32 v242, 0, v34, s[22:23]
v_cndmask_b32 v242, v242, v38, s[24:25]
v_lshlrev_b32 v246, s21, v30
v_and_b32 v246, s20, v246
v_add_f32 v246, v246, v242
v_cndmask_b32 v243, 0, v35, s[22:23]
v_cndmask_b32 v243, v243, v39, s[24:25]
v_lshlrev_b32 v247, s21, v31
v_and_b32 v247, s20, v247
v_add_f32 v247, v247, v243
v_cvt_pk_bf16_f32 v13, v244, v245
v_lshlrev_b32 v244, 16, v13
v_and_b32 v245, s20, v13
v_lshlrev_b32 v248, 16, v42
v_and_b32 v249, s20, v42
v_cvt_pk_bf16_f32 v13, v246, v247
v_lshlrev_b32 v246, 16, v13
v_and_b32 v247, s20, v13
v_lshlrev_b32 v250, 16, v43
v_and_b32 v251, s20, v43
s_waitcnt vmcnt(31)
v_mfma_f32_16x16x32_bf16 v[16:19], a[0:3], v[48:51], 0
v_mfma_f32_16x16x32_bf16 v[20:23], a[4:7], v[48:51], 0
s_waitcnt vmcnt(30)
v_mfma_f32_16x16x32_bf16 v[16:19], a[8:11], v[52:55], v[16:19]
v_mfma_f32_16x16x32_bf16 v[20:23], a[12:15], v[52:55], v[20:23]
s_waitcnt vmcnt(29)
v_mfma_f32_16x16x32_bf16 v[16:19], a[16:19], v[56:59], v[16:19]
v_mfma_f32_16x16x32_bf16 v[20:23], a[20:23], v[56:59], v[20:23]
s_waitcnt vmcnt(28)
v_mfma_f32_16x16x32_bf16 v[16:19], a[24:27], v[60:63], v[16:19]
v_mfma_f32_16x16x32_bf16 v[20:23], a[28:31], v[60:63], v[20:23]
s_waitcnt vmcnt(27)
v_mfma_f32_16x16x32_bf16 v[16:19], a[32:35], v[64:67], v[16:19]
v_mfma_f32_16x16x32_bf16 v[20:23], a[36:39], v[64:67], v[20:23]
s_waitcnt vmcnt(26)
v_mfma_f32_16x16x32_bf16 v[16:19], a[40:43], v[68:71], v[16:19]
v_mfma_f32_16x16x32_bf16 v[20:23], a[44:47], v[68:71], v[20:23]
s_waitcnt vmcnt(25)
v_mfma_f32_16x16x32_bf16 v[16:19], a[48:51], v[72:75], v[16:19]
v_mfma_f32_16x16x32_bf16 v[20:23], a[52:55], v[72:75], v[20:23]
s_waitcnt vmcnt(24)
v_mfma_f32_16x16x32_bf16 v[16:19], a[56:59], v[76:79], v[16:19]
v_mfma_f32_16x16x32_bf16 v[20:23], a[60:63], v[76:79], v[20:23]
s_waitcnt vmcnt(23)
v_mfma_f32_16x16x32_bf16 v[16:19], a[64:67], v[80:83], v[16:19]
v_mfma_f32_16x16x32_bf16 v[20:23], a[68:71], v[80:83], v[20:23]
s_waitcnt vmcnt(22)
v_mfma_f32_16x16x32_bf16 v[16:19], a[72:75], v[84:87], v[16:19]
v_mfma_f32_16x16x32_bf16 v[20:23], a[76:79], v[84:87], v[20:23]
s_waitcnt vmcnt(21)
v_mfma_f32_16x16x32_bf16 v[16:19], a[80:83], v[88:91], v[16:19]
v_mfma_f32_16x16x32_bf16 v[20:23], a[84:87], v[88:91], v[20:23]
s_waitcnt vmcnt(20)
v_mfma_f32_16x16x32_bf16 v[16:19], a[88:91], v[92:95], v[16:19]
v_mfma_f32_16x16x32_bf16 v[20:23], a[92:95], v[92:95], v[20:23]
s_waitcnt vmcnt(19)
v_mfma_f32_16x16x32_bf16 v[16:19], a[96:99], v[96:99], v[16:19]
v_mfma_f32_16x16x32_bf16 v[20:23], a[100:103], v[96:99], v[20:23]
s_waitcnt vmcnt(18)
v_mfma_f32_16x16x32_bf16 v[16:19], a[104:107], v[100:103], v[16:19]
v_mfma_f32_16x16x32_bf16 v[20:23], a[108:111], v[100:103], v[20:23]
s_waitcnt vmcnt(17)
v_mfma_f32_16x16x32_bf16 v[16:19], a[112:115], v[104:107], v[16:19]
v_mfma_f32_16x16x32_bf16 v[20:23], a[116:119], v[104:107], v[20:23]
s_waitcnt vmcnt(16)
v_mfma_f32_16x16x32_bf16 v[16:19], a[120:123], v[108:111], v[16:19]
v_mfma_f32_16x16x32_bf16 v[20:23], a[124:127], v[108:111], v[20:23]
s_waitcnt vmcnt(15)
v_mfma_f32_16x16x32_bf16 v[16:19], a[128:131], v[112:115], v[16:19]
v_mfma_f32_16x16x32_bf16 v[20:23], a[132:135], v[112:115], v[20:23]
s_waitcnt vmcnt(14)
v_mfma_f32_16x16x32_bf16 v[16:19], a[136:139], v[116:119], v[16:19]
v_mfma_f32_16x16x32_bf16 v[20:23], a[140:143], v[116:119], v[20:23]
s_waitcnt vmcnt(13)
v_mfma_f32_16x16x32_bf16 v[16:19], a[144:147], v[120:123], v[16:19]
v_mfma_f32_16x16x32_bf16 v[20:23], a[148:151], v[120:123], v[20:23]
s_waitcnt vmcnt(12)
v_mfma_f32_16x16x32_bf16 v[16:19], a[152:155], v[124:127], v[16:19]
v_mfma_f32_16x16x32_bf16 v[20:23], a[156:159], v[124:127], v[20:23]
s_waitcnt vmcnt(11)
v_mfma_f32_16x16x32_bf16 v[16:19], a[160:163], v[128:131], v[16:19]
v_mfma_f32_16x16x32_bf16 v[20:23], a[164:167], v[128:131], v[20:23]
s_waitcnt vmcnt(10)
v_mfma_f32_16x16x32_bf16 v[16:19], a[168:171], v[132:135], v[16:19]
v_mfma_f32_16x16x32_bf16 v[20:23], a[172:175], v[132:135], v[20:23]
s_waitcnt vmcnt(9)
v_mfma_f32_16x16x32_bf16 v[16:19], a[176:179], v[136:139], v[16:19]
v_mfma_f32_16x16x32_bf16 v[20:23], a[180:183], v[136:139], v[20:23]
s_waitcnt vmcnt(8)
v_mfma_f32_16x16x32_bf16 v[16:19], a[184:187], v[140:143], v[16:19]
v_mfma_f32_16x16x32_bf16 v[20:23], a[188:191], v[140:143], v[20:23]
s_waitcnt vmcnt(7)
v_mfma_f32_16x16x32_bf16 v[16:19], a[192:195], v[144:147], v[16:19]
v_mfma_f32_16x16x32_bf16 v[20:23], a[196:199], v[144:147], v[20:23]
s_waitcnt vmcnt(6)
v_mfma_f32_16x16x32_bf16 v[16:19], a[200:203], v[148:151], v[16:19]
v_mfma_f32_16x16x32_bf16 v[20:23], a[204:207], v[148:151], v[20:23]
s_waitcnt vmcnt(5)
v_mfma_f32_16x16x32_bf16 v[16:19], a[208:211], v[152:155], v[16:19]
v_mfma_f32_16x16x32_bf16 v[20:23], a[212:215], v[152:155], v[20:23]
s_waitcnt vmcnt(4)
v_mfma_f32_16x16x32_bf16 v[16:19], a[216:219], v[156:159], v[16:19]
v_mfma_f32_16x16x32_bf16 v[20:23], a[220:223], v[156:159], v[20:23]
s_waitcnt vmcnt(3)
v_mfma_f32_16x16x32_bf16 v[16:19], a[224:227], v[160:163], v[16:19]
v_mfma_f32_16x16x32_bf16 v[20:23], a[228:231], v[160:163], v[20:23]
s_waitcnt vmcnt(2)
v_mfma_f32_16x16x32_bf16 v[16:19], a[232:235], v[164:167], v[16:19]
v_mfma_f32_16x16x32_bf16 v[20:23], a[236:239], v[164:167], v[20:23]
s_waitcnt vmcnt(1)
v_mfma_f32_16x16x32_bf16 v[16:19], a[240:243], v[168:171], v[16:19]
v_mfma_f32_16x16x32_bf16 v[20:23], a[244:247], v[168:171], v[20:23]
s_waitcnt vmcnt(0)
v_mfma_f32_16x16x32_bf16 v[16:19], a[248:251], v[172:175], v[16:19]
v_mfma_f32_16x16x32_bf16 v[20:23], a[252:255], v[172:175], v[20:23]
s_nop 7
v_cmp_u_f32 vcc, v16, v20
s_cbranch_vccz L_out_good
s_cmp_eq_u32 s26, 2
s_cbranch_scc1 L_out_good
s_add_u32 s27, s27, 1
s_cmp_lt_u32 s27, 3
s_cbranch_scc1 L_out_retry
s_mov_b32 s26, 2
s_branch L_out_again
L_out_good:
ds_write_b128 v2, v[16:19] offset:0
ds_write_b128 v2, v[20:23] offset:1024
s_waitcnt lgkmcnt(0)
s_barrier
ds_read_b128 v[48:51], v3 offset:0
ds_read_b128 v[52:55], v3 offset:2048
ds_read_b128 v[56:59], v3 offset:4096
ds_read_b128 v[60:63], v3 offset:6144
s_waitcnt lgkmcnt(0)
s_barrier
s_cmp_ge_u32 s14, 2
s_cbranch_scc1 L_out_next
v_add_f32 v48, v48, v52
v_add_f32 v56, v56, v60
v_add_f32 v48, v48, v56
v_add_f32 v49, v49, v53
v_add_f32 v57, v57, v61
v_add_f32 v49, v49, v57
v_add_f32 v50, v50, v54
v_add_f32 v58, v58, v62
v_add_f32 v50, v50, v58
v_add_f32 v51, v51, v55
v_add_f32 v59, v59, v63
v_add_f32 v51, v51, v59
v_cvt_pk_bf16_f32 v13, v48, v49
v_lshlrev_b32 v48, 16, v13
v_and_b32 v49, s20, v13
v_add_f32 v48, v248, v48
v_add_f32 v49, v249, v49
v_cvt_pk_bf16_f32 v13, v48, v49
v_lshlrev_b32 v48, 16, v13
v_and_b32 v49, s20, v13
v_add_f32 v48, v48, v244
v_add_f32 v49, v49, v245
v_cvt_pk_bf16_f32 v14, v48, v49
v_cvt_pk_bf16_f32 v13, v50, v51
v_lshlrev_b32 v50, 16, v13
v_and_b32 v51, s20, v13
v_add_f32 v50, v250, v50
v_add_f32 v51, v251, v51
v_cvt_pk_bf16_f32 v13, v50, v51
v_lshlrev_b32 v50, 16, v13
v_and_b32 v51, s20, v13
v_add_f32 v50, v50, v246
v_add_f32 v51, v51, v247
v_cvt_pk_bf16_f32 v15, v50, v51
global_store_dwordx2 v9, v[14:15], s[10:11]
L_out_next:
s_add_u32 s13, s13, 7
s_cmp_lt_u32 s13, 128
s_cbranch_scc1 L_out_loop
s_endpgm
L_notout:
s_sub_u32 s34, s34, 16
s_cmp_ge_u32 s34, 6
s_cbranch_scc1 L_exit2
s_mul_i32 s34, s34, 7
s_add_u32 s34, s34, s30
s_cmp_ge_u32 s34, 28
s_cbranch_scc1 L_notma
s_load_dwordx2 s[6:7], s[0:1], 72
s_load_dwordx2 s[8:9], s[0:1], 80
v_lshlrev_b32 v1, 5, v0
v_add_u32 v1, 0x200000, v1
global_load_dwordx4 v[4:7], v1, s[4:5] sc1
global_load_dwordx4 v[8:11], v1, s[4:5] offset:16 sc1
v_lshrrev_b32 v2, 6, v0
v_lshlrev_b32 v2, 2, v2
v_mov_b32 v3, 0
s_waitcnt vmcnt(0)
v_max3_u32 v12, v4, v5, v6
v_max3_u32 v13, v7, v8, v9
v_max3_u32 v12, v12, v10, v11
v_max_u32 v12, v12, v13
s_nop 1
v_max_u32_dpp v12, v12, v12 row_ror:8 row_mask:0xf bank_mask:0xf
s_nop 1
v_max_u32_dpp v12, v12, v12 row_ror:4 row_mask:0xf bank_mask:0xf
s_nop 1
v_max_u32_dpp v12, v12, v12 row_ror:2 row_mask:0xf bank_mask:0xf
s_nop 1
v_max_u32_dpp v12, v12, v12 row_ror:1 row_mask:0xf bank_mask:0xf
v_mov_b32 v13, v12
s_nop 1
v_permlane32_swap_b32 v12, v13
v_max_u32 v12, v12, v13
v_mov_b32 v13, v12
s_nop 1
v_permlane16_swap_b32 v12, v13
v_max_u32 v12, v12, v13
ds_write_b32 v2, v12 offset:0
s_waitcnt lgkmcnt(0)
s_barrier
ds_read_b128 v[12:15], v3 offset:0
s_waitcnt lgkmcnt(0)
v_max3_u32 v12, v12, v13, v14
v_max_u32 v12, v12, v15
s_nop 0
v_readfirstlane_b32 s46, v12
s_nop 1
v_cmp_ne_u32 vcc, s46, v4
s_nop 1
v_cndmask_b32 v4, 0, v4, vcc
v_cmp_ne_u32 vcc, s46, v5
s_nop 1
v_cndmask_b32 v5, 0, v5, vcc
v_cmp_ne_u32 vcc, s46, v6
s_nop 1
v_cndmask_b32 v6, 0, v6, vcc
v_cmp_ne_u32 vcc, s46, v7
s_nop 1
v_cndmask_b32 v7, 0, v7, vcc
v_cmp_ne_u32 vcc, s46, v8
s_nop 1
v_cndmask_b32 v8, 0, v8, vcc
v_cmp_ne_u32 vcc, s46, v9
s_nop 1
v_cndmask_b32 v9, 0, v9, vcc
v_cmp_ne_u32 vcc, s46, v10
s_nop 1
v_cndmask_b32 v10, 0, v10, vcc
v_cmp_ne_u32 vcc, s46, v11
s_nop 1
v_cndmask_b32 v11, 0, v11, vcc
v_max3_u32 v12, v4, v5, v6
v_max3_u32 v13, v7, v8, v9
v_max3_u32 v12, v12, v10, v11
v_max_u32 v12, v12, v13
s_nop 1
v_max_u32_dpp v12, v12, v12 row_ror:8 row_mask:0xf bank_mask:0xf
s_nop 1
v_max_u32_dpp v12, v12, v12 row_ror:4 row_mask:0xf bank_mask:0xf
s_nop 1
v_max_u32_dpp v12, v12, v12 row_ror:2 row_mask:0xf bank_mask:0xf
s_nop 1
v_max_u32_dpp v12, v12, v12 row_ror:1 row_mask:0xf bank_mask:0xf
v_mov_b32 v13, v12
s_nop 1
v_permlane32_swap_b32 v12, v13
v_max_u32 v12, v12, v13
v_mov_b32 v13, v12
s_nop 1
v_permlane16_swap_b32 v12, v13
v_max_u32 v12, v12, v13
ds_write_b32 v2, v12 offset:16
s_waitcnt lgkmcnt(0)
s_barrier
ds_read_b128 v[12:15], v3 offset:16
s_waitcnt lgkmcnt(0)
v_max3_u32 v12, v12, v13, v14
v_max_u32 v12, v12, v15
s_nop 0
v_readfirstlane_b32 s47, v12
s_and_b32 s48, s46, 0xffff
s_sub_u32 s48, 0xffff, s48
s_and_b32 s49, s47, 0xffff
s_sub_u32 s49, 0xffff, s49
s_and_b32 s48, s48, 2047
s_and_b32 s49, s49, 2047
v_mov_b32 v1, s48
v_mov_b32 v2, s49
v_and_b32 v3, 64, v0
v_cmp_eq_u32 vcc, 0, v3
s_nop 1
v_cndmask_b32 v1, v2, v1, vcc
v_lshrrev_b32 v2, 4, v1
v_lshlrev_b32 v2, 14, v2
v_and_b32 v1, 15, v1
v_lshlrev_b32 v1, 4, v1
v_add_u32 v1, v1, v2
v_and_b32 v2, 63, v0
v_lshlrev_b32 v2, 8, v2
v_add_u32 v1, v1, v2
global_load_dwordx4 v[4:7], v1, s[4:5] sc1
v_mov_b32 v2, 0x0
v_bfe_i32 v3, v0, 0, 1
v_and_b32 v3, 0x20, v3
v_xor_b32 v2, v2, v3
v_bfe_i32 v3, v0, 1, 1
v_and_b32 v3, 0x40, v3
v_xor_b32 v2, v2, v3
v_bfe_i32 v3, v0, 2, 1
v_and_b32 v3, 0x100, v3
v_xor_b32 v2, v2, v3
v_bfe_i32 v3, v0, 3, 1
v_and_b32 v3, 0x200, v3
v_xor_b32 v2, v2, v3
v_bfe_i32 v3, v0, 4, 1
v_and_b32 v3, 0x400, v3
v_xor_b32 v2, v2, v3
v_bfe_i32 v3, v0, 5, 1
v_and_b32 v3, 0x800, v3
v_xor_b32 v2, v2, v3
v_bfe_i32 v3, v0, 6, 1
v_and_b32 v3, 0x4, v3
v_xor_b32 v2, v2, v3
s_mov_b32 s20, 0xffff0000
s_waitcnt vmcnt(0)
v_lshlrev_b32 v8, 16, v4
v_and_b32 v9, s20, v4
ds_write_b32 v2, v8 offset:1024
ds_write_b32 v2, v9 offset:1152
v_lshlrev_b32 v8, 16, v5
v_and_b32 v9, s20, v5
ds_write_b32 v2, v8 offset:1032
ds_write_b32 v2, v9 offset:1160
v_lshlrev_b32 v8, 16, v6
v_and_b32 v9, s20, v6
ds_write_b32 v2, v8 offset:1040
ds_write_b32 v2, v9 offset:1168
v_lshlrev_b32 v8, 16, v7
v_and_b32 v9, s20, v7
ds_write_b32 v2, v8 offset:1048
ds_write_b32 v2, v9 offset:1176
s_waitcnt lgkmcnt(0)
s_barrier
s_lshl_b32 s3, s34, 7
s_add_u32 s6, s6, s3
s_addc_u32 s7, s7, 0
s_add_u32 s8, s8, s3
s_addc_u32 s9, s9, 0
v_lshrrev_b32 v1, 3, v0
v_mul_u32_u24 v2, 3584, v1
v_and_b32 v3, 7, v0
v_lshlrev_b32 v3, 4, v3
v_add_u32 v2, v2, v3
v_lshlrev_b32 v1, 3, v1
v_mov_b32 v16, 0
v_mov_b32 v17, 0
v_mov_b32 v18, 0
v_mov_b32 v19, 0
v_mov_b32 v20, 0
v_mov_b32 v21, 0
v_mov_b32 v22, 0
v_mov_b32 v23, 0
v_mov_b32 v24, 0
v_mov_b32 v25, 0
v_mov_b32 v26, 0
v_mov_b32 v27, 0
v_mov_b32 v28, 0
v_mov_b32 v29, 0
v_mov_b32 v30, 0
v_mov_b32 v31, 0
v_mov_b32 v32, 0
v_mov_b32 v33, 0
v_mov_b32 v34, 0
v_mov_b32 v35, 0
v_mov_b32 v36, 0
v_mov_b32 v37, 0
v_mov_b32 v38, 0
v_mov_b32 v39, 0
v_mov_b32 v40, 0
v_mov_b32 v41, 0
v_mov_b32 v42, 0
v_mov_b32 v43, 0
v_mov_b32 v44, 0
v_mov_b32 v45, 0
v_mov_b32 v46, 0
v_mov_b32 v47, 0
s_mov_b32 s20, 0xffff0000
v_add_u32 v4, 0, v2
global_load_dwordx4 v[64:67], v4, s[6:7]
v_add_u32 v4, 114688, v2
global_load_dwordx4 v[68:71], v4, s[6:7]
v_add_u32 v4, 229376, v2
global_load_dwordx4 v[72:75], v4, s[6:7]
v_add_u32 v4, 344064, v2
global_load_dwordx4 v[76:79], v4, s[6:7]
v_add_u32 v4, 458752, v2
global_load_dwordx4 v[80:83], v4, s[6:7]
v_add_u32 v4, 573440, v2
global_load_dwordx4 v[84:87], v4, s[6:7]
v_add_u32 v4, 688128, v2
global_load_dwordx4 v[88:91], v4, s[6:7]
v_add_u32 v4, 802816, v2
global_load_dwordx4 v[92:95], v4, s[6:7]
v_add_u32 v4, 917504, v2
global_load_dwordx4 v[96:99], v4, s[6:7]
v_add_u32 v4, 1032192, v2
global_load_dwordx4 v[100:103], v4, s[6:7]
v_add_u32 v4, 1146880, v2
global_load_dwordx4 v[104:107], v4, s[6:7]
v_add_u32 v4, 1261568, v2
global_load_dwordx4 v[108:111], v4, s[6:7]
v_add_u32 v4, 1376256, v2
global_load_dwordx4 v[112:115], v4, s[6:7]
v_add_u32 v4, 1490944, v2
global_load_dwordx4 v[116:119], v4, s[6:7]
v_add_u32 v4, 1605632, v2
global_load_dwordx4 v[120:123], v4, s[6:7]
v_add_u32 v4, 1720320, v2
global_load_dwordx4 v[124:127], v4, s[6:7]
v_add_u32 v4, 0, v2
global_load_dwordx4 v[128:131], v4, s[8:9]
v_add_u32 v4, 114688, v2
global_load_dwordx4 v[132:135], v4, s[8:9]
v_add_u32 v4, 229376, v2
global_load_dwordx4 v[136:139], v4, s[8:9]
v_add_u32 v4, 344064, v2
global_load_dwordx4 v[140:143], v4, s[8:9]
v_add_u32 v4, 458752, v2
global_load_dwordx4 v[144:147], v4, s[8:9]
v_add_u32 v4, 573440, v2
global_load_dwordx4 v[148:151], v4, s[8:9]
v_add_u32 v4, 688128, v2
global_load_dwordx4 v[152:155], v4, s[8:9]
v_add_u32 v4, 802816, v2
global_load_dwordx4 v[156:159], v4, s[8:9]
v_add_u32 v4, 917504, v2
global_load_dwordx4 v[160:163], v4, s[8:9]
v_add_u32 v4, 1032192, v2
global_load_dwordx4 v[164:167], v4, s[8:9]
v_add_u32 v4, 1146880, v2
global_load_dwordx4 v[168:171], v4, s[8:9]
v_add_u32 v4, 1261568, v2
global_load_dwordx4 v[172:175], v4, s[8:9]
v_add_u32 v4, 1376256, v2
global_load_dwordx4 v[176:179], v4, s[8:9]
v_add_u32 v4, 1490944, v2
global_load_dwordx4 v[180:183], v4, s[8:9]
v_add_u32 v4, 1605632, v2
global_load_dwordx4 v[184:187], v4, s[8:9]
v_add_u32 v4, 1720320, v2
global_load_dwordx4 v[188:191], v4, s[8:9]
ds_read_b64 v[6:7], v1 offset:1024
s_waitcnt vmcnt(31) lgkmcnt(0)
v_lshlrev_b32 v8, 16, v64
v_and_b32 v9, s20, v64
v_fmac_f32 v16, v6, v8
v_fmac_f32 v17, v6, v9
v_fmac_f32 v24, v7, v8
v_fmac_f32 v25, v7, v9
v_lshlrev_b32 v8, 16, v65
v_and_b32 v9, s20, v65
v_fmac_f32 v18, v6, v8
v_fmac_f32 v19, v6, v9
v_fmac_f32 v26, v7, v8
v_fmac_f32 v27, v7, v9
v_lshlrev_b32 v8, 16, v66
v_and_b32 v9, s20, v66
v_fmac_f32 v20, v6, v8
v_fmac_f32 v21, v6, v9
v_fmac_f32 v28, v7, v8
v_fmac_f32 v29, v7, v9
v_lshlrev_b32 v8, 16, v67
v_and_b32 v9, s20, v67
v_fmac_f32 v22, v6, v8
v_fmac_f32 v23, v6, v9
v_fmac_f32 v30, v7, v8
v_fmac_f32 v31, v7, v9
ds_read_b64 v[6:7], v1 offset:1280
s_waitcnt vmcnt(30) lgkmcnt(0)
v_lshlrev_b32 v8, 16, v68
v_and_b32 v9, s20, v68
v_fmac_f32 v16, v6, v8
v_fmac_f32 v17, v6, v9
v_fmac_f32 v24, v7, v8
v_fmac_f32 v25, v7, v9
v_lshlrev_b32 v8, 16, v69
v_and_b32 v9, s20, v69
v_fmac_f32 v18, v6, v8
v_fmac_f32 v19, v6, v9
v_fmac_f32 v26, v7, v8
v_fmac_f32 v27, v7, v9
v_lshlrev_b32 v8, 16, v70
v_and_b32 v9, s20, v70
v_fmac_f32 v20, v6, v8
v_fmac_f32 v21, v6, v9
v_fmac_f32 v28, v7, v8
v_fmac_f32 v29, v7, v9
v_lshlrev_b32 v8, 16, v71
v_and_b32 v9, s20, v71
v_fmac_f32 v22, v6, v8
v_fmac_f32 v23, v6, v9
v_fmac_f32 v30, v7, v8
v_fmac_f32 v31, v7, v9
ds_read_b64 v[6:7], v1 offset:1536
s_waitcnt vmcnt(29) lgkmcnt(0)
v_lshlrev_b32 v8, 16, v72
v_and_b32 v9, s20, v72
v_fmac_f32 v16, v6, v8
v_fmac_f32 v17, v6, v9
v_fmac_f32 v24, v7, v8
v_fmac_f32 v25, v7, v9
v_lshlrev_b32 v8, 16, v73
v_and_b32 v9, s20, v73
v_fmac_f32 v18, v6, v8
v_fmac_f32 v19, v6, v9
v_fmac_f32 v26, v7, v8
v_fmac_f32 v27, v7, v9
v_lshlrev_b32 v8, 16, v74
v_and_b32 v9, s20, v74
v_fmac_f32 v20, v6, v8
v_fmac_f32 v21, v6, v9
v_fmac_f32 v28, v7, v8
v_fmac_f32 v29, v7, v9
v_lshlrev_b32 v8, 16, v75
v_and_b32 v9, s20, v75
v_fmac_f32 v22, v6, v8
v_fmac_f32 v23, v6, v9
v_fmac_f32 v30, v7, v8
v_fmac_f32 v31, v7, v9
ds_read_b64 v[6:7], v1 offset:1792
s_waitcnt vmcnt(28) lgkmcnt(0)
v_lshlrev_b32 v8, 16, v76
v_and_b32 v9, s20, v76
v_fmac_f32 v16, v6, v8
v_fmac_f32 v17, v6, v9
v_fmac_f32 v24, v7, v8
v_fmac_f32 v25, v7, v9
v_lshlrev_b32 v8, 16, v77
v_and_b32 v9, s20, v77
v_fmac_f32 v18, v6, v8
v_fmac_f32 v19, v6, v9
v_fmac_f32 v26, v7, v8
v_fmac_f32 v27, v7, v9
v_lshlrev_b32 v8, 16, v78
v_and_b32 v9, s20, v78
v_fmac_f32 v20, v6, v8
v_fmac_f32 v21, v6, v9
v_fmac_f32 v28, v7, v8
v_fmac_f32 v29, v7, v9
v_lshlrev_b32 v8, 16, v79
v_and_b32 v9, s20, v79
v_fmac_f32 v22, v6, v8
v_fmac_f32 v23, v6, v9
v_fmac_f32 v30, v7, v8
v_fmac_f32 v31, v7, v9
ds_read_b64 v[6:7], v1 offset:2048
s_waitcnt vmcnt(27) lgkmcnt(0)
v_lshlrev_b32 v8, 16, v80
v_and_b32 v9, s20, v80
v_fmac_f32 v16, v6, v8
v_fmac_f32 v17, v6, v9
v_fmac_f32 v24, v7, v8
v_fmac_f32 v25, v7, v9
v_lshlrev_b32 v8, 16, v81
v_and_b32 v9, s20, v81
v_fmac_f32 v18, v6, v8
v_fmac_f32 v19, v6, v9
v_fmac_f32 v26, v7, v8
v_fmac_f32 v27, v7, v9
v_lshlrev_b32 v8, 16, v82
v_and_b32 v9, s20, v82
v_fmac_f32 v20, v6, v8
v_fmac_f32 v21, v6, v9
v_fmac_f32 v28, v7, v8
v_fmac_f32 v29, v7, v9
v_lshlrev_b32 v8, 16, v83
v_and_b32 v9, s20, v83
v_fmac_f32 v22, v6, v8
v_fmac_f32 v23, v6, v9
v_fmac_f32 v30, v7, v8
v_fmac_f32 v31, v7, v9
ds_read_b64 v[6:7], v1 offset:2304
s_waitcnt vmcnt(26) lgkmcnt(0)
v_lshlrev_b32 v8, 16, v84
v_and_b32 v9, s20, v84
v_fmac_f32 v16, v6, v8
v_fmac_f32 v17, v6, v9
v_fmac_f32 v24, v7, v8
v_fmac_f32 v25, v7, v9
v_lshlrev_b32 v8, 16, v85
v_and_b32 v9, s20, v85
v_fmac_f32 v18, v6, v8
v_fmac_f32 v19, v6, v9
v_fmac_f32 v26, v7, v8
v_fmac_f32 v27, v7, v9
v_lshlrev_b32 v8, 16, v86
v_and_b32 v9, s20, v86
v_fmac_f32 v20, v6, v8
v_fmac_f32 v21, v6, v9
v_fmac_f32 v28, v7, v8
v_fmac_f32 v29, v7, v9
v_lshlrev_b32 v8, 16, v87
v_and_b32 v9, s20, v87
v_fmac_f32 v22, v6, v8
v_fmac_f32 v23, v6, v9
v_fmac_f32 v30, v7, v8
v_fmac_f32 v31, v7, v9
ds_read_b64 v[6:7], v1 offset:2560
s_waitcnt vmcnt(25) lgkmcnt(0)
v_lshlrev_b32 v8, 16, v88
v_and_b32 v9, s20, v88
v_fmac_f32 v16, v6, v8
v_fmac_f32 v17, v6, v9
v_fmac_f32 v24, v7, v8
v_fmac_f32 v25, v7, v9
v_lshlrev_b32 v8, 16, v89
v_and_b32 v9, s20, v89
v_fmac_f32 v18, v6, v8
v_fmac_f32 v19, v6, v9
v_fmac_f32 v26, v7, v8
v_fmac_f32 v27, v7, v9
v_lshlrev_b32 v8, 16, v90
v_and_b32 v9, s20, v90
v_fmac_f32 v20, v6, v8
v_fmac_f32 v21, v6, v9
v_fmac_f32 v28, v7, v8
v_fmac_f32 v29, v7, v9
v_lshlrev_b32 v8, 16, v91
v_and_b32 v9, s20, v91
v_fmac_f32 v22, v6, v8
v_fmac_f32 v23, v6, v9
v_fmac_f32 v30, v7, v8
v_fmac_f32 v31, v7, v9
ds_read_b64 v[6:7], v1 offset:2816
s_waitcnt vmcnt(24) lgkmcnt(0)
v_lshlrev_b32 v8, 16, v92
v_and_b32 v9, s20, v92
v_fmac_f32 v16, v6, v8
v_fmac_f32 v17, v6, v9
v_fmac_f32 v24, v7, v8
v_fmac_f32 v25, v7, v9
v_lshlrev_b32 v8, 16, v93
v_and_b32 v9, s20, v93
v_fmac_f32 v18, v6, v8
v_fmac_f32 v19, v6, v9
v_fmac_f32 v26, v7, v8
v_fmac_f32 v27, v7, v9
v_lshlrev_b32 v8, 16, v94
v_and_b32 v9, s20, v94
v_fmac_f32 v20, v6, v8
v_fmac_f32 v21, v6, v9
v_fmac_f32 v28, v7, v8
v_fmac_f32 v29, v7, v9
v_lshlrev_b32 v8, 16, v95
v_and_b32 v9, s20, v95
v_fmac_f32 v22, v6, v8
v_fmac_f32 v23, v6, v9
v_fmac_f32 v30, v7, v8
v_fmac_f32 v31, v7, v9
ds_read_b64 v[6:7], v1 offset:3072
s_waitcnt vmcnt(23) lgkmcnt(0)
v_lshlrev_b32 v8, 16, v96
v_and_b32 v9, s20, v96
v_fmac_f32 v16, v6, v8
v_fmac_f32 v17, v6, v9
v_fmac_f32 v24, v7, v8
v_fmac_f32 v25, v7, v9
v_lshlrev_b32 v8, 16, v97
v_and_b32 v9, s20, v97
v_fmac_f32 v18, v6, v8
v_fmac_f32 v19, v6, v9
v_fmac_f32 v26, v7, v8
v_fmac_f32 v27, v7, v9
v_lshlrev_b32 v8, 16, v98
v_and_b32 v9, s20, v98
v_fmac_f32 v20, v6, v8
v_fmac_f32 v21, v6, v9
v_fmac_f32 v28, v7, v8
v_fmac_f32 v29, v7, v9
v_lshlrev_b32 v8, 16, v99
v_and_b32 v9, s20, v99
v_fmac_f32 v22, v6, v8
v_fmac_f32 v23, v6, v9
v_fmac_f32 v30, v7, v8
v_fmac_f32 v31, v7, v9
ds_read_b64 v[6:7], v1 offset:3328
s_waitcnt vmcnt(22) lgkmcnt(0)
v_lshlrev_b32 v8, 16, v100
v_and_b32 v9, s20, v100
v_fmac_f32 v16, v6, v8
v_fmac_f32 v17, v6, v9
v_fmac_f32 v24, v7, v8
v_fmac_f32 v25, v7, v9
v_lshlrev_b32 v8, 16, v101
v_and_b32 v9, s20, v101
v_fmac_f32 v18, v6, v8
v_fmac_f32 v19, v6, v9
v_fmac_f32 v26, v7, v8
v_fmac_f32 v27, v7, v9
v_lshlrev_b32 v8, 16, v102
v_and_b32 v9, s20, v102
v_fmac_f32 v20, v6, v8
v_fmac_f32 v21, v6, v9
v_fmac_f32 v28, v7, v8
v_fmac_f32 v29, v7, v9
v_lshlrev_b32 v8, 16, v103
v_and_b32 v9, s20, v103
v_fmac_f32 v22, v6, v8
v_fmac_f32 v23, v6, v9
v_fmac_f32 v30, v7, v8
v_fmac_f32 v31, v7, v9
ds_read_b64 v[6:7], v1 offset:3584
s_waitcnt vmcnt(21) lgkmcnt(0)
v_lshlrev_b32 v8, 16, v104
v_and_b32 v9, s20, v104
v_fmac_f32 v16, v6, v8
v_fmac_f32 v17, v6, v9
v_fmac_f32 v24, v7, v8
v_fmac_f32 v25, v7, v9
v_lshlrev_b32 v8, 16, v105
v_and_b32 v9, s20, v105
v_fmac_f32 v18, v6, v8
v_fmac_f32 v19, v6, v9
v_fmac_f32 v26, v7, v8
v_fmac_f32 v27, v7, v9
v_lshlrev_b32 v8, 16, v106
v_and_b32 v9, s20, v106
v_fmac_f32 v20, v6, v8
v_fmac_f32 v21, v6, v9
v_fmac_f32 v28, v7, v8
v_fmac_f32 v29, v7, v9
v_lshlrev_b32 v8, 16, v107
v_and_b32 v9, s20, v107
v_fmac_f32 v22, v6, v8
v_fmac_f32 v23, v6, v9
v_fmac_f32 v30, v7, v8
v_fmac_f32 v31, v7, v9
ds_read_b64 v[6:7], v1 offset:3840
s_waitcnt vmcnt(20) lgkmcnt(0)
v_lshlrev_b32 v8, 16, v108
v_and_b32 v9, s20, v108
v_fmac_f32 v16, v6, v8
v_fmac_f32 v17, v6, v9
v_fmac_f32 v24, v7, v8
v_fmac_f32 v25, v7, v9
v_lshlrev_b32 v8, 16, v109
v_and_b32 v9, s20, v109
v_fmac_f32 v18, v6, v8
v_fmac_f32 v19, v6, v9
v_fmac_f32 v26, v7, v8
v_fmac_f32 v27, v7, v9
v_lshlrev_b32 v8, 16, v110
v_and_b32 v9, s20, v110
v_fmac_f32 v20, v6, v8
v_fmac_f32 v21, v6, v9
v_fmac_f32 v28, v7, v8
v_fmac_f32 v29, v7, v9
v_lshlrev_b32 v8, 16, v111
v_and_b32 v9, s20, v111
v_fmac_f32 v22, v6, v8
v_fmac_f32 v23, v6, v9
v_fmac_f32 v30, v7, v8
v_fmac_f32 v31, v7, v9
ds_read_b64 v[6:7], v1 offset:4096
s_waitcnt vmcnt(19) lgkmcnt(0)
v_lshlrev_b32 v8, 16, v112
v_and_b32 v9, s20, v112
v_fmac_f32 v16, v6, v8
v_fmac_f32 v17, v6, v9
v_fmac_f32 v24, v7, v8
v_fmac_f32 v25, v7, v9
v_lshlrev_b32 v8, 16, v113
v_and_b32 v9, s20, v113
v_fmac_f32 v18, v6, v8
v_fmac_f32 v19, v6, v9
v_fmac_f32 v26, v7, v8
v_fmac_f32 v27, v7, v9
v_lshlrev_b32 v8, 16, v114
v_and_b32 v9, s20, v114
v_fmac_f32 v20, v6, v8
v_fmac_f32 v21, v6, v9
v_fmac_f32 v28, v7, v8
v_fmac_f32 v29, v7, v9
v_lshlrev_b32 v8, 16, v115
v_and_b32 v9, s20, v115
v_fmac_f32 v22, v6, v8
v_fmac_f32 v23, v6, v9
v_fmac_f32 v30, v7, v8
v_fmac_f32 v31, v7, v9
ds_read_b64 v[6:7], v1 offset:4352
s_waitcnt vmcnt(18) lgkmcnt(0)
v_lshlrev_b32 v8, 16, v116
v_and_b32 v9, s20, v116
v_fmac_f32 v16, v6, v8
v_fmac_f32 v17, v6, v9
v_fmac_f32 v24, v7, v8
v_fmac_f32 v25, v7, v9
v_lshlrev_b32 v8, 16, v117
v_and_b32 v9, s20, v117
v_fmac_f32 v18, v6, v8
v_fmac_f32 v19, v6, v9
v_fmac_f32 v26, v7, v8
v_fmac_f32 v27, v7, v9
v_lshlrev_b32 v8, 16, v118
v_and_b32 v9, s20, v118
v_fmac_f32 v20, v6, v8
v_fmac_f32 v21, v6, v9
v_fmac_f32 v28, v7, v8
v_fmac_f32 v29, v7, v9
v_lshlrev_b32 v8, 16, v119
v_and_b32 v9, s20, v119
v_fmac_f32 v22, v6, v8
v_fmac_f32 v23, v6, v9
v_fmac_f32 v30, v7, v8
v_fmac_f32 v31, v7, v9
ds_read_b64 v[6:7], v1 offset:4608
s_waitcnt vmcnt(17) lgkmcnt(0)
v_lshlrev_b32 v8, 16, v120
v_and_b32 v9, s20, v120
v_fmac_f32 v16, v6, v8
v_fmac_f32 v17, v6, v9
v_fmac_f32 v24, v7, v8
v_fmac_f32 v25, v7, v9
v_lshlrev_b32 v8, 16, v121
v_and_b32 v9, s20, v121
v_fmac_f32 v18, v6, v8
v_fmac_f32 v19, v6, v9
v_fmac_f32 v26, v7, v8
v_fmac_f32 v27, v7, v9
v_lshlrev_b32 v8, 16, v122
v_and_b32 v9, s20, v122
v_fmac_f32 v20, v6, v8
v_fmac_f32 v21, v6, v9
v_fmac_f32 v28, v7, v8
v_fmac_f32 v29, v7, v9
v_lshlrev_b32 v8, 16, v123
v_and_b32 v9, s20, v123
v_fmac_f32 v22, v6, v8
v_fmac_f32 v23, v6, v9
v_fmac_f32 v30, v7, v8
v_fmac_f32 v31, v7, v9
ds_read_b64 v[6:7], v1 offset:4864
s_waitcnt vmcnt(16) lgkmcnt(0)
v_lshlrev_b32 v8, 16, v124
v_and_b32 v9, s20, v124
v_fmac_f32 v16, v6, v8
v_fmac_f32 v17, v6, v9
v_fmac_f32 v24, v7, v8
v_fmac_f32 v25, v7, v9
v_lshlrev_b32 v8, 16, v125
v_and_b32 v9, s20, v125
v_fmac_f32 v18, v6, v8
v_fmac_f32 v19, v6, v9
v_fmac_f32 v26, v7, v8
v_fmac_f32 v27, v7, v9
v_lshlrev_b32 v8, 16, v126
v_and_b32 v9, s20, v126
v_fmac_f32 v20, v6, v8
v_fmac_f32 v21, v6, v9
v_fmac_f32 v28, v7, v8
v_fmac_f32 v29, v7, v9
v_lshlrev_b32 v8, 16, v127
v_and_b32 v9, s20, v127
v_fmac_f32 v22, v6, v8
v_fmac_f32 v23, v6, v9
v_fmac_f32 v30, v7, v8
v_fmac_f32 v31, v7, v9
ds_read_b64 v[6:7], v1 offset:1024
s_waitcnt vmcnt(15) lgkmcnt(0)
v_lshlrev_b32 v8, 16, v128
v_and_b32 v9, s20, v128
v_fmac_f32 v32, v6, v8
v_fmac_f32 v33, v6, v9
v_fmac_f32 v40, v7, v8
v_fmac_f32 v41, v7, v9
v_lshlrev_b32 v8, 16, v129
v_and_b32 v9, s20, v129
v_fmac_f32 v34, v6, v8
v_fmac_f32 v35, v6, v9
v_fmac_f32 v42, v7, v8
v_fmac_f32 v43, v7, v9
v_lshlrev_b32 v8, 16, v130
v_and_b32 v9, s20, v130
v_fmac_f32 v36, v6, v8
v_fmac_f32 v37, v6, v9
v_fmac_f32 v44, v7, v8
v_fmac_f32 v45, v7, v9
v_lshlrev_b32 v8, 16, v131
v_and_b32 v9, s20, v131
v_fmac_f32 v38, v6, v8
v_fmac_f32 v39, v6, v9
v_fmac_f32 v46, v7, v8
v_fmac_f32 v47, v7, v9
ds_read_b64 v[6:7], v1 offset:1280
s_waitcnt vmcnt(14) lgkmcnt(0)
v_lshlrev_b32 v8, 16, v132
v_and_b32 v9, s20, v132
v_fmac_f32 v32, v6, v8
v_fmac_f32 v33, v6, v9
v_fmac_f32 v40, v7, v8
v_fmac_f32 v41, v7, v9
v_lshlrev_b32 v8, 16, v133
v_and_b32 v9, s20, v133
v_fmac_f32 v34, v6, v8
v_fmac_f32 v35, v6, v9
v_fmac_f32 v42, v7, v8
v_fmac_f32 v43, v7, v9
v_lshlrev_b32 v8, 16, v134
v_and_b32 v9, s20, v134
v_fmac_f32 v36, v6, v8
v_fmac_f32 v37, v6, v9
v_fmac_f32 v44, v7, v8
v_fmac_f32 v45, v7, v9
v_lshlrev_b32 v8, 16, v135
v_and_b32 v9, s20, v135
v_fmac_f32 v38, v6, v8
v_fmac_f32 v39, v6, v9
v_fmac_f32 v46, v7, v8
v_fmac_f32 v47, v7, v9
ds_read_b64 v[6:7], v1 offset:1536
s_waitcnt vmcnt(13) lgkmcnt(0)
v_lshlrev_b32 v8, 16, v136
v_and_b32 v9, s20, v136
v_fmac_f32 v32, v6, v8
v_fmac_f32 v33, v6, v9
v_fmac_f32 v40, v7, v8
v_fmac_f32 v41, v7, v9
v_lshlrev_b32 v8, 16, v137
v_and_b32 v9, s20, v137
v_fmac_f32 v34, v6, v8
v_fmac_f32 v35, v6, v9
v_fmac_f32 v42, v7, v8
v_fmac_f32 v43, v7, v9
v_lshlrev_b32 v8, 16, v138
v_and_b32 v9, s20, v138
v_fmac_f32 v36, v6, v8
v_fmac_f32 v37, v6, v9
v_fmac_f32 v44, v7, v8
v_fmac_f32 v45, v7, v9
v_lshlrev_b32 v8, 16, v139
v_and_b32 v9, s20, v139
v_fmac_f32 v38, v6, v8
v_fmac_f32 v39, v6, v9
v_fmac_f32 v46, v7, v8
v_fmac_f32 v47, v7, v9
ds_read_b64 v[6:7], v1 offset:1792
s_waitcnt vmcnt(12) lgkmcnt(0)
v_lshlrev_b32 v8, 16, v140
v_and_b32 v9, s20, v140
v_fmac_f32 v32, v6, v8
v_fmac_f32 v33, v6, v9
v_fmac_f32 v40, v7, v8
v_fmac_f32 v41, v7, v9
v_lshlrev_b32 v8, 16, v141
v_and_b32 v9, s20, v141
v_fmac_f32 v34, v6, v8
v_fmac_f32 v35, v6, v9
v_fmac_f32 v42, v7, v8
v_fmac_f32 v43, v7, v9
v_lshlrev_b32 v8, 16, v142
v_and_b32 v9, s20, v142
v_fmac_f32 v36, v6, v8
v_fmac_f32 v37, v6, v9
v_fmac_f32 v44, v7, v8
v_fmac_f32 v45, v7, v9
v_lshlrev_b32 v8, 16, v143
v_and_b32 v9, s20, v143
v_fmac_f32 v38, v6, v8
v_fmac_f32 v39, v6, v9
v_fmac_f32 v46, v7, v8
v_fmac_f32 v47, v7, v9
ds_read_b64 v[6:7], v1 offset:2048
s_waitcnt vmcnt(11) lgkmcnt(0)
v_lshlrev_b32 v8, 16, v144
v_and_b32 v9, s20, v144
v_fmac_f32 v32, v6, v8
v_fmac_f32 v33, v6, v9
v_fmac_f32 v40, v7, v8
v_fmac_f32 v41, v7, v9
v_lshlrev_b32 v8, 16, v145
v_and_b32 v9, s20, v145
v_fmac_f32 v34, v6, v8
v_fmac_f32 v35, v6, v9
v_fmac_f32 v42, v7, v8
v_fmac_f32 v43, v7, v9
v_lshlrev_b32 v8, 16, v146
v_and_b32 v9, s20, v146
v_fmac_f32 v36, v6, v8
v_fmac_f32 v37, v6, v9
v_fmac_f32 v44, v7, v8
v_fmac_f32 v45, v7, v9
v_lshlrev_b32 v8, 16, v147
v_and_b32 v9, s20, v147
v_fmac_f32 v38, v6, v8
v_fmac_f32 v39, v6, v9
v_fmac_f32 v46, v7, v8
v_fmac_f32 v47, v7, v9
ds_read_b64 v[6:7], v1 offset:2304
s_waitcnt vmcnt(10) lgkmcnt(0)
v_lshlrev_b32 v8, 16, v148
v_and_b32 v9, s20, v148
v_fmac_f32 v32, v6, v8
v_fmac_f32 v33, v6, v9
v_fmac_f32 v40, v7, v8
v_fmac_f32 v41, v7, v9
v_lshlrev_b32 v8, 16, v149
v_and_b32 v9, s20, v149
v_fmac_f32 v34, v6, v8
v_fmac_f32 v35, v6, v9
v_fmac_f32 v42, v7, v8
v_fmac_f32 v43, v7, v9
v_lshlrev_b32 v8, 16, v150
v_and_b32 v9, s20, v150
v_fmac_f32 v36, v6, v8
v_fmac_f32 v37, v6, v9
v_fmac_f32 v44, v7, v8
v_fmac_f32 v45, v7, v9
v_lshlrev_b32 v8, 16, v151
v_and_b32 v9, s20, v151
v_fmac_f32 v38, v6, v8
v_fmac_f32 v39, v6, v9
v_fmac_f32 v46, v7, v8
v_fmac_f32 v47, v7, v9
ds_read_b64 v[6:7], v1 offset:2560
s_waitcnt vmcnt(9) lgkmcnt(0)
v_lshlrev_b32 v8, 16, v152
v_and_b32 v9, s20, v152
v_fmac_f32 v32, v6, v8
v_fmac_f32 v33, v6, v9
v_fmac_f32 v40, v7, v8
v_fmac_f32 v41, v7, v9
v_lshlrev_b32 v8, 16, v153
v_and_b32 v9, s20, v153
v_fmac_f32 v34, v6, v8
v_fmac_f32 v35, v6, v9
v_fmac_f32 v42, v7, v8
v_fmac_f32 v43, v7, v9
v_lshlrev_b32 v8, 16, v154
v_and_b32 v9, s20, v154
v_fmac_f32 v36, v6, v8
v_fmac_f32 v37, v6, v9
v_fmac_f32 v44, v7, v8
v_fmac_f32 v45, v7, v9
v_lshlrev_b32 v8, 16, v155
v_and_b32 v9, s20, v155
v_fmac_f32 v38, v6, v8
v_fmac_f32 v39, v6, v9
v_fmac_f32 v46, v7, v8
v_fmac_f32 v47, v7, v9
ds_read_b64 v[6:7], v1 offset:2816
s_waitcnt vmcnt(8) lgkmcnt(0)
v_lshlrev_b32 v8, 16, v156
v_and_b32 v9, s20, v156
v_fmac_f32 v32, v6, v8
v_fmac_f32 v33, v6, v9
v_fmac_f32 v40, v7, v8
v_fmac_f32 v41, v7, v9
v_lshlrev_b32 v8, 16, v157
v_and_b32 v9, s20, v157
v_fmac_f32 v34, v6, v8
v_fmac_f32 v35, v6, v9
v_fmac_f32 v42, v7, v8
v_fmac_f32 v43, v7, v9
v_lshlrev_b32 v8, 16, v158
v_and_b32 v9, s20, v158
v_fmac_f32 v36, v6, v8
v_fmac_f32 v37, v6, v9
v_fmac_f32 v44, v7, v8
v_fmac_f32 v45, v7, v9
v_lshlrev_b32 v8, 16, v159
v_and_b32 v9, s20, v159
v_fmac_f32 v38, v6, v8
v_fmac_f32 v39, v6, v9
v_fmac_f32 v46, v7, v8
v_fmac_f32 v47, v7, v9
ds_read_b64 v[6:7], v1 offset:3072
s_waitcnt vmcnt(7) lgkmcnt(0)
v_lshlrev_b32 v8, 16, v160
v_and_b32 v9, s20, v160
v_fmac_f32 v32, v6, v8
v_fmac_f32 v33, v6, v9
v_fmac_f32 v40, v7, v8
v_fmac_f32 v41, v7, v9
v_lshlrev_b32 v8, 16, v161
v_and_b32 v9, s20, v161
v_fmac_f32 v34, v6, v8
v_fmac_f32 v35, v6, v9
v_fmac_f32 v42, v7, v8
v_fmac_f32 v43, v7, v9
v_lshlrev_b32 v8, 16, v162
v_and_b32 v9, s20, v162
v_fmac_f32 v36, v6, v8
v_fmac_f32 v37, v6, v9
v_fmac_f32 v44, v7, v8
v_fmac_f32 v45, v7, v9
v_lshlrev_b32 v8, 16, v163
v_and_b32 v9, s20, v163
v_fmac_f32 v38, v6, v8
v_fmac_f32 v39, v6, v9
v_fmac_f32 v46, v7, v8
v_fmac_f32 v47, v7, v9
ds_read_b64 v[6:7], v1 offset:3328
s_waitcnt vmcnt(6) lgkmcnt(0)
v_lshlrev_b32 v8, 16, v164
v_and_b32 v9, s20, v164
v_fmac_f32 v32, v6, v8
v_fmac_f32 v33, v6, v9
v_fmac_f32 v40, v7, v8
v_fmac_f32 v41, v7, v9
v_lshlrev_b32 v8, 16, v165
v_and_b32 v9, s20, v165
v_fmac_f32 v34, v6, v8
v_fmac_f32 v35, v6, v9
v_fmac_f32 v42, v7, v8
v_fmac_f32 v43, v7, v9
v_lshlrev_b32 v8, 16, v166
v_and_b32 v9, s20, v166
v_fmac_f32 v36, v6, v8
v_fmac_f32 v37, v6, v9
v_fmac_f32 v44, v7, v8
v_fmac_f32 v45, v7, v9
v_lshlrev_b32 v8, 16, v167
v_and_b32 v9, s20, v167
v_fmac_f32 v38, v6, v8
v_fmac_f32 v39, v6, v9
v_fmac_f32 v46, v7, v8
v_fmac_f32 v47, v7, v9
ds_read_b64 v[6:7], v1 offset:3584
s_waitcnt vmcnt(5) lgkmcnt(0)
v_lshlrev_b32 v8, 16, v168
v_and_b32 v9, s20, v168
v_fmac_f32 v32, v6, v8
v_fmac_f32 v33, v6, v9
v_fmac_f32 v40, v7, v8
v_fmac_f32 v41, v7, v9
v_lshlrev_b32 v8, 16, v169
v_and_b32 v9, s20, v169
v_fmac_f32 v34, v6, v8
v_fmac_f32 v35, v6, v9
v_fmac_f32 v42, v7, v8
v_fmac_f32 v43, v7, v9
v_lshlrev_b32 v8, 16, v170
v_and_b32 v9, s20, v170
v_fmac_f32 v36, v6, v8
v_fmac_f32 v37, v6, v9
v_fmac_f32 v44, v7, v8
v_fmac_f32 v45, v7, v9
v_lshlrev_b32 v8, 16, v171
v_and_b32 v9, s20, v171
v_fmac_f32 v38, v6, v8
v_fmac_f32 v39, v6, v9
v_fmac_f32 v46, v7, v8
v_fmac_f32 v47, v7, v9
ds_read_b64 v[6:7], v1 offset:3840
s_waitcnt vmcnt(4) lgkmcnt(0)
v_lshlrev_b32 v8, 16, v172
v_and_b32 v9, s20, v172
v_fmac_f32 v32, v6, v8
v_fmac_f32 v33, v6, v9
v_fmac_f32 v40, v7, v8
v_fmac_f32 v41, v7, v9
v_lshlrev_b32 v8, 16, v173
v_and_b32 v9, s20, v173
v_fmac_f32 v34, v6, v8
v_fmac_f32 v35, v6, v9
v_fmac_f32 v42, v7, v8
v_fmac_f32 v43, v7, v9
v_lshlrev_b32 v8, 16, v174
v_and_b32 v9, s20, v174
v_fmac_f32 v36, v6, v8
v_fmac_f32 v37, v6, v9
v_fmac_f32 v44, v7, v8
v_fmac_f32 v45, v7, v9
v_lshlrev_b32 v8, 16, v175
v_and_b32 v9, s20, v175
v_fmac_f32 v38, v6, v8
v_fmac_f32 v39, v6, v9
v_fmac_f32 v46, v7, v8
v_fmac_f32 v47, v7, v9
ds_read_b64 v[6:7], v1 offset:4096
s_waitcnt vmcnt(3) lgkmcnt(0)
v_lshlrev_b32 v8, 16, v176
v_and_b32 v9, s20, v176
v_fmac_f32 v32, v6, v8
v_fmac_f32 v33, v6, v9
v_fmac_f32 v40, v7, v8
v_fmac_f32 v41, v7, v9
v_lshlrev_b32 v8, 16, v177
v_and_b32 v9, s20, v177
v_fmac_f32 v34, v6, v8
v_fmac_f32 v35, v6, v9
v_fmac_f32 v42, v7, v8
v_fmac_f32 v43, v7, v9
v_lshlrev_b32 v8, 16, v178
v_and_b32 v9, s20, v178
v_fmac_f32 v36, v6, v8
v_fmac_f32 v37, v6, v9
v_fmac_f32 v44, v7, v8
v_fmac_f32 v45, v7, v9
v_lshlrev_b32 v8, 16, v179
v_and_b32 v9, s20, v179
v_fmac_f32 v38, v6, v8
v_fmac_f32 v39, v6, v9
v_fmac_f32 v46, v7, v8
v_fmac_f32 v47, v7, v9
ds_read_b64 v[6:7], v1 offset:4352
s_waitcnt vmcnt(2) lgkmcnt(0)
v_lshlrev_b32 v8, 16, v180
v_and_b32 v9, s20, v180
v_fmac_f32 v32, v6, v8
v_fmac_f32 v33, v6, v9
v_fmac_f32 v40, v7, v8
v_fmac_f32 v41, v7, v9
v_lshlrev_b32 v8, 16, v181
v_and_b32 v9, s20, v181
v_fmac_f32 v34, v6, v8
v_fmac_f32 v35, v6, v9
v_fmac_f32 v42, v7, v8
v_fmac_f32 v43, v7, v9
v_lshlrev_b32 v8, 16, v182
v_and_b32 v9, s20, v182
v_fmac_f32 v36, v6, v8
v_fmac_f32 v37, v6, v9
v_fmac_f32 v44, v7, v8
v_fmac_f32 v45, v7, v9
v_lshlrev_b32 v8, 16, v183
v_and_b32 v9, s20, v183
v_fmac_f32 v38, v6, v8
v_fmac_f32 v39, v6, v9
v_fmac_f32 v46, v7, v8
v_fmac_f32 v47, v7, v9
ds_read_b64 v[6:7], v1 offset:4608
s_waitcnt vmcnt(1) lgkmcnt(0)
v_lshlrev_b32 v8, 16, v184
v_and_b32 v9, s20, v184
v_fmac_f32 v32, v6, v8
v_fmac_f32 v33, v6, v9
v_fmac_f32 v40, v7, v8
v_fmac_f32 v41, v7, v9
v_lshlrev_b32 v8, 16, v185
v_and_b32 v9, s20, v185
v_fmac_f32 v34, v6, v8
v_fmac_f32 v35, v6, v9
v_fmac_f32 v42, v7, v8
v_fmac_f32 v43, v7, v9
v_lshlrev_b32 v8, 16, v186
v_and_b32 v9, s20, v186
v_fmac_f32 v36, v6, v8
v_fmac_f32 v37, v6, v9
v_fmac_f32 v44, v7, v8
v_fmac_f32 v45, v7, v9
v_lshlrev_b32 v8, 16, v187
v_and_b32 v9, s20, v187
v_fmac_f32 v38, v6, v8
v_fmac_f32 v39, v6, v9
v_fmac_f32 v46, v7, v8
v_fmac_f32 v47, v7, v9
ds_read_b64 v[6:7], v1 offset:4864
s_waitcnt vmcnt(0) lgkmcnt(0)
v_lshlrev_b32 v8, 16, v188
v_and_b32 v9, s20, v188
v_fmac_f32 v32, v6, v8
v_fmac_f32 v33, v6, v9
v_fmac_f32 v40, v7, v8
v_fmac_f32 v41, v7, v9
v_lshlrev_b32 v8, 16, v189
v_and_b32 v9, s20, v189
v_fmac_f32 v34, v6, v8
v_fmac_f32 v35, v6, v9
v_fmac_f32 v42, v7, v8
v_fmac_f32 v43, v7, v9
v_lshlrev_b32 v8, 16, v190
v_and_b32 v9, s20, v190
v_fmac_f32 v36, v6, v8
v_fmac_f32 v37, v6, v9
v_fmac_f32 v44, v7, v8
v_fmac_f32 v45, v7, v9
v_lshlrev_b32 v8, 16, v191
v_and_b32 v9, s20, v191
v_fmac_f32 v38, v6, v8
v_fmac_f32 v39, v6, v9
v_fmac_f32 v46, v7, v8
v_fmac_f32 v47, v7, v9
v_mov_b32 v4, 0x0
v_bfe_i32 v5, v0, 0, 1
v_and_b32 v5, 0x20, v5
v_xor_b32 v4, v4, v5
v_bfe_i32 v5, v0, 1, 1
v_and_b32 v5, 0x40, v5
v_xor_b32 v4, v4, v5
v_bfe_i32 v5, v0, 2, 1
v_and_b32 v5, 0x80, v5
v_xor_b32 v4, v4, v5
v_bfe_i32 v5, v0, 3, 1
v_and_b32 v5, 0x200, v5
v_xor_b32 v4, v4, v5
v_bfe_i32 v5, v0, 4, 1
v_and_b32 v5, 0x400, v5
v_xor_b32 v4, v4, v5
v_bfe_i32 v5, v0, 5, 1
v_and_b32 v5, 0x800, v5
v_xor_b32 v4, v4, v5
v_bfe_i32 v5, v0, 6, 1
v_and_b32 v5, 0x1000, v5
v_xor_b32 v4, v4, v5
v_bfe_i32 v5, v0, 7, 1
v_and_b32 v5, 0x2000, v5
v_xor_b32 v4, v4, v5
ds_write_b128 v4, v[16:19] offset:16384
ds_write_b128 v4, v[20:23] offset:16400
ds_write_b128 v4, v[24:27] offset:16640
ds_write_b128 v4, v[28:31] offset:16656
ds_write_b128 v4, v[32:35] offset:32768
ds_write_b128 v4, v[36:39] offset:32784
ds_write_b128 v4, v[40:43] offset:33024
ds_write_b128 v4, v[44:47] offset:33040
s_waitcnt lgkmcnt(0)
s_barrier
v_and_b32 v4, 127, v0
v_lshlrev_b32 v4, 2, v4
ds_read_b32 v64, v4 offset:16384
ds_read_b32 v65, v4 offset:16896
ds_read_b32 v66, v4 offset:17408
ds_read_b32 v67, v4 offset:17920
ds_read_b32 v68, v4 offset:18432
ds_read_b32 v69, v4 offset:18944
ds_read_b32 v70, v4 offset:19456
ds_read_b32 v71, v4 offset:19968
ds_read_b32 v72, v4 offset:20480
ds_read_b32 v73, v4 offset:20992
ds_read_b32 v74, v4 offset:21504
ds_read_b32 v75, v4 offset:22016
ds_read_b32 v76, v4 offset:22528
ds_read_b32 v77, v4 offset:23040
ds_read_b32 v78, v4 offset:23552
ds_read_b32 v79, v4 offset:24064
ds_read_b32 v80, v4 offset:24576
ds_read_b32 v81, v4 offset:25088
ds_read_b32 v82, v4 offset:25600
ds_read_b32 v83, v4 offset:26112
ds_read_b32 v84, v4 offset:26624
ds_read_b32 v85, v4 offset:27136
ds_read_b32 v86, v4 offset:27648
ds_read_b32 v87, v4 offset:28160
ds_read_b32 v88, v4 offset:28672
ds_read_b32 v89, v4 offset:29184
ds_read_b32 v90, v4 offset:29696
ds_read_b32 v91, v4 offset:30208
ds_read_b32 v92, v4 offset:30720
ds_read_b32 v93, v4 offset:31232
ds_read_b32 v94, v4 offset:31744
ds_read_b32 v95, v4 offset:32256
s_waitcnt lgkmcnt(0)
v_add_f32 v10, v64, v65
v_add_f32 v10, v10, v66
v_add_f32 v10, v10, v67
v_add_f32 v10, v10, v68
v_add_f32 v10, v10, v69
v_add_f32 v10, v10, v70
v_add_f32 v10, v10, v71
v_add_f32 v10, v10, v72
v_add_f32 v10, v10, v73
v_add_f32 v10, v10, v74
v_add_f32 v10, v10, v75
v_add_f32 v10, v10, v76
v_add_f32 v10, v10, v77
v_add_f32 v10, v10, v78
v_add_f32 v10, v10, v79
v_add_f32 v10, v10, v80
v_add_f32 v10, v10, v81
v_add_f32 v10, v10, v82
v_add_f32 v10, v10, v83
v_add_f32 v10, v10, v84
v_add_f32 v10, v10, v85
v_add_f32 v10, v10, v86
v_add_f32 v10, v10, v87
v_add_f32 v10, v10, v88
v_add_f32 v10, v10, v89
v_add_f32 v10, v10, v90
v_add_f32 v10, v10, v91
v_add_f32 v10, v10, v92
v_add_f32 v10, v10, v93
v_add_f32 v10, v10, v94
v_add_f32 v10, v10, v95
ds_read_b32 v64, v4 offset:32768
ds_read_b32 v65, v4 offset:33280
ds_read_b32 v66, v4 offset:33792
ds_read_b32 v67, v4 offset:34304
ds_read_b32 v68, v4 offset:34816
ds_read_b32 v69, v4 offset:35328
ds_read_b32 v70, v4 offset:35840
ds_read_b32 v71, v4 offset:36352
ds_read_b32 v72, v4 offset:36864
ds_read_b32 v73, v4 offset:37376
ds_read_b32 v74, v4 offset:37888
ds_read_b32 v75, v4 offset:38400
ds_read_b32 v76, v4 offset:38912
ds_read_b32 v77, v4 offset:39424
ds_read_b32 v78, v4 offset:39936
ds_read_b32 v79, v4 offset:40448
ds_read_b32 v80, v4 offset:40960
ds_read_b32 v81, v4 offset:41472
ds_read_b32 v82, v4 offset:41984
ds_read_b32 v83, v4 offset:42496
ds_read_b32 v84, v4 offset:43008
ds_read_b32 v85, v4 offset:43520
ds_read_b32 v86, v4 offset:44032
ds_read_b32 v87, v4 offset:44544
ds_read_b32 v88, v4 offset:45056
ds_read_b32 v89, v4 offset:45568
ds_read_b32 v90, v4 offset:46080
ds_read_b32 v91, v4 offset:46592
ds_read_b32 v92, v4 offset:47104
ds_read_b32 v93, v4 offset:47616
ds_read_b32 v94, v4 offset:48128
ds_read_b32 v95, v4 offset:48640
s_waitcnt lgkmcnt(0)
v_add_f32 v11, v64, v65
v_add_f32 v11, v11, v66
v_add_f32 v11, v11, v67
v_add_f32 v11, v11, v68
v_add_f32 v11, v11, v69
v_add_f32 v11, v11, v70
v_add_f32 v11, v11, v71
v_add_f32 v11, v11, v72
v_add_f32 v11, v11, v73
v_add_f32 v11, v11, v74
v_add_f32 v11, v11, v75
v_add_f32 v11, v11, v76
v_add_f32 v11, v11, v77
v_add_f32 v11, v11, v78
v_add_f32 v11, v11, v79
v_add_f32 v11, v11, v80
v_add_f32 v11, v11, v81
v_add_f32 v11, v11, v82
v_add_f32 v11, v11, v83
v_add_f32 v11, v11, v84
v_add_f32 v11, v11, v85
v_add_f32 v11, v11, v86
v_add_f32 v11, v11, v87
v_add_f32 v11, v11, v88
v_add_f32 v11, v11, v89
v_add_f32 v11, v11, v90
v_add_f32 v11, v11, v91
v_add_f32 v11, v11, v92
v_add_f32 v11, v11, v93
v_add_f32 v11, v11, v94
v_add_f32 v11, v11, v95
v_cvt_pk_bf16_f32 v10, v10, v10
v_and_b32 v10, s20, v10
v_cvt_pk_bf16_f32 v11, v11, v11
v_and_b32 v11, s20, v11
v_mul_f32 v12, 0xbfb8aa3b, v10
v_exp_f32 v12, v12
s_nop 0
v_add_f32 v12, 1.0, v12
v_rcp_f32 v12, v12
s_nop 0
v_mul_f32 v10, v10, v12
v_cvt_pk_bf16_f32 v10, v10, v10
v_and_b32 v10, s20, v10
v_mul_f32 v10, v10, v11
v_cvt_pk_bf16_f32 v10, v10, v10
v_and_b32 v10, s20, v10
v_mov_b32 v4, 0x390000
v_bfe_i32 v5, v0, 0, 1
v_and_b32 v5, 0x8, v5
v_xor_b32 v4, v4, v5
v_bfe_i32 v5, v0, 1, 1
v_and_b32 v5, 0x10, v5
v_xor_b32 v4, v4, v5
v_bfe_i32 v5, v0, 2, 1
v_and_b32 v5, 0x20, v5
v_xor_b32 v4, v4, v5
v_bfe_i32 v5, v0, 3, 1
v_and_b32 v5, 0x40, v5
v_xor_b32 v4, v4, v5
v_bfe_i32 v5, v0, 4, 1
v_and_b32 v5, 0x80, v5
v_xor_b32 v4, v4, v5
v_bfe_i32 v5, v0, 5, 1
v_and_b32 v5, 0x100, v5
v_xor_b32 v4, v4, v5
v_bfe_i32 v5, v0, 6, 1
v_and_b32 v5, 0x4, v5
v_xor_b32 v4, v4, v5
s_lshl_b32 s3, s34, 9
v_add_u32 v4, s3, v4
global_store_dword v4, v10, s[4:5] sc1
s_waitcnt vmcnt(0)
s_barrier
s_cmp_lg_u32 s14, 0
s_cbranch_scc1 L_moea_f
s_lshl_b32 s3, s34, 2
s_add_u32 s3, s3, 0x3aa000
v_mov_b32 v4, s3
v_mov_b32 v5, 1
s_mov_b64 exec, 1
global_store_dword v4, v5, s[4:5] sc1
s_mov_b64 exec, -1
L_moea_f:
s_endpgm
L_notma:
s_sub_u32 s34, s34, 28
s_cmp_ge_u32 s34, 8
s_cbranch_scc1 L_exit2
v_min_u32 v4, 27, v0
v_lshlrev_b32 v4, 2, v4
v_add_u32 v4, 0x3aa000, v4
v_and_b32 v4, 63, v0
v_min_u32 v4, 27, v4
v_lshlrev_b32 v4, 2, v4
v_add_u32 v4, 0x3aa000, v4
L_moeb_w:
global_load_dword v9, v4, s[4:5] sc1
s_waitcnt vmcnt(0)
v_cmp_ne_u32 vcc, 1, v9
s_cmp_eq_u64 vcc, 0
s_cbranch_scc1 L_moeb_w_ok
s_sleep 8
s_sub_u32 s41, s41, 1
s_cbranch_scc0 L_moeb_w
s_mov_b32 s41, 0
L_moeb_w_ok:
s_load_dwordx2 s[6:7], s[0:1], 88
v_lshlrev_b32 v1, 5, v0
v_add_u32 v1, 0x200000, v1
global_load_dwordx4 v[4:7], v1, s[4:5] sc1
global_load_dwordx4 v[8:11], v1, s[4:5] offset:16 sc1
v_lshrrev_b32 v2, 6, v0
v_lshlrev_b32 v2, 2, v2
v_mov_b32 v3, 0
s_waitcnt vmcnt(0)
v_max3_u32 v12, v4, v5, v6
v_max3_u32 v13, v7, v8, v9
v_max3_u32 v12, v12, v10, v11
v_max_u32 v12, v12, v13
s_nop 1
v_max_u32_dpp v12, v12, v12 row_ror:8 row_mask:0xf bank_mask:0xf
s_nop 1
v_max_u32_dpp v12, v12, v12 row_ror:4 row_mask:0xf bank_mask:0xf
s_nop 1
v_max_u32_dpp v12, v12, v12 row_ror:2 row_mask:0xf bank_mask:0xf
s_nop 1
v_max_u32_dpp v12, v12, v12 row_ror:1 row_mask:0xf bank_mask:0xf
v_mov_b32 v13, v12
s_nop 1
v_permlane32_swap_b32 v12, v13
v_max_u32 v12, v12, v13
v_mov_b32 v13, v12
s_nop 1
v_permlane16_swap_b32 v12, v13
v_max_u32 v12, v12, v13
ds_write_b32 v2, v12 offset:0
s_waitcnt lgkmcnt(0)
s_barrier
ds_read_b128 v[12:15], v3 offset:0
s_waitcnt lgkmcnt(0)
v_max3_u32 v12, v12, v13, v14
v_max_u32 v12, v12, v15
s_nop 0
v_readfirstlane_b32 s46, v12
s_nop 1
v_cmp_ne_u32 vcc, s46, v4
s_nop 1
v_cndmask_b32 v4, 0, v4, vcc
v_cmp_ne_u32 vcc, s46, v5
s_nop 1
v_cndmask_b32 v5, 0, v5, vcc
v_cmp_ne_u32 vcc, s46, v6
s_nop 1
v_cndmask_b32 v6, 0, v6, vcc
v_cmp_ne_u32 vcc, s46, v7
s_nop 1
v_cndmask_b32 v7, 0, v7, vcc
v_cmp_ne_u32 vcc, s46, v8
s_nop 1
v_cndmask_b32 v8, 0, v8, vcc
v_cmp_ne_u32 vcc, s46, v9
s_nop 1
v_cndmask_b32 v9, 0, v9, vcc
v_cmp_ne_u32 vcc, s46, v10
s_nop 1
v_cndmask_b32 v10, 0, v10, vcc
v_cmp_ne_u32 vcc, s46, v11
s_nop 1
v_cndmask_b32 v11, 0, v11, vcc
v_max3_u32 v12, v4, v5, v6
v_max3_u32 v13, v7, v8, v9
v_max3_u32 v12, v12, v10, v11
v_max_u32 v12, v12, v13
s_nop 1
v_max_u32_dpp v12, v12, v12 row_ror:8 row_mask:0xf bank_mask:0xf
s_nop 1
v_max_u32_dpp v12, v12, v12 row_ror:4 row_mask:0xf bank_mask:0xf
s_nop 1
v_max_u32_dpp v12, v12, v12 row_ror:2 row_mask:0xf bank_mask:0xf
s_nop 1
v_max_u32_dpp v12, v12, v12 row_ror:1 row_mask:0xf bank_mask:0xf
v_mov_b32 v13, v12
s_nop 1
v_permlane32_swap_b32 v12, v13
v_max_u32 v12, v12, v13
v_mov_b32 v13, v12
s_nop 1
v_permlane16_swap_b32 v12, v13
v_max_u32 v12, v12, v13
ds_write_b32 v2, v12 offset:16
s_waitcnt lgkmcnt(0)
s_barrier
ds_read_b128 v[12:15], v3 offset:16
s_waitcnt lgkmcnt(0)
v_max3_u32 v12, v12, v13, v14
v_max_u32 v12, v12, v15
s_nop 0
v_readfirstlane_b32 s47, v12
v_lshlrev_b32 v1, 4, v0
v_add_u32 v2, 0x390000, v1
v_add_u32 v3, 0, v2
global_load_dwordx4 v[16:19], v3, s[4:5] sc1
v_add_u32 v3, 4096, v2
global_load_dwordx4 v[20:23], v3, s[4:5] sc1
v_add_u32 v3, 8192, v2
global_load_dwordx4 v[24:27], v3, s[4:5] sc1
v_add_u32 v3, 12288, v2
global_load_dwordx4 v[28:31], v3, s[4:5] sc1
s_waitcnt vmcnt(0)
ds_write_b128 v1, v[16:19] offset:1024
ds_write_b128 v1, v[20:23] offset:5120
ds_write_b128 v1, v[24:27] offset:9216
ds_write_b128 v1, v[28:31] offset:13312
s_waitcnt lgkmcnt(0)
s_barrier
s_lshl_b32 s3, s34, 7
s_add_u32 s6, s6, s3
s_addc_u32 s7, s7, 0
v_lshrrev_b32 v1, 3, v0
v_mul_u32_u24 v2, 1024, v1
v_and_b32 v3, 7, v0
v_lshlrev_b32 v3, 4, v3
v_add_u32 v2, v2, v3
v_lshlrev_b32 v1, 3, v1
v_mov_b32 v16, 0
v_mov_b32 v17, 0
v_mov_b32 v18, 0
v_mov_b32 v19, 0
v_mov_b32 v20, 0
v_mov_b32 v21, 0
v_mov_b32 v22, 0
v_mov_b32 v23, 0
v_mov_b32 v24, 0
v_mov_b32 v25, 0
v_mov_b32 v26, 0
v_mov_b32 v27, 0
v_mov_b32 v28, 0
v_mov_b32 v29, 0
v_mov_b32 v30, 0
v_mov_b32 v31, 0
s_mov_b32 s20, 0xffff0000
v_add_u32 v4, 0, v2
global_load_dwordx4 v[64:67], v4, s[6:7]
v_add_u32 v4, 32768, v2
global_load_dwordx4 v[68:71], v4, s[6:7]
v_add_u32 v4, 65536, v2
global_load_dwordx4 v[72:75], v4, s[6:7]
v_add_u32 v4, 98304, v2
global_load_dwordx4 v[76:79], v4, s[6:7]
v_add_u32 v4, 131072, v2
global_load_dwordx4 v[80:83], v4, s[6:7]
v_add_u32 v4, 163840, v2
global_load_dwordx4 v[84:87], v4, s[6:7]
v_add_u32 v4, 196608, v2
global_load_dwordx4 v[88:91], v4, s[6:7]
v_add_u32 v4, 229376, v2
global_load_dwordx4 v[92:95], v4, s[6:7]
v_add_u32 v4, 262144, v2
global_load_dwordx4 v[96:99], v4, s[6:7]
v_add_u32 v4, 294912, v2
global_load_dwordx4 v[100:103], v4, s[6:7]
v_add_u32 v4, 327680, v2
global_load_dwordx4 v[104:107], v4, s[6:7]
v_add_u32 v4, 360448, v2
global_load_dwordx4 v[108:111], v4, s[6:7]
v_add_u32 v4, 393216, v2
global_load_dwordx4 v[112:115], v4, s[6:7]
v_add_u32 v4, 425984, v2
global_load_dwordx4 v[116:119], v4, s[6:7]
v_add_u32 v4, 458752, v2
global_load_dwordx4 v[120:123], v4, s[6:7]
v_add_u32 v4, 491520, v2
global_load_dwordx4 v[124:127], v4, s[6:7]
v_add_u32 v4, 524288, v2
global_load_dwordx4 v[128:131], v4, s[6:7]
v_add_u32 v4, 557056, v2
global_load_dwordx4 v[132:135], v4, s[6:7]
v_add_u32 v4, 589824, v2
global_load_dwordx4 v[136:139], v4, s[6:7]
v_add_u32 v4, 622592, v2
global_load_dwordx4 v[140:143], v4, s[6:7]
v_add_u32 v4, 655360, v2
global_load_dwordx4 v[144:147], v4, s[6:7]
v_add_u32 v4, 688128, v2
global_load_dwordx4 v[148:151], v4, s[6:7]
v_add_u32 v4, 720896, v2
global_load_dwordx4 v[152:155], v4, s[6:7]
v_add_u32 v4, 753664, v2
global_load_dwordx4 v[156:159], v4, s[6:7]
v_add_u32 v4, 786432, v2
global_load_dwordx4 v[160:163], v4, s[6:7]
v_add_u32 v4, 819200, v2
global_load_dwordx4 v[164:167], v4, s[6:7]
v_add_u32 v4, 851968, v2
global_load_dwordx4 v[168:171], v4, s[6:7]
v_add_u32 v4, 884736, v2
global_load_dwordx4 v[172:175], v4, s[6:7]
ds_read_b64 v[6:7], v1 offset:1024
s_waitcnt vmcnt(27) lgkmcnt(0)
v_lshlrev_b32 v8, 16, v64
v_and_b32 v9, s20, v64
v_fmac_f32 v16, v6, v8
v_fmac_f32 v17, v6, v9
v_fmac_f32 v24, v7, v8
v_fmac_f32 v25, v7, v9
v_lshlrev_b32 v8, 16, v65
v_and_b32 v9, s20, v65
v_fmac_f32 v18, v6, v8
v_fmac_f32 v19, v6, v9
v_fmac_f32 v26, v7, v8
v_fmac_f32 v27, v7, v9
v_lshlrev_b32 v8, 16, v66
v_and_b32 v9, s20, v66
v_fmac_f32 v20, v6, v8
v_fmac_f32 v21, v6, v9
v_fmac_f32 v28, v7, v8
v_fmac_f32 v29, v7, v9
v_lshlrev_b32 v8, 16, v67
v_and_b32 v9, s20, v67
v_fmac_f32 v22, v6, v8
v_fmac_f32 v23, v6, v9
v_fmac_f32 v30, v7, v8
v_fmac_f32 v31, v7, v9
ds_read_b64 v[6:7], v1 offset:1280
s_waitcnt vmcnt(26) lgkmcnt(0)
v_lshlrev_b32 v8, 16, v68
v_and_b32 v9, s20, v68
v_fmac_f32 v16, v6, v8
v_fmac_f32 v17, v6, v9
v_fmac_f32 v24, v7, v8
v_fmac_f32 v25, v7, v9
v_lshlrev_b32 v8, 16, v69
v_and_b32 v9, s20, v69
v_fmac_f32 v18, v6, v8
v_fmac_f32 v19, v6, v9
v_fmac_f32 v26, v7, v8
v_fmac_f32 v27, v7, v9
v_lshlrev_b32 v8, 16, v70
v_and_b32 v9, s20, v70
v_fmac_f32 v20, v6, v8
v_fmac_f32 v21, v6, v9
v_fmac_f32 v28, v7, v8
v_fmac_f32 v29, v7, v9
v_lshlrev_b32 v8, 16, v71
v_and_b32 v9, s20, v71
v_fmac_f32 v22, v6, v8
v_fmac_f32 v23, v6, v9
v_fmac_f32 v30, v7, v8
v_fmac_f32 v31, v7, v9
ds_read_b64 v[6:7], v1 offset:1536
s_waitcnt vmcnt(25) lgkmcnt(0)
v_lshlrev_b32 v8, 16, v72
v_and_b32 v9, s20, v72
v_fmac_f32 v16, v6, v8
v_fmac_f32 v17, v6, v9
v_fmac_f32 v24, v7, v8
v_fmac_f32 v25, v7, v9
v_lshlrev_b32 v8, 16, v73
v_and_b32 v9, s20, v73
v_fmac_f32 v18, v6, v8
v_fmac_f32 v19, v6, v9
v_fmac_f32 v26, v7, v8
v_fmac_f32 v27, v7, v9
v_lshlrev_b32 v8, 16, v74
v_and_b32 v9, s20, v74
v_fmac_f32 v20, v6, v8
v_fmac_f32 v21, v6, v9
v_fmac_f32 v28, v7, v8
v_fmac_f32 v29, v7, v9
v_lshlrev_b32 v8, 16, v75
v_and_b32 v9, s20, v75
v_fmac_f32 v22, v6, v8
v_fmac_f32 v23, v6, v9
v_fmac_f32 v30, v7, v8
v_fmac_f32 v31, v7, v9
ds_read_b64 v[6:7], v1 offset:1792
s_waitcnt vmcnt(24) lgkmcnt(0)
v_lshlrev_b32 v8, 16, v76
v_and_b32 v9, s20, v76
v_fmac_f32 v16, v6, v8
v_fmac_f32 v17, v6, v9
v_fmac_f32 v24, v7, v8
v_fmac_f32 v25, v7, v9
v_lshlrev_b32 v8, 16, v77
v_and_b32 v9, s20, v77
v_fmac_f32 v18, v6, v8
v_fmac_f32 v19, v6, v9
v_fmac_f32 v26, v7, v8
v_fmac_f32 v27, v7, v9
v_lshlrev_b32 v8, 16, v78
v_and_b32 v9, s20, v78
v_fmac_f32 v20, v6, v8
v_fmac_f32 v21, v6, v9
v_fmac_f32 v28, v7, v8
v_fmac_f32 v29, v7, v9
v_lshlrev_b32 v8, 16, v79
v_and_b32 v9, s20, v79
v_fmac_f32 v22, v6, v8
v_fmac_f32 v23, v6, v9
v_fmac_f32 v30, v7, v8
v_fmac_f32 v31, v7, v9
ds_read_b64 v[6:7], v1 offset:2048
s_waitcnt vmcnt(23) lgkmcnt(0)
v_lshlrev_b32 v8, 16, v80
v_and_b32 v9, s20, v80
v_fmac_f32 v16, v6, v8
v_fmac_f32 v17, v6, v9
v_fmac_f32 v24, v7, v8
v_fmac_f32 v25, v7, v9
v_lshlrev_b32 v8, 16, v81
v_and_b32 v9, s20, v81
v_fmac_f32 v18, v6, v8
v_fmac_f32 v19, v6, v9
v_fmac_f32 v26, v7, v8
v_fmac_f32 v27, v7, v9
v_lshlrev_b32 v8, 16, v82
v_and_b32 v9, s20, v82
v_fmac_f32 v20, v6, v8
v_fmac_f32 v21, v6, v9
v_fmac_f32 v28, v7, v8
v_fmac_f32 v29, v7, v9
v_lshlrev_b32 v8, 16, v83
v_and_b32 v9, s20, v83
v_fmac_f32 v22, v6, v8
v_fmac_f32 v23, v6, v9
v_fmac_f32 v30, v7, v8
v_fmac_f32 v31, v7, v9
ds_read_b64 v[6:7], v1 offset:2304
s_waitcnt vmcnt(22) lgkmcnt(0)
v_lshlrev_b32 v8, 16, v84
v_and_b32 v9, s20, v84
v_fmac_f32 v16, v6, v8
v_fmac_f32 v17, v6, v9
v_fmac_f32 v24, v7, v8
v_fmac_f32 v25, v7, v9
v_lshlrev_b32 v8, 16, v85
v_and_b32 v9, s20, v85
v_fmac_f32 v18, v6, v8
v_fmac_f32 v19, v6, v9
v_fmac_f32 v26, v7, v8
v_fmac_f32 v27, v7, v9
v_lshlrev_b32 v8, 16, v86
v_and_b32 v9, s20, v86
v_fmac_f32 v20, v6, v8
v_fmac_f32 v21, v6, v9
v_fmac_f32 v28, v7, v8
v_fmac_f32 v29, v7, v9
v_lshlrev_b32 v8, 16, v87
v_and_b32 v9, s20, v87
v_fmac_f32 v22, v6, v8
v_fmac_f32 v23, v6, v9
v_fmac_f32 v30, v7, v8
v_fmac_f32 v31, v7, v9
ds_read_b64 v[6:7], v1 offset:2560
s_waitcnt vmcnt(21) lgkmcnt(0)
v_lshlrev_b32 v8, 16, v88
v_and_b32 v9, s20, v88
v_fmac_f32 v16, v6, v8
v_fmac_f32 v17, v6, v9
v_fmac_f32 v24, v7, v8
v_fmac_f32 v25, v7, v9
v_lshlrev_b32 v8, 16, v89
v_and_b32 v9, s20, v89
v_fmac_f32 v18, v6, v8
v_fmac_f32 v19, v6, v9
v_fmac_f32 v26, v7, v8
v_fmac_f32 v27, v7, v9
v_lshlrev_b32 v8, 16, v90
v_and_b32 v9, s20, v90
v_fmac_f32 v20, v6, v8
v_fmac_f32 v21, v6, v9
v_fmac_f32 v28, v7, v8
v_fmac_f32 v29, v7, v9
v_lshlrev_b32 v8, 16, v91
v_and_b32 v9, s20, v91
v_fmac_f32 v22, v6, v8
v_fmac_f32 v23, v6, v9
v_fmac_f32 v30, v7, v8
v_fmac_f32 v31, v7, v9
ds_read_b64 v[6:7], v1 offset:2816
s_waitcnt vmcnt(20) lgkmcnt(0)
v_lshlrev_b32 v8, 16, v92
v_and_b32 v9, s20, v92
v_fmac_f32 v16, v6, v8
v_fmac_f32 v17, v6, v9
v_fmac_f32 v24, v7, v8
v_fmac_f32 v25, v7, v9
v_lshlrev_b32 v8, 16, v93
v_and_b32 v9, s20, v93
v_fmac_f32 v18, v6, v8
v_fmac_f32 v19, v6, v9
v_fmac_f32 v26, v7, v8
v_fmac_f32 v27, v7, v9
v_lshlrev_b32 v8, 16, v94
v_and_b32 v9, s20, v94
v_fmac_f32 v20, v6, v8
v_fmac_f32 v21, v6, v9
v_fmac_f32 v28, v7, v8
v_fmac_f32 v29, v7, v9
v_lshlrev_b32 v8, 16, v95
v_and_b32 v9, s20, v95
v_fmac_f32 v22, v6, v8
v_fmac_f32 v23, v6, v9
v_fmac_f32 v30, v7, v8
v_fmac_f32 v31, v7, v9
ds_read_b64 v[6:7], v1 offset:3072
s_waitcnt vmcnt(19) lgkmcnt(0)
v_lshlrev_b32 v8, 16, v96
v_and_b32 v9, s20, v96
v_fmac_f32 v16, v6, v8
v_fmac_f32 v17, v6, v9
v_fmac_f32 v24, v7, v8
v_fmac_f32 v25, v7, v9
v_lshlrev_b32 v8, 16, v97
v_and_b32 v9, s20, v97
v_fmac_f32 v18, v6, v8
v_fmac_f32 v19, v6, v9
v_fmac_f32 v26, v7, v8
v_fmac_f32 v27, v7, v9
v_lshlrev_b32 v8, 16, v98
v_and_b32 v9, s20, v98
v_fmac_f32 v20, v6, v8
v_fmac_f32 v21, v6, v9
v_fmac_f32 v28, v7, v8
v_fmac_f32 v29, v7, v9
v_lshlrev_b32 v8, 16, v99
v_and_b32 v9, s20, v99
v_fmac_f32 v22, v6, v8
v_fmac_f32 v23, v6, v9
v_fmac_f32 v30, v7, v8
v_fmac_f32 v31, v7, v9
ds_read_b64 v[6:7], v1 offset:3328
s_waitcnt vmcnt(18) lgkmcnt(0)
v_lshlrev_b32 v8, 16, v100
v_and_b32 v9, s20, v100
v_fmac_f32 v16, v6, v8
v_fmac_f32 v17, v6, v9
v_fmac_f32 v24, v7, v8
v_fmac_f32 v25, v7, v9
v_lshlrev_b32 v8, 16, v101
v_and_b32 v9, s20, v101
v_fmac_f32 v18, v6, v8
v_fmac_f32 v19, v6, v9
v_fmac_f32 v26, v7, v8
v_fmac_f32 v27, v7, v9
v_lshlrev_b32 v8, 16, v102
v_and_b32 v9, s20, v102
v_fmac_f32 v20, v6, v8
v_fmac_f32 v21, v6, v9
v_fmac_f32 v28, v7, v8
v_fmac_f32 v29, v7, v9
v_lshlrev_b32 v8, 16, v103
v_and_b32 v9, s20, v103
v_fmac_f32 v22, v6, v8
v_fmac_f32 v23, v6, v9
v_fmac_f32 v30, v7, v8
v_fmac_f32 v31, v7, v9
ds_read_b64 v[6:7], v1 offset:3584
s_waitcnt vmcnt(17) lgkmcnt(0)
v_lshlrev_b32 v8, 16, v104
v_and_b32 v9, s20, v104
v_fmac_f32 v16, v6, v8
v_fmac_f32 v17, v6, v9
v_fmac_f32 v24, v7, v8
v_fmac_f32 v25, v7, v9
v_lshlrev_b32 v8, 16, v105
v_and_b32 v9, s20, v105
v_fmac_f32 v18, v6, v8
v_fmac_f32 v19, v6, v9
v_fmac_f32 v26, v7, v8
v_fmac_f32 v27, v7, v9
v_lshlrev_b32 v8, 16, v106
v_and_b32 v9, s20, v106
v_fmac_f32 v20, v6, v8
v_fmac_f32 v21, v6, v9
v_fmac_f32 v28, v7, v8
v_fmac_f32 v29, v7, v9
v_lshlrev_b32 v8, 16, v107
v_and_b32 v9, s20, v107
v_fmac_f32 v22, v6, v8
v_fmac_f32 v23, v6, v9
v_fmac_f32 v30, v7, v8
v_fmac_f32 v31, v7, v9
ds_read_b64 v[6:7], v1 offset:3840
s_waitcnt vmcnt(16) lgkmcnt(0)
v_lshlrev_b32 v8, 16, v108
v_and_b32 v9, s20, v108
v_fmac_f32 v16, v6, v8
v_fmac_f32 v17, v6, v9
v_fmac_f32 v24, v7, v8
v_fmac_f32 v25, v7, v9
v_lshlrev_b32 v8, 16, v109
v_and_b32 v9, s20, v109
v_fmac_f32 v18, v6, v8
v_fmac_f32 v19, v6, v9
v_fmac_f32 v26, v7, v8
v_fmac_f32 v27, v7, v9
v_lshlrev_b32 v8, 16, v110
v_and_b32 v9, s20, v110
v_fmac_f32 v20, v6, v8
v_fmac_f32 v21, v6, v9
v_fmac_f32 v28, v7, v8
v_fmac_f32 v29, v7, v9
v_lshlrev_b32 v8, 16, v111
v_and_b32 v9, s20, v111
v_fmac_f32 v22, v6, v8
v_fmac_f32 v23, v6, v9
v_fmac_f32 v30, v7, v8
v_fmac_f32 v31, v7, v9
ds_read_b64 v[6:7], v1 offset:4096
s_waitcnt vmcnt(15) lgkmcnt(0)
v_lshlrev_b32 v8, 16, v112
v_and_b32 v9, s20, v112
v_fmac_f32 v16, v6, v8
v_fmac_f32 v17, v6, v9
v_fmac_f32 v24, v7, v8
v_fmac_f32 v25, v7, v9
v_lshlrev_b32 v8, 16, v113
v_and_b32 v9, s20, v113
v_fmac_f32 v18, v6, v8
v_fmac_f32 v19, v6, v9
v_fmac_f32 v26, v7, v8
v_fmac_f32 v27, v7, v9
v_lshlrev_b32 v8, 16, v114
v_and_b32 v9, s20, v114
v_fmac_f32 v20, v6, v8
v_fmac_f32 v21, v6, v9
v_fmac_f32 v28, v7, v8
v_fmac_f32 v29, v7, v9
v_lshlrev_b32 v8, 16, v115
v_and_b32 v9, s20, v115
v_fmac_f32 v22, v6, v8
v_fmac_f32 v23, v6, v9
v_fmac_f32 v30, v7, v8
v_fmac_f32 v31, v7, v9
ds_read_b64 v[6:7], v1 offset:4352
s_waitcnt vmcnt(14) lgkmcnt(0)
v_lshlrev_b32 v8, 16, v116
v_and_b32 v9, s20, v116
v_fmac_f32 v16, v6, v8
v_fmac_f32 v17, v6, v9
v_fmac_f32 v24, v7, v8
v_fmac_f32 v25, v7, v9
v_lshlrev_b32 v8, 16, v117
v_and_b32 v9, s20, v117
v_fmac_f32 v18, v6, v8
v_fmac_f32 v19, v6, v9
v_fmac_f32 v26, v7, v8
v_fmac_f32 v27, v7, v9
v_lshlrev_b32 v8, 16, v118
v_and_b32 v9, s20, v118
v_fmac_f32 v20, v6, v8
v_fmac_f32 v21, v6, v9
v_fmac_f32 v28, v7, v8
v_fmac_f32 v29, v7, v9
v_lshlrev_b32 v8, 16, v119
v_and_b32 v9, s20, v119
v_fmac_f32 v22, v6, v8
v_fmac_f32 v23, v6, v9
v_fmac_f32 v30, v7, v8
v_fmac_f32 v31, v7, v9
ds_read_b64 v[6:7], v1 offset:4608
s_waitcnt vmcnt(13) lgkmcnt(0)
v_lshlrev_b32 v8, 16, v120
v_and_b32 v9, s20, v120
v_fmac_f32 v16, v6, v8
v_fmac_f32 v17, v6, v9
v_fmac_f32 v24, v7, v8
v_fmac_f32 v25, v7, v9
v_lshlrev_b32 v8, 16, v121
v_and_b32 v9, s20, v121
v_fmac_f32 v18, v6, v8
v_fmac_f32 v19, v6, v9
v_fmac_f32 v26, v7, v8
v_fmac_f32 v27, v7, v9
v_lshlrev_b32 v8, 16, v122
v_and_b32 v9, s20, v122
v_fmac_f32 v20, v6, v8
v_fmac_f32 v21, v6, v9
v_fmac_f32 v28, v7, v8
v_fmac_f32 v29, v7, v9
v_lshlrev_b32 v8, 16, v123
v_and_b32 v9, s20, v123
v_fmac_f32 v22, v6, v8
v_fmac_f32 v23, v6, v9
v_fmac_f32 v30, v7, v8
v_fmac_f32 v31, v7, v9
ds_read_b64 v[6:7], v1 offset:4864
s_waitcnt vmcnt(12) lgkmcnt(0)
v_lshlrev_b32 v8, 16, v124
v_and_b32 v9, s20, v124
v_fmac_f32 v16, v6, v8
v_fmac_f32 v17, v6, v9
v_fmac_f32 v24, v7, v8
v_fmac_f32 v25, v7, v9
v_lshlrev_b32 v8, 16, v125
v_and_b32 v9, s20, v125
v_fmac_f32 v18, v6, v8
v_fmac_f32 v19, v6, v9
v_fmac_f32 v26, v7, v8
v_fmac_f32 v27, v7, v9
v_lshlrev_b32 v8, 16, v126
v_and_b32 v9, s20, v126
v_fmac_f32 v20, v6, v8
v_fmac_f32 v21, v6, v9
v_fmac_f32 v28, v7, v8
v_fmac_f32 v29, v7, v9
v_lshlrev_b32 v8, 16, v127
v_and_b32 v9, s20, v127
v_fmac_f32 v22, v6, v8
v_fmac_f32 v23, v6, v9
v_fmac_f32 v30, v7, v8
v_fmac_f32 v31, v7, v9
ds_read_b64 v[6:7], v1 offset:5120
s_waitcnt vmcnt(11) lgkmcnt(0)
v_lshlrev_b32 v8, 16, v128
v_and_b32 v9, s20, v128
v_fmac_f32 v16, v6, v8
v_fmac_f32 v17, v6, v9
v_fmac_f32 v24, v7, v8
v_fmac_f32 v25, v7, v9
v_lshlrev_b32 v8, 16, v129
v_and_b32 v9, s20, v129
v_fmac_f32 v18, v6, v8
v_fmac_f32 v19, v6, v9
v_fmac_f32 v26, v7, v8
v_fmac_f32 v27, v7, v9
v_lshlrev_b32 v8, 16, v130
v_and_b32 v9, s20, v130
v_fmac_f32 v20, v6, v8
v_fmac_f32 v21, v6, v9
v_fmac_f32 v28, v7, v8
v_fmac_f32 v29, v7, v9
v_lshlrev_b32 v8, 16, v131
v_and_b32 v9, s20, v131
v_fmac_f32 v22, v6, v8
v_fmac_f32 v23, v6, v9
v_fmac_f32 v30, v7, v8
v_fmac_f32 v31, v7, v9
ds_read_b64 v[6:7], v1 offset:5376
s_waitcnt vmcnt(10) lgkmcnt(0)
v_lshlrev_b32 v8, 16, v132
v_and_b32 v9, s20, v132
v_fmac_f32 v16, v6, v8
v_fmac_f32 v17, v6, v9
v_fmac_f32 v24, v7, v8
v_fmac_f32 v25, v7, v9
v_lshlrev_b32 v8, 16, v133
v_and_b32 v9, s20, v133
v_fmac_f32 v18, v6, v8
v_fmac_f32 v19, v6, v9
v_fmac_f32 v26, v7, v8
v_fmac_f32 v27, v7, v9
v_lshlrev_b32 v8, 16, v134
v_and_b32 v9, s20, v134
v_fmac_f32 v20, v6, v8
v_fmac_f32 v21, v6, v9
v_fmac_f32 v28, v7, v8
v_fmac_f32 v29, v7, v9
v_lshlrev_b32 v8, 16, v135
v_and_b32 v9, s20, v135
v_fmac_f32 v22, v6, v8
v_fmac_f32 v23, v6, v9
v_fmac_f32 v30, v7, v8
v_fmac_f32 v31, v7, v9
ds_read_b64 v[6:7], v1 offset:5632
s_waitcnt vmcnt(9) lgkmcnt(0)
v_lshlrev_b32 v8, 16, v136
v_and_b32 v9, s20, v136
v_fmac_f32 v16, v6, v8
v_fmac_f32 v17, v6, v9
v_fmac_f32 v24, v7, v8
v_fmac_f32 v25, v7, v9
v_lshlrev_b32 v8, 16, v137
v_and_b32 v9, s20, v137
v_fmac_f32 v18, v6, v8
v_fmac_f32 v19, v6, v9
v_fmac_f32 v26, v7, v8
v_fmac_f32 v27, v7, v9
v_lshlrev_b32 v8, 16, v138
v_and_b32 v9, s20, v138
v_fmac_f32 v20, v6, v8
v_fmac_f32 v21, v6, v9
v_fmac_f32 v28, v7, v8
v_fmac_f32 v29, v7, v9
v_lshlrev_b32 v8, 16, v139
v_and_b32 v9, s20, v139
v_fmac_f32 v22, v6, v8
v_fmac_f32 v23, v6, v9
v_fmac_f32 v30, v7, v8
v_fmac_f32 v31, v7, v9
ds_read_b64 v[6:7], v1 offset:5888
s_waitcnt vmcnt(8) lgkmcnt(0)
v_lshlrev_b32 v8, 16, v140
v_and_b32 v9, s20, v140
v_fmac_f32 v16, v6, v8
v_fmac_f32 v17, v6, v9
v_fmac_f32 v24, v7, v8
v_fmac_f32 v25, v7, v9
v_lshlrev_b32 v8, 16, v141
v_and_b32 v9, s20, v141
v_fmac_f32 v18, v6, v8
v_fmac_f32 v19, v6, v9
v_fmac_f32 v26, v7, v8
v_fmac_f32 v27, v7, v9
v_lshlrev_b32 v8, 16, v142
v_and_b32 v9, s20, v142
v_fmac_f32 v20, v6, v8
v_fmac_f32 v21, v6, v9
v_fmac_f32 v28, v7, v8
v_fmac_f32 v29, v7, v9
v_lshlrev_b32 v8, 16, v143
v_and_b32 v9, s20, v143
v_fmac_f32 v22, v6, v8
v_fmac_f32 v23, v6, v9
v_fmac_f32 v30, v7, v8
v_fmac_f32 v31, v7, v9
ds_read_b64 v[6:7], v1 offset:6144
s_waitcnt vmcnt(7) lgkmcnt(0)
v_lshlrev_b32 v8, 16, v144
v_and_b32 v9, s20, v144
v_fmac_f32 v16, v6, v8
v_fmac_f32 v17, v6, v9
v_fmac_f32 v24, v7, v8
v_fmac_f32 v25, v7, v9
v_lshlrev_b32 v8, 16, v145
v_and_b32 v9, s20, v145
v_fmac_f32 v18, v6, v8
v_fmac_f32 v19, v6, v9
v_fmac_f32 v26, v7, v8
v_fmac_f32 v27, v7, v9
v_lshlrev_b32 v8, 16, v146
v_and_b32 v9, s20, v146
v_fmac_f32 v20, v6, v8
v_fmac_f32 v21, v6, v9
v_fmac_f32 v28, v7, v8
v_fmac_f32 v29, v7, v9
v_lshlrev_b32 v8, 16, v147
v_and_b32 v9, s20, v147
v_fmac_f32 v22, v6, v8
v_fmac_f32 v23, v6, v9
v_fmac_f32 v30, v7, v8
v_fmac_f32 v31, v7, v9
ds_read_b64 v[6:7], v1 offset:6400
s_waitcnt vmcnt(6) lgkmcnt(0)
v_lshlrev_b32 v8, 16, v148
v_and_b32 v9, s20, v148
v_fmac_f32 v16, v6, v8
v_fmac_f32 v17, v6, v9
v_fmac_f32 v24, v7, v8
v_fmac_f32 v25, v7, v9
v_lshlrev_b32 v8, 16, v149
v_and_b32 v9, s20, v149
v_fmac_f32 v18, v6, v8
v_fmac_f32 v19, v6, v9
v_fmac_f32 v26, v7, v8
v_fmac_f32 v27, v7, v9
v_lshlrev_b32 v8, 16, v150
v_and_b32 v9, s20, v150
v_fmac_f32 v20, v6, v8
v_fmac_f32 v21, v6, v9
v_fmac_f32 v28, v7, v8
v_fmac_f32 v29, v7, v9
v_lshlrev_b32 v8, 16, v151
v_and_b32 v9, s20, v151
v_fmac_f32 v22, v6, v8
v_fmac_f32 v23, v6, v9
v_fmac_f32 v30, v7, v8
v_fmac_f32 v31, v7, v9
ds_read_b64 v[6:7], v1 offset:6656
s_waitcnt vmcnt(5) lgkmcnt(0)
v_lshlrev_b32 v8, 16, v152
v_and_b32 v9, s20, v152
v_fmac_f32 v16, v6, v8
v_fmac_f32 v17, v6, v9
v_fmac_f32 v24, v7, v8
v_fmac_f32 v25, v7, v9
v_lshlrev_b32 v8, 16, v153
v_and_b32 v9, s20, v153
v_fmac_f32 v18, v6, v8
v_fmac_f32 v19, v6, v9
v_fmac_f32 v26, v7, v8
v_fmac_f32 v27, v7, v9
v_lshlrev_b32 v8, 16, v154
v_and_b32 v9, s20, v154
v_fmac_f32 v20, v6, v8
v_fmac_f32 v21, v6, v9
v_fmac_f32 v28, v7, v8
v_fmac_f32 v29, v7, v9
v_lshlrev_b32 v8, 16, v155
v_and_b32 v9, s20, v155
v_fmac_f32 v22, v6, v8
v_fmac_f32 v23, v6, v9
v_fmac_f32 v30, v7, v8
v_fmac_f32 v31, v7, v9
ds_read_b64 v[6:7], v1 offset:6912
s_waitcnt vmcnt(4) lgkmcnt(0)
v_lshlrev_b32 v8, 16, v156
v_and_b32 v9, s20, v156
v_fmac_f32 v16, v6, v8
v_fmac_f32 v17, v6, v9
v_fmac_f32 v24, v7, v8
v_fmac_f32 v25, v7, v9
v_lshlrev_b32 v8, 16, v157
v_and_b32 v9, s20, v157
v_fmac_f32 v18, v6, v8
v_fmac_f32 v19, v6, v9
v_fmac_f32 v26, v7, v8
v_fmac_f32 v27, v7, v9
v_lshlrev_b32 v8, 16, v158
v_and_b32 v9, s20, v158
v_fmac_f32 v20, v6, v8
v_fmac_f32 v21, v6, v9
v_fmac_f32 v28, v7, v8
v_fmac_f32 v29, v7, v9
v_lshlrev_b32 v8, 16, v159
v_and_b32 v9, s20, v159
v_fmac_f32 v22, v6, v8
v_fmac_f32 v23, v6, v9
v_fmac_f32 v30, v7, v8
v_fmac_f32 v31, v7, v9
ds_read_b64 v[6:7], v1 offset:7168
s_waitcnt vmcnt(3) lgkmcnt(0)
v_lshlrev_b32 v8, 16, v160
v_and_b32 v9, s20, v160
v_fmac_f32 v16, v6, v8
v_fmac_f32 v17, v6, v9
v_fmac_f32 v24, v7, v8
v_fmac_f32 v25, v7, v9
v_lshlrev_b32 v8, 16, v161
v_and_b32 v9, s20, v161
v_fmac_f32 v18, v6, v8
v_fmac_f32 v19, v6, v9
v_fmac_f32 v26, v7, v8
v_fmac_f32 v27, v7, v9
v_lshlrev_b32 v8, 16, v162
v_and_b32 v9, s20, v162
v_fmac_f32 v20, v6, v8
v_fmac_f32 v21, v6, v9
v_fmac_f32 v28, v7, v8
v_fmac_f32 v29, v7, v9
v_lshlrev_b32 v8, 16, v163
v_and_b32 v9, s20, v163
v_fmac_f32 v22, v6, v8
v_fmac_f32 v23, v6, v9
v_fmac_f32 v30, v7, v8
v_fmac_f32 v31, v7, v9
ds_read_b64 v[6:7], v1 offset:7424
s_waitcnt vmcnt(2) lgkmcnt(0)
v_lshlrev_b32 v8, 16, v164
v_and_b32 v9, s20, v164
v_fmac_f32 v16, v6, v8
v_fmac_f32 v17, v6, v9
v_fmac_f32 v24, v7, v8
v_fmac_f32 v25, v7, v9
v_lshlrev_b32 v8, 16, v165
v_and_b32 v9, s20, v165
v_fmac_f32 v18, v6, v8
v_fmac_f32 v19, v6, v9
v_fmac_f32 v26, v7, v8
v_fmac_f32 v27, v7, v9
v_lshlrev_b32 v8, 16, v166
v_and_b32 v9, s20, v166
v_fmac_f32 v20, v6, v8
v_fmac_f32 v21, v6, v9
v_fmac_f32 v28, v7, v8
v_fmac_f32 v29, v7, v9
v_lshlrev_b32 v8, 16, v167
v_and_b32 v9, s20, v167
v_fmac_f32 v22, v6, v8
v_fmac_f32 v23, v6, v9
v_fmac_f32 v30, v7, v8
v_fmac_f32 v31, v7, v9
ds_read_b64 v[6:7], v1 offset:7680
s_waitcnt vmcnt(1) lgkmcnt(0)
v_lshlrev_b32 v8, 16, v168
v_and_b32 v9, s20, v168
v_fmac_f32 v16, v6, v8
v_fmac_f32 v17, v6, v9
v_fmac_f32 v24, v7, v8
v_fmac_f32 v25, v7, v9
v_lshlrev_b32 v8, 16, v169
v_and_b32 v9, s20, v169
v_fmac_f32 v18, v6, v8
v_fmac_f32 v19, v6, v9
v_fmac_f32 v26, v7, v8
v_fmac_f32 v27, v7, v9
v_lshlrev_b32 v8, 16, v170
v_and_b32 v9, s20, v170
v_fmac_f32 v20, v6, v8
v_fmac_f32 v21, v6, v9
v_fmac_f32 v28, v7, v8
v_fmac_f32 v29, v7, v9
v_lshlrev_b32 v8, 16, v171
v_and_b32 v9, s20, v171
v_fmac_f32 v22, v6, v8
v_fmac_f32 v23, v6, v9
v_fmac_f32 v30, v7, v8
v_fmac_f32 v31, v7, v9
ds_read_b64 v[6:7], v1 offset:7936
s_waitcnt vmcnt(0) lgkmcnt(0)
v_lshlrev_b32 v8, 16, v172
v_and_b32 v9, s20, v172
v_fmac_f32 v16, v6, v8
v_fmac_f32 v17, v6, v9
v_fmac_f32 v24, v7, v8
v_fmac_f32 v25, v7, v9
v_lshlrev_b32 v8, 16, v173
v_and_b32 v9, s20, v173
v_fmac_f32 v18, v6, v8
v_fmac_f32 v19, v6, v9
v_fmac_f32 v26, v7, v8
v_fmac_f32 v27, v7, v9
v_lshlrev_b32 v8, 16, v174
v_and_b32 v9, s20, v174
v_fmac_f32 v20, v6, v8
v_fmac_f32 v21, v6, v9
v_fmac_f32 v28, v7, v8
v_fmac_f32 v29, v7, v9
v_lshlrev_b32 v8, 16, v175
v_and_b32 v9, s20, v175
v_fmac_f32 v22, v6, v8
v_fmac_f32 v23, v6, v9
v_fmac_f32 v30, v7, v8
v_fmac_f32 v31, v7, v9
v_add_u32 v4, 917504, v2
global_load_dwordx4 v[64:67], v4, s[6:7]
v_add_u32 v4, 950272, v2
global_load_dwordx4 v[68:71], v4, s[6:7]
v_add_u32 v4, 983040, v2
global_load_dwordx4 v[72:75], v4, s[6:7]
v_add_u32 v4, 1015808, v2
global_load_dwordx4 v[76:79], v4, s[6:7]
v_add_u32 v4, 1048576, v2
global_load_dwordx4 v[80:83], v4, s[6:7]
v_add_u32 v4, 1081344, v2
global_load_dwordx4 v[84:87], v4, s[6:7]
v_add_u32 v4, 1114112, v2
global_load_dwordx4 v[88:91], v4, s[6:7]
v_add_u32 v4, 1146880, v2
global_load_dwordx4 v[92:95], v4, s[6:7]
v_add_u32 v4, 1179648, v2
global_load_dwordx4 v[96:99], v4, s[6:7]
v_add_u32 v4, 1212416, v2
global_load_dwordx4 v[100:103], v4, s[6:7]
v_add_u32 v4, 1245184, v2
global_load_dwordx4 v[104:107], v4, s[6:7]
v_add_u32 v4, 1277952, v2
global_load_dwordx4 v[108:111], v4, s[6:7]
v_add_u32 v4, 1310720, v2
global_load_dwordx4 v[112:115], v4, s[6:7]
v_add_u32 v4, 1343488, v2
global_load_dwordx4 v[116:119], v4, s[6:7]
v_add_u32 v4, 1376256, v2
global_load_dwordx4 v[120:123], v4, s[6:7]
v_add_u32 v4, 1409024, v2
global_load_dwordx4 v[124:127], v4, s[6:7]
v_add_u32 v4, 1441792, v2
global_load_dwordx4 v[128:131], v4, s[6:7]
v_add_u32 v4, 1474560, v2
global_load_dwordx4 v[132:135], v4, s[6:7]
v_add_u32 v4, 1507328, v2
global_load_dwordx4 v[136:139], v4, s[6:7]
v_add_u32 v4, 1540096, v2
global_load_dwordx4 v[140:143], v4, s[6:7]
v_add_u32 v4, 1572864, v2
global_load_dwordx4 v[144:147], v4, s[6:7]
v_add_u32 v4, 1605632, v2
global_load_dwordx4 v[148:151], v4, s[6:7]
v_add_u32 v4, 1638400, v2
global_load_dwordx4 v[152:155], v4, s[6:7]
v_add_u32 v4, 1671168, v2
global_load_dwordx4 v[156:159], v4, s[6:7]
v_add_u32 v4, 1703936, v2
global_load_dwordx4 v[160:163], v4, s[6:7]
v_add_u32 v4, 1736704, v2
global_load_dwordx4 v[164:167], v4, s[6:7]
v_add_u32 v4, 1769472, v2
global_load_dwordx4 v[168:171], v4, s[6:7]
v_add_u32 v4, 1802240, v2
global_load_dwordx4 v[172:175], v4, s[6:7]
ds_read_b64 v[6:7], v1 offset:8192
s_waitcnt vmcnt(27) lgkmcnt(0)
v_lshlrev_b32 v8, 16, v64
v_and_b32 v9, s20, v64
v_fmac_f32 v16, v6, v8
v_fmac_f32 v17, v6, v9
v_fmac_f32 v24, v7, v8
v_fmac_f32 v25, v7, v9
v_lshlrev_b32 v8, 16, v65
v_and_b32 v9, s20, v65
v_fmac_f32 v18, v6, v8
v_fmac_f32 v19, v6, v9
v_fmac_f32 v26, v7, v8
v_fmac_f32 v27, v7, v9
v_lshlrev_b32 v8, 16, v66
v_and_b32 v9, s20, v66
v_fmac_f32 v20, v6, v8
v_fmac_f32 v21, v6, v9
v_fmac_f32 v28, v7, v8
v_fmac_f32 v29, v7, v9
v_lshlrev_b32 v8, 16, v67
v_and_b32 v9, s20, v67
v_fmac_f32 v22, v6, v8
v_fmac_f32 v23, v6, v9
v_fmac_f32 v30, v7, v8
v_fmac_f32 v31, v7, v9
ds_read_b64 v[6:7], v1 offset:8448
s_waitcnt vmcnt(26) lgkmcnt(0)
v_lshlrev_b32 v8, 16, v68
v_and_b32 v9, s20, v68
v_fmac_f32 v16, v6, v8
v_fmac_f32 v17, v6, v9
v_fmac_f32 v24, v7, v8
v_fmac_f32 v25, v7, v9
v_lshlrev_b32 v8, 16, v69
v_and_b32 v9, s20, v69
v_fmac_f32 v18, v6, v8
v_fmac_f32 v19, v6, v9
v_fmac_f32 v26, v7, v8
v_fmac_f32 v27, v7, v9
v_lshlrev_b32 v8, 16, v70
v_and_b32 v9, s20, v70
v_fmac_f32 v20, v6, v8
v_fmac_f32 v21, v6, v9
v_fmac_f32 v28, v7, v8
v_fmac_f32 v29, v7, v9
v_lshlrev_b32 v8, 16, v71
v_and_b32 v9, s20, v71
v_fmac_f32 v22, v6, v8
v_fmac_f32 v23, v6, v9
v_fmac_f32 v30, v7, v8
v_fmac_f32 v31, v7, v9
ds_read_b64 v[6:7], v1 offset:8704
s_waitcnt vmcnt(25) lgkmcnt(0)
v_lshlrev_b32 v8, 16, v72
v_and_b32 v9, s20, v72
v_fmac_f32 v16, v6, v8
v_fmac_f32 v17, v6, v9
v_fmac_f32 v24, v7, v8
v_fmac_f32 v25, v7, v9
v_lshlrev_b32 v8, 16, v73
v_and_b32 v9, s20, v73
v_fmac_f32 v18, v6, v8
v_fmac_f32 v19, v6, v9
v_fmac_f32 v26, v7, v8
v_fmac_f32 v27, v7, v9
v_lshlrev_b32 v8, 16, v74
v_and_b32 v9, s20, v74
v_fmac_f32 v20, v6, v8
v_fmac_f32 v21, v6, v9
v_fmac_f32 v28, v7, v8
v_fmac_f32 v29, v7, v9
v_lshlrev_b32 v8, 16, v75
v_and_b32 v9, s20, v75
v_fmac_f32 v22, v6, v8
v_fmac_f32 v23, v6, v9
v_fmac_f32 v30, v7, v8
v_fmac_f32 v31, v7, v9
ds_read_b64 v[6:7], v1 offset:8960
s_waitcnt vmcnt(24) lgkmcnt(0)
v_lshlrev_b32 v8, 16, v76
v_and_b32 v9, s20, v76
v_fmac_f32 v16, v6, v8
v_fmac_f32 v17, v6, v9
v_fmac_f32 v24, v7, v8
v_fmac_f32 v25, v7, v9
v_lshlrev_b32 v8, 16, v77
v_and_b32 v9, s20, v77
v_fmac_f32 v18, v6, v8
v_fmac_f32 v19, v6, v9
v_fmac_f32 v26, v7, v8
v_fmac_f32 v27, v7, v9
v_lshlrev_b32 v8, 16, v78
v_and_b32 v9, s20, v78
v_fmac_f32 v20, v6, v8
v_fmac_f32 v21, v6, v9
v_fmac_f32 v28, v7, v8
v_fmac_f32 v29, v7, v9
v_lshlrev_b32 v8, 16, v79
v_and_b32 v9, s20, v79
v_fmac_f32 v22, v6, v8
v_fmac_f32 v23, v6, v9
v_fmac_f32 v30, v7, v8
v_fmac_f32 v31, v7, v9
ds_read_b64 v[6:7], v1 offset:9216
s_waitcnt vmcnt(23) lgkmcnt(0)
v_lshlrev_b32 v8, 16, v80
v_and_b32 v9, s20, v80
v_fmac_f32 v16, v6, v8
v_fmac_f32 v17, v6, v9
v_fmac_f32 v24, v7, v8
v_fmac_f32 v25, v7, v9
v_lshlrev_b32 v8, 16, v81
v_and_b32 v9, s20, v81
v_fmac_f32 v18, v6, v8
v_fmac_f32 v19, v6, v9
v_fmac_f32 v26, v7, v8
v_fmac_f32 v27, v7, v9
v_lshlrev_b32 v8, 16, v82
v_and_b32 v9, s20, v82
v_fmac_f32 v20, v6, v8
v_fmac_f32 v21, v6, v9
v_fmac_f32 v28, v7, v8
v_fmac_f32 v29, v7, v9
v_lshlrev_b32 v8, 16, v83
v_and_b32 v9, s20, v83
v_fmac_f32 v22, v6, v8
v_fmac_f32 v23, v6, v9
v_fmac_f32 v30, v7, v8
v_fmac_f32 v31, v7, v9
ds_read_b64 v[6:7], v1 offset:9472
s_waitcnt vmcnt(22) lgkmcnt(0)
v_lshlrev_b32 v8, 16, v84
v_and_b32 v9, s20, v84
v_fmac_f32 v16, v6, v8
v_fmac_f32 v17, v6, v9
v_fmac_f32 v24, v7, v8
v_fmac_f32 v25, v7, v9
v_lshlrev_b32 v8, 16, v85
v_and_b32 v9, s20, v85
v_fmac_f32 v18, v6, v8
v_fmac_f32 v19, v6, v9
v_fmac_f32 v26, v7, v8
v_fmac_f32 v27, v7, v9
v_lshlrev_b32 v8, 16, v86
v_and_b32 v9, s20, v86
v_fmac_f32 v20, v6, v8
v_fmac_f32 v21, v6, v9
v_fmac_f32 v28, v7, v8
v_fmac_f32 v29, v7, v9
v_lshlrev_b32 v8, 16, v87
v_and_b32 v9, s20, v87
v_fmac_f32 v22, v6, v8
v_fmac_f32 v23, v6, v9
v_fmac_f32 v30, v7, v8
v_fmac_f32 v31, v7, v9
ds_read_b64 v[6:7], v1 offset:9728
s_waitcnt vmcnt(21) lgkmcnt(0)
v_lshlrev_b32 v8, 16, v88
v_and_b32 v9, s20, v88
v_fmac_f32 v16, v6, v8
v_fmac_f32 v17, v6, v9
v_fmac_f32 v24, v7, v8
v_fmac_f32 v25, v7, v9
v_lshlrev_b32 v8, 16, v89
v_and_b32 v9, s20, v89
v_fmac_f32 v18, v6, v8
v_fmac_f32 v19, v6, v9
v_fmac_f32 v26, v7, v8
v_fmac_f32 v27, v7, v9
v_lshlrev_b32 v8, 16, v90
v_and_b32 v9, s20, v90
v_fmac_f32 v20, v6, v8
v_fmac_f32 v21, v6, v9
v_fmac_f32 v28, v7, v8
v_fmac_f32 v29, v7, v9
v_lshlrev_b32 v8, 16, v91
v_and_b32 v9, s20, v91
v_fmac_f32 v22, v6, v8
v_fmac_f32 v23, v6, v9
v_fmac_f32 v30, v7, v8
v_fmac_f32 v31, v7, v9
ds_read_b64 v[6:7], v1 offset:9984
s_waitcnt vmcnt(20) lgkmcnt(0)
v_lshlrev_b32 v8, 16, v92
v_and_b32 v9, s20, v92
v_fmac_f32 v16, v6, v8
v_fmac_f32 v17, v6, v9
v_fmac_f32 v24, v7, v8
v_fmac_f32 v25, v7, v9
v_lshlrev_b32 v8, 16, v93
v_and_b32 v9, s20, v93
v_fmac_f32 v18, v6, v8
v_fmac_f32 v19, v6, v9
v_fmac_f32 v26, v7, v8
v_fmac_f32 v27, v7, v9
v_lshlrev_b32 v8, 16, v94
v_and_b32 v9, s20, v94
v_fmac_f32 v20, v6, v8
v_fmac_f32 v21, v6, v9
v_fmac_f32 v28, v7, v8
v_fmac_f32 v29, v7, v9
v_lshlrev_b32 v8, 16, v95
v_and_b32 v9, s20, v95
v_fmac_f32 v22, v6, v8
v_fmac_f32 v23, v6, v9
v_fmac_f32 v30, v7, v8
v_fmac_f32 v31, v7, v9
ds_read_b64 v[6:7], v1 offset:10240
s_waitcnt vmcnt(19) lgkmcnt(0)
v_lshlrev_b32 v8, 16, v96
v_and_b32 v9, s20, v96
v_fmac_f32 v16, v6, v8
v_fmac_f32 v17, v6, v9
v_fmac_f32 v24, v7, v8
v_fmac_f32 v25, v7, v9
v_lshlrev_b32 v8, 16, v97
v_and_b32 v9, s20, v97
v_fmac_f32 v18, v6, v8
v_fmac_f32 v19, v6, v9
v_fmac_f32 v26, v7, v8
v_fmac_f32 v27, v7, v9
v_lshlrev_b32 v8, 16, v98
v_and_b32 v9, s20, v98
v_fmac_f32 v20, v6, v8
v_fmac_f32 v21, v6, v9
v_fmac_f32 v28, v7, v8
v_fmac_f32 v29, v7, v9
v_lshlrev_b32 v8, 16, v99
v_and_b32 v9, s20, v99
v_fmac_f32 v22, v6, v8
v_fmac_f32 v23, v6, v9
v_fmac_f32 v30, v7, v8
v_fmac_f32 v31, v7, v9
ds_read_b64 v[6:7], v1 offset:10496
s_waitcnt vmcnt(18) lgkmcnt(0)
v_lshlrev_b32 v8, 16, v100
v_and_b32 v9, s20, v100
v_fmac_f32 v16, v6, v8
v_fmac_f32 v17, v6, v9
v_fmac_f32 v24, v7, v8
v_fmac_f32 v25, v7, v9
v_lshlrev_b32 v8, 16, v101
v_and_b32 v9, s20, v101
v_fmac_f32 v18, v6, v8
v_fmac_f32 v19, v6, v9
v_fmac_f32 v26, v7, v8
v_fmac_f32 v27, v7, v9
v_lshlrev_b32 v8, 16, v102
v_and_b32 v9, s20, v102
v_fmac_f32 v20, v6, v8
v_fmac_f32 v21, v6, v9
v_fmac_f32 v28, v7, v8
v_fmac_f32 v29, v7, v9
v_lshlrev_b32 v8, 16, v103
v_and_b32 v9, s20, v103
v_fmac_f32 v22, v6, v8
v_fmac_f32 v23, v6, v9
v_fmac_f32 v30, v7, v8
v_fmac_f32 v31, v7, v9
ds_read_b64 v[6:7], v1 offset:10752
s_waitcnt vmcnt(17) lgkmcnt(0)
v_lshlrev_b32 v8, 16, v104
v_and_b32 v9, s20, v104
v_fmac_f32 v16, v6, v8
v_fmac_f32 v17, v6, v9
v_fmac_f32 v24, v7, v8
v_fmac_f32 v25, v7, v9
v_lshlrev_b32 v8, 16, v105
v_and_b32 v9, s20, v105
v_fmac_f32 v18, v6, v8
v_fmac_f32 v19, v6, v9
v_fmac_f32 v26, v7, v8
v_fmac_f32 v27, v7, v9
v_lshlrev_b32 v8, 16, v106
v_and_b32 v9, s20, v106
v_fmac_f32 v20, v6, v8
v_fmac_f32 v21, v6, v9
v_fmac_f32 v28, v7, v8
v_fmac_f32 v29, v7, v9
v_lshlrev_b32 v8, 16, v107
v_and_b32 v9, s20, v107
v_fmac_f32 v22, v6, v8
v_fmac_f32 v23, v6, v9
v_fmac_f32 v30, v7, v8
v_fmac_f32 v31, v7, v9
ds_read_b64 v[6:7], v1 offset:11008
s_waitcnt vmcnt(16) lgkmcnt(0)
v_lshlrev_b32 v8, 16, v108
v_and_b32 v9, s20, v108
v_fmac_f32 v16, v6, v8
v_fmac_f32 v17, v6, v9
v_fmac_f32 v24, v7, v8
v_fmac_f32 v25, v7, v9
v_lshlrev_b32 v8, 16, v109
v_and_b32 v9, s20, v109
v_fmac_f32 v18, v6, v8
v_fmac_f32 v19, v6, v9
v_fmac_f32 v26, v7, v8
v_fmac_f32 v27, v7, v9
v_lshlrev_b32 v8, 16, v110
v_and_b32 v9, s20, v110
v_fmac_f32 v20, v6, v8
v_fmac_f32 v21, v6, v9
v_fmac_f32 v28, v7, v8
v_fmac_f32 v29, v7, v9
v_lshlrev_b32 v8, 16, v111
v_and_b32 v9, s20, v111
v_fmac_f32 v22, v6, v8
v_fmac_f32 v23, v6, v9
v_fmac_f32 v30, v7, v8
v_fmac_f32 v31, v7, v9
ds_read_b64 v[6:7], v1 offset:11264
s_waitcnt vmcnt(15) lgkmcnt(0)
v_lshlrev_b32 v8, 16, v112
v_and_b32 v9, s20, v112
v_fmac_f32 v16, v6, v8
v_fmac_f32 v17, v6, v9
v_fmac_f32 v24, v7, v8
v_fmac_f32 v25, v7, v9
v_lshlrev_b32 v8, 16, v113
v_and_b32 v9, s20, v113
v_fmac_f32 v18, v6, v8
v_fmac_f32 v19, v6, v9
v_fmac_f32 v26, v7, v8
v_fmac_f32 v27, v7, v9
v_lshlrev_b32 v8, 16, v114
v_and_b32 v9, s20, v114
v_fmac_f32 v20, v6, v8
v_fmac_f32 v21, v6, v9
v_fmac_f32 v28, v7, v8
v_fmac_f32 v29, v7, v9
v_lshlrev_b32 v8, 16, v115
v_and_b32 v9, s20, v115
v_fmac_f32 v22, v6, v8
v_fmac_f32 v23, v6, v9
v_fmac_f32 v30, v7, v8
v_fmac_f32 v31, v7, v9
ds_read_b64 v[6:7], v1 offset:11520
s_waitcnt vmcnt(14) lgkmcnt(0)
v_lshlrev_b32 v8, 16, v116
v_and_b32 v9, s20, v116
v_fmac_f32 v16, v6, v8
v_fmac_f32 v17, v6, v9
v_fmac_f32 v24, v7, v8
v_fmac_f32 v25, v7, v9
v_lshlrev_b32 v8, 16, v117
v_and_b32 v9, s20, v117
v_fmac_f32 v18, v6, v8
v_fmac_f32 v19, v6, v9
v_fmac_f32 v26, v7, v8
v_fmac_f32 v27, v7, v9
v_lshlrev_b32 v8, 16, v118
v_and_b32 v9, s20, v118
v_fmac_f32 v20, v6, v8
v_fmac_f32 v21, v6, v9
v_fmac_f32 v28, v7, v8
v_fmac_f32 v29, v7, v9
v_lshlrev_b32 v8, 16, v119
v_and_b32 v9, s20, v119
v_fmac_f32 v22, v6, v8
v_fmac_f32 v23, v6, v9
v_fmac_f32 v30, v7, v8
v_fmac_f32 v31, v7, v9
ds_read_b64 v[6:7], v1 offset:11776
s_waitcnt vmcnt(13) lgkmcnt(0)
v_lshlrev_b32 v8, 16, v120
v_and_b32 v9, s20, v120
v_fmac_f32 v16, v6, v8
v_fmac_f32 v17, v6, v9
v_fmac_f32 v24, v7, v8
v_fmac_f32 v25, v7, v9
v_lshlrev_b32 v8, 16, v121
v_and_b32 v9, s20, v121
v_fmac_f32 v18, v6, v8
v_fmac_f32 v19, v6, v9
v_fmac_f32 v26, v7, v8
v_fmac_f32 v27, v7, v9
v_lshlrev_b32 v8, 16, v122
v_and_b32 v9, s20, v122
v_fmac_f32 v20, v6, v8
v_fmac_f32 v21, v6, v9
v_fmac_f32 v28, v7, v8
v_fmac_f32 v29, v7, v9
v_lshlrev_b32 v8, 16, v123
v_and_b32 v9, s20, v123
v_fmac_f32 v22, v6, v8
v_fmac_f32 v23, v6, v9
v_fmac_f32 v30, v7, v8
v_fmac_f32 v31, v7, v9
ds_read_b64 v[6:7], v1 offset:12032
s_waitcnt vmcnt(12) lgkmcnt(0)
v_lshlrev_b32 v8, 16, v124
v_and_b32 v9, s20, v124
v_fmac_f32 v16, v6, v8
v_fmac_f32 v17, v6, v9
v_fmac_f32 v24, v7, v8
v_fmac_f32 v25, v7, v9
v_lshlrev_b32 v8, 16, v125
v_and_b32 v9, s20, v125
v_fmac_f32 v18, v6, v8
v_fmac_f32 v19, v6, v9
v_fmac_f32 v26, v7, v8
v_fmac_f32 v27, v7, v9
v_lshlrev_b32 v8, 16, v126
v_and_b32 v9, s20, v126
v_fmac_f32 v20, v6, v8
v_fmac_f32 v21, v6, v9
v_fmac_f32 v28, v7, v8
v_fmac_f32 v29, v7, v9
v_lshlrev_b32 v8, 16, v127
v_and_b32 v9, s20, v127
v_fmac_f32 v22, v6, v8
v_fmac_f32 v23, v6, v9
v_fmac_f32 v30, v7, v8
v_fmac_f32 v31, v7, v9
ds_read_b64 v[6:7], v1 offset:12288
s_waitcnt vmcnt(11) lgkmcnt(0)
v_lshlrev_b32 v8, 16, v128
v_and_b32 v9, s20, v128
v_fmac_f32 v16, v6, v8
v_fmac_f32 v17, v6, v9
v_fmac_f32 v24, v7, v8
v_fmac_f32 v25, v7, v9
v_lshlrev_b32 v8, 16, v129
v_and_b32 v9, s20, v129
v_fmac_f32 v18, v6, v8
v_fmac_f32 v19, v6, v9
v_fmac_f32 v26, v7, v8
v_fmac_f32 v27, v7, v9
v_lshlrev_b32 v8, 16, v130
v_and_b32 v9, s20, v130
v_fmac_f32 v20, v6, v8
v_fmac_f32 v21, v6, v9
v_fmac_f32 v28, v7, v8
v_fmac_f32 v29, v7, v9
v_lshlrev_b32 v8, 16, v131
v_and_b32 v9, s20, v131
v_fmac_f32 v22, v6, v8
v_fmac_f32 v23, v6, v9
v_fmac_f32 v30, v7, v8
v_fmac_f32 v31, v7, v9
ds_read_b64 v[6:7], v1 offset:12544
s_waitcnt vmcnt(10) lgkmcnt(0)
v_lshlrev_b32 v8, 16, v132
v_and_b32 v9, s20, v132
v_fmac_f32 v16, v6, v8
v_fmac_f32 v17, v6, v9
v_fmac_f32 v24, v7, v8
v_fmac_f32 v25, v7, v9
v_lshlrev_b32 v8, 16, v133
v_and_b32 v9, s20, v133
v_fmac_f32 v18, v6, v8
v_fmac_f32 v19, v6, v9
v_fmac_f32 v26, v7, v8
v_fmac_f32 v27, v7, v9
v_lshlrev_b32 v8, 16, v134
v_and_b32 v9, s20, v134
v_fmac_f32 v20, v6, v8
v_fmac_f32 v21, v6, v9
v_fmac_f32 v28, v7, v8
v_fmac_f32 v29, v7, v9
v_lshlrev_b32 v8, 16, v135
v_and_b32 v9, s20, v135
v_fmac_f32 v22, v6, v8
v_fmac_f32 v23, v6, v9
v_fmac_f32 v30, v7, v8
v_fmac_f32 v31, v7, v9
ds_read_b64 v[6:7], v1 offset:12800
s_waitcnt vmcnt(9) lgkmcnt(0)
v_lshlrev_b32 v8, 16, v136
v_and_b32 v9, s20, v136
v_fmac_f32 v16, v6, v8
v_fmac_f32 v17, v6, v9
v_fmac_f32 v24, v7, v8
v_fmac_f32 v25, v7, v9
v_lshlrev_b32 v8, 16, v137
v_and_b32 v9, s20, v137
v_fmac_f32 v18, v6, v8
v_fmac_f32 v19, v6, v9
v_fmac_f32 v26, v7, v8
v_fmac_f32 v27, v7, v9
v_lshlrev_b32 v8, 16, v138
v_and_b32 v9, s20, v138
v_fmac_f32 v20, v6, v8
v_fmac_f32 v21, v6, v9
v_fmac_f32 v28, v7, v8
v_fmac_f32 v29, v7, v9
v_lshlrev_b32 v8, 16, v139
v_and_b32 v9, s20, v139
v_fmac_f32 v22, v6, v8
v_fmac_f32 v23, v6, v9
v_fmac_f32 v30, v7, v8
v_fmac_f32 v31, v7, v9
ds_read_b64 v[6:7], v1 offset:13056
s_waitcnt vmcnt(8) lgkmcnt(0)
v_lshlrev_b32 v8, 16, v140
v_and_b32 v9, s20, v140
v_fmac_f32 v16, v6, v8
v_fmac_f32 v17, v6, v9
v_fmac_f32 v24, v7, v8
v_fmac_f32 v25, v7, v9
v_lshlrev_b32 v8, 16, v141
v_and_b32 v9, s20, v141
v_fmac_f32 v18, v6, v8
v_fmac_f32 v19, v6, v9
v_fmac_f32 v26, v7, v8
v_fmac_f32 v27, v7, v9
v_lshlrev_b32 v8, 16, v142
v_and_b32 v9, s20, v142
v_fmac_f32 v20, v6, v8
v_fmac_f32 v21, v6, v9
v_fmac_f32 v28, v7, v8
v_fmac_f32 v29, v7, v9
v_lshlrev_b32 v8, 16, v143
v_and_b32 v9, s20, v143
v_fmac_f32 v22, v6, v8
v_fmac_f32 v23, v6, v9
v_fmac_f32 v30, v7, v8
v_fmac_f32 v31, v7, v9
ds_read_b64 v[6:7], v1 offset:13312
s_waitcnt vmcnt(7) lgkmcnt(0)
v_lshlrev_b32 v8, 16, v144
v_and_b32 v9, s20, v144
v_fmac_f32 v16, v6, v8
v_fmac_f32 v17, v6, v9
v_fmac_f32 v24, v7, v8
v_fmac_f32 v25, v7, v9
v_lshlrev_b32 v8, 16, v145
v_and_b32 v9, s20, v145
v_fmac_f32 v18, v6, v8
v_fmac_f32 v19, v6, v9
v_fmac_f32 v26, v7, v8
v_fmac_f32 v27, v7, v9
v_lshlrev_b32 v8, 16, v146
v_and_b32 v9, s20, v146
v_fmac_f32 v20, v6, v8
v_fmac_f32 v21, v6, v9
v_fmac_f32 v28, v7, v8
v_fmac_f32 v29, v7, v9
v_lshlrev_b32 v8, 16, v147
v_and_b32 v9, s20, v147
v_fmac_f32 v22, v6, v8
v_fmac_f32 v23, v6, v9
v_fmac_f32 v30, v7, v8
v_fmac_f32 v31, v7, v9
ds_read_b64 v[6:7], v1 offset:13568
s_waitcnt vmcnt(6) lgkmcnt(0)
v_lshlrev_b32 v8, 16, v148
v_and_b32 v9, s20, v148
v_fmac_f32 v16, v6, v8
v_fmac_f32 v17, v6, v9
v_fmac_f32 v24, v7, v8
v_fmac_f32 v25, v7, v9
v_lshlrev_b32 v8, 16, v149
v_and_b32 v9, s20, v149
v_fmac_f32 v18, v6, v8
v_fmac_f32 v19, v6, v9
v_fmac_f32 v26, v7, v8
v_fmac_f32 v27, v7, v9
v_lshlrev_b32 v8, 16, v150
v_and_b32 v9, s20, v150
v_fmac_f32 v20, v6, v8
v_fmac_f32 v21, v6, v9
v_fmac_f32 v28, v7, v8
v_fmac_f32 v29, v7, v9
v_lshlrev_b32 v8, 16, v151
v_and_b32 v9, s20, v151
v_fmac_f32 v22, v6, v8
v_fmac_f32 v23, v6, v9
v_fmac_f32 v30, v7, v8
v_fmac_f32 v31, v7, v9
ds_read_b64 v[6:7], v1 offset:13824
s_waitcnt vmcnt(5) lgkmcnt(0)
v_lshlrev_b32 v8, 16, v152
v_and_b32 v9, s20, v152
v_fmac_f32 v16, v6, v8
v_fmac_f32 v17, v6, v9
v_fmac_f32 v24, v7, v8
v_fmac_f32 v25, v7, v9
v_lshlrev_b32 v8, 16, v153
v_and_b32 v9, s20, v153
v_fmac_f32 v18, v6, v8
v_fmac_f32 v19, v6, v9
v_fmac_f32 v26, v7, v8
v_fmac_f32 v27, v7, v9
v_lshlrev_b32 v8, 16, v154
v_and_b32 v9, s20, v154
v_fmac_f32 v20, v6, v8
v_fmac_f32 v21, v6, v9
v_fmac_f32 v28, v7, v8
v_fmac_f32 v29, v7, v9
v_lshlrev_b32 v8, 16, v155
v_and_b32 v9, s20, v155
v_fmac_f32 v22, v6, v8
v_fmac_f32 v23, v6, v9
v_fmac_f32 v30, v7, v8
v_fmac_f32 v31, v7, v9
ds_read_b64 v[6:7], v1 offset:14080
s_waitcnt vmcnt(4) lgkmcnt(0)
v_lshlrev_b32 v8, 16, v156
v_and_b32 v9, s20, v156
v_fmac_f32 v16, v6, v8
v_fmac_f32 v17, v6, v9
v_fmac_f32 v24, v7, v8
v_fmac_f32 v25, v7, v9
v_lshlrev_b32 v8, 16, v157
v_and_b32 v9, s20, v157
v_fmac_f32 v18, v6, v8
v_fmac_f32 v19, v6, v9
v_fmac_f32 v26, v7, v8
v_fmac_f32 v27, v7, v9
v_lshlrev_b32 v8, 16, v158
v_and_b32 v9, s20, v158
v_fmac_f32 v20, v6, v8
v_fmac_f32 v21, v6, v9
v_fmac_f32 v28, v7, v8
v_fmac_f32 v29, v7, v9
v_lshlrev_b32 v8, 16, v159
v_and_b32 v9, s20, v159
v_fmac_f32 v22, v6, v8
v_fmac_f32 v23, v6, v9
v_fmac_f32 v30, v7, v8
v_fmac_f32 v31, v7, v9
ds_read_b64 v[6:7], v1 offset:14336
s_waitcnt vmcnt(3) lgkmcnt(0)
v_lshlrev_b32 v8, 16, v160
v_and_b32 v9, s20, v160
v_fmac_f32 v16, v6, v8
v_fmac_f32 v17, v6, v9
v_fmac_f32 v24, v7, v8
v_fmac_f32 v25, v7, v9
v_lshlrev_b32 v8, 16, v161
v_and_b32 v9, s20, v161
v_fmac_f32 v18, v6, v8
v_fmac_f32 v19, v6, v9
v_fmac_f32 v26, v7, v8
v_fmac_f32 v27, v7, v9
v_lshlrev_b32 v8, 16, v162
v_and_b32 v9, s20, v162
v_fmac_f32 v20, v6, v8
v_fmac_f32 v21, v6, v9
v_fmac_f32 v28, v7, v8
v_fmac_f32 v29, v7, v9
v_lshlrev_b32 v8, 16, v163
v_and_b32 v9, s20, v163
v_fmac_f32 v22, v6, v8
v_fmac_f32 v23, v6, v9
v_fmac_f32 v30, v7, v8
v_fmac_f32 v31, v7, v9
ds_read_b64 v[6:7], v1 offset:14592
s_waitcnt vmcnt(2) lgkmcnt(0)
v_lshlrev_b32 v8, 16, v164
v_and_b32 v9, s20, v164
v_fmac_f32 v16, v6, v8
v_fmac_f32 v17, v6, v9
v_fmac_f32 v24, v7, v8
v_fmac_f32 v25, v7, v9
v_lshlrev_b32 v8, 16, v165
v_and_b32 v9, s20, v165
v_fmac_f32 v18, v6, v8
v_fmac_f32 v19, v6, v9
v_fmac_f32 v26, v7, v8
v_fmac_f32 v27, v7, v9
v_lshlrev_b32 v8, 16, v166
v_and_b32 v9, s20, v166
v_fmac_f32 v20, v6, v8
v_fmac_f32 v21, v6, v9
v_fmac_f32 v28, v7, v8
v_fmac_f32 v29, v7, v9
v_lshlrev_b32 v8, 16, v167
v_and_b32 v9, s20, v167
v_fmac_f32 v22, v6, v8
v_fmac_f32 v23, v6, v9
v_fmac_f32 v30, v7, v8
v_fmac_f32 v31, v7, v9
ds_read_b64 v[6:7], v1 offset:14848
s_waitcnt vmcnt(1) lgkmcnt(0)
v_lshlrev_b32 v8, 16, v168
v_and_b32 v9, s20, v168
v_fmac_f32 v16, v6, v8
v_fmac_f32 v17, v6, v9
v_fmac_f32 v24, v7, v8
v_fmac_f32 v25, v7, v9
v_lshlrev_b32 v8, 16, v169
v_and_b32 v9, s20, v169
v_fmac_f32 v18, v6, v8
v_fmac_f32 v19, v6, v9
v_fmac_f32 v26, v7, v8
v_fmac_f32 v27, v7, v9
v_lshlrev_b32 v8, 16, v170
v_and_b32 v9, s20, v170
v_fmac_f32 v20, v6, v8
v_fmac_f32 v21, v6, v9
v_fmac_f32 v28, v7, v8
v_fmac_f32 v29, v7, v9
v_lshlrev_b32 v8, 16, v171
v_and_b32 v9, s20, v171
v_fmac_f32 v22, v6, v8
v_fmac_f32 v23, v6, v9
v_fmac_f32 v30, v7, v8
v_fmac_f32 v31, v7, v9
ds_read_b64 v[6:7], v1 offset:15104
s_waitcnt vmcnt(0) lgkmcnt(0)
v_lshlrev_b32 v8, 16, v172
v_and_b32 v9, s20, v172
v_fmac_f32 v16, v6, v8
v_fmac_f32 v17, v6, v9
v_fmac_f32 v24, v7, v8
v_fmac_f32 v25, v7, v9
v_lshlrev_b32 v8, 16, v173
v_and_b32 v9, s20, v173
v_fmac_f32 v18, v6, v8
v_fmac_f32 v19, v6, v9
v_fmac_f32 v26, v7, v8
v_fmac_f32 v27, v7, v9
v_lshlrev_b32 v8, 16, v174
v_and_b32 v9, s20, v174
v_fmac_f32 v20, v6, v8
v_fmac_f32 v21, v6, v9
v_fmac_f32 v28, v7, v8
v_fmac_f32 v29, v7, v9
v_lshlrev_b32 v8, 16, v175
v_and_b32 v9, s20, v175
v_fmac_f32 v22, v6, v8
v_fmac_f32 v23, v6, v9
v_fmac_f32 v30, v7, v8
v_fmac_f32 v31, v7, v9
v_mov_b32 v4, 0x0
v_bfe_i32 v5, v0, 0, 1
v_and_b32 v5, 0x20, v5
v_xor_b32 v4, v4, v5
v_bfe_i32 v5, v0, 1, 1
v_and_b32 v5, 0x40, v5
v_xor_b32 v4, v4, v5
v_bfe_i32 v5, v0, 2, 1
v_and_b32 v5, 0x80, v5
v_xor_b32 v4, v4, v5
v_bfe_i32 v5, v0, 3, 1
v_and_b32 v5, 0x200, v5
v_xor_b32 v4, v4, v5
v_bfe_i32 v5, v0, 4, 1
v_and_b32 v5, 0x400, v5
v_xor_b32 v4, v4, v5
v_bfe_i32 v5, v0, 5, 1
v_and_b32 v5, 0x800, v5
v_xor_b32 v4, v4, v5
v_bfe_i32 v5, v0, 6, 1
v_and_b32 v5, 0x1000, v5
v_xor_b32 v4, v4, v5
v_bfe_i32 v5, v0, 7, 1
v_and_b32 v5, 0x2000, v5
v_xor_b32 v4, v4, v5
ds_write_b128 v4, v[16:19] offset:32768
ds_write_b128 v4, v[20:23] offset:32784
ds_write_b128 v4, v[24:27] offset:33024
ds_write_b128 v4, v[28:31] offset:33040
s_waitcnt lgkmcnt(0)
s_barrier
v_and_b32 v4, 127, v0
v_lshlrev_b32 v4, 2, v4
ds_read_b32 v64, v4 offset:32768
ds_read_b32 v65, v4 offset:33280
ds_read_b32 v66, v4 offset:33792
ds_read_b32 v67, v4 offset:34304
ds_read_b32 v68, v4 offset:34816
ds_read_b32 v69, v4 offset:35328
ds_read_b32 v70, v4 offset:35840
ds_read_b32 v71, v4 offset:36352
ds_read_b32 v72, v4 offset:36864
ds_read_b32 v73, v4 offset:37376
ds_read_b32 v74, v4 offset:37888
ds_read_b32 v75, v4 offset:38400
ds_read_b32 v76, v4 offset:38912
ds_read_b32 v77, v4 offset:39424
ds_read_b32 v78, v4 offset:39936
ds_read_b32 v79, v4 offset:40448
ds_read_b32 v80, v4 offset:40960
ds_read_b32 v81, v4 offset:41472
ds_read_b32 v82, v4 offset:41984
ds_read_b32 v83, v4 offset:42496
ds_read_b32 v84, v4 offset:43008
ds_read_b32 v85, v4 offset:43520
ds_read_b32 v86, v4 offset:44032
ds_read_b32 v87, v4 offset:44544
ds_read_b32 v88, v4 offset:45056
ds_read_b32 v89, v4 offset:45568
ds_read_b32 v90, v4 offset:46080
ds_read_b32 v91, v4 offset:46592
ds_read_b32 v92, v4 offset:47104
ds_read_b32 v93, v4 offset:47616
ds_read_b32 v94, v4 offset:48128
ds_read_b32 v95, v4 offset:48640
s_waitcnt lgkmcnt(0)
v_add_f32 v10, v64, v65
v_add_f32 v10, v10, v66
v_add_f32 v10, v10, v67
v_add_f32 v10, v10, v68
v_add_f32 v10, v10, v69
v_add_f32 v10, v10, v70
v_add_f32 v10, v10, v71
v_add_f32 v10, v10, v72
v_add_f32 v10, v10, v73
v_add_f32 v10, v10, v74
v_add_f32 v10, v10, v75
v_add_f32 v10, v10, v76
v_add_f32 v10, v10, v77
v_add_f32 v10, v10, v78
v_add_f32 v10, v10, v79
v_add_f32 v10, v10, v80
v_add_f32 v10, v10, v81
v_add_f32 v10, v10, v82
v_add_f32 v10, v10, v83
v_add_f32 v10, v10, v84
v_add_f32 v10, v10, v85
v_add_f32 v10, v10, v86
v_add_f32 v10, v10, v87
v_add_f32 v10, v10, v88
v_add_f32 v10, v10, v89
v_add_f32 v10, v10, v90
v_add_f32 v10, v10, v91
v_add_f32 v10, v10, v92
v_add_f32 v10, v10, v93
v_add_f32 v10, v10, v94
v_add_f32 v10, v10, v95
v_cvt_pk_bf16_f32 v10, v10, v10
v_and_b32 v10, s20, v10
v_mov_b32 v1, s46
v_mov_b32 v2, s47
v_and_b32 v3, 64, v0
v_cmp_eq_u32 vcc, 0, v3
s_nop 1
v_cndmask_b32 v1, v2, v1, vcc
v_ashrrev_i32 v2, 31, v1
v_not_b32 v2, v2
v_or_b32 v2, 0x80000000, v2
v_xor_b32 v2, v1, v2
v_and_b32 v2, s20, v2
v_mul_f32 v12, 0xbfb8aa3b, v2
v_exp_f32 v12, v12
s_nop 0
v_add_f32 v12, 1.0, v12
v_rcp_f32 v12, v12
s_nop 0
v_cvt_pk_bf16_f32 v12, v12, v12
v_and_b32 v12, s20, v12
v_mul_f32 v10, v10, v12
v_cvt_pk_bf16_f32 v10, v10, v10
v_and_b32 v10, s20, v10
v_mov_b32 v4, 0x398000
v_bfe_i32 v5, v0, 0, 1
v_and_b32 v5, 0x4, v5
v_xor_b32 v4, v4, v5
v_bfe_i32 v5, v0, 1, 1
v_and_b32 v5, 0x8, v5
v_xor_b32 v4, v4, v5
v_bfe_i32 v5, v0, 2, 1
v_and_b32 v5, 0x10, v5
v_xor_b32 v4, v4, v5
v_bfe_i32 v5, v0, 3, 1
v_and_b32 v5, 0x20, v5
v_xor_b32 v4, v4, v5
v_bfe_i32 v5, v0, 4, 1
v_and_b32 v5, 0x40, v5
v_xor_b32 v4, v4, v5
v_bfe_i32 v5, v0, 5, 1
v_and_b32 v5, 0x80, v5
v_xor_b32 v4, v4, v5
v_bfe_i32 v5, v0, 6, 1
v_and_b32 v5, 0x800, v5
v_xor_b32 v4, v4, v5
s_lshl_b32 s3, s34, 8
v_add_u32 v4, s3, v4
global_store_dword v4, v10, s[4:5] sc1
v_and_b32 v1, 0xffff, v1
v_sub_u32 v1, 0xffff, v1
v_mov_b32 v4, 0x399000
v_bfe_i32 v5, v0, 6, 1
v_and_b32 v5, 0x4, v5
v_xor_b32 v4, v4, v5
global_store_dword v4, v1, s[4:5] sc1
s_waitcnt vmcnt(0)
s_barrier
s_cmp_lg_u32 s14, 0
s_cbranch_scc1 L_moeb_f
s_lshl_b32 s3, s34, 2
s_add_u32 s3, s3, 0x3aa100
v_mov_b32 v4, s3
v_mov_b32 v5, 1
s_mov_b64 exec, 1
global_store_dword v4, v5, s[4:5] sc1
s_mov_b64 exec, -1
L_moeb_f:
L_exit2:
s_endpgm
.section .rodata,"a"
.p2align 6
.amdhsa_kernel parallel_sum__memory_aug_recurrent_mem_tr__moe_arch_mod__prompt_kernel
  .amdhsa_next_free_vgpr 512
  .amdhsa_next_free_sgpr 102
  .amdhsa_accum_offset 256
  .amdhsa_group_segment_fixed_size 0
  .amdhsa_kernarg_size 120
  .amdhsa_user_sgpr_count 2
  .amdhsa_user_sgpr_kernarg_segment_ptr 1
  .amdhsa_system_sgpr_workgroup_id_x 1
  .amdhsa_float_denorm_mode_32 3
.end_amdhsa_kernel
```
